```python
import torch

def _softmax(x, axis=-1):
    return torch.softmax(x, dim=axis)
def _gelu(x):
    return torch.nn.functional.gelu(x, approximate="tanh")
def _silu(x):
    return torch.nn.functional.silu(x)
def _sigmoid(x):
    return torch.sigmoid(x)
def _layernorm(x, axis=-1, eps=1e-5):
    m = x.mean(dim=axis, keepdim=True)
    v = x.var(dim=axis, keepdim=True, unbiased=False)
    return (x - m) / torch.sqrt(v + eps)
def _scatter_add(tgt, idx, src, axis=0):
    return tgt.clone().index_add_(axis, idx, src)
def _segment_sum(src, seg, n):
    out = torch.zeros((n,) + src.shape[1:], dtype=src.dtype)
    return out.index_add_(0, seg, src)
def _pad(x, pw):
    flat = tuple(v for pair in reversed(pw) for v in pair)
    return torch.nn.functional.pad(x, flat)

kernel_name = 'concat_heads__mha_block_cached__mha_block_cached__near_ridge'

def setup_inputs():

    _w = (lambda a: (lambda t: t.to(torch.bfloat16) if t.is_floating_point() else t)(torch.as_tensor(a)))
    def _A_setup():
        B, Sq, D = 8, 288, 448
        H, Sk, Dh = 16, 1024, 256
        return {
            "x": _w((lambda *s: torch.randn(*s, dtype=torch.bfloat16) * 0.8)(B, Sq, D)),
            "k_cache": _w((lambda *s: torch.randn(*s, dtype=torch.bfloat16) * 0.8)(B, H, Sk, Dh)),
            "v_cache": _w((lambda *s: torch.randn(*s, dtype=torch.bfloat16) * 0.05)(B, H, Sk, Dh)),
            "wq": _w((lambda *s: torch.randn(*s, dtype=torch.bfloat16) * 0.8)(D, H * Dh) * (D ** -0.5)),
            "wo": _w((lambda *s: torch.randn(*s, dtype=torch.bfloat16) * 0.05)(H * Dh, D) * ((H * Dh) ** -0.5)),
        }
    _A_in = _A_setup()

    def _B_setup():
        B, Sq, D = 8, 288, 448
        H, Sk, Dh = 16, 1024, 256
        return {
            "x": _w((lambda *s: torch.randn(*s, dtype=torch.bfloat16) * 0.8)(B, Sq, D)),
            "k_cache": _w((lambda *s: torch.randn(*s, dtype=torch.bfloat16) * 0.8)(B, H, Sk, Dh)),
            "v_cache": _w((lambda *s: torch.randn(*s, dtype=torch.bfloat16) * 0.05)(B, H, Sk, Dh)),
            "wq": _w((lambda *s: torch.randn(*s, dtype=torch.bfloat16) * 0.8)(D, H * Dh) * (D ** -0.5)),
            "wo": _w((lambda *s: torch.randn(*s, dtype=torch.bfloat16) * 0.05)(H * Dh, D) * ((H * Dh) ** -0.5)),
        }
    _B_in = _B_setup()

    return {
        "A_x": _A_in["x"],
        "A_k_cache": _A_in["k_cache"],
        "A_v_cache": _A_in["v_cache"],
        "A_wq": _A_in["wq"],
        "A_wo": _A_in["wo"],
        "B_x": _B_in["x"],
        "B_k_cache": _B_in["k_cache"],
        "B_v_cache": _B_in["v_cache"],
        "B_wq": _B_in["wq"],
        "B_wo": _B_in["wo"],
    }

def reference(A_x, A_k_cache, A_v_cache, A_wq, A_wo, B_x, B_k_cache, B_v_cache, B_wq, B_wo):
    def _A_ref(x, k_cache, v_cache, wq, wo):
        B, Sq, D = x.shape
        H, Dh = 16, 256
        q = (lambda x, *d: x.permute(*d))((x @ wq).reshape(B, Sq, H, Dh), 0, 2, 1, 3)
        scores = torch.einsum("bhqd,bhkd->bhqk", q, k_cache) * (Dh ** -0.5)
        p = _softmax(scores, axis=-1)
        o = torch.einsum("bhqk,bhkd->bhqd", p, v_cache)
        return (lambda x, *d: x.permute(*d))(o, 0, 2, 1, 3).reshape(B, Sq, H * Dh) @ wo

    def _B_ref(x, k_cache, v_cache, wq, wo):
        B, Sq, D = x.shape
        H, Dh = 16, 256
        q = (lambda x, *d: x.permute(*d))((x @ wq).reshape(B, Sq, H, Dh), 0, 2, 1, 3)
        scores = torch.einsum("bhqd,bhkd->bhqk", q, k_cache) * (Dh ** -0.5)
        p = _softmax(scores, axis=-1)
        o = torch.einsum("bhqk,bhkd->bhqd", p, v_cache)
        return (lambda x, *d: x.permute(*d))(o, 0, 2, 1, 3).reshape(B, Sq, H * Dh) @ wo

    a = _A_ref(A_x, A_k_cache, A_v_cache, A_wq, A_wo)
    b = _B_ref(B_x, B_k_cache, B_v_cache, B_wq, B_wo)
    return torch.concatenate([a, b], axis=-1)
```

```asm
; @launch grid=(256,1,1) block=(256,1,1) lds=162304
.amdgcn_target "amdgcn-amd-amdhsa--gfx950"
.text
.globl concat_heads__mha_block_cached__mha_block_cached__near_ridge_kernel
.p2align 8
.type concat_heads__mha_block_cached__mha_block_cached__near_ridge_kernel,@function
concat_heads__mha_block_cached__mha_block_cached__near_ridge_kernel:
    s_cmp_ge_u32 s2, 256
    s_cbranch_scc1 L_exit
    s_load_dwordx16 s[60:75], s[0:1], 0
    s_load_dwordx8 s[76:83], s[0:1], 64
    s_load_dwordx2 s[84:85], s[0:1], 96
    v_and_b32 v100, 63, v0
    v_lshrrev_b32 v101, 6, v0
    v_lshrrev_b32 v111, 5, v100
    v_readfirstlane_b32 s28, v101
    s_getpc_b64 s[50:51]
L_pc:
    s_sub_u32 s50, s50, L_pc-concat_heads__mha_block_cached__mha_block_cached__near_ridge_kernel
    s_subb_u32 s51, s51, 0
    s_lshr_b32 s39, s2, 3
    s_lshl_b32 s39, s39, 2
    s_add_u32 s39, s39, s28
    s_mul_hi_u32 s40, s39, 477218589
    s_mul_i32 s40, s40, 9
    s_sub_u32 s39, s39, s40
    s_add_u32 s39, s39, 0
    s_lshl_b32 s39, s39, 13
    v_lshlrev_b32 v95, 7, v100
    v_add_u32 v95, s39, v95
    global_load_dword v99, v95, s[50:51]
    s_and_b32 s39, s2, 7
    s_lshr_b32 s49, s39, 2
    s_and_b32 s39, s39, 3
    s_lshl_b32 s48, s39, 1
    s_lshr_b32 s39, s2, 3
    s_and_b32 s47, s39, 15
    s_lshr_b32 s39, s39, 4
    s_add_u32 s48, s48, s39
    s_lshr_b32 s29, s28, 1
    s_and_b32 s30, s28, 1
    s_lshl_b32 s41, s30, 13
    s_mul_i32 s34, s28, 2080
    s_mov_b32 s31, 0x3db8aa3b
    s_mov_b32 s46, 0x41000000
    s_mul_i32 s42, s29, 8320
    s_lshl_b32 s39, s30, 9
    s_add_u32 s42, s42, s39
    s_lshl_b32 s39, s48, 4
    s_add_u32 s39, s39, s47
    s_lshl_b32 s32, s39, 19
    s_lshl_b32 s39, s28, 12
    s_add_u32 s86, s32, s39
    s_mul_i32 s39, s2, 1
    s_lshr_b32 s40, s2, 5
    s_add_u32 s39, s39, s40
    s_and_b32 s39, s39, 31
    s_lshl_b32 s87, s39, 14
    s_mov_b32 s88, s87
    s_add_u32 s32, s86, s87
    s_mov_b32 s33, s32
    s_mul_i32 s39, s48, 288
    s_lshl_b32 s40, s28, 6
    s_add_u32 s40, s40, s39
    s_mul_i32 s35, s40, 896
    s_lshl_b32 s40, s28, 3
    s_add_u32 s39, s39, s40
    s_add_u32 s39, s39, 256
    s_mul_i32 s36, s39, 896
    s_lshl_b32 s37, s28, 13
    s_add_u32 s37, s37, 91136
    s_lshl_b32 s38, s28, 16
    s_lshl_b32 s39, s47, 9
    s_add_u32 s38, s38, s39
    v_bfe_u32 v101, v100, 2, 2
    v_lshrrev_b32 v102, 4, v100
    v_and_b32 v103, 3, v100
    v_lshlrev_b32 v104, 6, v102
    v_lshl_add_u32 v104, v103, 4, v104
    v_lshl_add_u32 v249, v101, 9, v104
    v_lshl_add_u32 v105, v101, 13, v104
    v_lshrrev_b32 v112, 3, v100
    v_and_b32 v113, 7, v100
    v_lshrrev_b32 v114, 4, v100
    v_xor_b32 v113, v113, v114
    v_mul_u32_u24 v112, 896, v112
    v_lshl_add_u32 v106, v113, 4, v112
    v_xor_b32 v113, 4, v113
    v_lshl_add_u32 v107, v113, 4, v112
    s_cmp_eq_u32 s30, 0
    s_cselect_b64 vcc, -1, 0
    v_cndmask_b32 v108, v107, v106, vcc
    s_waitcnt lgkmcnt(0)
    s_cmp_eq_u32 s49, 0
    s_cselect_b32 s16, s66, s76
    s_cselect_b32 s17, s67, s77
    s_cselect_b32 s20, s60, s70
    s_cselect_b32 s21, s61, s71
    s_cselect_b32 s8, s62, s72
    s_cselect_b32 s9, s63, s73
    s_cselect_b32 s12, s64, s74
    s_cselect_b32 s13, s65, s75
    s_cselect_b32 s52, s68, s78
    s_cselect_b32 s53, s69, s79
    s_mov_b32 s18, 3670016
    s_mov_b32 s19, 0x00020000
    s_mov_b32 s22, 2064384
    s_mov_b32 s23, 0x00020000
    s_mov_b32 s10, 67108864
    s_mov_b32 s11, 0x00020000
    s_mov_b32 s14, 67108864
    s_mov_b32 s15, 0x00020000
    s_mov_b32 s54, 3670016
    s_mov_b32 s55, 0x00020000
    s_add_u32 m0, s34, 24576
    s_add_u32 s39, s38, 0
    buffer_load_dwordx4 v105, s[16:19], s39 offen lds
    s_add_u32 m0, s34, 32640
    s_add_u32 s39, s38, 0
    buffer_load_dwordx4 v105, s[16:19], s39 offen offset:256 lds
    s_add_u32 m0, s34, 25616
    s_add_u32 s39, s38, 32768
    buffer_load_dwordx4 v105, s[16:19], s39 offen lds
    s_add_u32 m0, s34, 33680
    s_add_u32 s39, s38, 32768
    buffer_load_dwordx4 v105, s[16:19], s39 offen offset:256 lds
    s_add_u32 m0, s37, 0
    s_add_u32 s39, s35, 0
    buffer_load_dwordx4 v106, s[20:23], s39 offen lds
    s_add_u32 m0, s37, 1024
    s_add_u32 s39, s35, 7168
    buffer_load_dwordx4 v107, s[20:23], s39 offen lds
    s_add_u32 m0, s37, 2048
    s_add_u32 s39, s35, 14336
    buffer_load_dwordx4 v106, s[20:23], s39 offen lds
    s_add_u32 m0, s37, 3072
    s_add_u32 s39, s35, 21504
    buffer_load_dwordx4 v107, s[20:23], s39 offen lds
    s_add_u32 m0, s37, 4096
    s_add_u32 s39, s35, 28672
    buffer_load_dwordx4 v106, s[20:23], s39 offen lds
    s_add_u32 m0, s37, 5120
    s_add_u32 s39, s35, 35840
    buffer_load_dwordx4 v107, s[20:23], s39 offen lds
    s_add_u32 m0, s37, 6144
    s_add_u32 s39, s35, 43008
    buffer_load_dwordx4 v106, s[20:23], s39 offen lds
    s_add_u32 m0, s37, 7168
    s_add_u32 s39, s35, 50176
    buffer_load_dwordx4 v107, s[20:23], s39 offen lds
    s_lshl_b32 s40, s28, 10
    s_add_u32 m0, s40, 0
    s_add_u32 s39, s36, 0
    buffer_load_dwordx4 v108, s[20:23], s39 offen lds
    s_mov_b32 s24, s84
    s_mov_b32 s25, s85
    s_mov_b32 s26, 287244288
    s_mov_b32 s27, 0x00020000
    s_mov_b32 s92, s80
    s_mov_b32 s93, s81
    s_mov_b32 s94, 4128768
    s_mov_b32 s95, 0x00020000
    s_mov_b32 s96, s82
    s_mov_b32 s97, s83
    s_mov_b32 s98, 256
    s_mov_b32 s99, 0x00020000
    s_lshl_b32 s89, s49, 3
    s_add_u32 s89, s89, s48
    s_mul_i32 s56, s89, 4194304
    s_lshl_b32 s91, s89, 12
    s_add_u32 s91, s91, 67108864
    s_lshl_b32 s90, s89, 4
    s_getreg_b32 s59, hwreg(HW_REG_XCC_ID)
    s_and_b32 s59, s59, 7
    s_mul_i32 s59, s59, 5
    s_add_u32 m0, s34, 41216
    s_add_u32 s39, s38, 262144
    buffer_load_dwordx4 v105, s[16:19], s39 offen lds
    s_add_u32 m0, s34, 49280
    s_add_u32 s39, s38, 262144
    buffer_load_dwordx4 v105, s[16:19], s39 offen offset:256 lds
    s_add_u32 m0, s34, 42256
    s_add_u32 s39, s38, 294912
    buffer_load_dwordx4 v105, s[16:19], s39 offen lds
    s_add_u32 m0, s34, 50320
    s_add_u32 s39, s38, 294912
    buffer_load_dwordx4 v105, s[16:19], s39 offen offset:256 lds
    s_lshl_b32 s40, s28, 10
    s_add_u32 m0, s40, 4096
    s_add_u32 s39, s36, 128
    buffer_load_dwordx4 v108, s[20:23], s39 offen lds
    s_add_u32 m0, s34, 57856
    s_add_u32 s39, s38, 524288
    buffer_load_dwordx4 v105, s[16:19], s39 offen lds
    s_add_u32 m0, s34, 65920
    s_add_u32 s39, s38, 524288
    buffer_load_dwordx4 v105, s[16:19], s39 offen offset:256 lds
    s_add_u32 m0, s34, 58896
    s_add_u32 s39, s38, 557056
    buffer_load_dwordx4 v105, s[16:19], s39 offen lds
    s_add_u32 m0, s34, 66960
    s_add_u32 s39, s38, 557056
    buffer_load_dwordx4 v105, s[16:19], s39 offen offset:256 lds
    v_lshlrev_b32 v94, 13, v100
    s_mul_i32 s39, s48, 516096
    buffer_load_dword v93, v94, s[92:95], s39 offen
    v_lshlrev_b32 v92, 12, v100
    s_mul_i32 s39, s47, 229376
    buffer_load_dword v91, v92, s[52:55], s39 offen
    v_bfe_u32 v104, v100, 2, 3
    v_mul_u32_u24 v244, 1040, v104
    v_lshl_add_u32 v244, v103, 6, v244
    v_lshl_add_u32 v244, v111, 4, v244
    v_add_u32 v244, 24576, v244
    v_mul_u32_u24 v245, 1040, v101
    v_lshl_add_u32 v245, v103, 6, v245
    v_lshl_add_u32 v245, v102, 4, v245
    s_mul_i32 s39, s29, 4160
    s_add_u32 s39, s39, 24576
    v_add_u32 v245, s39, v245
    v_and_b32 v104, 1, v102
    v_lshlrev_b32 v112, 6, v101
    v_lshl_add_u32 v112, v104, 5, v112
    v_mul_u32_u24 v246, 1040, v111
    v_add_u32 v246, v246, v112
    v_lshl_add_u32 v246, v103, 3, v246
    v_add_u32 v246, 91136, v246
    v_and_b32 v113, 1, v103
    v_lshrrev_b32 v114, 1, v103
    v_lshl_add_u32 v113, v113, 1, v114
    v_mul_u32_u24 v109, 2080, v111
    v_add_u32 v109, v109, v112
    v_lshl_add_u32 v109, v113, 3, v109
    v_add_u32 v109, 24576, v109
    v_add_u32 v110, s42, v109
    v_lshlrev_b32 v247, 4, v100
    v_add_u32 v247, s41, v247
    v_and_b32 v114, 15, v100
    v_lshl_add_u32 v114, v104, 5, v114
    v_lshlrev_b32 v248, 4, v114
    v_lshl_add_u32 v248, v111, 3, v248
    s_lshl_b32 s39, s29, 10
    s_lshl_b32 s40, s30, 8
    s_add_u32 s39, s39, s40
    v_add_u32 v248, s39, v248
    v_and_b32 v115, 15, v100
    v_lshl_add_u32 v115, v111, 4, v115
    v_lshlrev_b32 v115, 4, v115
    v_lshl_add_u32 v115, v104, 13, v115
    s_lshl_b32 s39, s28, 11
    v_add_u32 v115, s39, v115
    v_and_b32 v112, 31, v100
    v_lshlrev_b32 v112, 7, v112
    v_bfe_u32 v113, v100, 1, 3
    v_xor_b32 v113, v113, v111
    v_xor_b32 v114, 0, v113
    v_lshl_add_u32 v120, v114, 4, v112
    v_add_u32 v116, s37, v120
    v_xor_b32 v114, 2, v113
    v_lshl_add_u32 v121, v114, 4, v112
    v_add_u32 v117, s37, v121
    v_xor_b32 v114, 4, v113
    v_lshl_add_u32 v122, v114, 4, v112
    v_add_u32 v118, s37, v122
    v_xor_b32 v114, 6, v113
    v_lshl_add_u32 v123, v114, 4, v112
    v_add_u32 v119, s37, v123
    v_mov_b32 v252, 0
    v_mov_b32 v253, 0
    v_mov_b32 v255, 0
    v_mov_b32 v250, 0
    v_mov_b32 v251, 0
    v_mov_b32 v254, 0xf149f2ca
    s_waitcnt vmcnt(11)
    s_barrier
    ds_read_b128 v[0:3], v116
    ds_read_b128 v[8:11], v116 offset:4096
    ds_read_b128 v[16:19], v120
    ds_read_b128 v[4:7], v117
    ds_read_b128 v[12:15], v117 offset:4096
    ds_read_b128 v[20:23], v121
    ds_read_b64_tr_b16 v[128:129], v109
    ds_read_b64_tr_b16 v[130:131], v109 offset:1040
    ds_read_b64_tr_b16 v[132:133], v109 offset:256
    ds_read_b64_tr_b16 v[134:135], v109 offset:1296
    ds_read_b64_tr_b16 v[136:137], v109 offset:512
    ds_read_b64_tr_b16 v[138:139], v109 offset:1552
    ds_read_b64_tr_b16 v[140:141], v109 offset:768
    ds_read_b64_tr_b16 v[142:143], v109 offset:1808
    s_waitcnt lgkmcnt(6)
    v_mfma_f32_32x32x16_bf16 a[0:15], v[128:131], v[0:3], 0
    ds_read_b64_tr_b16 v[144:145], v109 offset:8320
    ds_read_b64_tr_b16 v[146:147], v109 offset:9360
    s_add_u32 m0, s37, 33280
    s_add_u32 s39, s35, 128
    buffer_load_dwordx4 v106, s[20:23], s39 offen lds
    v_mfma_f32_32x32x16_bf16 a[128:143], v[128:131], v[8:11], 0
    s_waitcnt lgkmcnt(6)
    v_mfma_f32_32x32x16_bf16 a[16:31], v[132:135], v[0:3], 0
    ds_read_b64_tr_b16 v[148:149], v109 offset:8576
    ds_read_b64_tr_b16 v[150:151], v109 offset:9616
    s_add_u32 m0, s37, 34304
    s_add_u32 s39, s35, 7296
    buffer_load_dwordx4 v107, s[20:23], s39 offen lds
    v_mfma_f32_32x32x16_bf16 a[144:159], v[132:135], v[8:11], 0
    s_waitcnt lgkmcnt(6)
    v_mfma_f32_32x32x16_bf16 a[32:47], v[136:139], v[0:3], 0
    ds_read_b64_tr_b16 v[152:153], v109 offset:8832
    ds_read_b64_tr_b16 v[154:155], v109 offset:9872
    s_add_u32 m0, s37, 35328
    s_add_u32 s39, s35, 14464
    buffer_load_dwordx4 v106, s[20:23], s39 offen lds
    v_mfma_f32_32x32x16_bf16 a[160:175], v[136:139], v[8:11], 0
    s_waitcnt lgkmcnt(6)
    v_mfma_f32_32x32x16_bf16 a[48:63], v[140:143], v[0:3], 0
    ds_read_b64_tr_b16 v[156:157], v109 offset:9088
    ds_read_b64_tr_b16 v[158:159], v109 offset:10128
    s_add_u32 m0, s37, 36352
    s_add_u32 s39, s35, 21632
    buffer_load_dwordx4 v107, s[20:23], s39 offen lds
    v_mfma_f32_32x32x16_bf16 a[176:191], v[140:143], v[8:11], 0
    s_waitcnt lgkmcnt(6)
    v_mfma_f32_32x32x16_bf16 a[64:79], v[144:147], v[0:3], 0
    ds_read_b64_tr_b16 v[128:129], v110
    ds_read_b64_tr_b16 v[130:131], v110 offset:1040
    s_add_u32 m0, s37, 37376
    s_add_u32 s39, s35, 28800
    buffer_load_dwordx4 v106, s[20:23], s39 offen lds
    v_mfma_f32_32x32x16_bf16 a[192:207], v[144:147], v[8:11], 0
    s_waitcnt lgkmcnt(6)
    v_mfma_f32_32x32x16_bf16 a[80:95], v[148:151], v[0:3], 0
    ds_read_b64_tr_b16 v[132:133], v110 offset:256
    ds_read_b64_tr_b16 v[134:135], v110 offset:1296
    s_add_u32 m0, s37, 38400
    s_add_u32 s39, s35, 35968
    buffer_load_dwordx4 v107, s[20:23], s39 offen lds
    v_mfma_f32_32x32x16_bf16 a[208:223], v[148:151], v[8:11], 0
    s_waitcnt lgkmcnt(6)
    v_mfma_f32_32x32x16_bf16 a[96:111], v[152:155], v[0:3], 0
    ds_read_b64_tr_b16 v[136:137], v109 offset:4160
    ds_read_b64_tr_b16 v[138:139], v109 offset:5200
    s_add_u32 m0, s37, 39424
    s_add_u32 s39, s35, 43136
    buffer_load_dwordx4 v106, s[20:23], s39 offen lds
    v_mfma_f32_32x32x16_bf16 a[224:239], v[152:155], v[8:11], 0
    s_waitcnt lgkmcnt(6)
    v_mfma_f32_32x32x16_bf16 a[112:127], v[156:159], v[0:3], 0
    ds_read_b64_tr_b16 v[140:141], v109 offset:4416
    ds_read_b64_tr_b16 v[142:143], v109 offset:5456
    s_add_u32 m0, s37, 40448
    s_add_u32 s39, s35, 50304
    buffer_load_dwordx4 v107, s[20:23], s39 offen lds
    v_mfma_f32_32x32x16_bf16 a[240:255], v[156:159], v[8:11], 0
    s_waitcnt lgkmcnt(6)
    v_mfma_f32_32x32x16_bf16 v[192:207], v[128:131], v[16:19], 0
    ds_read_b64_tr_b16 v[144:145], v109 offset:4672
    ds_read_b64_tr_b16 v[146:147], v109 offset:5712
    s_add_u32 m0, s34, 74496
    s_add_u32 s39, s38, 786432
    buffer_load_dwordx4 v105, s[16:19], s39 offen lds
    s_waitcnt lgkmcnt(6)
    v_mfma_f32_32x32x16_bf16 v[208:223], v[132:135], v[16:19], 0
    ds_read_b64_tr_b16 v[148:149], v109 offset:4928
    ds_read_b64_tr_b16 v[150:151], v109 offset:5968
    s_waitcnt lgkmcnt(6)
    v_mfma_f32_32x32x16_bf16 a[0:15], v[136:139], v[4:7], a[0:15]
    ds_read_b64_tr_b16 v[152:153], v109 offset:12480
    ds_read_b64_tr_b16 v[154:155], v109 offset:13520
    s_add_u32 m0, s34, 82560
    s_add_u32 s39, s38, 786432
    buffer_load_dwordx4 v105, s[16:19], s39 offen offset:256 lds
    v_mfma_f32_32x32x16_bf16 a[128:143], v[136:139], v[12:15], a[128:143]
    s_waitcnt lgkmcnt(6)
    v_mfma_f32_32x32x16_bf16 a[16:31], v[140:143], v[4:7], a[16:31]
    ds_read_b64_tr_b16 v[156:157], v109 offset:12736
    ds_read_b64_tr_b16 v[158:159], v109 offset:13776
    s_add_u32 m0, s34, 75536
    s_add_u32 s39, s38, 819200
    buffer_load_dwordx4 v105, s[16:19], s39 offen lds
    v_mfma_f32_32x32x16_bf16 a[144:159], v[140:143], v[12:15], a[144:159]
    s_waitcnt lgkmcnt(6)
    v_mfma_f32_32x32x16_bf16 a[32:47], v[144:147], v[4:7], a[32:47]
    ds_read_b64_tr_b16 v[128:129], v109 offset:12992
    ds_read_b64_tr_b16 v[130:131], v109 offset:14032
    s_add_u32 m0, s34, 83600
    s_add_u32 s39, s38, 819200
    buffer_load_dwordx4 v105, s[16:19], s39 offen offset:256 lds
    v_mfma_f32_32x32x16_bf16 a[160:175], v[144:147], v[12:15], a[160:175]
    s_waitcnt lgkmcnt(6)
    v_mfma_f32_32x32x16_bf16 a[48:63], v[148:151], v[4:7], a[48:63]
    ds_read_b64_tr_b16 v[132:133], v109 offset:13248
    ds_read_b64_tr_b16 v[134:135], v109 offset:14288
    v_mfma_f32_32x32x16_bf16 a[176:191], v[148:151], v[12:15], a[176:191]
    s_waitcnt lgkmcnt(6)
    v_mfma_f32_32x32x16_bf16 a[64:79], v[152:155], v[4:7], a[64:79]
    ds_read_b64_tr_b16 v[136:137], v110 offset:4160
    ds_read_b64_tr_b16 v[138:139], v110 offset:5200
    v_mfma_f32_32x32x16_bf16 a[192:207], v[152:155], v[12:15], a[192:207]
    s_waitcnt lgkmcnt(6)
    v_mfma_f32_32x32x16_bf16 a[80:95], v[156:159], v[4:7], a[80:95]
    ds_read_b64_tr_b16 v[140:141], v110 offset:4416
    ds_read_b64_tr_b16 v[142:143], v110 offset:5456
    v_mfma_f32_32x32x16_bf16 a[208:223], v[156:159], v[12:15], a[208:223]
    s_waitcnt lgkmcnt(6)
    v_mfma_f32_32x32x16_bf16 a[96:111], v[128:131], v[4:7], a[96:111]
    s_waitcnt vmcnt(19)
    s_waitcnt lgkmcnt(0)
    s_barrier
    ds_read_b64_tr_b16 v[144:145], v109 offset:16640
    ds_read_b64_tr_b16 v[146:147], v109 offset:17680
    v_mfma_f32_32x32x16_bf16 a[224:239], v[128:131], v[12:15], a[224:239]
    ds_read_b128 v[24:27], v118
    ds_read_b128 v[32:35], v118 offset:4096
    v_mfma_f32_32x32x16_bf16 a[112:127], v[132:135], v[4:7], a[112:127]
    ds_read_b64_tr_b16 v[148:149], v109 offset:16896
    ds_read_b64_tr_b16 v[150:151], v109 offset:17936
    ds_read_b128 v[40:43], v122
    ds_read_b128 v[28:31], v119
    v_mfma_f32_32x32x16_bf16 a[240:255], v[132:135], v[12:15], a[240:255]
    ds_read_b128 v[36:39], v119 offset:4096
    ds_read_b128 v[44:47], v123
    v_mfma_f32_32x32x16_bf16 v[192:207], v[136:139], v[20:23], v[192:207]
    ds_read_b64_tr_b16 v[152:153], v109 offset:17152
    ds_read_b64_tr_b16 v[154:155], v109 offset:18192
    v_mfma_f32_32x32x16_bf16 v[208:223], v[140:143], v[20:23], v[208:223]
    ds_read_b64_tr_b16 v[156:157], v109 offset:17408
    ds_read_b64_tr_b16 v[158:159], v109 offset:18448
    s_waitcnt lgkmcnt(11)
    v_mfma_f32_32x32x16_bf16 a[0:15], v[144:147], v[24:27], a[0:15]
    ds_read_b64_tr_b16 v[128:129], v109 offset:24960
    ds_read_b64_tr_b16 v[130:131], v109 offset:26000
    s_add_u32 m0, s34, 24576
    s_add_u32 s39, s38, 1048576
    buffer_load_dwordx4 v105, s[16:19], s39 offen lds
    s_waitcnt lgkmcnt(12)
    v_mfma_f32_32x32x16_bf16 a[128:143], v[144:147], v[32:35], a[128:143]
    s_waitcnt lgkmcnt(10)
    v_mfma_f32_32x32x16_bf16 a[16:31], v[148:151], v[24:27], a[16:31]
    ds_read_b64_tr_b16 v[132:133], v109 offset:25216
    ds_read_b64_tr_b16 v[134:135], v109 offset:26256
    s_add_u32 m0, s34, 32640
    s_add_u32 s39, s38, 1048576
    buffer_load_dwordx4 v105, s[16:19], s39 offen offset:256 lds
    v_mfma_f32_32x32x16_bf16 a[144:159], v[148:151], v[32:35], a[144:159]
    s_waitcnt lgkmcnt(6)
    v_mfma_f32_32x32x16_bf16 a[32:47], v[152:155], v[24:27], a[32:47]
    ds_read_b64_tr_b16 v[136:137], v109 offset:25472
    ds_read_b64_tr_b16 v[138:139], v109 offset:26512
    s_add_u32 m0, s34, 25616
    s_add_u32 s39, s38, 1081344
    buffer_load_dwordx4 v105, s[16:19], s39 offen lds
    v_mfma_f32_32x32x16_bf16 a[160:175], v[152:155], v[32:35], a[160:175]
    s_waitcnt lgkmcnt(6)
    v_mfma_f32_32x32x16_bf16 a[48:63], v[156:159], v[24:27], a[48:63]
    ds_read_b64_tr_b16 v[140:141], v109 offset:25728
    ds_read_b64_tr_b16 v[142:143], v109 offset:26768
    s_add_u32 m0, s34, 33680
    s_add_u32 s39, s38, 1081344
    buffer_load_dwordx4 v105, s[16:19], s39 offen offset:256 lds
    v_mfma_f32_32x32x16_bf16 a[176:191], v[156:159], v[32:35], a[176:191]
    s_waitcnt lgkmcnt(6)
    v_mfma_f32_32x32x16_bf16 a[64:79], v[128:131], v[24:27], a[64:79]
    ds_read_b64_tr_b16 v[144:145], v110 offset:16640
    ds_read_b64_tr_b16 v[146:147], v110 offset:17680
    s_lshl_b32 s40, s28, 10
    s_add_u32 m0, s40, 8192
    s_add_u32 s39, s36, 256
    buffer_load_dwordx4 v108, s[20:23], s39 offen lds
    v_mfma_f32_32x32x16_bf16 a[192:207], v[128:131], v[32:35], a[192:207]
    s_waitcnt lgkmcnt(6)
    v_mfma_f32_32x32x16_bf16 a[80:95], v[132:135], v[24:27], a[80:95]
    ds_read_b64_tr_b16 v[148:149], v110 offset:16896
    ds_read_b64_tr_b16 v[150:151], v110 offset:17936
    s_lshl_b32 s40, s28, 10
    s_add_u32 m0, s40, 12288
    s_add_u32 s39, s36, 384
    buffer_load_dwordx4 v108, s[20:23], s39 offen lds
    v_mfma_f32_32x32x16_bf16 a[208:223], v[132:135], v[32:35], a[208:223]
    s_waitcnt lgkmcnt(6)
    v_mfma_f32_32x32x16_bf16 a[96:111], v[136:139], v[24:27], a[96:111]
    ds_read_b64_tr_b16 v[152:153], v109 offset:20800
    ds_read_b64_tr_b16 v[154:155], v109 offset:21840
    s_lshl_b32 s40, s28, 10
    s_add_u32 m0, s40, 16384
    s_add_u32 s39, s36, 512
    buffer_load_dwordx4 v108, s[20:23], s39 offen lds
    v_mfma_f32_32x32x16_bf16 a[224:239], v[136:139], v[32:35], a[224:239]
    s_waitcnt lgkmcnt(6)
    v_mfma_f32_32x32x16_bf16 a[112:127], v[140:143], v[24:27], a[112:127]
    ds_read_b64_tr_b16 v[156:157], v109 offset:21056
    ds_read_b64_tr_b16 v[158:159], v109 offset:22096
    s_lshl_b32 s40, s28, 10
    s_add_u32 m0, s40, 20480
    s_add_u32 s39, s36, 640
    buffer_load_dwordx4 v108, s[20:23], s39 offen lds
    v_mfma_f32_32x32x16_bf16 a[240:255], v[140:143], v[32:35], a[240:255]
    s_waitcnt lgkmcnt(6)
    v_mfma_f32_32x32x16_bf16 v[192:207], v[144:147], v[40:43], v[192:207]
    ds_read_b64_tr_b16 v[128:129], v109 offset:21312
    ds_read_b64_tr_b16 v[130:131], v109 offset:22352
    s_lshl_b32 s40, s28, 10
    s_add_u32 m0, s40, 157696
    s_add_u32 s39, s36, 768
    buffer_load_dwordx4 v108, s[20:23], s39 offen lds
    s_waitcnt lgkmcnt(6)
    v_mfma_f32_32x32x16_bf16 v[208:223], v[148:151], v[40:43], v[208:223]
    ds_read_b64_tr_b16 v[132:133], v109 offset:21568
    ds_read_b64_tr_b16 v[134:135], v109 offset:22608
    s_waitcnt lgkmcnt(6)
    v_mfma_f32_32x32x16_bf16 a[0:15], v[152:155], v[28:31], a[0:15]
    ds_read_b64_tr_b16 v[136:137], v109 offset:29120
    ds_read_b64_tr_b16 v[138:139], v109 offset:30160
    v_mfma_f32_32x32x16_bf16 a[128:143], v[152:155], v[36:39], a[128:143]
    s_waitcnt lgkmcnt(6)
    v_mfma_f32_32x32x16_bf16 a[16:31], v[156:159], v[28:31], a[16:31]
    ds_read_b64_tr_b16 v[140:141], v109 offset:29376
    ds_read_b64_tr_b16 v[142:143], v109 offset:30416
    v_mfma_f32_32x32x16_bf16 a[144:159], v[156:159], v[36:39], a[144:159]
    s_waitcnt lgkmcnt(6)
    v_mfma_f32_32x32x16_bf16 a[32:47], v[128:131], v[28:31], a[32:47]
    ds_read_b64_tr_b16 v[144:145], v109 offset:29632
    ds_read_b64_tr_b16 v[146:147], v109 offset:30672
    v_mfma_f32_32x32x16_bf16 a[160:175], v[128:131], v[36:39], a[160:175]
    s_waitcnt lgkmcnt(6)
    v_mfma_f32_32x32x16_bf16 a[48:63], v[132:135], v[28:31], a[48:63]
    ds_read_b64_tr_b16 v[148:149], v109 offset:29888
    ds_read_b64_tr_b16 v[150:151], v109 offset:30928
    v_mfma_f32_32x32x16_bf16 a[176:191], v[132:135], v[36:39], a[176:191]
    s_waitcnt lgkmcnt(6)
    v_mfma_f32_32x32x16_bf16 a[64:79], v[136:139], v[28:31], a[64:79]
    ds_read_b64_tr_b16 v[152:153], v110 offset:20800
    ds_read_b64_tr_b16 v[154:155], v110 offset:21840
    v_mfma_f32_32x32x16_bf16 a[192:207], v[136:139], v[36:39], a[192:207]
    s_waitcnt lgkmcnt(6)
    v_mfma_f32_32x32x16_bf16 a[80:95], v[140:143], v[28:31], a[80:95]
    ds_read_b64_tr_b16 v[156:157], v110 offset:21056
    ds_read_b64_tr_b16 v[158:159], v110 offset:22096
    v_mfma_f32_32x32x16_bf16 a[208:223], v[140:143], v[36:39], a[208:223]
    s_waitcnt lgkmcnt(6)
    v_mfma_f32_32x32x16_bf16 a[96:111], v[144:147], v[28:31], a[96:111]
    s_waitcnt vmcnt(23)
    s_waitcnt vmcnt(13)
    s_waitcnt lgkmcnt(0)
    s_barrier
    ds_read_b64_tr_b16 v[128:129], v109 offset:33280
    ds_read_b64_tr_b16 v[130:131], v109 offset:34320
    v_mfma_f32_32x32x16_bf16 a[224:239], v[144:147], v[36:39], a[224:239]
    ds_read_b128 v[0:3], v116 offset:33280
    ds_read_b128 v[8:11], v116 offset:37376
    v_mfma_f32_32x32x16_bf16 a[112:127], v[148:151], v[28:31], a[112:127]
    ds_read_b64_tr_b16 v[132:133], v109 offset:33536
    ds_read_b64_tr_b16 v[134:135], v109 offset:34576
    ds_read_b128 v[16:19], v120 offset:4096
    ds_read_b128 v[4:7], v117 offset:33280
    v_mfma_f32_32x32x16_bf16 a[240:255], v[148:151], v[36:39], a[240:255]
    ds_read_b128 v[12:15], v117 offset:37376
    ds_read_b128 v[20:23], v121 offset:4096
    v_mfma_f32_32x32x16_bf16 v[192:207], v[152:155], v[44:47], v[192:207]
    ds_read_b64_tr_b16 v[136:137], v109 offset:33792
    ds_read_b64_tr_b16 v[138:139], v109 offset:34832
    v_mfma_f32_32x32x16_bf16 v[208:223], v[156:159], v[44:47], v[208:223]
    ds_read_b64_tr_b16 v[140:141], v109 offset:34048
    ds_read_b64_tr_b16 v[142:143], v109 offset:35088
    s_waitcnt lgkmcnt(11)
    v_mfma_f32_32x32x16_bf16 a[0:15], v[128:131], v[0:3], a[0:15]
    ds_read_b64_tr_b16 v[144:145], v109 offset:41600
    ds_read_b64_tr_b16 v[146:147], v109 offset:42640
    s_add_u32 m0, s34, 41216
    s_add_u32 s39, s38, 1310720
    buffer_load_dwordx4 v105, s[16:19], s39 offen lds
    s_waitcnt lgkmcnt(12)
    v_mfma_f32_32x32x16_bf16 a[128:143], v[128:131], v[8:11], a[128:143]
    s_waitcnt lgkmcnt(10)
    v_mfma_f32_32x32x16_bf16 a[16:31], v[132:135], v[0:3], a[16:31]
    ds_read_b64_tr_b16 v[148:149], v109 offset:41856
    ds_read_b64_tr_b16 v[150:151], v109 offset:42896
    s_add_u32 m0, s34, 49280
    s_add_u32 s39, s38, 1310720
    buffer_load_dwordx4 v105, s[16:19], s39 offen offset:256 lds
    v_mfma_f32_32x32x16_bf16 a[144:159], v[132:135], v[8:11], a[144:159]
    s_waitcnt lgkmcnt(6)
    v_mfma_f32_32x32x16_bf16 a[32:47], v[136:139], v[0:3], a[32:47]
    ds_read_b64_tr_b16 v[152:153], v109 offset:42112
    ds_read_b64_tr_b16 v[154:155], v109 offset:43152
    s_add_u32 m0, s34, 42256
    s_add_u32 s39, s38, 1343488
    buffer_load_dwordx4 v105, s[16:19], s39 offen lds
    v_mfma_f32_32x32x16_bf16 a[160:175], v[136:139], v[8:11], a[160:175]
    s_waitcnt lgkmcnt(6)
    v_mfma_f32_32x32x16_bf16 a[48:63], v[140:143], v[0:3], a[48:63]
    ds_read_b64_tr_b16 v[156:157], v109 offset:42368
    ds_read_b64_tr_b16 v[158:159], v109 offset:43408
    s_add_u32 m0, s34, 50320
    s_add_u32 s39, s38, 1343488
    buffer_load_dwordx4 v105, s[16:19], s39 offen offset:256 lds
    v_mfma_f32_32x32x16_bf16 a[176:191], v[140:143], v[8:11], a[176:191]
    s_waitcnt lgkmcnt(6)
    v_mfma_f32_32x32x16_bf16 a[64:79], v[144:147], v[0:3], a[64:79]
    ds_read_b64_tr_b16 v[128:129], v110 offset:33280
    ds_read_b64_tr_b16 v[130:131], v110 offset:34320
    s_add_u32 m0, s37, 0
    s_add_u32 s39, s35, 256
    buffer_load_dwordx4 v106, s[20:23], s39 offen lds
    v_mfma_f32_32x32x16_bf16 a[192:207], v[144:147], v[8:11], a[192:207]
    s_waitcnt lgkmcnt(6)
    v_mfma_f32_32x32x16_bf16 a[80:95], v[148:151], v[0:3], a[80:95]
    ds_read_b64_tr_b16 v[132:133], v110 offset:33536
    ds_read_b64_tr_b16 v[134:135], v110 offset:34576
    s_add_u32 m0, s37, 1024
    s_add_u32 s39, s35, 7424
    buffer_load_dwordx4 v107, s[20:23], s39 offen lds
    v_mfma_f32_32x32x16_bf16 a[208:223], v[148:151], v[8:11], a[208:223]
    s_waitcnt lgkmcnt(6)
    v_mfma_f32_32x32x16_bf16 a[96:111], v[152:155], v[0:3], a[96:111]
    ds_read_b64_tr_b16 v[136:137], v109 offset:37440
    ds_read_b64_tr_b16 v[138:139], v109 offset:38480
    s_add_u32 m0, s37, 2048
    s_add_u32 s39, s35, 14592
    buffer_load_dwordx4 v106, s[20:23], s39 offen lds
    v_mfma_f32_32x32x16_bf16 a[224:239], v[152:155], v[8:11], a[224:239]
    s_waitcnt lgkmcnt(6)
    v_mfma_f32_32x32x16_bf16 a[112:127], v[156:159], v[0:3], a[112:127]
    ds_read_b64_tr_b16 v[140:141], v109 offset:37696
    ds_read_b64_tr_b16 v[142:143], v109 offset:38736
    s_add_u32 m0, s37, 3072
    s_add_u32 s39, s35, 21760
    buffer_load_dwordx4 v107, s[20:23], s39 offen lds
    v_mfma_f32_32x32x16_bf16 a[240:255], v[156:159], v[8:11], a[240:255]
    s_waitcnt lgkmcnt(6)
    v_mfma_f32_32x32x16_bf16 v[192:207], v[128:131], v[16:19], v[192:207]
    ds_read_b64_tr_b16 v[144:145], v109 offset:37952
    ds_read_b64_tr_b16 v[146:147], v109 offset:38992
    s_add_u32 m0, s37, 4096
    s_add_u32 s39, s35, 28928
    buffer_load_dwordx4 v106, s[20:23], s39 offen lds
    s_waitcnt lgkmcnt(6)
    v_mfma_f32_32x32x16_bf16 v[208:223], v[132:135], v[16:19], v[208:223]
    ds_read_b64_tr_b16 v[148:149], v109 offset:38208
    ds_read_b64_tr_b16 v[150:151], v109 offset:39248
    s_waitcnt lgkmcnt(6)
    v_mfma_f32_32x32x16_bf16 a[0:15], v[136:139], v[4:7], a[0:15]
    ds_read_b64_tr_b16 v[152:153], v109 offset:45760
    ds_read_b64_tr_b16 v[154:155], v109 offset:46800
    s_add_u32 m0, s37, 5120
    s_add_u32 s39, s35, 36096
    buffer_load_dwordx4 v107, s[20:23], s39 offen lds
    v_mfma_f32_32x32x16_bf16 a[128:143], v[136:139], v[12:15], a[128:143]
    s_waitcnt lgkmcnt(6)
    v_mfma_f32_32x32x16_bf16 a[16:31], v[140:143], v[4:7], a[16:31]
    ds_read_b64_tr_b16 v[156:157], v109 offset:46016
    ds_read_b64_tr_b16 v[158:159], v109 offset:47056
    s_add_u32 m0, s37, 6144
    s_add_u32 s39, s35, 43264
    buffer_load_dwordx4 v106, s[20:23], s39 offen lds
    v_mfma_f32_32x32x16_bf16 a[144:159], v[140:143], v[12:15], a[144:159]
    s_waitcnt lgkmcnt(6)
    v_mfma_f32_32x32x16_bf16 a[32:47], v[144:147], v[4:7], a[32:47]
    ds_read_b64_tr_b16 v[128:129], v109 offset:46272
    ds_read_b64_tr_b16 v[130:131], v109 offset:47312
    s_add_u32 m0, s37, 7168
    s_add_u32 s39, s35, 50432
    buffer_load_dwordx4 v107, s[20:23], s39 offen lds
    v_mfma_f32_32x32x16_bf16 a[160:175], v[144:147], v[12:15], a[160:175]
    s_waitcnt lgkmcnt(6)
    v_mfma_f32_32x32x16_bf16 a[48:63], v[148:151], v[4:7], a[48:63]
    ds_read_b64_tr_b16 v[132:133], v109 offset:46528
    ds_read_b64_tr_b16 v[134:135], v109 offset:47568
    v_mfma_f32_32x32x16_bf16 a[176:191], v[148:151], v[12:15], a[176:191]
    s_waitcnt lgkmcnt(6)
    v_mfma_f32_32x32x16_bf16 a[64:79], v[152:155], v[4:7], a[64:79]
    ds_read_b64_tr_b16 v[136:137], v110 offset:37440
    ds_read_b64_tr_b16 v[138:139], v110 offset:38480
    v_mfma_f32_32x32x16_bf16 a[192:207], v[152:155], v[12:15], a[192:207]
    s_waitcnt lgkmcnt(6)
    v_mfma_f32_32x32x16_bf16 a[80:95], v[156:159], v[4:7], a[80:95]
    ds_read_b64_tr_b16 v[140:141], v110 offset:37696
    ds_read_b64_tr_b16 v[142:143], v110 offset:38736
    v_mfma_f32_32x32x16_bf16 a[208:223], v[156:159], v[12:15], a[208:223]
    s_waitcnt lgkmcnt(6)
    v_mfma_f32_32x32x16_bf16 a[96:111], v[128:131], v[4:7], a[96:111]
    s_waitcnt vmcnt(21)
    s_waitcnt lgkmcnt(0)
    s_barrier
    ds_read_b64_tr_b16 v[144:145], v109 offset:49920
    ds_read_b64_tr_b16 v[146:147], v109 offset:50960
    v_mfma_f32_32x32x16_bf16 a[224:239], v[128:131], v[12:15], a[224:239]
    ds_read_b128 v[24:27], v118 offset:33280
    ds_read_b128 v[32:35], v118 offset:37376
    v_mfma_f32_32x32x16_bf16 a[112:127], v[132:135], v[4:7], a[112:127]
    ds_read_b64_tr_b16 v[148:149], v109 offset:50176
    ds_read_b64_tr_b16 v[150:151], v109 offset:51216
    ds_read_b128 v[40:43], v122 offset:4096
    ds_read_b128 v[28:31], v119 offset:33280
    v_mfma_f32_32x32x16_bf16 a[240:255], v[132:135], v[12:15], a[240:255]
    ds_read_b128 v[36:39], v119 offset:37376
    ds_read_b128 v[44:47], v123 offset:4096
    v_mfma_f32_32x32x16_bf16 v[192:207], v[136:139], v[20:23], v[192:207]
    ds_read_b64_tr_b16 v[152:153], v109 offset:50432
    ds_read_b64_tr_b16 v[154:155], v109 offset:51472
    v_mfma_f32_32x32x16_bf16 v[208:223], v[140:143], v[20:23], v[208:223]
    ds_read_b64_tr_b16 v[156:157], v109 offset:50688
    ds_read_b64_tr_b16 v[158:159], v109 offset:51728
    s_waitcnt lgkmcnt(11)
    v_mfma_f32_32x32x16_bf16 a[0:15], v[144:147], v[24:27], a[0:15]
    ds_read_b64_tr_b16 v[128:129], v109 offset:58240
    ds_read_b64_tr_b16 v[130:131], v109 offset:59280
    s_add_u32 m0, s34, 57856
    s_add_u32 s39, s38, 1572864
    buffer_load_dwordx4 v105, s[16:19], s39 offen lds
    s_waitcnt lgkmcnt(12)
    v_mfma_f32_32x32x16_bf16 a[128:143], v[144:147], v[32:35], a[128:143]
    s_waitcnt lgkmcnt(10)
    v_mfma_f32_32x32x16_bf16 a[16:31], v[148:151], v[24:27], a[16:31]
    ds_read_b64_tr_b16 v[132:133], v109 offset:58496
    ds_read_b64_tr_b16 v[134:135], v109 offset:59536
    s_add_u32 m0, s34, 65920
    s_add_u32 s39, s38, 1572864
    buffer_load_dwordx4 v105, s[16:19], s39 offen offset:256 lds
    v_mfma_f32_32x32x16_bf16 a[144:159], v[148:151], v[32:35], a[144:159]
    s_waitcnt lgkmcnt(6)
    v_mfma_f32_32x32x16_bf16 a[32:47], v[152:155], v[24:27], a[32:47]
    ds_read_b64_tr_b16 v[136:137], v109 offset:58752
    ds_read_b64_tr_b16 v[138:139], v109 offset:59792
    s_add_u32 m0, s34, 58896
    s_add_u32 s39, s38, 1605632
    buffer_load_dwordx4 v105, s[16:19], s39 offen lds
    v_mfma_f32_32x32x16_bf16 a[160:175], v[152:155], v[32:35], a[160:175]
    s_waitcnt lgkmcnt(6)
    v_mfma_f32_32x32x16_bf16 a[48:63], v[156:159], v[24:27], a[48:63]
    ds_read_b64_tr_b16 v[140:141], v109 offset:59008
    ds_read_b64_tr_b16 v[142:143], v109 offset:60048
    s_add_u32 m0, s34, 66960
    s_add_u32 s39, s38, 1605632
    buffer_load_dwordx4 v105, s[16:19], s39 offen offset:256 lds
    v_mfma_f32_32x32x16_bf16 a[176:191], v[156:159], v[32:35], a[176:191]
    s_waitcnt lgkmcnt(6)
    v_mfma_f32_32x32x16_bf16 a[64:79], v[128:131], v[24:27], a[64:79]
    ds_read_b64_tr_b16 v[144:145], v110 offset:49920
    ds_read_b64_tr_b16 v[146:147], v110 offset:50960
    v_lshlrev_b32 v124, 2, v100
    s_mov_b32 m0, 161792
    v_lshlrev_b32 v125, 7, v100
    buffer_load_dword v124, s[24:27], s91 offen sc1 lds
    v_mfma_f32_32x32x16_bf16 a[192:207], v[128:131], v[32:35], a[192:207]
    s_waitcnt lgkmcnt(6)
    v_mfma_f32_32x32x16_bf16 a[80:95], v[132:135], v[24:27], a[80:95]
    ds_read_b64_tr_b16 v[148:149], v110 offset:50176
    ds_read_b64_tr_b16 v[150:151], v110 offset:51216
    s_cmp_lg_u32 s28, 0
    s_cbranch_scc1 L_nopub
    s_lshl_b64 s[4:5], 1, s59
    s_mov_b64 exec, 1
    v_mov_b32 v126, s4
    v_mov_b32 v127, s5
    buffer_atomic_add_x2 v[126:127], off, s[96:99], s90 offset:8 sc1
    s_mov_b64 exec, -1
L_nopub:
    v_mfma_f32_32x32x16_bf16 a[208:223], v[132:135], v[32:35], a[208:223]
    s_waitcnt lgkmcnt(6)
    v_mfma_f32_32x32x16_bf16 a[96:111], v[136:139], v[24:27], a[96:111]
    ds_read_b64_tr_b16 v[152:153], v109 offset:54080
    ds_read_b64_tr_b16 v[154:155], v109 offset:55120
    v_mfma_f32_32x32x16_bf16 a[224:239], v[136:139], v[32:35], a[224:239]
    s_waitcnt lgkmcnt(6)
    v_mfma_f32_32x32x16_bf16 a[112:127], v[140:143], v[24:27], a[112:127]
    ds_read_b64_tr_b16 v[156:157], v109 offset:54336
    ds_read_b64_tr_b16 v[158:159], v109 offset:55376
    v_mfma_f32_32x32x16_bf16 a[240:255], v[140:143], v[32:35], a[240:255]
    s_waitcnt lgkmcnt(6)
    v_mfma_f32_32x32x16_bf16 v[192:207], v[144:147], v[40:43], v[192:207]
    ds_read_b64_tr_b16 v[128:129], v109 offset:54592
    ds_read_b64_tr_b16 v[130:131], v109 offset:55632
    s_waitcnt lgkmcnt(6)
    v_mfma_f32_32x32x16_bf16 v[208:223], v[148:151], v[40:43], v[208:223]
    ds_read_b64_tr_b16 v[132:133], v109 offset:54848
    ds_read_b64_tr_b16 v[134:135], v109 offset:55888
    s_waitcnt lgkmcnt(6)
    v_mfma_f32_32x32x16_bf16 a[0:15], v[152:155], v[28:31], a[0:15]
    ds_read_b64_tr_b16 v[136:137], v109 offset:62400
    ds_read_b64_tr_b16 v[138:139], v109 offset:63440
    v_mfma_f32_32x32x16_bf16 a[128:143], v[152:155], v[36:39], a[128:143]
    s_waitcnt lgkmcnt(6)
    v_mfma_f32_32x32x16_bf16 a[16:31], v[156:159], v[28:31], a[16:31]
    ds_read_b64_tr_b16 v[140:141], v109 offset:62656
    ds_read_b64_tr_b16 v[142:143], v109 offset:63696
    v_mfma_f32_32x32x16_bf16 a[144:159], v[156:159], v[36:39], a[144:159]
    s_waitcnt lgkmcnt(6)
    v_mfma_f32_32x32x16_bf16 a[32:47], v[128:131], v[28:31], a[32:47]
    ds_read_b64_tr_b16 v[144:145], v109 offset:62912
    ds_read_b64_tr_b16 v[146:147], v109 offset:63952
    v_mfma_f32_32x32x16_bf16 a[160:175], v[128:131], v[36:39], a[160:175]
    s_waitcnt lgkmcnt(6)
    v_mfma_f32_32x32x16_bf16 a[48:63], v[132:135], v[28:31], a[48:63]
    ds_read_b64_tr_b16 v[148:149], v109 offset:63168
    ds_read_b64_tr_b16 v[150:151], v109 offset:64208
    v_mfma_f32_32x32x16_bf16 a[176:191], v[132:135], v[36:39], a[176:191]
    s_waitcnt lgkmcnt(6)
    v_mfma_f32_32x32x16_bf16 a[64:79], v[136:139], v[28:31], a[64:79]
    ds_read_b64_tr_b16 v[152:153], v110 offset:54080
    ds_read_b64_tr_b16 v[154:155], v110 offset:55120
    v_mfma_f32_32x32x16_bf16 a[192:207], v[136:139], v[36:39], a[192:207]
    s_waitcnt lgkmcnt(6)
    v_mfma_f32_32x32x16_bf16 a[80:95], v[140:143], v[28:31], a[80:95]
    ds_read_b64_tr_b16 v[156:157], v110 offset:54336
    ds_read_b64_tr_b16 v[158:159], v110 offset:55376
    v_mfma_f32_32x32x16_bf16 a[208:223], v[140:143], v[36:39], a[208:223]
    s_waitcnt lgkmcnt(6)
    v_mfma_f32_32x32x16_bf16 a[96:111], v[144:147], v[28:31], a[96:111]
    s_waitcnt vmcnt(22)
    s_waitcnt vmcnt(5)
    s_waitcnt lgkmcnt(0)
    s_barrier
    ds_read_b64_tr_b16 v[128:129], v109
    ds_read_b64_tr_b16 v[130:131], v109 offset:1040
    v_mfma_f32_32x32x16_bf16 a[224:239], v[144:147], v[36:39], a[224:239]
    ds_read_b128 v[0:3], v116
    ds_read_b128 v[8:11], v116 offset:4096
    v_mfma_f32_32x32x16_bf16 a[112:127], v[148:151], v[28:31], a[112:127]
    ds_read_b64_tr_b16 v[132:133], v109 offset:256
    ds_read_b64_tr_b16 v[134:135], v109 offset:1296
    ds_read_b128 v[16:19], v120 offset:8192
    ds_read_b128 v[4:7], v117
    v_mfma_f32_32x32x16_bf16 a[240:255], v[148:151], v[36:39], a[240:255]
    ds_read_b128 v[12:15], v117 offset:4096
    ds_read_b128 v[20:23], v121 offset:8192
    v_mfma_f32_32x32x16_bf16 v[192:207], v[152:155], v[44:47], v[192:207]
    ds_read_b64_tr_b16 v[136:137], v109 offset:512
    ds_read_b64_tr_b16 v[138:139], v109 offset:1552
    v_mfma_f32_32x32x16_bf16 v[208:223], v[156:159], v[44:47], v[208:223]
    ds_read_b64_tr_b16 v[140:141], v109 offset:768
    ds_read_b64_tr_b16 v[142:143], v109 offset:1808
    s_waitcnt lgkmcnt(11)
    v_mfma_f32_32x32x16_bf16 a[0:15], v[128:131], v[0:3], a[0:15]
    ds_read_b64_tr_b16 v[144:145], v109 offset:8320
    ds_read_b64_tr_b16 v[146:147], v109 offset:9360
    s_add_u32 m0, s34, 74496
    s_add_u32 s39, s38, 1835008
    buffer_load_dwordx4 v105, s[16:19], s39 offen lds
    s_waitcnt lgkmcnt(12)
    v_mfma_f32_32x32x16_bf16 a[128:143], v[128:131], v[8:11], a[128:143]
    s_waitcnt lgkmcnt(10)
    v_mfma_f32_32x32x16_bf16 a[16:31], v[132:135], v[0:3], a[16:31]
    ds_read_b64_tr_b16 v[148:149], v109 offset:8576
    ds_read_b64_tr_b16 v[150:151], v109 offset:9616
    s_add_u32 m0, s34, 82560
    s_add_u32 s39, s38, 1835008
    buffer_load_dwordx4 v105, s[16:19], s39 offen offset:256 lds
    v_mfma_f32_32x32x16_bf16 a[144:159], v[132:135], v[8:11], a[144:159]
    s_waitcnt lgkmcnt(6)
    v_mfma_f32_32x32x16_bf16 a[32:47], v[136:139], v[0:3], a[32:47]
    ds_read_b64_tr_b16 v[152:153], v109 offset:8832
    ds_read_b64_tr_b16 v[154:155], v109 offset:9872
    s_add_u32 m0, s34, 75536
    s_add_u32 s39, s38, 1867776
    buffer_load_dwordx4 v105, s[16:19], s39 offen lds
    v_mfma_f32_32x32x16_bf16 a[160:175], v[136:139], v[8:11], a[160:175]
    s_waitcnt lgkmcnt(6)
    v_mfma_f32_32x32x16_bf16 a[48:63], v[140:143], v[0:3], a[48:63]
    ds_read_b64_tr_b16 v[156:157], v109 offset:9088
    ds_read_b64_tr_b16 v[158:159], v109 offset:10128
    s_add_u32 m0, s34, 83600
    s_add_u32 s39, s38, 1867776
    buffer_load_dwordx4 v105, s[16:19], s39 offen offset:256 lds
    v_mfma_f32_32x32x16_bf16 a[176:191], v[140:143], v[8:11], a[176:191]
    s_waitcnt lgkmcnt(6)
    v_mfma_f32_32x32x16_bf16 a[64:79], v[144:147], v[0:3], a[64:79]
    ds_read_b64_tr_b16 v[128:129], v110
    ds_read_b64_tr_b16 v[130:131], v110 offset:1040
    s_add_u32 m0, s37, 33280
    s_add_u32 s39, s35, 384
    buffer_load_dwordx4 v106, s[20:23], s39 offen lds
    v_mfma_f32_32x32x16_bf16 a[192:207], v[144:147], v[8:11], a[192:207]
    s_waitcnt lgkmcnt(6)
    v_mfma_f32_32x32x16_bf16 a[80:95], v[148:151], v[0:3], a[80:95]
    ds_read_b64_tr_b16 v[132:133], v110 offset:256
    ds_read_b64_tr_b16 v[134:135], v110 offset:1296
    s_add_u32 m0, s37, 34304
    s_add_u32 s39, s35, 7552
    buffer_load_dwordx4 v107, s[20:23], s39 offen lds
    v_mfma_f32_32x32x16_bf16 a[208:223], v[148:151], v[8:11], a[208:223]
    s_waitcnt lgkmcnt(6)
    v_mfma_f32_32x32x16_bf16 a[96:111], v[152:155], v[0:3], a[96:111]
    ds_read_b64_tr_b16 v[136:137], v109 offset:4160
    ds_read_b64_tr_b16 v[138:139], v109 offset:5200
    s_add_u32 m0, s37, 35328
    s_add_u32 s39, s35, 14720
    buffer_load_dwordx4 v106, s[20:23], s39 offen lds
    v_mfma_f32_32x32x16_bf16 a[224:239], v[152:155], v[8:11], a[224:239]
    s_waitcnt lgkmcnt(6)
    v_mfma_f32_32x32x16_bf16 a[112:127], v[156:159], v[0:3], a[112:127]
    ds_read_b64_tr_b16 v[140:141], v109 offset:4416
    ds_read_b64_tr_b16 v[142:143], v109 offset:5456
    s_add_u32 m0, s37, 36352
    s_add_u32 s39, s35, 21888
    buffer_load_dwordx4 v107, s[20:23], s39 offen lds
    v_mfma_f32_32x32x16_bf16 a[240:255], v[156:159], v[8:11], a[240:255]
    s_waitcnt lgkmcnt(6)
    v_mfma_f32_32x32x16_bf16 v[192:207], v[128:131], v[16:19], v[192:207]
    ds_read_b64_tr_b16 v[144:145], v109 offset:4672
    ds_read_b64_tr_b16 v[146:147], v109 offset:5712
    s_add_u32 m0, s37, 37376
    s_add_u32 s39, s35, 29056
    buffer_load_dwordx4 v106, s[20:23], s39 offen lds
    s_waitcnt lgkmcnt(6)
    v_mfma_f32_32x32x16_bf16 v[208:223], v[132:135], v[16:19], v[208:223]
    ds_read_b64_tr_b16 v[148:149], v109 offset:4928
    ds_read_b64_tr_b16 v[150:151], v109 offset:5968
    s_waitcnt lgkmcnt(6)
    v_mfma_f32_32x32x16_bf16 a[0:15], v[136:139], v[4:7], a[0:15]
    ds_read_b64_tr_b16 v[152:153], v109 offset:12480
    ds_read_b64_tr_b16 v[154:155], v109 offset:13520
    s_add_u32 m0, s37, 38400
    s_add_u32 s39, s35, 36224
    buffer_load_dwordx4 v107, s[20:23], s39 offen lds
    v_mfma_f32_32x32x16_bf16 a[128:143], v[136:139], v[12:15], a[128:143]
    s_waitcnt lgkmcnt(6)
    v_mfma_f32_32x32x16_bf16 a[16:31], v[140:143], v[4:7], a[16:31]
    ds_read_b64_tr_b16 v[156:157], v109 offset:12736
    ds_read_b64_tr_b16 v[158:159], v109 offset:13776
    s_add_u32 m0, s37, 39424
    s_add_u32 s39, s35, 43392
    buffer_load_dwordx4 v106, s[20:23], s39 offen lds
    v_mfma_f32_32x32x16_bf16 a[144:159], v[140:143], v[12:15], a[144:159]
    s_waitcnt lgkmcnt(6)
    v_mfma_f32_32x32x16_bf16 a[32:47], v[144:147], v[4:7], a[32:47]
    ds_read_b64_tr_b16 v[128:129], v109 offset:12992
    ds_read_b64_tr_b16 v[130:131], v109 offset:14032
    s_add_u32 m0, s37, 40448
    s_add_u32 s39, s35, 50560
    buffer_load_dwordx4 v107, s[20:23], s39 offen lds
    v_mfma_f32_32x32x16_bf16 a[160:175], v[144:147], v[12:15], a[160:175]
    s_waitcnt lgkmcnt(6)
    v_mfma_f32_32x32x16_bf16 a[48:63], v[148:151], v[4:7], a[48:63]
    ds_read_b64_tr_b16 v[132:133], v109 offset:13248
    ds_read_b64_tr_b16 v[134:135], v109 offset:14288
    v_mfma_f32_32x32x16_bf16 a[176:191], v[148:151], v[12:15], a[176:191]
    s_waitcnt lgkmcnt(6)
    v_mfma_f32_32x32x16_bf16 a[64:79], v[152:155], v[4:7], a[64:79]
    ds_read_b64_tr_b16 v[136:137], v110 offset:4160
    ds_read_b64_tr_b16 v[138:139], v110 offset:5200
    v_mfma_f32_32x32x16_bf16 a[192:207], v[152:155], v[12:15], a[192:207]
    s_waitcnt lgkmcnt(6)
    v_mfma_f32_32x32x16_bf16 a[80:95], v[156:159], v[4:7], a[80:95]
    ds_read_b64_tr_b16 v[140:141], v110 offset:4416
    ds_read_b64_tr_b16 v[142:143], v110 offset:5456
    v_mfma_f32_32x32x16_bf16 a[208:223], v[156:159], v[12:15], a[208:223]
    s_waitcnt lgkmcnt(6)
    v_mfma_f32_32x32x16_bf16 a[96:111], v[128:131], v[4:7], a[96:111]
    s_waitcnt lgkmcnt(0)
    s_barrier
    ds_read_b64_tr_b16 v[144:145], v109 offset:16640
    ds_read_b64_tr_b16 v[146:147], v109 offset:17680
    v_mfma_f32_32x32x16_bf16 a[224:239], v[128:131], v[12:15], a[224:239]
    ds_read_b128 v[24:27], v118
    ds_read_b128 v[32:35], v118 offset:4096
    v_mfma_f32_32x32x16_bf16 a[112:127], v[132:135], v[4:7], a[112:127]
    ds_read_b64_tr_b16 v[148:149], v109 offset:16896
    ds_read_b64_tr_b16 v[150:151], v109 offset:17936
    ds_read_b128 v[40:43], v122 offset:8192
    ds_read_b128 v[28:31], v119
    v_mfma_f32_32x32x16_bf16 a[240:255], v[132:135], v[12:15], a[240:255]
    ds_read_b128 v[36:39], v119 offset:4096
    ds_read_b128 v[44:47], v123 offset:8192
    v_mfma_f32_32x32x16_bf16 v[192:207], v[136:139], v[20:23], v[192:207]
    ds_read_b64_tr_b16 v[152:153], v109 offset:17152
    ds_read_b64_tr_b16 v[154:155], v109 offset:18192
    v_mfma_f32_32x32x16_bf16 v[208:223], v[140:143], v[20:23], v[208:223]
    ds_read_b64_tr_b16 v[156:157], v109 offset:17408
    ds_read_b64_tr_b16 v[158:159], v109 offset:18448
    s_waitcnt lgkmcnt(11)
    v_mfma_f32_32x32x16_bf16 a[0:15], v[144:147], v[24:27], a[0:15]
    ds_read_b64_tr_b16 v[128:129], v109 offset:24960
    ds_read_b64_tr_b16 v[130:131], v109 offset:26000
    s_add_u32 m0, s34, 24576
    s_add_u32 s39, s38, 2097152
    buffer_load_dwordx4 v105, s[16:19], s39 offen lds
    s_waitcnt lgkmcnt(12)
    v_mfma_f32_32x32x16_bf16 a[128:143], v[144:147], v[32:35], a[128:143]
    s_waitcnt lgkmcnt(10)
    v_mfma_f32_32x32x16_bf16 a[16:31], v[148:151], v[24:27], a[16:31]
    ds_read_b64_tr_b16 v[132:133], v109 offset:25216
    ds_read_b64_tr_b16 v[134:135], v109 offset:26256
    s_add_u32 m0, s34, 32640
    s_add_u32 s39, s38, 2097152
    buffer_load_dwordx4 v105, s[16:19], s39 offen offset:256 lds
    v_mfma_f32_32x32x16_bf16 a[144:159], v[148:151], v[32:35], a[144:159]
    s_waitcnt lgkmcnt(6)
    v_mfma_f32_32x32x16_bf16 a[32:47], v[152:155], v[24:27], a[32:47]
    ds_read_b64_tr_b16 v[136:137], v109 offset:25472
    ds_read_b64_tr_b16 v[138:139], v109 offset:26512
    s_add_u32 m0, s34, 25616
    s_add_u32 s39, s38, 2129920
    buffer_load_dwordx4 v105, s[16:19], s39 offen lds
    v_mfma_f32_32x32x16_bf16 a[160:175], v[152:155], v[32:35], a[160:175]
    s_waitcnt lgkmcnt(6)
    v_mfma_f32_32x32x16_bf16 a[48:63], v[156:159], v[24:27], a[48:63]
    ds_read_b64_tr_b16 v[140:141], v109 offset:25728
    ds_read_b64_tr_b16 v[142:143], v109 offset:26768
    s_add_u32 m0, s34, 33680
    s_add_u32 s39, s38, 2129920
    buffer_load_dwordx4 v105, s[16:19], s39 offen offset:256 lds
    v_mfma_f32_32x32x16_bf16 a[176:191], v[156:159], v[32:35], a[176:191]
    s_waitcnt lgkmcnt(6)
    v_mfma_f32_32x32x16_bf16 a[64:79], v[128:131], v[24:27], a[64:79]
    ds_read_b64_tr_b16 v[144:145], v110 offset:16640
    ds_read_b64_tr_b16 v[146:147], v110 offset:17680
    v_mfma_f32_32x32x16_bf16 a[192:207], v[128:131], v[32:35], a[192:207]
    s_waitcnt lgkmcnt(6)
    v_mfma_f32_32x32x16_bf16 a[80:95], v[132:135], v[24:27], a[80:95]
    ds_read_b64_tr_b16 v[148:149], v110 offset:16896
    ds_read_b64_tr_b16 v[150:151], v110 offset:17936
    v_mfma_f32_32x32x16_bf16 a[208:223], v[132:135], v[32:35], a[208:223]
    s_waitcnt lgkmcnt(6)
    v_mfma_f32_32x32x16_bf16 a[96:111], v[136:139], v[24:27], a[96:111]
    ds_read_b64_tr_b16 v[152:153], v109 offset:20800
    ds_read_b64_tr_b16 v[154:155], v109 offset:21840
    v_mfma_f32_32x32x16_bf16 a[224:239], v[136:139], v[32:35], a[224:239]
    s_waitcnt lgkmcnt(6)
    v_mfma_f32_32x32x16_bf16 a[112:127], v[140:143], v[24:27], a[112:127]
    ds_read_b64_tr_b16 v[156:157], v109 offset:21056
    ds_read_b64_tr_b16 v[158:159], v109 offset:22096
    v_mfma_f32_32x32x16_bf16 a[240:255], v[140:143], v[32:35], a[240:255]
    s_waitcnt lgkmcnt(6)
    v_mfma_f32_32x32x16_bf16 v[192:207], v[144:147], v[40:43], v[192:207]
    ds_read_b64_tr_b16 v[128:129], v109 offset:21312
    ds_read_b64_tr_b16 v[130:131], v109 offset:22352
    s_waitcnt lgkmcnt(6)
    v_mfma_f32_32x32x16_bf16 v[208:223], v[148:151], v[40:43], v[208:223]
    ds_read_b64_tr_b16 v[132:133], v109 offset:21568
    ds_read_b64_tr_b16 v[134:135], v109 offset:22608
    s_waitcnt lgkmcnt(6)
    v_mfma_f32_32x32x16_bf16 a[0:15], v[152:155], v[28:31], a[0:15]
    ds_read_b64_tr_b16 v[136:137], v109 offset:29120
    ds_read_b64_tr_b16 v[138:139], v109 offset:30160
    v_mfma_f32_32x32x16_bf16 a[128:143], v[152:155], v[36:39], a[128:143]
    s_waitcnt lgkmcnt(6)
    v_mfma_f32_32x32x16_bf16 a[16:31], v[156:159], v[28:31], a[16:31]
    ds_read_b64_tr_b16 v[140:141], v109 offset:29376
    ds_read_b64_tr_b16 v[142:143], v109 offset:30416
    v_mfma_f32_32x32x16_bf16 a[144:159], v[156:159], v[36:39], a[144:159]
    s_waitcnt lgkmcnt(6)
    v_mfma_f32_32x32x16_bf16 a[32:47], v[128:131], v[28:31], a[32:47]
    ds_read_b64_tr_b16 v[144:145], v109 offset:29632
    ds_read_b64_tr_b16 v[146:147], v109 offset:30672
    v_mfma_f32_32x32x16_bf16 a[160:175], v[128:131], v[36:39], a[160:175]
    s_waitcnt lgkmcnt(6)
    v_mfma_f32_32x32x16_bf16 a[48:63], v[132:135], v[28:31], a[48:63]
    ds_read_b64_tr_b16 v[148:149], v109 offset:29888
    ds_read_b64_tr_b16 v[150:151], v109 offset:30928
    v_mfma_f32_32x32x16_bf16 a[176:191], v[132:135], v[36:39], a[176:191]
    s_waitcnt lgkmcnt(6)
    v_mfma_f32_32x32x16_bf16 a[64:79], v[136:139], v[28:31], a[64:79]
    ds_read_b64_tr_b16 v[152:153], v110 offset:20800
    ds_read_b64_tr_b16 v[154:155], v110 offset:21840
    v_mfma_f32_32x32x16_bf16 a[192:207], v[136:139], v[36:39], a[192:207]
    s_waitcnt lgkmcnt(6)
    v_mfma_f32_32x32x16_bf16 a[80:95], v[140:143], v[28:31], a[80:95]
    ds_read_b64_tr_b16 v[156:157], v110 offset:21056
    ds_read_b64_tr_b16 v[158:159], v110 offset:22096
    v_mfma_f32_32x32x16_bf16 a[208:223], v[140:143], v[36:39], a[208:223]
    s_waitcnt lgkmcnt(6)
    v_mfma_f32_32x32x16_bf16 a[96:111], v[144:147], v[28:31], a[96:111]
    s_waitcnt vmcnt(17)
    s_waitcnt vmcnt(4)
    s_waitcnt lgkmcnt(0)
    s_barrier
    ds_read_b64_tr_b16 v[128:129], v109 offset:33280
    ds_read_b64_tr_b16 v[130:131], v109 offset:34320
    v_mfma_f32_32x32x16_bf16 a[224:239], v[144:147], v[36:39], a[224:239]
    ds_read_b128 v[0:3], v116 offset:33280
    ds_read_b128 v[8:11], v116 offset:37376
    v_mfma_f32_32x32x16_bf16 a[112:127], v[148:151], v[28:31], a[112:127]
    ds_read_b64_tr_b16 v[132:133], v109 offset:33536
    ds_read_b64_tr_b16 v[134:135], v109 offset:34576
    ds_read_b128 v[16:19], v120 offset:12288
    ds_read_b128 v[4:7], v117 offset:33280
    v_mfma_f32_32x32x16_bf16 a[240:255], v[148:151], v[36:39], a[240:255]
    ds_read_b128 v[12:15], v117 offset:37376
    ds_read_b128 v[20:23], v121 offset:12288
    v_mfma_f32_32x32x16_bf16 v[192:207], v[152:155], v[44:47], v[192:207]
    ds_read_b64_tr_b16 v[136:137], v109 offset:33792
    ds_read_b64_tr_b16 v[138:139], v109 offset:34832
    v_mfma_f32_32x32x16_bf16 v[208:223], v[156:159], v[44:47], v[208:223]
    ds_read_b64_tr_b16 v[140:141], v109 offset:34048
    ds_read_b64_tr_b16 v[142:143], v109 offset:35088
    s_waitcnt lgkmcnt(11)
    v_mfma_f32_32x32x16_bf16 a[0:15], v[128:131], v[0:3], a[0:15]
    ds_read_b64_tr_b16 v[144:145], v109 offset:41600
    ds_read_b64_tr_b16 v[146:147], v109 offset:42640
    s_add_u32 m0, s34, 41216
    s_add_u32 s39, s38, 2359296
    buffer_load_dwordx4 v105, s[16:19], s39 offen lds
    s_waitcnt lgkmcnt(12)
    v_mfma_f32_32x32x16_bf16 a[128:143], v[128:131], v[8:11], a[128:143]
    s_waitcnt lgkmcnt(10)
    v_mfma_f32_32x32x16_bf16 a[16:31], v[132:135], v[0:3], a[16:31]
    ds_read_b64_tr_b16 v[148:149], v109 offset:41856
    ds_read_b64_tr_b16 v[150:151], v109 offset:42896
    s_add_u32 m0, s34, 49280
    s_add_u32 s39, s38, 2359296
    buffer_load_dwordx4 v105, s[16:19], s39 offen offset:256 lds
    v_mfma_f32_32x32x16_bf16 a[144:159], v[132:135], v[8:11], a[144:159]
    s_waitcnt lgkmcnt(6)
    v_mfma_f32_32x32x16_bf16 a[32:47], v[136:139], v[0:3], a[32:47]
    ds_read_b64_tr_b16 v[152:153], v109 offset:42112
    ds_read_b64_tr_b16 v[154:155], v109 offset:43152
    s_add_u32 m0, s34, 42256
    s_add_u32 s39, s38, 2392064
    buffer_load_dwordx4 v105, s[16:19], s39 offen lds
    v_mfma_f32_32x32x16_bf16 a[160:175], v[136:139], v[8:11], a[160:175]
    s_waitcnt lgkmcnt(6)
    v_mfma_f32_32x32x16_bf16 a[48:63], v[140:143], v[0:3], a[48:63]
    ds_read_b64_tr_b16 v[156:157], v109 offset:42368
    ds_read_b64_tr_b16 v[158:159], v109 offset:43408
    s_add_u32 m0, s34, 50320
    s_add_u32 s39, s38, 2392064
    buffer_load_dwordx4 v105, s[16:19], s39 offen offset:256 lds
    v_mfma_f32_32x32x16_bf16 a[176:191], v[140:143], v[8:11], a[176:191]
    s_waitcnt lgkmcnt(6)
    v_mfma_f32_32x32x16_bf16 a[64:79], v[144:147], v[0:3], a[64:79]
    ds_read_b64_tr_b16 v[128:129], v110 offset:33280
    ds_read_b64_tr_b16 v[130:131], v110 offset:34320
    s_add_u32 m0, s37, 0
    s_add_u32 s39, s35, 512
    buffer_load_dwordx4 v106, s[20:23], s39 offen lds
    v_mfma_f32_32x32x16_bf16 a[192:207], v[144:147], v[8:11], a[192:207]
    s_waitcnt lgkmcnt(6)
    v_mfma_f32_32x32x16_bf16 a[80:95], v[148:151], v[0:3], a[80:95]
    ds_read_b64_tr_b16 v[132:133], v110 offset:33536
    ds_read_b64_tr_b16 v[134:135], v110 offset:34576
    s_add_u32 m0, s37, 1024
    s_add_u32 s39, s35, 7680
    buffer_load_dwordx4 v107, s[20:23], s39 offen lds
    v_mfma_f32_32x32x16_bf16 a[208:223], v[148:151], v[8:11], a[208:223]
    s_waitcnt lgkmcnt(6)
    v_mfma_f32_32x32x16_bf16 a[96:111], v[152:155], v[0:3], a[96:111]
    ds_read_b64_tr_b16 v[136:137], v109 offset:37440
    ds_read_b64_tr_b16 v[138:139], v109 offset:38480
    s_add_u32 m0, s37, 2048
    s_add_u32 s39, s35, 14848
    buffer_load_dwordx4 v106, s[20:23], s39 offen lds
    v_mfma_f32_32x32x16_bf16 a[224:239], v[152:155], v[8:11], a[224:239]
    s_waitcnt lgkmcnt(6)
    v_mfma_f32_32x32x16_bf16 a[112:127], v[156:159], v[0:3], a[112:127]
    ds_read_b64_tr_b16 v[140:141], v109 offset:37696
    ds_read_b64_tr_b16 v[142:143], v109 offset:38736
    s_add_u32 m0, s37, 3072
    s_add_u32 s39, s35, 22016
    buffer_load_dwordx4 v107, s[20:23], s39 offen lds
    v_mfma_f32_32x32x16_bf16 a[240:255], v[156:159], v[8:11], a[240:255]
    s_waitcnt lgkmcnt(6)
    v_mfma_f32_32x32x16_bf16 v[192:207], v[128:131], v[16:19], v[192:207]
    ds_read_b64_tr_b16 v[144:145], v109 offset:37952
    ds_read_b64_tr_b16 v[146:147], v109 offset:38992
    s_add_u32 m0, s37, 4096
    s_add_u32 s39, s35, 29184
    buffer_load_dwordx4 v106, s[20:23], s39 offen lds
    s_waitcnt lgkmcnt(6)
    v_mfma_f32_32x32x16_bf16 v[208:223], v[132:135], v[16:19], v[208:223]
    ds_read_b64_tr_b16 v[148:149], v109 offset:38208
    ds_read_b64_tr_b16 v[150:151], v109 offset:39248
    s_waitcnt lgkmcnt(6)
    v_mfma_f32_32x32x16_bf16 a[0:15], v[136:139], v[4:7], a[0:15]
    ds_read_b64_tr_b16 v[152:153], v109 offset:45760
    ds_read_b64_tr_b16 v[154:155], v109 offset:46800
    s_add_u32 m0, s37, 5120
    s_add_u32 s39, s35, 36352
    buffer_load_dwordx4 v107, s[20:23], s39 offen lds
    v_mfma_f32_32x32x16_bf16 a[128:143], v[136:139], v[12:15], a[128:143]
    s_waitcnt lgkmcnt(6)
    v_mfma_f32_32x32x16_bf16 a[16:31], v[140:143], v[4:7], a[16:31]
    ds_read_b64_tr_b16 v[156:157], v109 offset:46016
    ds_read_b64_tr_b16 v[158:159], v109 offset:47056
    s_add_u32 m0, s37, 6144
    s_add_u32 s39, s35, 43520
    buffer_load_dwordx4 v106, s[20:23], s39 offen lds
    v_mfma_f32_32x32x16_bf16 a[144:159], v[140:143], v[12:15], a[144:159]
    s_waitcnt lgkmcnt(6)
    v_mfma_f32_32x32x16_bf16 a[32:47], v[144:147], v[4:7], a[32:47]
    ds_read_b64_tr_b16 v[128:129], v109 offset:46272
    ds_read_b64_tr_b16 v[130:131], v109 offset:47312
    s_add_u32 m0, s37, 7168
    s_add_u32 s39, s35, 50688
    buffer_load_dwordx4 v107, s[20:23], s39 offen lds
    v_mfma_f32_32x32x16_bf16 a[160:175], v[144:147], v[12:15], a[160:175]
    s_waitcnt lgkmcnt(6)
    v_mfma_f32_32x32x16_bf16 a[48:63], v[148:151], v[4:7], a[48:63]
    ds_read_b64_tr_b16 v[132:133], v109 offset:46528
    ds_read_b64_tr_b16 v[134:135], v109 offset:47568
    v_mfma_f32_32x32x16_bf16 a[176:191], v[148:151], v[12:15], a[176:191]
    s_waitcnt lgkmcnt(6)
    v_mfma_f32_32x32x16_bf16 a[64:79], v[152:155], v[4:7], a[64:79]
    ds_read_b64_tr_b16 v[136:137], v110 offset:37440
    ds_read_b64_tr_b16 v[138:139], v110 offset:38480
    v_mfma_f32_32x32x16_bf16 a[192:207], v[152:155], v[12:15], a[192:207]
    s_waitcnt lgkmcnt(6)
    v_mfma_f32_32x32x16_bf16 a[80:95], v[156:159], v[4:7], a[80:95]
    ds_read_b64_tr_b16 v[140:141], v110 offset:37696
    ds_read_b64_tr_b16 v[142:143], v110 offset:38736
    v_mfma_f32_32x32x16_bf16 a[208:223], v[156:159], v[12:15], a[208:223]
    s_waitcnt lgkmcnt(6)
    v_mfma_f32_32x32x16_bf16 a[96:111], v[128:131], v[4:7], a[96:111]
    s_waitcnt lgkmcnt(0)
    s_barrier
    ds_read_b64_tr_b16 v[144:145], v109 offset:49920
    ds_read_b64_tr_b16 v[146:147], v109 offset:50960
    v_mfma_f32_32x32x16_bf16 a[224:239], v[128:131], v[12:15], a[224:239]
    ds_read_b128 v[24:27], v118 offset:33280
    ds_read_b128 v[32:35], v118 offset:37376
    v_mfma_f32_32x32x16_bf16 a[112:127], v[132:135], v[4:7], a[112:127]
    ds_read_b64_tr_b16 v[148:149], v109 offset:50176
    ds_read_b64_tr_b16 v[150:151], v109 offset:51216
    ds_read_b128 v[40:43], v122 offset:12288
    ds_read_b128 v[28:31], v119 offset:33280
    v_mfma_f32_32x32x16_bf16 a[240:255], v[132:135], v[12:15], a[240:255]
    ds_read_b128 v[36:39], v119 offset:37376
    ds_read_b128 v[44:47], v123 offset:12288
    v_mfma_f32_32x32x16_bf16 v[192:207], v[136:139], v[20:23], v[192:207]
    ds_read_b64_tr_b16 v[152:153], v109 offset:50432
    ds_read_b64_tr_b16 v[154:155], v109 offset:51472
    v_mfma_f32_32x32x16_bf16 v[208:223], v[140:143], v[20:23], v[208:223]
    ds_read_b64_tr_b16 v[156:157], v109 offset:50688
    ds_read_b64_tr_b16 v[158:159], v109 offset:51728
    s_waitcnt lgkmcnt(11)
    v_mfma_f32_32x32x16_bf16 a[0:15], v[144:147], v[24:27], a[0:15]
    ds_read_b64_tr_b16 v[128:129], v109 offset:58240
    ds_read_b64_tr_b16 v[130:131], v109 offset:59280
    s_add_u32 m0, s34, 57856
    s_add_u32 s39, s38, 2621440
    buffer_load_dwordx4 v105, s[16:19], s39 offen lds
    s_waitcnt lgkmcnt(12)
    v_mfma_f32_32x32x16_bf16 a[128:143], v[144:147], v[32:35], a[128:143]
    s_waitcnt lgkmcnt(10)
    v_mfma_f32_32x32x16_bf16 a[16:31], v[148:151], v[24:27], a[16:31]
    ds_read_b64_tr_b16 v[132:133], v109 offset:58496
    ds_read_b64_tr_b16 v[134:135], v109 offset:59536
    s_add_u32 m0, s34, 65920
    s_add_u32 s39, s38, 2621440
    buffer_load_dwordx4 v105, s[16:19], s39 offen offset:256 lds
    v_mfma_f32_32x32x16_bf16 a[144:159], v[148:151], v[32:35], a[144:159]
    s_waitcnt lgkmcnt(6)
    v_mfma_f32_32x32x16_bf16 a[32:47], v[152:155], v[24:27], a[32:47]
    ds_read_b64_tr_b16 v[136:137], v109 offset:58752
    ds_read_b64_tr_b16 v[138:139], v109 offset:59792
    s_add_u32 m0, s34, 58896
    s_add_u32 s39, s38, 2654208
    buffer_load_dwordx4 v105, s[16:19], s39 offen lds
    v_mfma_f32_32x32x16_bf16 a[160:175], v[152:155], v[32:35], a[160:175]
    s_waitcnt lgkmcnt(6)
    v_mfma_f32_32x32x16_bf16 a[48:63], v[156:159], v[24:27], a[48:63]
    ds_read_b64_tr_b16 v[140:141], v109 offset:59008
    ds_read_b64_tr_b16 v[142:143], v109 offset:60048
    s_add_u32 m0, s34, 66960
    s_add_u32 s39, s38, 2654208
    buffer_load_dwordx4 v105, s[16:19], s39 offen offset:256 lds
    v_mfma_f32_32x32x16_bf16 a[176:191], v[156:159], v[32:35], a[176:191]
    s_waitcnt lgkmcnt(6)
    v_mfma_f32_32x32x16_bf16 a[64:79], v[128:131], v[24:27], a[64:79]
    ds_read_b64_tr_b16 v[144:145], v110 offset:49920
    ds_read_b64_tr_b16 v[146:147], v110 offset:50960
    v_mfma_f32_32x32x16_bf16 a[192:207], v[128:131], v[32:35], a[192:207]
    s_waitcnt lgkmcnt(6)
    v_mfma_f32_32x32x16_bf16 a[80:95], v[132:135], v[24:27], a[80:95]
    ds_read_b64_tr_b16 v[148:149], v110 offset:50176
    ds_read_b64_tr_b16 v[150:151], v110 offset:51216
    v_mfma_f32_32x32x16_bf16 a[208:223], v[132:135], v[32:35], a[208:223]
    s_waitcnt lgkmcnt(6)
    v_mfma_f32_32x32x16_bf16 a[96:111], v[136:139], v[24:27], a[96:111]
    ds_read_b64_tr_b16 v[152:153], v109 offset:54080
    ds_read_b64_tr_b16 v[154:155], v109 offset:55120
    v_mfma_f32_32x32x16_bf16 a[224:239], v[136:139], v[32:35], a[224:239]
    s_waitcnt lgkmcnt(6)
    v_mfma_f32_32x32x16_bf16 a[112:127], v[140:143], v[24:27], a[112:127]
    ds_read_b64_tr_b16 v[156:157], v109 offset:54336
    ds_read_b64_tr_b16 v[158:159], v109 offset:55376
    v_mfma_f32_32x32x16_bf16 a[240:255], v[140:143], v[32:35], a[240:255]
    s_waitcnt lgkmcnt(6)
    v_mfma_f32_32x32x16_bf16 v[192:207], v[144:147], v[40:43], v[192:207]
    ds_read_b64_tr_b16 v[128:129], v109 offset:54592
    ds_read_b64_tr_b16 v[130:131], v109 offset:55632
    s_waitcnt lgkmcnt(6)
    v_mfma_f32_32x32x16_bf16 v[208:223], v[148:151], v[40:43], v[208:223]
    ds_read_b64_tr_b16 v[132:133], v109 offset:54848
    ds_read_b64_tr_b16 v[134:135], v109 offset:55888
    s_waitcnt lgkmcnt(6)
    v_mfma_f32_32x32x16_bf16 a[0:15], v[152:155], v[28:31], a[0:15]
    ds_read_b64_tr_b16 v[136:137], v109 offset:62400
    ds_read_b64_tr_b16 v[138:139], v109 offset:63440
    v_mfma_f32_32x32x16_bf16 a[128:143], v[152:155], v[36:39], a[128:143]
    s_waitcnt lgkmcnt(6)
    v_mfma_f32_32x32x16_bf16 a[16:31], v[156:159], v[28:31], a[16:31]
    ds_read_b64_tr_b16 v[140:141], v109 offset:62656
    ds_read_b64_tr_b16 v[142:143], v109 offset:63696
    v_mfma_f32_32x32x16_bf16 a[144:159], v[156:159], v[36:39], a[144:159]
    s_waitcnt lgkmcnt(6)
    v_mfma_f32_32x32x16_bf16 a[32:47], v[128:131], v[28:31], a[32:47]
    ds_read_b64_tr_b16 v[144:145], v109 offset:62912
    ds_read_b64_tr_b16 v[146:147], v109 offset:63952
    v_mfma_f32_32x32x16_bf16 a[160:175], v[128:131], v[36:39], a[160:175]
    s_waitcnt lgkmcnt(6)
    v_mfma_f32_32x32x16_bf16 a[48:63], v[132:135], v[28:31], a[48:63]
    ds_read_b64_tr_b16 v[148:149], v109 offset:63168
    ds_read_b64_tr_b16 v[150:151], v109 offset:64208
    v_mfma_f32_32x32x16_bf16 a[176:191], v[132:135], v[36:39], a[176:191]
    s_waitcnt lgkmcnt(6)
    v_mfma_f32_32x32x16_bf16 a[64:79], v[136:139], v[28:31], a[64:79]
    ds_read_b64_tr_b16 v[152:153], v110 offset:54080
    ds_read_b64_tr_b16 v[154:155], v110 offset:55120
    v_mfma_f32_32x32x16_bf16 a[192:207], v[136:139], v[36:39], a[192:207]
    s_waitcnt lgkmcnt(6)
    v_mfma_f32_32x32x16_bf16 a[80:95], v[140:143], v[28:31], a[80:95]
    ds_read_b64_tr_b16 v[156:157], v110 offset:54336
    ds_read_b64_tr_b16 v[158:159], v110 offset:55376
    v_mfma_f32_32x32x16_bf16 a[208:223], v[140:143], v[36:39], a[208:223]
    s_waitcnt lgkmcnt(6)
    v_mfma_f32_32x32x16_bf16 a[96:111], v[144:147], v[28:31], a[96:111]
    s_waitcnt vmcnt(16)
    s_waitcnt vmcnt(4)
    s_waitcnt lgkmcnt(0)
    s_barrier
    ds_read_b64_tr_b16 v[128:129], v109
    ds_read_b64_tr_b16 v[130:131], v109 offset:1040
    v_mfma_f32_32x32x16_bf16 a[224:239], v[144:147], v[36:39], a[224:239]
    ds_read_b128 v[0:3], v116
    ds_read_b128 v[8:11], v116 offset:4096
    v_mfma_f32_32x32x16_bf16 a[112:127], v[148:151], v[28:31], a[112:127]
    ds_read_b64_tr_b16 v[132:133], v109 offset:256
    ds_read_b64_tr_b16 v[134:135], v109 offset:1296
    ds_read_b128 v[16:19], v120 offset:16384
    ds_read_b128 v[4:7], v117
    v_mfma_f32_32x32x16_bf16 a[240:255], v[148:151], v[36:39], a[240:255]
    ds_read_b128 v[12:15], v117 offset:4096
    ds_read_b128 v[20:23], v121 offset:16384
    v_mfma_f32_32x32x16_bf16 v[192:207], v[152:155], v[44:47], v[192:207]
    ds_read_b64_tr_b16 v[136:137], v109 offset:512
    ds_read_b64_tr_b16 v[138:139], v109 offset:1552
    v_mfma_f32_32x32x16_bf16 v[208:223], v[156:159], v[44:47], v[208:223]
    ds_read_b64_tr_b16 v[140:141], v109 offset:768
    ds_read_b64_tr_b16 v[142:143], v109 offset:1808
    s_waitcnt lgkmcnt(11)
    v_mfma_f32_32x32x16_bf16 a[0:15], v[128:131], v[0:3], a[0:15]
    ds_read_b64_tr_b16 v[144:145], v109 offset:8320
    ds_read_b64_tr_b16 v[146:147], v109 offset:9360
    s_add_u32 m0, s34, 74496
    s_add_u32 s39, s38, 2883584
    buffer_load_dwordx4 v105, s[16:19], s39 offen lds
    s_waitcnt lgkmcnt(12)
    v_mfma_f32_32x32x16_bf16 a[128:143], v[128:131], v[8:11], a[128:143]
    s_waitcnt lgkmcnt(10)
    v_mfma_f32_32x32x16_bf16 a[16:31], v[132:135], v[0:3], a[16:31]
    ds_read_b64_tr_b16 v[148:149], v109 offset:8576
    ds_read_b64_tr_b16 v[150:151], v109 offset:9616
    s_add_u32 m0, s34, 82560
    s_add_u32 s39, s38, 2883584
    buffer_load_dwordx4 v105, s[16:19], s39 offen offset:256 lds
    v_mfma_f32_32x32x16_bf16 a[144:159], v[132:135], v[8:11], a[144:159]
    s_waitcnt lgkmcnt(6)
    v_mfma_f32_32x32x16_bf16 a[32:47], v[136:139], v[0:3], a[32:47]
    ds_read_b64_tr_b16 v[152:153], v109 offset:8832
    ds_read_b64_tr_b16 v[154:155], v109 offset:9872
    s_add_u32 m0, s34, 75536
    s_add_u32 s39, s38, 2916352
    buffer_load_dwordx4 v105, s[16:19], s39 offen lds
    v_mfma_f32_32x32x16_bf16 a[160:175], v[136:139], v[8:11], a[160:175]
    s_waitcnt lgkmcnt(6)
    v_mfma_f32_32x32x16_bf16 a[48:63], v[140:143], v[0:3], a[48:63]
    ds_read_b64_tr_b16 v[156:157], v109 offset:9088
    ds_read_b64_tr_b16 v[158:159], v109 offset:10128
    s_add_u32 m0, s34, 83600
    s_add_u32 s39, s38, 2916352
    buffer_load_dwordx4 v105, s[16:19], s39 offen offset:256 lds
    v_mfma_f32_32x32x16_bf16 a[176:191], v[140:143], v[8:11], a[176:191]
    s_waitcnt lgkmcnt(6)
    v_mfma_f32_32x32x16_bf16 a[64:79], v[144:147], v[0:3], a[64:79]
    ds_read_b64_tr_b16 v[128:129], v110
    ds_read_b64_tr_b16 v[130:131], v110 offset:1040
    s_add_u32 m0, s37, 33280
    s_add_u32 s39, s35, 640
    buffer_load_dwordx4 v106, s[20:23], s39 offen lds
    v_mfma_f32_32x32x16_bf16 a[192:207], v[144:147], v[8:11], a[192:207]
    s_waitcnt lgkmcnt(6)
    v_mfma_f32_32x32x16_bf16 a[80:95], v[148:151], v[0:3], a[80:95]
    ds_read_b64_tr_b16 v[132:133], v110 offset:256
    ds_read_b64_tr_b16 v[134:135], v110 offset:1296
    s_add_u32 m0, s37, 34304
    s_add_u32 s39, s35, 7808
    buffer_load_dwordx4 v107, s[20:23], s39 offen lds
    v_mfma_f32_32x32x16_bf16 a[208:223], v[148:151], v[8:11], a[208:223]
    s_waitcnt lgkmcnt(6)
    v_mfma_f32_32x32x16_bf16 a[96:111], v[152:155], v[0:3], a[96:111]
    ds_read_b64_tr_b16 v[136:137], v109 offset:4160
    ds_read_b64_tr_b16 v[138:139], v109 offset:5200
    s_add_u32 m0, s37, 35328
    s_add_u32 s39, s35, 14976
    buffer_load_dwordx4 v106, s[20:23], s39 offen lds
    v_mfma_f32_32x32x16_bf16 a[224:239], v[152:155], v[8:11], a[224:239]
    s_waitcnt lgkmcnt(6)
    v_mfma_f32_32x32x16_bf16 a[112:127], v[156:159], v[0:3], a[112:127]
    ds_read_b64_tr_b16 v[140:141], v109 offset:4416
    ds_read_b64_tr_b16 v[142:143], v109 offset:5456
    s_add_u32 m0, s37, 36352
    s_add_u32 s39, s35, 22144
    buffer_load_dwordx4 v107, s[20:23], s39 offen lds
    v_mfma_f32_32x32x16_bf16 a[240:255], v[156:159], v[8:11], a[240:255]
    s_waitcnt lgkmcnt(6)
    v_mfma_f32_32x32x16_bf16 v[192:207], v[128:131], v[16:19], v[192:207]
    ds_read_b64_tr_b16 v[144:145], v109 offset:4672
    ds_read_b64_tr_b16 v[146:147], v109 offset:5712
    s_add_u32 m0, s37, 37376
    s_add_u32 s39, s35, 29312
    buffer_load_dwordx4 v106, s[20:23], s39 offen lds
    s_waitcnt lgkmcnt(6)
    v_mfma_f32_32x32x16_bf16 v[208:223], v[132:135], v[16:19], v[208:223]
    ds_read_b64_tr_b16 v[148:149], v109 offset:4928
    ds_read_b64_tr_b16 v[150:151], v109 offset:5968
    s_waitcnt lgkmcnt(6)
    v_mfma_f32_32x32x16_bf16 a[0:15], v[136:139], v[4:7], a[0:15]
    ds_read_b64_tr_b16 v[152:153], v109 offset:12480
    ds_read_b64_tr_b16 v[154:155], v109 offset:13520
    s_add_u32 m0, s37, 38400
    s_add_u32 s39, s35, 36480
    buffer_load_dwordx4 v107, s[20:23], s39 offen lds
    v_mfma_f32_32x32x16_bf16 a[128:143], v[136:139], v[12:15], a[128:143]
    s_waitcnt lgkmcnt(6)
    v_mfma_f32_32x32x16_bf16 a[16:31], v[140:143], v[4:7], a[16:31]
    ds_read_b64_tr_b16 v[156:157], v109 offset:12736
    ds_read_b64_tr_b16 v[158:159], v109 offset:13776
    s_add_u32 m0, s37, 39424
    s_add_u32 s39, s35, 43648
    buffer_load_dwordx4 v106, s[20:23], s39 offen lds
    v_mfma_f32_32x32x16_bf16 a[144:159], v[140:143], v[12:15], a[144:159]
    s_waitcnt lgkmcnt(6)
    v_mfma_f32_32x32x16_bf16 a[32:47], v[144:147], v[4:7], a[32:47]
    ds_read_b64_tr_b16 v[128:129], v109 offset:12992
    ds_read_b64_tr_b16 v[130:131], v109 offset:14032
    s_add_u32 m0, s37, 40448
    s_add_u32 s39, s35, 50816
    buffer_load_dwordx4 v107, s[20:23], s39 offen lds
    v_mfma_f32_32x32x16_bf16 a[160:175], v[144:147], v[12:15], a[160:175]
    s_waitcnt lgkmcnt(6)
    v_mfma_f32_32x32x16_bf16 a[48:63], v[148:151], v[4:7], a[48:63]
    ds_read_b64_tr_b16 v[132:133], v109 offset:13248
    ds_read_b64_tr_b16 v[134:135], v109 offset:14288
    v_mfma_f32_32x32x16_bf16 a[176:191], v[148:151], v[12:15], a[176:191]
    s_waitcnt lgkmcnt(6)
    v_mfma_f32_32x32x16_bf16 a[64:79], v[152:155], v[4:7], a[64:79]
    ds_read_b64_tr_b16 v[136:137], v110 offset:4160
    ds_read_b64_tr_b16 v[138:139], v110 offset:5200
    v_mfma_f32_32x32x16_bf16 a[192:207], v[152:155], v[12:15], a[192:207]
    s_waitcnt lgkmcnt(6)
    v_mfma_f32_32x32x16_bf16 a[80:95], v[156:159], v[4:7], a[80:95]
    ds_read_b64_tr_b16 v[140:141], v110 offset:4416
    ds_read_b64_tr_b16 v[142:143], v110 offset:5456
    v_mfma_f32_32x32x16_bf16 a[208:223], v[156:159], v[12:15], a[208:223]
    s_waitcnt lgkmcnt(6)
    v_mfma_f32_32x32x16_bf16 a[96:111], v[128:131], v[4:7], a[96:111]
    s_waitcnt lgkmcnt(0)
    s_barrier
    ds_read_b64_tr_b16 v[144:145], v109 offset:16640
    ds_read_b64_tr_b16 v[146:147], v109 offset:17680
    v_mfma_f32_32x32x16_bf16 a[224:239], v[128:131], v[12:15], a[224:239]
    ds_read_b128 v[24:27], v118
    ds_read_b128 v[32:35], v118 offset:4096
    v_mfma_f32_32x32x16_bf16 a[112:127], v[132:135], v[4:7], a[112:127]
    ds_read_b64_tr_b16 v[148:149], v109 offset:16896
    ds_read_b64_tr_b16 v[150:151], v109 offset:17936
    ds_read_b128 v[40:43], v122 offset:16384
    ds_read_b128 v[28:31], v119
    v_mfma_f32_32x32x16_bf16 a[240:255], v[132:135], v[12:15], a[240:255]
    ds_read_b128 v[36:39], v119 offset:4096
    ds_read_b128 v[44:47], v123 offset:16384
    v_mfma_f32_32x32x16_bf16 v[192:207], v[136:139], v[20:23], v[192:207]
    ds_read_b64_tr_b16 v[152:153], v109 offset:17152
    ds_read_b64_tr_b16 v[154:155], v109 offset:18192
    v_mfma_f32_32x32x16_bf16 v[208:223], v[140:143], v[20:23], v[208:223]
    ds_read_b64_tr_b16 v[156:157], v109 offset:17408
    ds_read_b64_tr_b16 v[158:159], v109 offset:18448
    s_waitcnt lgkmcnt(11)
    v_mfma_f32_32x32x16_bf16 a[0:15], v[144:147], v[24:27], a[0:15]
    ds_read_b64_tr_b16 v[128:129], v109 offset:24960
    ds_read_b64_tr_b16 v[130:131], v109 offset:26000
    s_add_u32 m0, s34, 24576
    s_add_u32 s39, s38, 3145728
    buffer_load_dwordx4 v105, s[16:19], s39 offen lds
    s_waitcnt lgkmcnt(12)
    v_mfma_f32_32x32x16_bf16 a[128:143], v[144:147], v[32:35], a[128:143]
    s_waitcnt lgkmcnt(10)
    v_mfma_f32_32x32x16_bf16 a[16:31], v[148:151], v[24:27], a[16:31]
    ds_read_b64_tr_b16 v[132:133], v109 offset:25216
    ds_read_b64_tr_b16 v[134:135], v109 offset:26256
    s_add_u32 m0, s34, 32640
    s_add_u32 s39, s38, 3145728
    buffer_load_dwordx4 v105, s[16:19], s39 offen offset:256 lds
    v_mfma_f32_32x32x16_bf16 a[144:159], v[148:151], v[32:35], a[144:159]
    s_waitcnt lgkmcnt(6)
    v_mfma_f32_32x32x16_bf16 a[32:47], v[152:155], v[24:27], a[32:47]
    ds_read_b64_tr_b16 v[136:137], v109 offset:25472
    ds_read_b64_tr_b16 v[138:139], v109 offset:26512
    s_add_u32 m0, s34, 25616
    s_add_u32 s39, s38, 3178496
    buffer_load_dwordx4 v105, s[16:19], s39 offen lds
    v_mfma_f32_32x32x16_bf16 a[160:175], v[152:155], v[32:35], a[160:175]
    s_waitcnt lgkmcnt(6)
    v_mfma_f32_32x32x16_bf16 a[48:63], v[156:159], v[24:27], a[48:63]
    ds_read_b64_tr_b16 v[140:141], v109 offset:25728
    ds_read_b64_tr_b16 v[142:143], v109 offset:26768
    s_add_u32 m0, s34, 33680
    s_add_u32 s39, s38, 3178496
    buffer_load_dwordx4 v105, s[16:19], s39 offen offset:256 lds
    v_mfma_f32_32x32x16_bf16 a[176:191], v[156:159], v[32:35], a[176:191]
    s_waitcnt lgkmcnt(6)
    v_mfma_f32_32x32x16_bf16 a[64:79], v[128:131], v[24:27], a[64:79]
    ds_read_b64_tr_b16 v[144:145], v110 offset:16640
    ds_read_b64_tr_b16 v[146:147], v110 offset:17680
    v_mfma_f32_32x32x16_bf16 a[192:207], v[128:131], v[32:35], a[192:207]
    s_waitcnt lgkmcnt(6)
    v_mfma_f32_32x32x16_bf16 a[80:95], v[132:135], v[24:27], a[80:95]
    ds_read_b64_tr_b16 v[148:149], v110 offset:16896
    ds_read_b64_tr_b16 v[150:151], v110 offset:17936
    v_mfma_f32_32x32x16_bf16 a[208:223], v[132:135], v[32:35], a[208:223]
    s_waitcnt lgkmcnt(6)
    v_mfma_f32_32x32x16_bf16 a[96:111], v[136:139], v[24:27], a[96:111]
    ds_read_b64_tr_b16 v[152:153], v109 offset:20800
    ds_read_b64_tr_b16 v[154:155], v109 offset:21840
    v_mfma_f32_32x32x16_bf16 a[224:239], v[136:139], v[32:35], a[224:239]
    s_waitcnt lgkmcnt(6)
    v_mfma_f32_32x32x16_bf16 a[112:127], v[140:143], v[24:27], a[112:127]
    ds_read_b64_tr_b16 v[156:157], v109 offset:21056
    ds_read_b64_tr_b16 v[158:159], v109 offset:22096
    v_mfma_f32_32x32x16_bf16 a[240:255], v[140:143], v[32:35], a[240:255]
    s_waitcnt lgkmcnt(6)
    v_mfma_f32_32x32x16_bf16 v[192:207], v[144:147], v[40:43], v[192:207]
    ds_read_b64_tr_b16 v[128:129], v109 offset:21312
    ds_read_b64_tr_b16 v[130:131], v109 offset:22352
    s_waitcnt lgkmcnt(6)
    v_mfma_f32_32x32x16_bf16 v[208:223], v[148:151], v[40:43], v[208:223]
    ds_read_b64_tr_b16 v[132:133], v109 offset:21568
    ds_read_b64_tr_b16 v[134:135], v109 offset:22608
    s_waitcnt lgkmcnt(6)
    v_mfma_f32_32x32x16_bf16 a[0:15], v[152:155], v[28:31], a[0:15]
    ds_read_b64_tr_b16 v[136:137], v109 offset:29120
    ds_read_b64_tr_b16 v[138:139], v109 offset:30160
    v_mfma_f32_32x32x16_bf16 a[128:143], v[152:155], v[36:39], a[128:143]
    s_waitcnt lgkmcnt(6)
    v_mfma_f32_32x32x16_bf16 a[16:31], v[156:159], v[28:31], a[16:31]
    ds_read_b64_tr_b16 v[140:141], v109 offset:29376
    ds_read_b64_tr_b16 v[142:143], v109 offset:30416
    v_mfma_f32_32x32x16_bf16 a[144:159], v[156:159], v[36:39], a[144:159]
    s_waitcnt lgkmcnt(6)
    v_mfma_f32_32x32x16_bf16 a[32:47], v[128:131], v[28:31], a[32:47]
    ds_read_b64_tr_b16 v[144:145], v109 offset:29632
    ds_read_b64_tr_b16 v[146:147], v109 offset:30672
    v_mfma_f32_32x32x16_bf16 a[160:175], v[128:131], v[36:39], a[160:175]
    s_waitcnt lgkmcnt(6)
    v_mfma_f32_32x32x16_bf16 a[48:63], v[132:135], v[28:31], a[48:63]
    ds_read_b64_tr_b16 v[148:149], v109 offset:29888
    ds_read_b64_tr_b16 v[150:151], v109 offset:30928
    v_mfma_f32_32x32x16_bf16 a[176:191], v[132:135], v[36:39], a[176:191]
    s_waitcnt lgkmcnt(6)
    v_mfma_f32_32x32x16_bf16 a[64:79], v[136:139], v[28:31], a[64:79]
    ds_read_b64_tr_b16 v[152:153], v110 offset:20800
    ds_read_b64_tr_b16 v[154:155], v110 offset:21840
    v_mfma_f32_32x32x16_bf16 a[192:207], v[136:139], v[36:39], a[192:207]
    s_waitcnt lgkmcnt(6)
    v_mfma_f32_32x32x16_bf16 a[80:95], v[140:143], v[28:31], a[80:95]
    ds_read_b64_tr_b16 v[156:157], v110 offset:21056
    ds_read_b64_tr_b16 v[158:159], v110 offset:22096
    v_mfma_f32_32x32x16_bf16 a[208:223], v[140:143], v[36:39], a[208:223]
    s_waitcnt lgkmcnt(6)
    v_mfma_f32_32x32x16_bf16 a[96:111], v[144:147], v[28:31], a[96:111]
    s_waitcnt vmcnt(16)
    s_waitcnt vmcnt(4)
    s_waitcnt lgkmcnt(0)
    s_barrier
    ds_read_b64_tr_b16 v[128:129], v109 offset:33280
    ds_read_b64_tr_b16 v[130:131], v109 offset:34320
    v_mfma_f32_32x32x16_bf16 a[224:239], v[144:147], v[36:39], a[224:239]
    ds_read_b128 v[0:3], v116 offset:33280
    ds_read_b128 v[8:11], v116 offset:37376
    v_mfma_f32_32x32x16_bf16 a[112:127], v[148:151], v[28:31], a[112:127]
    ds_read_b64_tr_b16 v[132:133], v109 offset:33536
    ds_read_b64_tr_b16 v[134:135], v109 offset:34576
    ds_read_b128 v[16:19], v120 offset:20480
    ds_read_b128 v[4:7], v117 offset:33280
    v_mfma_f32_32x32x16_bf16 a[240:255], v[148:151], v[36:39], a[240:255]
    ds_read_b128 v[12:15], v117 offset:37376
    ds_read_b128 v[20:23], v121 offset:20480
    v_mfma_f32_32x32x16_bf16 v[192:207], v[152:155], v[44:47], v[192:207]
    ds_read_b64_tr_b16 v[136:137], v109 offset:33792
    ds_read_b64_tr_b16 v[138:139], v109 offset:34832
    v_mfma_f32_32x32x16_bf16 v[208:223], v[156:159], v[44:47], v[208:223]
    ds_read_b64_tr_b16 v[140:141], v109 offset:34048
    ds_read_b64_tr_b16 v[142:143], v109 offset:35088
    s_waitcnt lgkmcnt(11)
    v_mfma_f32_32x32x16_bf16 a[0:15], v[128:131], v[0:3], a[0:15]
    ds_read_b64_tr_b16 v[144:145], v109 offset:41600
    ds_read_b64_tr_b16 v[146:147], v109 offset:42640
    s_add_u32 m0, s34, 41216
    s_add_u32 s39, s38, 3407872
    buffer_load_dwordx4 v105, s[16:19], s39 offen lds
    s_waitcnt lgkmcnt(12)
    v_mfma_f32_32x32x16_bf16 a[128:143], v[128:131], v[8:11], a[128:143]
    s_waitcnt lgkmcnt(10)
    v_mfma_f32_32x32x16_bf16 a[16:31], v[132:135], v[0:3], a[16:31]
    ds_read_b64_tr_b16 v[148:149], v109 offset:41856
    ds_read_b64_tr_b16 v[150:151], v109 offset:42896
    s_add_u32 m0, s34, 49280
    s_add_u32 s39, s38, 3407872
    buffer_load_dwordx4 v105, s[16:19], s39 offen offset:256 lds
    v_mfma_f32_32x32x16_bf16 a[144:159], v[132:135], v[8:11], a[144:159]
    s_waitcnt lgkmcnt(6)
    v_mfma_f32_32x32x16_bf16 a[32:47], v[136:139], v[0:3], a[32:47]
    ds_read_b64_tr_b16 v[152:153], v109 offset:42112
    ds_read_b64_tr_b16 v[154:155], v109 offset:43152
    s_add_u32 m0, s34, 42256
    s_add_u32 s39, s38, 3440640
    buffer_load_dwordx4 v105, s[16:19], s39 offen lds
    v_mfma_f32_32x32x16_bf16 a[160:175], v[136:139], v[8:11], a[160:175]
    s_waitcnt lgkmcnt(6)
    v_mfma_f32_32x32x16_bf16 a[48:63], v[140:143], v[0:3], a[48:63]
    ds_read_b64_tr_b16 v[156:157], v109 offset:42368
    ds_read_b64_tr_b16 v[158:159], v109 offset:43408
    s_add_u32 m0, s34, 50320
    s_add_u32 s39, s38, 3440640
    buffer_load_dwordx4 v105, s[16:19], s39 offen offset:256 lds
    v_mfma_f32_32x32x16_bf16 a[176:191], v[140:143], v[8:11], a[176:191]
    s_waitcnt lgkmcnt(6)
    v_mfma_f32_32x32x16_bf16 a[64:79], v[144:147], v[0:3], a[64:79]
    ds_read_b64_tr_b16 v[128:129], v110 offset:33280
    ds_read_b64_tr_b16 v[130:131], v110 offset:34320
    s_add_u32 m0, s37, 0
    s_add_u32 s39, s35, 768
    buffer_load_dwordx4 v106, s[20:23], s39 offen lds
    v_mfma_f32_32x32x16_bf16 a[192:207], v[144:147], v[8:11], a[192:207]
    s_waitcnt lgkmcnt(6)
    v_mfma_f32_32x32x16_bf16 a[80:95], v[148:151], v[0:3], a[80:95]
    ds_read_b64_tr_b16 v[132:133], v110 offset:33536
    ds_read_b64_tr_b16 v[134:135], v110 offset:34576
    s_add_u32 m0, s37, 1024
    s_add_u32 s39, s35, 7936
    buffer_load_dwordx4 v107, s[20:23], s39 offen lds
    v_mfma_f32_32x32x16_bf16 a[208:223], v[148:151], v[8:11], a[208:223]
    s_waitcnt lgkmcnt(6)
    v_mfma_f32_32x32x16_bf16 a[96:111], v[152:155], v[0:3], a[96:111]
    ds_read_b64_tr_b16 v[136:137], v109 offset:37440
    ds_read_b64_tr_b16 v[138:139], v109 offset:38480
    s_add_u32 m0, s37, 2048
    s_add_u32 s39, s35, 15104
    buffer_load_dwordx4 v106, s[20:23], s39 offen lds
    v_mfma_f32_32x32x16_bf16 a[224:239], v[152:155], v[8:11], a[224:239]
    s_waitcnt lgkmcnt(6)
    v_mfma_f32_32x32x16_bf16 a[112:127], v[156:159], v[0:3], a[112:127]
    ds_read_b64_tr_b16 v[140:141], v109 offset:37696
    ds_read_b64_tr_b16 v[142:143], v109 offset:38736
    s_add_u32 m0, s37, 3072
    s_add_u32 s39, s35, 22272
    buffer_load_dwordx4 v107, s[20:23], s39 offen lds
    v_mfma_f32_32x32x16_bf16 a[240:255], v[156:159], v[8:11], a[240:255]
    s_waitcnt lgkmcnt(6)
    v_mfma_f32_32x32x16_bf16 v[192:207], v[128:131], v[16:19], v[192:207]
    ds_read_b64_tr_b16 v[144:145], v109 offset:37952
    ds_read_b64_tr_b16 v[146:147], v109 offset:38992
    s_add_u32 m0, s37, 4096
    s_add_u32 s39, s35, 29440
    buffer_load_dwordx4 v106, s[20:23], s39 offen lds
    s_waitcnt lgkmcnt(6)
    v_mfma_f32_32x32x16_bf16 v[208:223], v[132:135], v[16:19], v[208:223]
    ds_read_b64_tr_b16 v[148:149], v109 offset:38208
    ds_read_b64_tr_b16 v[150:151], v109 offset:39248
    s_waitcnt lgkmcnt(6)
    v_mfma_f32_32x32x16_bf16 a[0:15], v[136:139], v[4:7], a[0:15]
    ds_read_b64_tr_b16 v[152:153], v109 offset:45760
    ds_read_b64_tr_b16 v[154:155], v109 offset:46800
    s_add_u32 m0, s37, 5120
    s_add_u32 s39, s35, 36608
    buffer_load_dwordx4 v107, s[20:23], s39 offen lds
    v_mfma_f32_32x32x16_bf16 a[128:143], v[136:139], v[12:15], a[128:143]
    s_waitcnt lgkmcnt(6)
    v_mfma_f32_32x32x16_bf16 a[16:31], v[140:143], v[4:7], a[16:31]
    ds_read_b64_tr_b16 v[156:157], v109 offset:46016
    ds_read_b64_tr_b16 v[158:159], v109 offset:47056
    s_add_u32 m0, s37, 6144
    s_add_u32 s39, s35, 43776
    buffer_load_dwordx4 v106, s[20:23], s39 offen lds
    v_mfma_f32_32x32x16_bf16 a[144:159], v[140:143], v[12:15], a[144:159]
    s_waitcnt lgkmcnt(6)
    v_mfma_f32_32x32x16_bf16 a[32:47], v[144:147], v[4:7], a[32:47]
    ds_read_b64_tr_b16 v[128:129], v109 offset:46272
    ds_read_b64_tr_b16 v[130:131], v109 offset:47312
    s_add_u32 m0, s37, 7168
    s_add_u32 s39, s35, 50944
    buffer_load_dwordx4 v107, s[20:23], s39 offen lds
    v_mfma_f32_32x32x16_bf16 a[160:175], v[144:147], v[12:15], a[160:175]
    s_waitcnt lgkmcnt(6)
    v_mfma_f32_32x32x16_bf16 a[48:63], v[148:151], v[4:7], a[48:63]
    ds_read_b64_tr_b16 v[132:133], v109 offset:46528
    ds_read_b64_tr_b16 v[134:135], v109 offset:47568
    v_mfma_f32_32x32x16_bf16 a[176:191], v[148:151], v[12:15], a[176:191]
    s_waitcnt lgkmcnt(6)
    v_mfma_f32_32x32x16_bf16 a[64:79], v[152:155], v[4:7], a[64:79]
    ds_read_b64_tr_b16 v[136:137], v110 offset:37440
    ds_read_b64_tr_b16 v[138:139], v110 offset:38480
    v_mfma_f32_32x32x16_bf16 a[192:207], v[152:155], v[12:15], a[192:207]
    s_waitcnt lgkmcnt(6)
    v_mfma_f32_32x32x16_bf16 a[80:95], v[156:159], v[4:7], a[80:95]
    ds_read_b64_tr_b16 v[140:141], v110 offset:37696
    ds_read_b64_tr_b16 v[142:143], v110 offset:38736
    v_mfma_f32_32x32x16_bf16 a[208:223], v[156:159], v[12:15], a[208:223]
    s_waitcnt lgkmcnt(6)
    v_mfma_f32_32x32x16_bf16 a[96:111], v[128:131], v[4:7], a[96:111]
    s_waitcnt lgkmcnt(0)
    s_barrier
    ds_read_b64_tr_b16 v[144:145], v109 offset:49920
    ds_read_b64_tr_b16 v[146:147], v109 offset:50960
    v_mfma_f32_32x32x16_bf16 a[224:239], v[128:131], v[12:15], a[224:239]
    ds_read_b128 v[24:27], v118 offset:33280
    ds_read_b128 v[32:35], v118 offset:37376
    v_mfma_f32_32x32x16_bf16 a[112:127], v[132:135], v[4:7], a[112:127]
    ds_read_b64_tr_b16 v[148:149], v109 offset:50176
    ds_read_b64_tr_b16 v[150:151], v109 offset:51216
    ds_read_b128 v[40:43], v122 offset:20480
    ds_read_b128 v[28:31], v119 offset:33280
    v_mfma_f32_32x32x16_bf16 a[240:255], v[132:135], v[12:15], a[240:255]
    ds_read_b128 v[36:39], v119 offset:37376
    ds_read_b128 v[44:47], v123 offset:20480
    v_mfma_f32_32x32x16_bf16 v[192:207], v[136:139], v[20:23], v[192:207]
    ds_read_b64_tr_b16 v[152:153], v109 offset:50432
    ds_read_b64_tr_b16 v[154:155], v109 offset:51472
    v_mfma_f32_32x32x16_bf16 v[208:223], v[140:143], v[20:23], v[208:223]
    ds_read_b64_tr_b16 v[156:157], v109 offset:50688
    ds_read_b64_tr_b16 v[158:159], v109 offset:51728
    s_waitcnt lgkmcnt(11)
    v_mfma_f32_32x32x16_bf16 a[0:15], v[144:147], v[24:27], a[0:15]
    ds_read_b64_tr_b16 v[128:129], v109 offset:58240
    ds_read_b64_tr_b16 v[130:131], v109 offset:59280
    s_add_u32 m0, s34, 57856
    s_nop 0
    buffer_load_dwordx4 v249, s[8:11], s32 offen nt lds
    s_waitcnt lgkmcnt(12)
    v_mfma_f32_32x32x16_bf16 a[128:143], v[144:147], v[32:35], a[128:143]
    s_waitcnt lgkmcnt(10)
    v_mfma_f32_32x32x16_bf16 a[16:31], v[148:151], v[24:27], a[16:31]
    ds_read_b64_tr_b16 v[132:133], v109 offset:58496
    ds_read_b64_tr_b16 v[134:135], v109 offset:59536
    s_add_u32 m0, s34, 65920
    s_nop 0
    buffer_load_dwordx4 v249, s[8:11], s32 offen offset:256 nt lds
    v_mfma_f32_32x32x16_bf16 a[144:159], v[148:151], v[32:35], a[144:159]
    s_waitcnt lgkmcnt(6)
    v_mfma_f32_32x32x16_bf16 a[32:47], v[152:155], v[24:27], a[32:47]
    ds_read_b64_tr_b16 v[136:137], v109 offset:58752
    ds_read_b64_tr_b16 v[138:139], v109 offset:59792
    s_add_u32 m0, s34, 56848
    s_nop 0
    buffer_load_dwordx4 v249, s[8:11], s32 offen offset:2048 nt lds
    v_mfma_f32_32x32x16_bf16 a[160:175], v[152:155], v[32:35], a[160:175]
    s_waitcnt lgkmcnt(6)
    v_mfma_f32_32x32x16_bf16 a[48:63], v[156:159], v[24:27], a[48:63]
    ds_read_b64_tr_b16 v[140:141], v109 offset:59008
    ds_read_b64_tr_b16 v[142:143], v109 offset:60048
    s_add_u32 m0, s34, 64912
    s_nop 0
    buffer_load_dwordx4 v249, s[8:11], s32 offen offset:2304 nt lds
    v_mfma_f32_32x32x16_bf16 a[176:191], v[156:159], v[32:35], a[176:191]
    s_waitcnt lgkmcnt(6)
    v_mfma_f32_32x32x16_bf16 a[64:79], v[128:131], v[24:27], a[64:79]
    ds_read_b64_tr_b16 v[144:145], v110 offset:49920
    ds_read_b64_tr_b16 v[146:147], v110 offset:50960
    s_add_u32 s87, s87, 16384
    s_and_b32 s87, s87, 0x7ffff
    s_add_u32 s32, s86, s87
    v_mfma_f32_32x32x16_bf16 a[192:207], v[128:131], v[32:35], a[192:207]
    s_waitcnt lgkmcnt(6)
    v_mfma_f32_32x32x16_bf16 a[80:95], v[132:135], v[24:27], a[80:95]
    ds_read_b64_tr_b16 v[148:149], v110 offset:50176
    ds_read_b64_tr_b16 v[150:151], v110 offset:51216
    v_mfma_f32_32x32x16_bf16 a[208:223], v[132:135], v[32:35], a[208:223]
    s_waitcnt lgkmcnt(6)
    v_mfma_f32_32x32x16_bf16 a[96:111], v[136:139], v[24:27], a[96:111]
    ds_read_b64_tr_b16 v[152:153], v109 offset:54080
    ds_read_b64_tr_b16 v[154:155], v109 offset:55120
    v_mfma_f32_32x32x16_bf16 a[224:239], v[136:139], v[32:35], a[224:239]
    s_waitcnt lgkmcnt(6)
    v_mfma_f32_32x32x16_bf16 a[112:127], v[140:143], v[24:27], a[112:127]
    ds_read_b64_tr_b16 v[156:157], v109 offset:54336
    ds_read_b64_tr_b16 v[158:159], v109 offset:55376
    v_mfma_f32_32x32x16_bf16 a[240:255], v[140:143], v[32:35], a[240:255]
    s_waitcnt lgkmcnt(6)
    v_mfma_f32_32x32x16_bf16 v[192:207], v[144:147], v[40:43], v[192:207]
    ds_read_b64_tr_b16 v[128:129], v109 offset:54592
    ds_read_b64_tr_b16 v[130:131], v109 offset:55632
    s_waitcnt lgkmcnt(6)
    v_mfma_f32_32x32x16_bf16 v[208:223], v[148:151], v[40:43], v[208:223]
    ds_read_b64_tr_b16 v[132:133], v109 offset:54848
    ds_read_b64_tr_b16 v[134:135], v109 offset:55888
    s_waitcnt lgkmcnt(6)
    v_mfma_f32_32x32x16_bf16 a[0:15], v[152:155], v[28:31], a[0:15]
    ds_read_b64_tr_b16 v[136:137], v109 offset:62400
    ds_read_b64_tr_b16 v[138:139], v109 offset:63440
    v_mfma_f32_32x32x16_bf16 a[128:143], v[152:155], v[36:39], a[128:143]
    s_waitcnt lgkmcnt(6)
    v_mfma_f32_32x32x16_bf16 a[16:31], v[156:159], v[28:31], a[16:31]
    ds_read_b64_tr_b16 v[140:141], v109 offset:62656
    ds_read_b64_tr_b16 v[142:143], v109 offset:63696
    v_mfma_f32_32x32x16_bf16 a[144:159], v[156:159], v[36:39], a[144:159]
    s_waitcnt lgkmcnt(6)
    v_mfma_f32_32x32x16_bf16 a[32:47], v[128:131], v[28:31], a[32:47]
    ds_read_b64_tr_b16 v[144:145], v109 offset:62912
    ds_read_b64_tr_b16 v[146:147], v109 offset:63952
    v_mfma_f32_32x32x16_bf16 a[160:175], v[128:131], v[36:39], a[160:175]
    s_waitcnt lgkmcnt(6)
    v_mfma_f32_32x32x16_bf16 a[48:63], v[132:135], v[28:31], a[48:63]
    ds_read_b64_tr_b16 v[148:149], v109 offset:63168
    ds_read_b64_tr_b16 v[150:151], v109 offset:64208
    v_mfma_f32_32x32x16_bf16 a[176:191], v[132:135], v[36:39], a[176:191]
    s_waitcnt lgkmcnt(6)
    v_mfma_f32_32x32x16_bf16 a[64:79], v[136:139], v[28:31], a[64:79]
    ds_read_b64_tr_b16 v[152:153], v110 offset:54080
    ds_read_b64_tr_b16 v[154:155], v110 offset:55120
    v_mfma_f32_32x32x16_bf16 a[192:207], v[136:139], v[36:39], a[192:207]
    s_waitcnt lgkmcnt(6)
    v_mfma_f32_32x32x16_bf16 a[80:95], v[140:143], v[28:31], a[80:95]
    ds_read_b64_tr_b16 v[156:157], v110 offset:54336
    ds_read_b64_tr_b16 v[158:159], v110 offset:55376
    v_mfma_f32_32x32x16_bf16 a[208:223], v[140:143], v[36:39], a[208:223]
    s_waitcnt lgkmcnt(6)
    v_mfma_f32_32x32x16_bf16 a[96:111], v[144:147], v[28:31], a[96:111]
    s_waitcnt vmcnt(16)
    s_waitcnt vmcnt(4)
    s_waitcnt lgkmcnt(0)
    s_barrier
    ds_read_b64_tr_b16 v[128:129], v109
    ds_read_b64_tr_b16 v[130:131], v109 offset:1040
    v_mfma_f32_32x32x16_bf16 a[224:239], v[144:147], v[36:39], a[224:239]
    v_add_u32 v120, 157696, v120
    v_add_u32 v121, 157696, v121
    v_mfma_f32_32x32x16_bf16 a[112:127], v[148:151], v[28:31], a[112:127]
    ds_read_b64_tr_b16 v[132:133], v109 offset:256
    ds_read_b64_tr_b16 v[134:135], v109 offset:1296
    v_add_u32 v122, 157696, v122
    v_add_u32 v123, 157696, v123
    v_mfma_f32_32x32x16_bf16 a[240:255], v[148:151], v[36:39], a[240:255]
    ds_read_b128 v[0:3], v116
    ds_read_b128 v[8:11], v116 offset:4096
    v_mfma_f32_32x32x16_bf16 v[192:207], v[152:155], v[44:47], v[192:207]
    ds_read_b64_tr_b16 v[136:137], v109 offset:512
    ds_read_b64_tr_b16 v[138:139], v109 offset:1552
    ds_read_b128 v[16:19], v120
    ds_read_b128 v[4:7], v117
    v_mfma_f32_32x32x16_bf16 v[208:223], v[156:159], v[44:47], v[208:223]
    ds_read_b64_tr_b16 v[140:141], v109 offset:768
    ds_read_b64_tr_b16 v[142:143], v109 offset:1808
    ds_read_b128 v[12:15], v117 offset:4096
    ds_read_b128 v[20:23], v121
    s_waitcnt lgkmcnt(9)
    v_mfma_f32_32x32x16_bf16 a[0:15], v[128:131], v[0:3], a[0:15]
    ds_read_b64_tr_b16 v[144:145], v109 offset:8320
    ds_read_b64_tr_b16 v[146:147], v109 offset:9360
    s_add_u32 m0, s34, 74496
    s_nop 0
    buffer_load_dwordx4 v249, s[8:11], s32 offen nt lds
    s_waitcnt lgkmcnt(10)
    v_mfma_f32_32x32x16_bf16 a[128:143], v[128:131], v[8:11], a[128:143]
    v_mfma_f32_32x32x16_bf16 a[16:31], v[132:135], v[0:3], a[16:31]
    ds_read_b64_tr_b16 v[148:149], v109 offset:8576
    ds_read_b64_tr_b16 v[150:151], v109 offset:9616
    s_add_u32 m0, s34, 82560
    s_nop 0
    buffer_load_dwordx4 v249, s[8:11], s32 offen offset:256 nt lds
    v_mfma_f32_32x32x16_bf16 a[144:159], v[132:135], v[8:11], a[144:159]
    s_waitcnt lgkmcnt(10)
    v_mfma_f32_32x32x16_bf16 a[32:47], v[136:139], v[0:3], a[32:47]
    ds_read_b64_tr_b16 v[152:153], v109 offset:8832
    ds_read_b64_tr_b16 v[154:155], v109 offset:9872
    s_add_u32 m0, s34, 73488
    s_nop 0
    buffer_load_dwordx4 v249, s[8:11], s32 offen offset:2048 nt lds
    v_mfma_f32_32x32x16_bf16 a[160:175], v[136:139], v[8:11], a[160:175]
    s_waitcnt lgkmcnt(8)
    v_mfma_f32_32x32x16_bf16 a[48:63], v[140:143], v[0:3], a[48:63]
    ds_read_b64_tr_b16 v[156:157], v109 offset:9088
    ds_read_b64_tr_b16 v[158:159], v109 offset:10128
    s_add_u32 m0, s34, 81552
    s_nop 0
    buffer_load_dwordx4 v249, s[8:11], s32 offen offset:2304 nt lds
    v_mfma_f32_32x32x16_bf16 a[176:191], v[140:143], v[8:11], a[176:191]
    s_waitcnt lgkmcnt(6)
    v_mfma_f32_32x32x16_bf16 a[64:79], v[144:147], v[0:3], a[64:79]
    ds_read_b64_tr_b16 v[128:129], v110
    ds_read_b64_tr_b16 v[130:131], v110 offset:1040
    s_add_u32 s87, s87, 16384
    s_and_b32 s87, s87, 0x7ffff
    s_add_u32 s32, s86, s87
    v_mfma_f32_32x32x16_bf16 a[192:207], v[144:147], v[8:11], a[192:207]
    s_waitcnt lgkmcnt(6)
    v_mfma_f32_32x32x16_bf16 a[80:95], v[148:151], v[0:3], a[80:95]
    ds_read_b64_tr_b16 v[132:133], v110 offset:256
    ds_read_b64_tr_b16 v[134:135], v110 offset:1296
    s_add_u32 m0, s34, 124416
    s_nop 0
    buffer_load_dwordx4 v249, s[12:15], s33 offen nt lds
    v_mfma_f32_32x32x16_bf16 a[208:223], v[148:151], v[8:11], a[208:223]
    s_waitcnt lgkmcnt(6)
    v_mfma_f32_32x32x16_bf16 a[96:111], v[152:155], v[0:3], a[96:111]
    ds_read_b64_tr_b16 v[136:137], v109 offset:4160
    ds_read_b64_tr_b16 v[138:139], v109 offset:5200
    s_add_u32 m0, s34, 132480
    s_nop 0
    buffer_load_dwordx4 v249, s[12:15], s33 offen offset:256 nt lds
    v_mfma_f32_32x32x16_bf16 a[224:239], v[152:155], v[8:11], a[224:239]
    s_waitcnt lgkmcnt(6)
    v_mfma_f32_32x32x16_bf16 a[112:127], v[156:159], v[0:3], a[112:127]
    ds_read_b64_tr_b16 v[140:141], v109 offset:4416
    ds_read_b64_tr_b16 v[142:143], v109 offset:5456
    s_add_u32 m0, s34, 123408
    s_nop 0
    buffer_load_dwordx4 v249, s[12:15], s33 offen offset:2048 nt lds
    v_mfma_f32_32x32x16_bf16 a[240:255], v[156:159], v[8:11], a[240:255]
    s_waitcnt lgkmcnt(6)
    v_mfma_f32_32x32x16_bf16 v[192:207], v[128:131], v[16:19], v[192:207]
    ds_read_b64_tr_b16 v[144:145], v109 offset:4672
    ds_read_b64_tr_b16 v[146:147], v109 offset:5712
    s_add_u32 m0, s34, 131472
    s_nop 0
    buffer_load_dwordx4 v249, s[12:15], s33 offen offset:2304 nt lds
    s_waitcnt lgkmcnt(6)
    v_mfma_f32_32x32x16_bf16 v[208:223], v[132:135], v[16:19], v[208:223]
    ds_read_b64_tr_b16 v[148:149], v109 offset:4928
    ds_read_b64_tr_b16 v[150:151], v109 offset:5968
    s_waitcnt lgkmcnt(6)
    v_mfma_f32_32x32x16_bf16 a[0:15], v[136:139], v[4:7], a[0:15]
    ds_read_b64_tr_b16 v[152:153], v109 offset:12480
    ds_read_b64_tr_b16 v[154:155], v109 offset:13520
    s_add_u32 s88, s88, 16384
    s_and_b32 s88, s88, 0x7ffff
    s_add_u32 s33, s86, s88
    v_mfma_f32_32x32x16_bf16 a[128:143], v[136:139], v[12:15], a[128:143]
    s_waitcnt lgkmcnt(6)
    v_mfma_f32_32x32x16_bf16 a[16:31], v[140:143], v[4:7], a[16:31]
    ds_read_b64_tr_b16 v[156:157], v109 offset:12736
    ds_read_b64_tr_b16 v[158:159], v109 offset:13776
    v_mfma_f32_32x32x16_bf16 a[144:159], v[140:143], v[12:15], a[144:159]
    s_waitcnt lgkmcnt(6)
    v_mfma_f32_32x32x16_bf16 a[32:47], v[144:147], v[4:7], a[32:47]
    ds_read_b64_tr_b16 v[128:129], v109 offset:12992
    ds_read_b64_tr_b16 v[130:131], v109 offset:14032
    v_mfma_f32_32x32x16_bf16 a[160:175], v[144:147], v[12:15], a[160:175]
    s_waitcnt lgkmcnt(6)
    v_mfma_f32_32x32x16_bf16 a[48:63], v[148:151], v[4:7], a[48:63]
    ds_read_b64_tr_b16 v[132:133], v109 offset:13248
    ds_read_b64_tr_b16 v[134:135], v109 offset:14288
    v_mfma_f32_32x32x16_bf16 a[176:191], v[148:151], v[12:15], a[176:191]
    s_waitcnt lgkmcnt(6)
    v_mfma_f32_32x32x16_bf16 a[64:79], v[152:155], v[4:7], a[64:79]
    ds_read_b64_tr_b16 v[136:137], v110 offset:4160
    ds_read_b64_tr_b16 v[138:139], v110 offset:5200
    v_mfma_f32_32x32x16_bf16 a[192:207], v[152:155], v[12:15], a[192:207]
    s_waitcnt lgkmcnt(6)
    v_mfma_f32_32x32x16_bf16 a[80:95], v[156:159], v[4:7], a[80:95]
    ds_read_b64_tr_b16 v[140:141], v110 offset:4416
    ds_read_b64_tr_b16 v[142:143], v110 offset:5456
    v_mfma_f32_32x32x16_bf16 a[208:223], v[156:159], v[12:15], a[208:223]
    s_waitcnt lgkmcnt(6)
    v_mfma_f32_32x32x16_bf16 a[96:111], v[128:131], v[4:7], a[96:111]
    s_waitcnt lgkmcnt(0)
    s_barrier
    ds_read_b64_tr_b16 v[144:145], v110 offset:16640
    ds_read_b64_tr_b16 v[146:147], v110 offset:17680
    v_mfma_f32_32x32x16_bf16 a[224:239], v[128:131], v[12:15], a[224:239]
    ds_read_b128 v[24:27], v118
    ds_read_b128 v[32:35], v118 offset:4096
    v_mfma_f32_32x32x16_bf16 a[112:127], v[132:135], v[4:7], a[112:127]
    ds_read_b64_tr_b16 v[148:149], v110 offset:16896
    ds_read_b64_tr_b16 v[150:151], v110 offset:17936
    ds_read_b128 v[40:43], v122
    ds_read_b128 v[28:31], v119
    v_mfma_f32_32x32x16_bf16 a[240:255], v[132:135], v[12:15], a[240:255]
    ds_read_b128 v[36:39], v119 offset:4096
    ds_read_b128 v[44:47], v123
    v_mfma_f32_32x32x16_bf16 v[192:207], v[136:139], v[20:23], v[192:207]
    ds_read_b64_tr_b16 v[152:153], v110 offset:20800
    ds_read_b64_tr_b16 v[154:155], v110 offset:21840
    v_mfma_f32_32x32x16_bf16 v[208:223], v[140:143], v[20:23], v[208:223]
    ds_read_b64_tr_b16 v[156:157], v110 offset:21056
    ds_read_b64_tr_b16 v[158:159], v110 offset:22096
    s_waitcnt lgkmcnt(7)
    v_mfma_f32_32x32x16_bf16 v[192:207], v[144:147], v[40:43], v[192:207]
    ds_read_b64_tr_b16 v[128:129], v109 offset:16640
    ds_read_b64_tr_b16 v[130:131], v109 offset:17680
    s_add_u32 m0, s34, 24576
    s_nop 0
    buffer_load_dwordx4 v249, s[8:11], s32 offen nt lds
    v_mfma_f32_32x32x16_bf16 v[208:223], v[148:151], v[40:43], v[208:223]
    ds_read_b64_tr_b16 v[132:133], v109 offset:16896
    ds_read_b64_tr_b16 v[134:135], v109 offset:17936
    s_waitcnt lgkmcnt(6)
    v_mfma_f32_32x32x16_bf16 v[192:207], v[152:155], v[44:47], v[192:207]
    ds_read_b64_tr_b16 v[136:137], v109 offset:17152
    ds_read_b64_tr_b16 v[138:139], v109 offset:18192
    s_add_u32 m0, s34, 32640
    s_nop 0
    buffer_load_dwordx4 v249, s[8:11], s32 offen offset:256 nt lds
    s_waitcnt lgkmcnt(6)
    v_mfma_f32_32x32x16_bf16 v[208:223], v[156:159], v[44:47], v[208:223]
    ds_read_b64_tr_b16 v[140:141], v109 offset:17408
    ds_read_b64_tr_b16 v[142:143], v109 offset:18448
    s_waitcnt lgkmcnt(6)
    v_mfma_f32_32x32x16_bf16 a[0:15], v[128:131], v[24:27], a[0:15]
    ds_read_b64_tr_b16 v[144:145], v109 offset:24960
    ds_read_b64_tr_b16 v[146:147], v109 offset:26000
    s_add_u32 m0, s34, 23568
    s_nop 0
    buffer_load_dwordx4 v249, s[8:11], s32 offen offset:2048 nt lds
    v_mfma_f32_32x32x16_bf16 a[128:143], v[128:131], v[32:35], a[128:143]
    s_waitcnt lgkmcnt(6)
    v_mfma_f32_32x32x16_bf16 a[16:31], v[132:135], v[24:27], a[16:31]
    ds_read_b64_tr_b16 v[148:149], v109 offset:25216
    ds_read_b64_tr_b16 v[150:151], v109 offset:26256
    s_add_u32 m0, s34, 31632
    s_nop 0
    buffer_load_dwordx4 v249, s[8:11], s32 offen offset:2304 nt lds
    v_mfma_f32_32x32x16_bf16 a[144:159], v[132:135], v[32:35], a[144:159]
    s_waitcnt lgkmcnt(6)
    v_mfma_f32_32x32x16_bf16 a[32:47], v[136:139], v[24:27], a[32:47]
    ds_read_b64_tr_b16 v[152:153], v109 offset:25472
    ds_read_b64_tr_b16 v[154:155], v109 offset:26512
    s_add_u32 s87, s87, 16384
    s_and_b32 s87, s87, 0x7ffff
    s_add_u32 s32, s86, s87
    v_cvt_pk_bf16_f32 v164, v192, v193
    v_cvt_pk_bf16_f32 v165, v194, v195
    v_cvt_pk_bf16_f32 v166, v196, v197
    v_mfma_f32_32x32x16_bf16 a[160:175], v[136:139], v[32:35], a[160:175]
    v_cvt_pk_bf16_f32 v167, v198, v199
    ds_write_b128 v115, v[164:167]
    s_waitcnt lgkmcnt(7)
    v_mfma_f32_32x32x16_bf16 a[48:63], v[140:143], v[24:27], a[48:63]
    ds_read_b64_tr_b16 v[156:157], v109 offset:25728
    ds_read_b64_tr_b16 v[158:159], v109 offset:26768
    s_add_u32 m0, s34, 141056
    s_nop 0
    buffer_load_dwordx4 v249, s[12:15], s33 offen nt lds
    v_cvt_pk_bf16_f32 v168, v200, v201
    v_cvt_pk_bf16_f32 v169, v202, v203
    v_cvt_pk_bf16_f32 v170, v204, v205
    v_mfma_f32_32x32x16_bf16 a[176:191], v[140:143], v[32:35], a[176:191]
    v_cvt_pk_bf16_f32 v171, v206, v207
    ds_write_b128 v115, v[168:171] offset:512
    s_waitcnt lgkmcnt(8)
    v_mfma_f32_32x32x16_bf16 a[64:79], v[144:147], v[24:27], a[64:79]
    ds_read_b64_tr_b16 v[128:129], v109 offset:20800
    ds_read_b64_tr_b16 v[130:131], v109 offset:21840
    s_add_u32 m0, s34, 149120
    s_nop 0
    buffer_load_dwordx4 v249, s[12:15], s33 offen offset:256 nt lds
    v_cvt_pk_bf16_f32 v172, v208, v209
    v_cvt_pk_bf16_f32 v173, v210, v211
    v_cvt_pk_bf16_f32 v174, v212, v213
    v_mfma_f32_32x32x16_bf16 a[192:207], v[144:147], v[32:35], a[192:207]
    v_cvt_pk_bf16_f32 v175, v214, v215
    ds_write_b128 v115, v[172:175] offset:1024
    s_waitcnt lgkmcnt(9)
    v_mfma_f32_32x32x16_bf16 a[80:95], v[148:151], v[24:27], a[80:95]
    ds_read_b64_tr_b16 v[132:133], v109 offset:21056
    ds_read_b64_tr_b16 v[134:135], v109 offset:22096
    s_add_u32 m0, s34, 140048
    s_nop 0
    buffer_load_dwordx4 v249, s[12:15], s33 offen offset:2048 nt lds
    v_cvt_pk_bf16_f32 v176, v216, v217
    v_cvt_pk_bf16_f32 v177, v218, v219
    v_cvt_pk_bf16_f32 v178, v220, v221
    v_mfma_f32_32x32x16_bf16 a[208:223], v[148:151], v[32:35], a[208:223]
    v_cvt_pk_bf16_f32 v179, v222, v223
    ds_write_b128 v115, v[176:179] offset:1536
    s_waitcnt lgkmcnt(10)
    v_mfma_f32_32x32x16_bf16 a[96:111], v[152:155], v[24:27], a[96:111]
    ds_read_b64_tr_b16 v[136:137], v109 offset:21312
    ds_read_b64_tr_b16 v[138:139], v109 offset:22352
    s_add_u32 m0, s34, 148112
    s_nop 0
    buffer_load_dwordx4 v249, s[12:15], s33 offen offset:2304 nt lds
    v_mov_b32 v192, 0
    v_mov_b32 v193, 0
    v_mfma_f32_32x32x16_bf16 a[224:239], v[152:155], v[32:35], a[224:239]
    v_mov_b32 v194, 0
    v_mov_b32 v195, 0
    v_mov_b32 v196, 0
    s_waitcnt lgkmcnt(9)
    v_mfma_f32_32x32x16_bf16 a[112:127], v[156:159], v[24:27], a[112:127]
    ds_read_b64_tr_b16 v[140:141], v109 offset:21568
    ds_read_b64_tr_b16 v[142:143], v109 offset:22608
    s_add_u32 s88, s88, 16384
    s_and_b32 s88, s88, 0x7ffff
    s_add_u32 s33, s86, s88
    v_mov_b32 v197, 0
    v_mov_b32 v198, 0
    v_mfma_f32_32x32x16_bf16 a[240:255], v[156:159], v[32:35], a[240:255]
    v_mov_b32 v199, 0
    v_mov_b32 v200, 0
    v_mov_b32 v201, 0
    s_waitcnt lgkmcnt(8)
    v_mfma_f32_32x32x16_bf16 a[0:15], v[128:131], v[28:31], a[0:15]
    ds_read_b64_tr_b16 v[144:145], v109 offset:29120
    ds_read_b64_tr_b16 v[146:147], v109 offset:30160
    v_mov_b32 v202, 0
    v_mov_b32 v203, 0
    v_mfma_f32_32x32x16_bf16 a[128:143], v[128:131], v[36:39], a[128:143]
    v_mov_b32 v204, 0
    v_mov_b32 v205, 0
    v_mov_b32 v206, 0
    s_waitcnt lgkmcnt(7)
    v_mfma_f32_32x32x16_bf16 a[16:31], v[132:135], v[28:31], a[16:31]
    ds_read_b64_tr_b16 v[148:149], v109 offset:29376
    ds_read_b64_tr_b16 v[150:151], v109 offset:30416
    v_mov_b32 v207, 0
    v_mov_b32 v208, 0
    v_mfma_f32_32x32x16_bf16 a[144:159], v[132:135], v[36:39], a[144:159]
    v_mov_b32 v209, 0
    v_mov_b32 v210, 0
    s_waitcnt lgkmcnt(6)
    v_mfma_f32_32x32x16_bf16 a[32:47], v[136:139], v[28:31], a[32:47]
    ds_read_b64_tr_b16 v[152:153], v109 offset:29632
    ds_read_b64_tr_b16 v[154:155], v109 offset:30672
    v_mov_b32 v211, 0
    v_mov_b32 v212, 0
    v_mov_b32 v213, 0
    v_mfma_f32_32x32x16_bf16 a[160:175], v[136:139], v[36:39], a[160:175]
    v_mov_b32 v214, 0
    v_mov_b32 v215, 0
    s_waitcnt lgkmcnt(6)
    v_mfma_f32_32x32x16_bf16 a[48:63], v[140:143], v[28:31], a[48:63]
    ds_read_b64_tr_b16 v[156:157], v109 offset:29888
    ds_read_b64_tr_b16 v[158:159], v109 offset:30928
    v_mov_b32 v216, 0
    v_mov_b32 v217, 0
    v_mov_b32 v218, 0
    v_mfma_f32_32x32x16_bf16 a[176:191], v[140:143], v[36:39], a[176:191]
    v_mov_b32 v219, 0
    v_mov_b32 v220, 0
    s_waitcnt lgkmcnt(6)
    v_mfma_f32_32x32x16_bf16 a[64:79], v[144:147], v[28:31], a[64:79]
    v_mov_b32 v221, 0
    v_mov_b32 v222, 0
    v_mov_b32 v223, 0
    v_mfma_f32_32x32x16_bf16 a[192:207], v[144:147], v[36:39], a[192:207]
    v_mov_b32 v160, 0
    v_mov_b32 v161, 0
    s_waitcnt lgkmcnt(4)
    v_mfma_f32_32x32x16_bf16 a[80:95], v[148:151], v[28:31], a[80:95]
    v_mov_b32 v162, 0
    v_mov_b32 v163, 0
    v_mfma_f32_32x32x16_bf16 a[208:223], v[148:151], v[36:39], a[208:223]
    s_waitcnt lgkmcnt(2)
    v_mfma_f32_32x32x16_bf16 a[96:111], v[152:155], v[28:31], a[96:111]
    v_mfma_f32_32x32x16_bf16 a[224:239], v[152:155], v[36:39], a[224:239]
    s_waitcnt lgkmcnt(0)
    v_mfma_f32_32x32x16_bf16 a[112:127], v[156:159], v[28:31], a[112:127]
    v_mfma_f32_32x32x16_bf16 a[240:255], v[156:159], v[36:39], a[240:255]
    s_waitcnt vmcnt(12)
    s_barrier
    s_add_u32 m0, s34, 41216
    s_nop 0
    buffer_load_dwordx4 v249, s[8:11], s32 offen nt lds
    s_add_u32 m0, s34, 49280
    s_nop 0
    buffer_load_dwordx4 v249, s[8:11], s32 offen offset:256 nt lds
    s_add_u32 m0, s34, 40208
    s_nop 0
    buffer_load_dwordx4 v249, s[8:11], s32 offen offset:2048 nt lds
    s_add_u32 m0, s34, 48272
    s_nop 0
    buffer_load_dwordx4 v249, s[8:11], s32 offen offset:2304 nt lds
    s_add_u32 s87, s87, 16384
    s_and_b32 s87, s87, 0x7ffff
    s_add_u32 s32, s86, s87
    s_add_u32 m0, s34, 91136
    s_nop 0
    buffer_load_dwordx4 v249, s[12:15], s33 offen nt lds
    s_add_u32 m0, s34, 99200
    s_nop 0
    buffer_load_dwordx4 v249, s[12:15], s33 offen offset:256 nt lds
    s_add_u32 m0, s34, 90128
    s_nop 0
    buffer_load_dwordx4 v249, s[12:15], s33 offen offset:2048 nt lds
    s_add_u32 m0, s34, 98192
    s_nop 0
    buffer_load_dwordx4 v249, s[12:15], s33 offen offset:2304 nt lds
    s_add_u32 s88, s88, 16384
    s_and_b32 s88, s88, 0x7ffff
    s_add_u32 s33, s86, s88
    ds_read_b128 v[224:227], v245 offset:33280
    ds_read_b128 v[228:231], v247
    ds_read_b128 v[232:235], v245 offset:33536
    ds_read_b128 v[236:239], v247 offset:1024
    ds_read_b128 v[180:183], v244 offset:33280
    ds_read_b128 v[184:187], v244 offset:33312
    v_accvgpr_read_b32 v164, a0
    v_accvgpr_read_b32 v165, a1
    v_accvgpr_read_b32 v166, a2
    v_accvgpr_read_b32 v167, a3
    v_accvgpr_read_b32 v168, a4
    v_accvgpr_read_b32 v169, a5
    v_accvgpr_read_b32 v170, a6
    v_accvgpr_read_b32 v171, a7
    v_cvt_pk_bf16_f32 v0, v164, v165
    v_cvt_pk_bf16_f32 v1, v166, v167
    v_cvt_pk_bf16_f32 v2, v168, v169
    v_cvt_pk_bf16_f32 v3, v170, v171
    v_accvgpr_read_b32 v172, a8
    v_accvgpr_read_b32 v173, a9
    v_accvgpr_read_b32 v174, a10
    v_accvgpr_read_b32 v175, a11
    v_accvgpr_read_b32 v176, a12
    v_accvgpr_read_b32 v177, a13
    v_accvgpr_read_b32 v178, a14
    v_accvgpr_read_b32 v179, a15
    v_cvt_pk_bf16_f32 v4, v172, v173
    v_cvt_pk_bf16_f32 v5, v174, v175
    v_cvt_pk_bf16_f32 v6, v176, v177
    v_cvt_pk_bf16_f32 v7, v178, v179
    v_accvgpr_read_b32 v164, a128
    v_accvgpr_read_b32 v165, a129
    v_accvgpr_read_b32 v166, a130
    v_accvgpr_read_b32 v167, a131
    v_accvgpr_read_b32 v168, a132
    v_accvgpr_read_b32 v169, a133
    v_accvgpr_read_b32 v170, a134
    v_accvgpr_read_b32 v171, a135
    v_cvt_pk_bf16_f32 v64, v164, v165
    v_cvt_pk_bf16_f32 v65, v166, v167
    v_cvt_pk_bf16_f32 v66, v168, v169
    v_cvt_pk_bf16_f32 v67, v170, v171
    v_accvgpr_read_b32 v172, a136
    v_accvgpr_read_b32 v173, a137
    v_accvgpr_read_b32 v174, a138
    v_accvgpr_read_b32 v175, a139
    v_accvgpr_read_b32 v176, a140
    v_accvgpr_read_b32 v177, a141
    v_accvgpr_read_b32 v178, a142
    v_accvgpr_read_b32 v179, a143
    v_cvt_pk_bf16_f32 v68, v172, v173
    v_cvt_pk_bf16_f32 v69, v174, v175
    v_cvt_pk_bf16_f32 v70, v176, v177
    v_cvt_pk_bf16_f32 v71, v178, v179
    s_waitcnt lgkmcnt(1)
    v_mfma_f32_32x32x16_bf16 v[128:143], v[180:183], v[0:3], 0
    v_accvgpr_read_b32 v164, a16
    v_accvgpr_read_b32 v165, a17
    v_accvgpr_read_b32 v166, a18
    v_accvgpr_read_b32 v167, a19
    v_accvgpr_read_b32 v168, a20
    v_accvgpr_read_b32 v169, a21
    v_mfma_f32_32x32x16_bf16 v[144:159], v[180:183], v[64:67], 0
    ds_read_b128 v[180:183], v244 offset:33536
    v_accvgpr_read_b32 v170, a22
    v_accvgpr_read_b32 v171, a23
    v_cvt_pk_bf16_f32 v8, v164, v165
    v_cvt_pk_bf16_f32 v9, v166, v167
    v_cvt_pk_bf16_f32 v10, v168, v169
    v_cvt_pk_bf16_f32 v11, v170, v171
    v_mfma_f32_16x16x32_bf16 v[240:243], v[224:227], v[228:231], 0
    ds_read_b128 v[224:227], v245 offset:33792
    ds_read_b128 v[228:231], v247 offset:2048
    v_accvgpr_read_b32 v172, a24
    v_accvgpr_read_b32 v173, a25
    v_accvgpr_read_b32 v174, a26
    v_accvgpr_read_b32 v175, a27
    v_accvgpr_read_b32 v176, a28
    v_accvgpr_read_b32 v177, a29
    s_waitcnt lgkmcnt(3)
    v_mfma_f32_32x32x16_bf16 v[128:143], v[184:187], v[4:7], v[128:143]
    v_accvgpr_read_b32 v178, a30
    v_accvgpr_read_b32 v179, a31
    v_cvt_pk_bf16_f32 v12, v172, v173
    v_cvt_pk_bf16_f32 v13, v174, v175
    v_cvt_pk_bf16_f32 v14, v176, v177
    v_cvt_pk_bf16_f32 v15, v178, v179
    v_mfma_f32_32x32x16_bf16 v[144:159], v[184:187], v[68:71], v[144:159]
    ds_read_b128 v[184:187], v244 offset:33568
    v_accvgpr_read_b32 v164, a144
    v_accvgpr_read_b32 v165, a145
    v_accvgpr_read_b32 v166, a146
    v_accvgpr_read_b32 v167, a147
    v_accvgpr_read_b32 v168, a148
    v_accvgpr_read_b32 v169, a149
    v_mfma_f32_16x16x32_bf16 v[240:243], v[232:235], v[236:239], v[240:243]
    ds_read_b128 v[232:235], v245 offset:34048
    ds_read_b128 v[236:239], v247 offset:3072
    v_accvgpr_read_b32 v170, a150
    v_accvgpr_read_b32 v171, a151
    v_cvt_pk_bf16_f32 v72, v164, v165
    v_cvt_pk_bf16_f32 v73, v166, v167
    v_cvt_pk_bf16_f32 v74, v168, v169
    v_cvt_pk_bf16_f32 v75, v170, v171
    v_mfma_f32_32x32x16_bf16 a[0:15], v[160:163], v[160:163], 0
    v_accvgpr_read_b32 v172, a152
    v_accvgpr_read_b32 v173, a153
    v_accvgpr_read_b32 v174, a154
    v_accvgpr_read_b32 v175, a155
    v_accvgpr_read_b32 v176, a156
    v_accvgpr_read_b32 v177, a157
    v_mfma_f32_32x32x16_bf16 a[128:143], v[160:163], v[160:163], 0
    v_accvgpr_read_b32 v178, a158
    v_accvgpr_read_b32 v179, a159
    v_cvt_pk_bf16_f32 v76, v172, v173
    v_cvt_pk_bf16_f32 v77, v174, v175
    v_cvt_pk_bf16_f32 v78, v176, v177
    v_cvt_pk_bf16_f32 v79, v178, v179
    s_waitcnt lgkmcnt(5)
    v_mfma_f32_32x32x16_bf16 v[128:143], v[180:183], v[8:11], v[128:143]
    v_accvgpr_read_b32 v164, a32
    v_accvgpr_read_b32 v165, a33
    v_accvgpr_read_b32 v166, a34
    v_accvgpr_read_b32 v167, a35
    v_accvgpr_read_b32 v168, a36
    v_accvgpr_read_b32 v169, a37
    v_mfma_f32_32x32x16_bf16 v[144:159], v[180:183], v[72:75], v[144:159]
    ds_read_b128 v[180:183], v244 offset:33792
    v_accvgpr_read_b32 v170, a38
    v_accvgpr_read_b32 v171, a39
    v_cvt_pk_bf16_f32 v16, v164, v165
    v_cvt_pk_bf16_f32 v17, v166, v167
    v_cvt_pk_bf16_f32 v18, v168, v169
    v_cvt_pk_bf16_f32 v19, v170, v171
    s_waitcnt lgkmcnt(4)
    v_mfma_f32_16x16x32_bf16 v[240:243], v[224:227], v[228:231], v[240:243]
    ds_read_b128 v[224:227], v245 offset:41600
    ds_read_b128 v[228:231], v247 offset:4096
    v_accvgpr_read_b32 v172, a40
    v_accvgpr_read_b32 v173, a41
    v_accvgpr_read_b32 v174, a42
    v_accvgpr_read_b32 v175, a43
    v_accvgpr_read_b32 v176, a44
    v_accvgpr_read_b32 v177, a45
    s_waitcnt lgkmcnt(5)
    v_mfma_f32_32x32x16_bf16 v[128:143], v[184:187], v[12:15], v[128:143]
    v_accvgpr_read_b32 v178, a46
    v_accvgpr_read_b32 v179, a47
    v_cvt_pk_bf16_f32 v20, v172, v173
    v_cvt_pk_bf16_f32 v21, v174, v175
    v_cvt_pk_bf16_f32 v22, v176, v177
    v_cvt_pk_bf16_f32 v23, v178, v179
    v_mfma_f32_32x32x16_bf16 v[144:159], v[184:187], v[76:79], v[144:159]
    ds_read_b128 v[184:187], v244 offset:33824
    v_accvgpr_read_b32 v164, a160
    v_accvgpr_read_b32 v165, a161
    v_accvgpr_read_b32 v166, a162
    v_accvgpr_read_b32 v167, a163
    v_accvgpr_read_b32 v168, a164
    v_accvgpr_read_b32 v169, a165
    s_waitcnt lgkmcnt(4)
    v_mfma_f32_16x16x32_bf16 v[240:243], v[232:235], v[236:239], v[240:243]
    ds_read_b128 v[232:235], v245 offset:41856
    ds_read_b128 v[236:239], v247 offset:5120
    v_accvgpr_read_b32 v170, a166
    v_accvgpr_read_b32 v171, a167
    v_cvt_pk_bf16_f32 v80, v164, v165
    v_cvt_pk_bf16_f32 v81, v166, v167
    v_cvt_pk_bf16_f32 v82, v168, v169
    v_cvt_pk_bf16_f32 v83, v170, v171
    v_mfma_f32_32x32x16_bf16 a[16:31], v[160:163], v[160:163], 0
    v_accvgpr_read_b32 v172, a168
    v_accvgpr_read_b32 v173, a169
    v_accvgpr_read_b32 v174, a170
    v_accvgpr_read_b32 v175, a171
    v_accvgpr_read_b32 v176, a172
    v_accvgpr_read_b32 v177, a173
    v_mfma_f32_32x32x16_bf16 a[144:159], v[160:163], v[160:163], 0
    v_accvgpr_read_b32 v178, a174
    v_accvgpr_read_b32 v179, a175
    v_cvt_pk_bf16_f32 v84, v172, v173
    v_cvt_pk_bf16_f32 v85, v174, v175
    v_cvt_pk_bf16_f32 v86, v176, v177
    v_cvt_pk_bf16_f32 v87, v178, v179
    s_waitcnt lgkmcnt(5)
    v_mfma_f32_32x32x16_bf16 v[128:143], v[180:183], v[16:19], v[128:143]
    v_accvgpr_read_b32 v164, a48
    v_accvgpr_read_b32 v165, a49
    v_accvgpr_read_b32 v166, a50
    v_accvgpr_read_b32 v167, a51
    v_accvgpr_read_b32 v168, a52
    v_accvgpr_read_b32 v169, a53
    v_mfma_f32_32x32x16_bf16 v[144:159], v[180:183], v[80:83], v[144:159]
    ds_read_b128 v[180:183], v244 offset:34048
    v_accvgpr_read_b32 v170, a54
    v_accvgpr_read_b32 v171, a55
    v_cvt_pk_bf16_f32 v24, v164, v165
    v_cvt_pk_bf16_f32 v25, v166, v167
    v_cvt_pk_bf16_f32 v26, v168, v169
    v_cvt_pk_bf16_f32 v27, v170, v171
    s_waitcnt lgkmcnt(4)
    v_mfma_f32_16x16x32_bf16 v[240:243], v[224:227], v[228:231], v[240:243]
    ds_read_b128 v[224:227], v245 offset:42112
    ds_read_b128 v[228:231], v247 offset:6144
    v_accvgpr_read_b32 v172, a56
    v_accvgpr_read_b32 v173, a57
    v_accvgpr_read_b32 v174, a58
    v_accvgpr_read_b32 v175, a59
    v_accvgpr_read_b32 v176, a60
    v_accvgpr_read_b32 v177, a61
    s_waitcnt lgkmcnt(5)
    v_mfma_f32_32x32x16_bf16 v[128:143], v[184:187], v[20:23], v[128:143]
    v_accvgpr_read_b32 v178, a62
    v_accvgpr_read_b32 v179, a63
    v_cvt_pk_bf16_f32 v28, v172, v173
    v_cvt_pk_bf16_f32 v29, v174, v175
    v_cvt_pk_bf16_f32 v30, v176, v177
    v_cvt_pk_bf16_f32 v31, v178, v179
    v_mfma_f32_32x32x16_bf16 v[144:159], v[184:187], v[84:87], v[144:159]
    ds_read_b128 v[184:187], v244 offset:34080
    v_accvgpr_read_b32 v164, a176
    v_accvgpr_read_b32 v165, a177
    v_accvgpr_read_b32 v166, a178
    v_accvgpr_read_b32 v167, a179
    v_accvgpr_read_b32 v168, a180
    v_accvgpr_read_b32 v169, a181
    s_waitcnt lgkmcnt(4)
    v_mfma_f32_16x16x32_bf16 v[240:243], v[232:235], v[236:239], v[240:243]
    ds_read_b128 v[232:235], v245 offset:42368
    ds_read_b128 v[236:239], v247 offset:7168
    v_accvgpr_read_b32 v170, a182
    v_accvgpr_read_b32 v171, a183
    v_cvt_pk_bf16_f32 v88, v164, v165
    v_cvt_pk_bf16_f32 v89, v166, v167
    v_cvt_pk_bf16_f32 v90, v168, v169
    v_cvt_pk_bf16_f32 v91, v170, v171
    v_mfma_f32_32x32x16_bf16 a[32:47], v[160:163], v[160:163], 0
    v_accvgpr_read_b32 v172, a184
    v_accvgpr_read_b32 v173, a185
    v_accvgpr_read_b32 v174, a186
    v_accvgpr_read_b32 v175, a187
    v_accvgpr_read_b32 v176, a188
    v_accvgpr_read_b32 v177, a189
    v_mfma_f32_32x32x16_bf16 a[160:175], v[160:163], v[160:163], 0
    v_accvgpr_read_b32 v178, a190
    v_accvgpr_read_b32 v179, a191
    v_cvt_pk_bf16_f32 v92, v172, v173
    v_cvt_pk_bf16_f32 v93, v174, v175
    v_cvt_pk_bf16_f32 v94, v176, v177
    v_cvt_pk_bf16_f32 v95, v178, v179
    s_waitcnt lgkmcnt(5)
    v_mfma_f32_32x32x16_bf16 v[128:143], v[180:183], v[24:27], v[128:143]
    v_accvgpr_read_b32 v164, a64
    v_accvgpr_read_b32 v165, a65
    v_accvgpr_read_b32 v166, a66
    v_accvgpr_read_b32 v167, a67
    v_accvgpr_read_b32 v168, a68
    v_accvgpr_read_b32 v169, a69
    v_mfma_f32_32x32x16_bf16 v[144:159], v[180:183], v[88:91], v[144:159]
    ds_read_b128 v[180:183], v244 offset:41600
    v_accvgpr_read_b32 v170, a70
    v_accvgpr_read_b32 v171, a71
    v_cvt_pk_bf16_f32 v32, v164, v165
    v_cvt_pk_bf16_f32 v33, v166, v167
    v_cvt_pk_bf16_f32 v34, v168, v169
    v_cvt_pk_bf16_f32 v35, v170, v171
    s_waitcnt lgkmcnt(4)
    v_mfma_f32_16x16x32_bf16 v[240:243], v[224:227], v[228:231], v[240:243]
    ds_read_b128 v[224:227], v245 offset:49920
    ds_read_b128 v[228:231], v247
    v_accvgpr_read_b32 v172, a72
    v_accvgpr_read_b32 v173, a73
    v_accvgpr_read_b32 v174, a74
    v_accvgpr_read_b32 v175, a75
    v_accvgpr_read_b32 v176, a76
    v_accvgpr_read_b32 v177, a77
    s_waitcnt lgkmcnt(5)
    v_mfma_f32_32x32x16_bf16 v[128:143], v[184:187], v[28:31], v[128:143]
    v_accvgpr_read_b32 v178, a78
    v_accvgpr_read_b32 v179, a79
    v_cvt_pk_bf16_f32 v36, v172, v173
    v_cvt_pk_bf16_f32 v37, v174, v175
    v_cvt_pk_bf16_f32 v38, v176, v177
    v_cvt_pk_bf16_f32 v39, v178, v179
    v_mfma_f32_32x32x16_bf16 v[144:159], v[184:187], v[92:95], v[144:159]
    ds_read_b128 v[184:187], v244 offset:41632
    v_accvgpr_read_b32 v164, a192
    v_accvgpr_read_b32 v165, a193
    v_accvgpr_read_b32 v166, a194
    v_accvgpr_read_b32 v167, a195
    v_accvgpr_read_b32 v168, a196
    v_accvgpr_read_b32 v169, a197
    s_waitcnt lgkmcnt(4)
    v_mfma_f32_16x16x32_bf16 v[240:243], v[232:235], v[236:239], v[240:243]
    ds_read_b128 v[232:235], v245 offset:50176
    ds_read_b128 v[236:239], v247 offset:1024
    v_accvgpr_read_b32 v170, a198
    v_accvgpr_read_b32 v171, a199
    v_cvt_pk_bf16_f32 v96, v164, v165
    v_cvt_pk_bf16_f32 v97, v166, v167
    v_cvt_pk_bf16_f32 v98, v168, v169
    v_cvt_pk_bf16_f32 v99, v170, v171
    v_mfma_f32_32x32x16_bf16 a[48:63], v[160:163], v[160:163], 0
    v_accvgpr_read_b32 v172, a200
    v_accvgpr_read_b32 v173, a201
    v_accvgpr_read_b32 v174, a202
    v_accvgpr_read_b32 v175, a203
    v_accvgpr_read_b32 v176, a204
    v_accvgpr_read_b32 v177, a205
    v_mfma_f32_32x32x16_bf16 a[176:191], v[160:163], v[160:163], 0
    v_accvgpr_read_b32 v178, a206
    v_accvgpr_read_b32 v179, a207
    v_cvt_pk_bf16_f32 v100, v172, v173
    v_cvt_pk_bf16_f32 v101, v174, v175
    v_cvt_pk_bf16_f32 v102, v176, v177
    v_cvt_pk_bf16_f32 v103, v178, v179
    s_waitcnt lgkmcnt(5)
    v_mfma_f32_32x32x16_bf16 v[128:143], v[180:183], v[32:35], v[128:143]
    v_accvgpr_read_b32 v164, a80
    v_accvgpr_read_b32 v165, a81
    v_accvgpr_read_b32 v166, a82
    v_accvgpr_read_b32 v167, a83
    v_accvgpr_read_b32 v168, a84
    v_accvgpr_read_b32 v169, a85
    v_mfma_f32_32x32x16_bf16 v[144:159], v[180:183], v[96:99], v[144:159]
    ds_read_b128 v[180:183], v244 offset:41856
    v_accvgpr_read_b32 v170, a86
    v_accvgpr_read_b32 v171, a87
    v_cvt_pk_bf16_f32 v40, v164, v165
    v_cvt_pk_bf16_f32 v41, v166, v167
    v_cvt_pk_bf16_f32 v42, v168, v169
    v_cvt_pk_bf16_f32 v43, v170, v171
    s_waitcnt lgkmcnt(4)
    v_mfma_f32_16x16x32_bf16 v[188:191], v[224:227], v[228:231], 0
    ds_read_b128 v[224:227], v245 offset:50432
    ds_read_b128 v[228:231], v247 offset:2048
    v_accvgpr_read_b32 v172, a88
    v_accvgpr_read_b32 v173, a89
    v_accvgpr_read_b32 v174, a90
    v_accvgpr_read_b32 v175, a91
    v_accvgpr_read_b32 v176, a92
    v_accvgpr_read_b32 v177, a93
    s_waitcnt lgkmcnt(5)
    v_mfma_f32_32x32x16_bf16 v[128:143], v[184:187], v[36:39], v[128:143]
    v_accvgpr_read_b32 v178, a94
    v_accvgpr_read_b32 v179, a95
    v_cvt_pk_bf16_f32 v44, v172, v173
    v_cvt_pk_bf16_f32 v45, v174, v175
    v_cvt_pk_bf16_f32 v46, v176, v177
    v_cvt_pk_bf16_f32 v47, v178, v179
    v_mfma_f32_32x32x16_bf16 v[144:159], v[184:187], v[100:103], v[144:159]
    ds_read_b128 v[184:187], v244 offset:41888
    v_accvgpr_read_b32 v164, a208
    v_accvgpr_read_b32 v165, a209
    v_accvgpr_read_b32 v166, a210
    v_accvgpr_read_b32 v167, a211
    v_accvgpr_read_b32 v168, a212
    v_accvgpr_read_b32 v169, a213
    s_waitcnt lgkmcnt(4)
    v_mfma_f32_16x16x32_bf16 v[188:191], v[232:235], v[236:239], v[188:191]
    ds_read_b128 v[232:235], v245 offset:50688
    ds_read_b128 v[236:239], v247 offset:3072
    v_accvgpr_read_b32 v170, a214
    v_accvgpr_read_b32 v171, a215
    v_cvt_pk_bf16_f32 v104, v164, v165
    v_cvt_pk_bf16_f32 v105, v166, v167
    v_cvt_pk_bf16_f32 v106, v168, v169
    v_cvt_pk_bf16_f32 v107, v170, v171
    v_mfma_f32_32x32x16_bf16 a[64:79], v[160:163], v[160:163], 0
    v_accvgpr_read_b32 v172, a216
    v_accvgpr_read_b32 v173, a217
    v_accvgpr_read_b32 v174, a218
    v_accvgpr_read_b32 v175, a219
    v_accvgpr_read_b32 v176, a220
    v_accvgpr_read_b32 v177, a221
    v_mfma_f32_32x32x16_bf16 a[192:207], v[160:163], v[160:163], 0
    v_accvgpr_read_b32 v178, a222
    v_accvgpr_read_b32 v179, a223
    v_cvt_pk_bf16_f32 v108, v172, v173
    v_cvt_pk_bf16_f32 v109, v174, v175
    v_cvt_pk_bf16_f32 v110, v176, v177
    v_cvt_pk_bf16_f32 v111, v178, v179
    s_waitcnt lgkmcnt(5)
    v_mfma_f32_32x32x16_bf16 v[128:143], v[180:183], v[40:43], v[128:143]
    v_accvgpr_read_b32 v164, a96
    v_accvgpr_read_b32 v165, a97
    v_accvgpr_read_b32 v166, a98
    v_accvgpr_read_b32 v167, a99
    v_accvgpr_read_b32 v168, a100
    v_accvgpr_read_b32 v169, a101
    v_mfma_f32_32x32x16_bf16 v[144:159], v[180:183], v[104:107], v[144:159]
    ds_read_b128 v[180:183], v244 offset:42112
    v_accvgpr_read_b32 v170, a102
    v_accvgpr_read_b32 v171, a103
    v_cvt_pk_bf16_f32 v48, v164, v165
    v_cvt_pk_bf16_f32 v49, v166, v167
    v_cvt_pk_bf16_f32 v50, v168, v169
    v_cvt_pk_bf16_f32 v51, v170, v171
    s_waitcnt lgkmcnt(4)
    v_mfma_f32_16x16x32_bf16 v[188:191], v[224:227], v[228:231], v[188:191]
    ds_read_b128 v[224:227], v245 offset:58240
    ds_read_b128 v[228:231], v247 offset:4096
    v_accvgpr_read_b32 v172, a104
    v_accvgpr_read_b32 v173, a105
    v_accvgpr_read_b32 v174, a106
    v_accvgpr_read_b32 v175, a107
    v_accvgpr_read_b32 v176, a108
    v_accvgpr_read_b32 v177, a109
    s_waitcnt lgkmcnt(5)
    v_mfma_f32_32x32x16_bf16 v[128:143], v[184:187], v[44:47], v[128:143]
    v_accvgpr_read_b32 v178, a110
    v_accvgpr_read_b32 v179, a111
    v_cvt_pk_bf16_f32 v52, v172, v173
    v_cvt_pk_bf16_f32 v53, v174, v175
    v_cvt_pk_bf16_f32 v54, v176, v177
    v_cvt_pk_bf16_f32 v55, v178, v179
    v_mfma_f32_32x32x16_bf16 v[144:159], v[184:187], v[108:111], v[144:159]
    ds_read_b128 v[184:187], v244 offset:42144
    v_accvgpr_read_b32 v164, a224
    v_accvgpr_read_b32 v165, a225
    v_accvgpr_read_b32 v166, a226
    v_accvgpr_read_b32 v167, a227
    v_accvgpr_read_b32 v168, a228
    v_accvgpr_read_b32 v169, a229
    s_waitcnt lgkmcnt(4)
    v_mfma_f32_16x16x32_bf16 v[188:191], v[232:235], v[236:239], v[188:191]
    ds_read_b128 v[232:235], v245 offset:58496
    ds_read_b128 v[236:239], v247 offset:5120
    v_accvgpr_read_b32 v170, a230
    v_accvgpr_read_b32 v171, a231
    v_cvt_pk_bf16_f32 v112, v164, v165
    v_cvt_pk_bf16_f32 v113, v166, v167
    v_cvt_pk_bf16_f32 v114, v168, v169
    v_cvt_pk_bf16_f32 v115, v170, v171
    v_mfma_f32_32x32x16_bf16 a[80:95], v[160:163], v[160:163], 0
    v_accvgpr_read_b32 v172, a232
    v_accvgpr_read_b32 v173, a233
    v_accvgpr_read_b32 v174, a234
    v_accvgpr_read_b32 v175, a235
    v_accvgpr_read_b32 v176, a236
    v_accvgpr_read_b32 v177, a237
    v_mfma_f32_32x32x16_bf16 a[208:223], v[160:163], v[160:163], 0
    v_accvgpr_read_b32 v178, a238
    v_accvgpr_read_b32 v179, a239
    v_cvt_pk_bf16_f32 v116, v172, v173
    v_cvt_pk_bf16_f32 v117, v174, v175
    v_cvt_pk_bf16_f32 v118, v176, v177
    v_cvt_pk_bf16_f32 v119, v178, v179
    s_waitcnt lgkmcnt(5)
    v_mfma_f32_32x32x16_bf16 v[128:143], v[180:183], v[48:51], v[128:143]
    v_accvgpr_read_b32 v164, a112
    v_accvgpr_read_b32 v165, a113
    v_accvgpr_read_b32 v166, a114
    v_accvgpr_read_b32 v167, a115
    v_accvgpr_read_b32 v168, a116
    v_accvgpr_read_b32 v169, a117
    v_mfma_f32_32x32x16_bf16 v[144:159], v[180:183], v[112:115], v[144:159]
    ds_read_b128 v[180:183], v244 offset:42368
    v_accvgpr_read_b32 v170, a118
    v_accvgpr_read_b32 v171, a119
    v_cvt_pk_bf16_f32 v56, v164, v165
    v_cvt_pk_bf16_f32 v57, v166, v167
    v_cvt_pk_bf16_f32 v58, v168, v169
    v_cvt_pk_bf16_f32 v59, v170, v171
    s_waitcnt lgkmcnt(4)
    v_mfma_f32_16x16x32_bf16 v[188:191], v[224:227], v[228:231], v[188:191]
    ds_read_b128 v[224:227], v245 offset:58752
    ds_read_b128 v[228:231], v247 offset:6144
    v_accvgpr_read_b32 v172, a120
    v_accvgpr_read_b32 v173, a121
    v_accvgpr_read_b32 v174, a122
    v_accvgpr_read_b32 v175, a123
    v_accvgpr_read_b32 v176, a124
    v_accvgpr_read_b32 v177, a125
    s_waitcnt lgkmcnt(5)
    v_mfma_f32_32x32x16_bf16 v[128:143], v[184:187], v[52:55], v[128:143]
    v_accvgpr_read_b32 v178, a126
    v_accvgpr_read_b32 v179, a127
    v_cvt_pk_bf16_f32 v60, v172, v173
    v_cvt_pk_bf16_f32 v61, v174, v175
    v_cvt_pk_bf16_f32 v62, v176, v177
    v_cvt_pk_bf16_f32 v63, v178, v179
    v_mfma_f32_32x32x16_bf16 v[144:159], v[184:187], v[116:119], v[144:159]
    ds_read_b128 v[184:187], v244 offset:42400
    v_accvgpr_read_b32 v164, a240
    v_accvgpr_read_b32 v165, a241
    v_accvgpr_read_b32 v166, a242
    v_accvgpr_read_b32 v167, a243
    v_accvgpr_read_b32 v168, a244
    v_accvgpr_read_b32 v169, a245
    s_waitcnt lgkmcnt(4)
    v_mfma_f32_16x16x32_bf16 v[188:191], v[232:235], v[236:239], v[188:191]
    ds_read_b128 v[232:235], v245 offset:59008
    ds_read_b128 v[236:239], v247 offset:7168
    v_accvgpr_read_b32 v170, a246
    v_accvgpr_read_b32 v171, a247
    v_cvt_pk_bf16_f32 v120, v164, v165
    v_cvt_pk_bf16_f32 v121, v166, v167
    v_cvt_pk_bf16_f32 v122, v168, v169
    v_cvt_pk_bf16_f32 v123, v170, v171
    v_mfma_f32_32x32x16_bf16 a[96:111], v[160:163], v[160:163], 0
    v_accvgpr_read_b32 v172, a248
    v_accvgpr_read_b32 v173, a249
    v_accvgpr_read_b32 v174, a250
    v_accvgpr_read_b32 v175, a251
    v_accvgpr_read_b32 v176, a252
    v_accvgpr_read_b32 v177, a253
    v_mfma_f32_32x32x16_bf16 a[224:239], v[160:163], v[160:163], 0
    v_accvgpr_read_b32 v178, a254
    v_accvgpr_read_b32 v179, a255
    v_cvt_pk_bf16_f32 v124, v172, v173
    v_cvt_pk_bf16_f32 v125, v174, v175
    v_cvt_pk_bf16_f32 v126, v176, v177
    v_cvt_pk_bf16_f32 v127, v178, v179
    s_waitcnt lgkmcnt(5)
    v_mfma_f32_32x32x16_bf16 v[128:143], v[180:183], v[56:59], v[128:143]
    v_mfma_f32_32x32x16_bf16 v[144:159], v[180:183], v[120:123], v[144:159]
    s_waitcnt lgkmcnt(3)
    v_mfma_f32_16x16x32_bf16 v[188:191], v[224:227], v[228:231], v[188:191]
    s_waitcnt lgkmcnt(2)
    v_mfma_f32_32x32x16_bf16 v[128:143], v[184:187], v[60:63], v[128:143]
    v_mfma_f32_32x32x16_bf16 v[144:159], v[184:187], v[124:127], v[144:159]
    s_waitcnt lgkmcnt(0)
    v_mfma_f32_16x16x32_bf16 v[188:191], v[232:235], v[236:239], v[188:191]
    v_mfma_f32_32x32x16_bf16 a[112:127], v[160:163], v[160:163], 0
    v_mfma_f32_32x32x16_bf16 a[240:255], v[160:163], v[160:163], 0
    v_max3_f32 v166, v240, v241, v242
    v_max_f32 v166, v166, v243
    v_mov_b32 v167, v166
    s_nop 1
    v_permlane32_swap_b32 v166, v167
    v_max_f32 v166, v166, v167
    v_mov_b32 v167, v166
    s_nop 1
    v_permlane16_swap_b32 v166, v167
    v_max_f32 v166, v166, v167
    ds_write_b32 v248, v166 offset:20480
    s_nop 1
    v_max3_f32 v166, v188, v189, v190
    v_max_f32 v166, v166, v191
    v_mov_b32 v167, v166
    s_nop 1
    v_permlane32_swap_b32 v166, v167
    v_max_f32 v166, v166, v167
    v_mov_b32 v167, v166
    s_nop 1
    v_permlane16_swap_b32 v166, v167
    v_max_f32 v166, v166, v167
    ds_write_b32 v248, v166 offset:22528
    v_fma_f32 v128, v128, s31, v250
    v_fma_f32 v129, v129, s31, v250
    v_fma_f32 v130, v130, s31, v250
    v_fma_f32 v131, v131, s31, v250
    v_fma_f32 v132, v132, s31, v250
    v_fma_f32 v133, v133, s31, v250
    v_fma_f32 v134, v134, s31, v250
    v_fma_f32 v135, v135, s31, v250
    v_fma_f32 v136, v136, s31, v250
    v_fma_f32 v137, v137, s31, v250
    v_fma_f32 v138, v138, s31, v250
    v_fma_f32 v139, v139, s31, v250
    v_fma_f32 v140, v140, s31, v250
    v_fma_f32 v141, v141, s31, v250
    v_fma_f32 v142, v142, s31, v250
    v_fma_f32 v143, v143, s31, v250
    v_fma_f32 v144, v144, s31, v251
    v_fma_f32 v145, v145, s31, v251
    v_fma_f32 v146, v146, s31, v251
    v_fma_f32 v147, v147, s31, v251
    v_fma_f32 v148, v148, s31, v251
    v_fma_f32 v149, v149, s31, v251
    v_fma_f32 v150, v150, s31, v251
    v_fma_f32 v151, v151, s31, v251
    v_fma_f32 v152, v152, s31, v251
    v_fma_f32 v153, v153, s31, v251
    v_fma_f32 v154, v154, s31, v251
    v_fma_f32 v155, v155, s31, v251
    v_fma_f32 v156, v156, s31, v251
    v_fma_f32 v157, v157, s31, v251
    v_fma_f32 v158, v158, s31, v251
    v_fma_f32 v159, v159, s31, v251
    s_waitcnt lgkmcnt(0)
    s_barrier
    v_and_b32 v164, 0xfffffbff, v248
    ds_read2st64_b32 v[166:167], v164 offset0:80 offset1:84
    s_add_u32 m0, s34, 57856
    s_nop 0
    buffer_load_dwordx4 v249, s[8:11], s32 offen nt lds
    s_add_u32 m0, s34, 65920
    s_nop 0
    buffer_load_dwordx4 v249, s[8:11], s32 offen offset:256 nt lds
    s_add_u32 m0, s34, 56848
    s_nop 0
    buffer_load_dwordx4 v249, s[8:11], s32 offen offset:2048 nt lds
    s_add_u32 m0, s34, 64912
    s_nop 0
    buffer_load_dwordx4 v249, s[8:11], s32 offen offset:2304 nt lds
    s_add_u32 s87, s87, 16384
    s_and_b32 s87, s87, 0x7ffff
    s_add_u32 s32, s86, s87
    ds_read_b128 v[224:227], v244 offset:49920
    ds_read_b128 v[228:231], v244 offset:49952
    ds_read_b128 v[232:235], v244 offset:50176
    ds_read_b128 v[236:239], v244 offset:50208
    v_max3_f32 v168, v128, v129, v130
    v_max3_f32 v168, v168, v131, v132
    v_max3_f32 v168, v168, v133, v134
    v_max3_f32 v168, v168, v135, v136
    v_max3_f32 v168, v168, v137, v138
    v_max3_f32 v168, v168, v139, v140
    v_max3_f32 v168, v168, v141, v142
    v_max_f32 v168, v168, v143
    v_mov_b32 v169, v168
    s_nop 1
    v_permlane32_swap_b32 v168, v169
    v_max_f32 v168, v168, v169
    v_sub_f32 v128, v128, v168
    v_sub_f32 v129, v129, v168
    v_sub_f32 v130, v130, v168
    v_sub_f32 v131, v131, v168
    v_sub_f32 v132, v132, v168
    v_sub_f32 v133, v133, v168
    v_sub_f32 v134, v134, v168
    v_sub_f32 v135, v135, v168
    v_sub_f32 v136, v136, v168
    v_sub_f32 v137, v137, v168
    v_sub_f32 v138, v138, v168
    v_sub_f32 v139, v139, v168
    v_sub_f32 v140, v140, v168
    v_sub_f32 v141, v141, v168
    v_sub_f32 v142, v142, v168
    v_sub_f32 v143, v143, v168
    v_sub_f32 v250, v250, v168
    v_max3_f32 v168, v144, v145, v146
    v_max3_f32 v168, v168, v147, v148
    v_max3_f32 v168, v168, v149, v150
    v_max3_f32 v168, v168, v151, v152
    v_max3_f32 v168, v168, v153, v154
    v_max3_f32 v168, v168, v155, v156
    v_max3_f32 v168, v168, v157, v158
    v_max_f32 v168, v168, v159
    v_mov_b32 v169, v168
    s_nop 1
    v_permlane32_swap_b32 v168, v169
    v_max_f32 v168, v168, v169
    v_sub_f32 v144, v144, v168
    v_sub_f32 v145, v145, v168
    v_sub_f32 v146, v146, v168
    v_sub_f32 v147, v147, v168
    v_sub_f32 v148, v148, v168
    v_sub_f32 v149, v149, v168
    v_sub_f32 v150, v150, v168
    v_sub_f32 v151, v151, v168
    v_sub_f32 v152, v152, v168
    v_sub_f32 v153, v153, v168
    v_sub_f32 v154, v154, v168
    v_sub_f32 v155, v155, v168
    v_sub_f32 v156, v156, v168
    v_sub_f32 v157, v157, v168
    v_sub_f32 v158, v158, v168
    v_sub_f32 v159, v159, v168
    v_sub_f32 v251, v251, v168
    s_waitcnt lgkmcnt(4)
    v_max_f32 v166, v166, v167
    v_mul_f32 v166, s31, v166
    v_add_f32 v167, s46, v254
    v_cmp_gt_f32 vcc, v166, v167
    s_nop 1
    v_cndmask_b32 v167, v254, v166, vcc
    v_sub_f32 v165, v254, v167
    v_mov_b32 v254, v167
    v_exp_f32 v165, v165
    v_fma_f32 v240, v240, s31, -v254
    v_fma_f32 v241, v241, s31, -v254
    v_fma_f32 v242, v242, s31, -v254
    v_fma_f32 v243, v243, s31, -v254
    v_exp_f32 v240, v240
    v_exp_f32 v241, v241
    v_exp_f32 v242, v242
    v_exp_f32 v243, v243
    v_fma_f32 v255, v255, v165, v240
    v_add_f32 v255, v255, v241
    v_add_f32 v255, v255, v242
    v_add_f32 v255, v255, v243
    v_cvt_pk_bf16_f32 v240, v240, v241
    v_cvt_pk_bf16_f32 v241, v242, v243
    ds_write_b64 v248, v[240:241] offset:16384
    ds_write_b32 v248, v165 offset:20484
    s_nop 0
    v_mov_b32 v240, v188
    v_mov_b32 v241, v189
    v_mov_b32 v242, v190
    v_mov_b32 v243, v191
    s_mov_b32 s43, 7
    s_waitcnt lgkmcnt(5)
    v_mfma_f32_32x32x16_bf16 v[160:175], v[224:227], v[0:3], 0
    v_exp_f32 v128, v128
    v_exp_f32 v129, v129
    v_exp_f32 v130, v130
    v_mfma_f32_32x32x16_bf16 v[176:191], v[224:227], v[64:67], 0
    ds_read_b128 v[224:227], v244 offset:50432
    v_exp_f32 v131, v131
    s_waitcnt lgkmcnt(5)
    v_mfma_f32_32x32x16_bf16 v[160:175], v[228:231], v[4:7], v[160:175]
    v_add_f32 v252, v252, v128
    v_add_f32 v252, v252, v129
    v_add_f32 v252, v252, v130
    v_add_f32 v252, v252, v131
    v_cvt_pk_bf16_f32 v128, v128, v129
    v_cvt_pk_bf16_f32 v129, v130, v131
    v_mfma_f32_32x32x16_bf16 v[176:191], v[228:231], v[68:71], v[176:191]
    ds_read_b128 v[228:231], v244 offset:50464
    v_exp_f32 v132, v132
    s_waitcnt lgkmcnt(5)
    v_mfma_f32_32x32x16_bf16 v[160:175], v[232:235], v[8:11], v[160:175]
    v_exp_f32 v133, v133
    v_exp_f32 v134, v134
    v_exp_f32 v135, v135
    v_mfma_f32_32x32x16_bf16 v[176:191], v[232:235], v[72:75], v[176:191]
    ds_read_b128 v[232:235], v244 offset:50688
    v_add_f32 v252, v252, v132
    v_add_f32 v252, v252, v133
    v_add_f32 v252, v252, v134
    s_waitcnt lgkmcnt(5)
    v_mfma_f32_32x32x16_bf16 v[160:175], v[236:239], v[12:15], v[160:175]
    v_add_f32 v252, v252, v135
    v_cvt_pk_bf16_f32 v130, v132, v133
    v_cvt_pk_bf16_f32 v131, v134, v135
    v_exp_f32 v136, v136
    v_mfma_f32_32x32x16_bf16 v[176:191], v[236:239], v[76:79], v[176:191]
    ds_read_b128 v[236:239], v244 offset:50720
    v_exp_f32 v137, v137
    v_exp_f32 v138, v138
    s_waitcnt lgkmcnt(3)
    v_mfma_f32_32x32x16_bf16 v[160:175], v[224:227], v[16:19], v[160:175]
    v_exp_f32 v139, v139
    v_add_f32 v252, v252, v136
    v_add_f32 v252, v252, v137
    v_add_f32 v252, v252, v138
    v_mfma_f32_32x32x16_bf16 v[176:191], v[224:227], v[80:83], v[176:191]
    ds_read_b128 v[224:227], v244 offset:58240
    v_add_f32 v252, v252, v139
    v_cvt_pk_bf16_f32 v132, v136, v137
    v_cvt_pk_bf16_f32 v133, v138, v139
    s_waitcnt lgkmcnt(3)
    v_mfma_f32_32x32x16_bf16 v[160:175], v[228:231], v[20:23], v[160:175]
    v_exp_f32 v140, v140
    v_exp_f32 v141, v141
    v_exp_f32 v142, v142
    v_mfma_f32_32x32x16_bf16 v[176:191], v[228:231], v[84:87], v[176:191]
    ds_read_b128 v[228:231], v244 offset:58272
    v_exp_f32 v143, v143
    v_add_f32 v252, v252, v140
    s_waitcnt lgkmcnt(3)
    v_mfma_f32_32x32x16_bf16 v[160:175], v[232:235], v[24:27], v[160:175]
    v_add_f32 v252, v252, v141
    v_add_f32 v252, v252, v142
    v_add_f32 v252, v252, v143
    v_cvt_pk_bf16_f32 v134, v140, v141
    v_cvt_pk_bf16_f32 v135, v142, v143
    v_mfma_f32_32x32x16_bf16 v[176:191], v[232:235], v[88:91], v[176:191]
    ds_read_b128 v[232:235], v244 offset:58496
    v_exp_f32 v144, v144
    v_exp_f32 v145, v145
    s_waitcnt lgkmcnt(3)
    v_mfma_f32_32x32x16_bf16 v[160:175], v[236:239], v[28:31], v[160:175]
    v_exp_f32 v146, v146
    v_exp_f32 v147, v147
    v_mfma_f32_32x32x16_bf16 v[176:191], v[236:239], v[92:95], v[176:191]
    ds_read_b128 v[236:239], v244 offset:58528
    v_add_f32 v253, v253, v144
    v_add_f32 v253, v253, v145
    v_add_f32 v253, v253, v146
    s_waitcnt lgkmcnt(3)
    v_mfma_f32_32x32x16_bf16 v[160:175], v[224:227], v[32:35], v[160:175]
    v_add_f32 v253, v253, v147
    v_cvt_pk_bf16_f32 v144, v144, v145
    v_cvt_pk_bf16_f32 v145, v146, v147
    v_exp_f32 v148, v148
    v_mfma_f32_32x32x16_bf16 v[176:191], v[224:227], v[96:99], v[176:191]
    ds_read_b128 v[224:227], v244 offset:58752
    v_exp_f32 v149, v149
    s_waitcnt lgkmcnt(3)
    v_mfma_f32_32x32x16_bf16 v[160:175], v[228:231], v[36:39], v[160:175]
    v_exp_f32 v150, v150
    v_exp_f32 v151, v151
    v_add_f32 v253, v253, v148
    v_mfma_f32_32x32x16_bf16 v[176:191], v[228:231], v[100:103], v[176:191]
    ds_read_b128 v[228:231], v244 offset:58784
    v_add_f32 v253, v253, v149
    v_add_f32 v253, v253, v150
    v_add_f32 v253, v253, v151
    s_waitcnt lgkmcnt(3)
    v_mfma_f32_32x32x16_bf16 v[160:175], v[232:235], v[40:43], v[160:175]
    v_cvt_pk_bf16_f32 v146, v148, v149
    v_cvt_pk_bf16_f32 v147, v150, v151
    v_exp_f32 v152, v152
    v_mfma_f32_32x32x16_bf16 v[176:191], v[232:235], v[104:107], v[176:191]
    ds_read_b128 v[232:235], v244 offset:59008
    v_exp_f32 v153, v153
    v_exp_f32 v154, v154
    s_waitcnt lgkmcnt(3)
    v_mfma_f32_32x32x16_bf16 v[160:175], v[236:239], v[44:47], v[160:175]
    v_exp_f32 v155, v155
    v_add_f32 v253, v253, v152
    v_add_f32 v253, v253, v153
    v_mfma_f32_32x32x16_bf16 v[176:191], v[236:239], v[108:111], v[176:191]
    ds_read_b128 v[236:239], v244 offset:59040
    v_add_f32 v253, v253, v154
    v_add_f32 v253, v253, v155
    v_cvt_pk_bf16_f32 v148, v152, v153
    s_waitcnt lgkmcnt(3)
    v_mfma_f32_32x32x16_bf16 v[160:175], v[224:227], v[48:51], v[160:175]
    v_cvt_pk_bf16_f32 v149, v154, v155
    v_exp_f32 v156, v156
    v_exp_f32 v157, v157
    v_mfma_f32_32x32x16_bf16 v[176:191], v[224:227], v[112:115], v[176:191]
    s_waitcnt vmcnt(16)
    s_waitcnt lgkmcnt(0)
    s_barrier
    .p2align 6
L_loop:
    v_mfma_f32_32x32x16_bf16 v[160:175], v[228:231], v[52:55], v[160:175]
    ds_read_b64_tr_b16 v[136:137], v246 offset:33280
    ds_read_b64_tr_b16 v[138:139], v246 offset:35360
    s_add_u32 m0, s34, 74496
    v_exp_f32 v158, v158
    v_exp_f32 v159, v159
    v_mfma_f32_32x32x16_bf16 v[176:191], v[228:231], v[116:119], v[176:191]
    ds_read_b64_tr_b16 v[140:141], v246 offset:37440
    ds_read_b64_tr_b16 v[142:143], v246 offset:39520
    buffer_load_dwordx4 v249, s[8:11], s32 offen nt lds
    s_add_u32 m0, s34, 82560
    v_mfma_f32_32x32x16_bf16 v[160:175], v[232:235], v[56:59], v[160:175]
    buffer_load_dwordx4 v249, s[8:11], s32 offen offset:256 nt lds
    s_add_u32 m0, s34, 73488
    v_add_f32 v253, v253, v156
    v_add_f32 v253, v253, v157
    v_add_f32 v253, v253, v158
    v_mfma_f32_32x32x16_bf16 v[176:191], v[232:235], v[120:123], v[176:191]
    buffer_load_dwordx4 v249, s[8:11], s32 offen offset:2048 nt lds
    s_add_u32 m0, s34, 81552
    v_add_f32 v253, v253, v159
    v_cvt_pk_bf16_f32 v150, v156, v157
    v_cvt_pk_bf16_f32 v151, v158, v159
    v_mfma_f32_32x32x16_bf16 v[160:175], v[236:239], v[60:63], v[160:175]
    ds_read_b64_tr_b16 v[152:153], v246 offset:33536
    ds_read_b64_tr_b16 v[154:155], v246 offset:35616
    buffer_load_dwordx4 v249, s[8:11], s32 offen offset:2304 nt lds
    v_mfma_f32_32x32x16_bf16 v[176:191], v[236:239], v[124:127], v[176:191]
    s_add_u32 s87, s87, 16384
    s_and_b32 s87, s87, 0x7ffff
    s_add_u32 s32, s86, s87
    v_subrev_u32 v156, s41, v247
    ds_read_b32 v157, v156 offset:20484
    ds_read_b128 v[224:227], v156 offset:16384
    ds_read_b128 v[228:231], v156 offset:17408
    v_add_u32 v156, s42, v246
    s_waitcnt lgkmcnt(7)
    v_mfma_f32_32x32x16_bf16 a[0:15], v[136:139], v[128:131], a[0:15]
    ds_read_b64_tr_b16 v[232:233], v156 offset:33280
    ds_read_b64_tr_b16 v[234:235], v156 offset:35360
    ds_read_b64_tr_b16 v[236:237], v156 offset:33536
    ds_read_b64_tr_b16 v[238:239], v156 offset:35616
    v_mfma_f32_32x32x16_bf16 a[128:143], v[136:139], v[144:147], a[128:143]
    ds_read_b64_tr_b16 v[136:137], v246 offset:37696
    ds_read_b64_tr_b16 v[138:139], v246 offset:39776
    v_and_b32 v158, 0xfffffbff, v248
    s_waitcnt lgkmcnt(11)
    v_mfma_f32_32x32x16_bf16 a[0:15], v[140:143], v[132:135], a[0:15]
    ds_read2st64_b32 v[158:159], v158 offset0:88 offset1:92
    v_fma_f32 v160, v160, s31, v250
    v_fma_f32 v161, v161, s31, v250
    v_fma_f32 v162, v162, s31, v250
    v_mfma_f32_32x32x16_bf16 a[128:143], v[140:143], v[148:151], a[128:143]
    ds_read_b64_tr_b16 v[140:141], v246 offset:33792
    ds_read_b64_tr_b16 v[142:143], v246 offset:35872
    s_waitcnt lgkmcnt(11)
    v_cmp_neq_f32 vcc, 0x3f800000, v157
    s_cbranch_vccz L_skip9_1
    v_mul_f32 v192, v192, v157
    v_mul_f32 v193, v193, v157
    v_mul_f32 v194, v194, v157
    v_mul_f32 v195, v195, v157
    v_mul_f32 v196, v196, v157
    v_mul_f32 v197, v197, v157
    v_mul_f32 v198, v198, v157
    v_mul_f32 v199, v199, v157
    v_mul_f32 v200, v200, v157
    v_mul_f32 v201, v201, v157
    v_mul_f32 v202, v202, v157
    v_mul_f32 v203, v203, v157
    v_mul_f32 v204, v204, v157
    v_mul_f32 v205, v205, v157
    v_mul_f32 v206, v206, v157
    v_mul_f32 v207, v207, v157
    v_mul_f32 v208, v208, v157
    v_mul_f32 v209, v209, v157
    v_mul_f32 v210, v210, v157
    v_mul_f32 v211, v211, v157
    v_mul_f32 v212, v212, v157
    v_mul_f32 v213, v213, v157
    v_mul_f32 v214, v214, v157
    v_mul_f32 v215, v215, v157
    v_mul_f32 v216, v216, v157
    v_mul_f32 v217, v217, v157
    v_mul_f32 v218, v218, v157
    v_mul_f32 v219, v219, v157
    v_mul_f32 v220, v220, v157
    v_mul_f32 v221, v221, v157
    v_mul_f32 v222, v222, v157
    v_mul_f32 v223, v223, v157
L_skip9_1:
    v_mfma_f32_32x32x16_bf16 a[16:31], v[152:155], v[128:131], a[16:31]
    v_fma_f32 v163, v163, s31, v250
    v_fma_f32 v164, v164, s31, v250
    v_fma_f32 v165, v165, s31, v250
    s_waitcnt lgkmcnt(7)
    v_mfma_f32_32x32x16_bf16 v[192:207], v[232:235], v[224:227], v[192:207]
    v_fma_f32 v166, v166, s31, v250
    v_fma_f32 v167, v167, s31, v250
    v_fma_f32 v168, v168, s31, v250
    v_mfma_f32_32x32x16_bf16 a[144:159], v[152:155], v[144:147], a[144:159]
    ds_read_b64_tr_b16 v[152:153], v246 offset:37952
    ds_read_b64_tr_b16 v[154:155], v246 offset:40032
    s_waitcnt lgkmcnt(4)
    v_max_f32 v158, v158, v159
    v_mul_f32 v158, s31, v158
    v_add_f32 v159, s46, v254
    v_mfma_f32_32x32x16_bf16 v[208:223], v[236:239], v[224:227], v[208:223]
    ds_read_b64_tr_b16 v[232:233], v156 offset:37440
    ds_read_b64_tr_b16 v[234:235], v156 offset:39520
    ds_read_b64_tr_b16 v[236:237], v156 offset:37696
    ds_read_b64_tr_b16 v[238:239], v156 offset:39776
    s_add_u32 m0, s34, 107776
    v_cmp_gt_f32 vcc, v158, v159
    v_mfma_f32_32x32x16_bf16 a[16:31], v[136:139], v[132:135], a[16:31]
    buffer_load_dwordx4 v249, s[12:15], s33 offen nt lds
    v_cndmask_b32 v159, v254, v158, vcc
    v_sub_f32 v157, v254, v159
    v_mov_b32 v254, v159
    v_fma_f32 v169, v169, s31, v250
    v_mfma_f32_32x32x16_bf16 a[144:159], v[136:139], v[148:151], a[144:159]
    ds_read_b64_tr_b16 v[136:137], v246 offset:34048
    ds_read_b64_tr_b16 v[138:139], v246 offset:36128
    v_exp_f32 v157, v157
    v_fma_f32 v240, v240, s31, -v254
    s_waitcnt lgkmcnt(8)
    v_mfma_f32_32x32x16_bf16 a[32:47], v[140:143], v[128:131], a[32:47]
    v_fma_f32 v241, v241, s31, -v254
    v_fma_f32 v242, v242, s31, -v254
    v_fma_f32 v243, v243, s31, -v254
    v_exp_f32 v240, v240
    s_waitcnt lgkmcnt(4)
    v_mfma_f32_32x32x16_bf16 v[192:207], v[232:235], v[228:231], v[192:207]
    ds_read_b128 v[224:227], v245
    v_exp_f32 v241, v241
    v_exp_f32 v242, v242
    v_exp_f32 v243, v243
    v_mfma_f32_32x32x16_bf16 a[160:175], v[140:143], v[144:147], a[160:175]
    ds_read_b64_tr_b16 v[140:141], v246 offset:38208
    ds_read_b64_tr_b16 v[142:143], v246 offset:40288
    v_fma_f32 v255, v255, v157, v240
    v_add_f32 v255, v255, v241
    v_fma_f32 v170, v170, s31, v250
    s_waitcnt lgkmcnt(5)
    v_mfma_f32_32x32x16_bf16 v[208:223], v[236:239], v[228:231], v[208:223]
    ds_read_b128 v[228:231], v247
    s_add_u32 m0, s34, 115840
    v_add_f32 v255, v255, v242
    v_add_f32 v255, v255, v243
    v_cvt_pk_bf16_f32 v240, v240, v241
    v_cvt_pk_bf16_f32 v241, v242, v243
    v_mfma_f32_32x32x16_bf16 a[32:47], v[152:155], v[132:135], a[32:47]
    ds_read_b128 v[232:235], v245 offset:256
    ds_read_b128 v[236:239], v247 offset:1024
    buffer_load_dwordx4 v249, s[12:15], s33 offen offset:256 nt lds
    ds_write_b64 v248, v[240:241] offset:18432
    ds_write_b32 v248, v157 offset:22532
    v_mfma_f32_32x32x16_bf16 a[160:175], v[152:155], v[148:151], a[160:175]
    ds_read_b64_tr_b16 v[152:153], v246 offset:41600
    ds_read_b64_tr_b16 v[154:155], v246 offset:43680
    s_add_u32 m0, s34, 106768
    v_fma_f32 v171, v171, s31, v250
    s_waitcnt lgkmcnt(10)
    v_mfma_f32_32x32x16_bf16 a[48:63], v[136:139], v[128:131], a[48:63]
    buffer_load_dwordx4 v249, s[12:15], s33 offen offset:2048 nt lds
    v_fma_f32 v172, v172, s31, v250
    v_fma_f32 v173, v173, s31, v250
    s_waitcnt lgkmcnt(6)
    v_mfma_f32_16x16x32_bf16 v[240:243], v[224:227], v[228:231], 0
    ds_read_b128 v[224:227], v245 offset:512
    ds_read_b128 v[228:231], v247 offset:2048
    v_mfma_f32_32x32x16_bf16 a[176:191], v[136:139], v[144:147], a[176:191]
    ds_read_b64_tr_b16 v[136:137], v246 offset:45760
    ds_read_b64_tr_b16 v[138:139], v246 offset:47840
    s_add_u32 m0, s34, 114832
    v_fma_f32 v174, v174, s31, v250
    v_mfma_f32_32x32x16_bf16 a[48:63], v[140:143], v[132:135], a[48:63]
    buffer_load_dwordx4 v249, s[12:15], s33 offen offset:2304 nt lds
    v_fma_f32 v175, v175, s31, v250
    v_fma_f32 v176, v176, s31, v251
    s_waitcnt lgkmcnt(8)
    v_mfma_f32_16x16x32_bf16 v[240:243], v[232:235], v[236:239], v[240:243]
    ds_read_b128 v[232:235], v245 offset:768
    ds_read_b128 v[236:239], v247 offset:3072
    v_mfma_f32_32x32x16_bf16 a[176:191], v[140:143], v[148:151], a[176:191]
    ds_read_b64_tr_b16 v[140:141], v246 offset:41856
    ds_read_b64_tr_b16 v[142:143], v246 offset:43936
    s_add_u32 s88, s88, 16384
    s_and_b32 s88, s88, 0x7ffff
    s_add_u32 s33, s86, s88
    s_waitcnt lgkmcnt(8)
    v_mfma_f32_32x32x16_bf16 a[64:79], v[152:155], v[128:131], a[64:79]
    v_fma_f32 v177, v177, s31, v251
    v_fma_f32 v178, v178, s31, v251
    v_fma_f32 v179, v179, s31, v251
    s_waitcnt lgkmcnt(6)
    v_mfma_f32_16x16x32_bf16 v[240:243], v[224:227], v[228:231], v[240:243]
    ds_read_b128 v[224:227], v245 offset:8320
    ds_read_b128 v[228:231], v247 offset:4096
    v_mfma_f32_32x32x16_bf16 a[192:207], v[152:155], v[144:147], a[192:207]
    ds_read_b64_tr_b16 v[152:153], v246 offset:46016
    ds_read_b64_tr_b16 v[154:155], v246 offset:48096
    v_fma_f32 v180, v180, s31, v251
    v_fma_f32 v181, v181, s31, v251
    s_waitcnt lgkmcnt(8)
    v_mfma_f32_32x32x16_bf16 a[64:79], v[136:139], v[132:135], a[64:79]
    v_fma_f32 v182, v182, s31, v251
    v_fma_f32 v183, v183, s31, v251
    v_fma_f32 v184, v184, s31, v251
    s_waitcnt lgkmcnt(6)
    v_mfma_f32_16x16x32_bf16 v[240:243], v[232:235], v[236:239], v[240:243]
    ds_read_b128 v[232:235], v245 offset:8576
    ds_read_b128 v[236:239], v247 offset:5120
    v_mfma_f32_32x32x16_bf16 a[192:207], v[136:139], v[148:151], a[192:207]
    ds_read_b64_tr_b16 v[136:137], v246 offset:42112
    ds_read_b64_tr_b16 v[138:139], v246 offset:44192
    v_fma_f32 v185, v185, s31, v251
    s_waitcnt lgkmcnt(8)
    v_mfma_f32_32x32x16_bf16 a[80:95], v[140:143], v[128:131], a[80:95]
    v_fma_f32 v186, v186, s31, v251
    v_fma_f32 v187, v187, s31, v251
    v_fma_f32 v188, v188, s31, v251
    v_fma_f32 v189, v189, s31, v251
    s_waitcnt lgkmcnt(6)
    v_mfma_f32_16x16x32_bf16 v[240:243], v[224:227], v[228:231], v[240:243]
    ds_read_b128 v[224:227], v245 offset:8832
    ds_read_b128 v[228:231], v247 offset:6144
    v_mfma_f32_32x32x16_bf16 a[208:223], v[140:143], v[144:147], a[208:223]
    ds_read_b64_tr_b16 v[140:141], v246 offset:46272
    ds_read_b64_tr_b16 v[142:143], v246 offset:48352
    v_fma_f32 v190, v190, s31, v251
    s_waitcnt lgkmcnt(8)
    v_mfma_f32_32x32x16_bf16 a[80:95], v[152:155], v[132:135], a[80:95]
    v_fma_f32 v191, v191, s31, v251
    v_max3_f32 v157, v160, v161, v162
    v_max3_f32 v157, v157, v163, v164
    s_waitcnt lgkmcnt(6)
    v_mfma_f32_16x16x32_bf16 v[240:243], v[232:235], v[236:239], v[240:243]
    ds_read_b128 v[232:235], v245 offset:9088
    ds_read_b128 v[236:239], v247 offset:7168
    v_mfma_f32_32x32x16_bf16 a[208:223], v[152:155], v[148:151], a[208:223]
    ds_read_b64_tr_b16 v[152:153], v246 offset:42368
    ds_read_b64_tr_b16 v[154:155], v246 offset:44448
    v_max3_f32 v157, v157, v165, v166
    v_max3_f32 v157, v157, v167, v168
    s_waitcnt lgkmcnt(6)
    v_mfma_f32_16x16x32_bf16 v[240:243], v[224:227], v[228:231], v[240:243]
    ds_read_b128 v[224:227], v244
    v_mfma_f32_32x32x16_bf16 a[96:111], v[136:139], v[128:131], a[96:111]
    ds_read_b128 v[228:231], v244 offset:32
    v_max3_f32 v157, v157, v169, v170
    v_max3_f32 v157, v157, v171, v172
    v_max3_f32 v157, v157, v173, v174
    v_mfma_f32_32x32x16_bf16 a[224:239], v[136:139], v[144:147], a[224:239]
    ds_read_b64_tr_b16 v[136:137], v246 offset:46528
    ds_read_b64_tr_b16 v[138:139], v246 offset:48608
    v_max3_f32 v157, v157, v175, v176
    s_waitcnt lgkmcnt(6)
    v_mfma_f32_16x16x32_bf16 v[240:243], v[232:235], v[236:239], v[240:243]
    ds_read_b128 v[232:235], v244 offset:256
    v_max3_f32 v157, v157, v177, v178
    v_mfma_f32_32x32x16_bf16 a[96:111], v[140:143], v[132:135], a[96:111]
    ds_read_b128 v[236:239], v244 offset:288
    v_max3_f32 v157, v157, v179, v180
    v_max3_f32 v157, v157, v181, v182
    v_mfma_f32_32x32x16_bf16 a[224:239], v[140:143], v[148:151], a[224:239]
    s_nop 0
    v_max3_f32 v158, v240, v241, v242
    v_max_f32 v158, v158, v243
    v_mov_b32 v159, v158
    v_max3_f32 v157, v157, v183, v184
    v_max3_f32 v157, v157, v185, v186
    s_waitcnt lgkmcnt(6)
    v_mfma_f32_32x32x16_bf16 a[112:127], v[152:155], v[128:131], a[112:127]
    v_permlane32_swap_b32 v158, v159
    v_max_f32 v158, v158, v159
    v_mov_b32 v159, v158
    v_max3_f32 v157, v157, v187, v188
    v_mfma_f32_32x32x16_bf16 a[240:255], v[152:155], v[144:147], a[240:255]
    v_permlane16_swap_b32 v158, v159
    v_max_f32 v158, v158, v159
    ds_write_b32 v248, v158 offset:20480
    v_max3_f32 v157, v157, v189, v190
    v_max_f32 v157, v157, v191
    s_waitcnt lgkmcnt(3)
    v_mfma_f32_32x32x16_bf16 a[112:127], v[136:139], v[132:135], a[112:127]
    v_cmp_lt_f32 vcc, s46, v157
    v_mfma_f32_32x32x16_bf16 a[240:255], v[136:139], v[148:151], a[240:255]
    s_cbranch_vccz L_norare_2
    s_call_b64 s[44:45], L_rare0
L_norare_2:
    v_mfma_f32_32x32x16_bf16 v[128:143], v[224:227], v[0:3], 0
    v_exp_f32 v160, v160
    v_exp_f32 v161, v161
    v_exp_f32 v162, v162
    v_mfma_f32_32x32x16_bf16 v[144:159], v[224:227], v[64:67], 0
    ds_read_b128 v[224:227], v244 offset:512
    v_exp_f32 v163, v163
    v_mfma_f32_32x32x16_bf16 v[128:143], v[228:231], v[4:7], v[128:143]
    v_add_f32 v252, v252, v160
    v_add_f32 v252, v252, v161
    v_add_f32 v252, v252, v162
    v_add_f32 v252, v252, v163
    v_cvt_pk_bf16_f32 v160, v160, v161
    v_cvt_pk_bf16_f32 v161, v162, v163
    v_mfma_f32_32x32x16_bf16 v[144:159], v[228:231], v[68:71], v[144:159]
    ds_read_b128 v[228:231], v244 offset:544
    v_exp_f32 v164, v164
    s_waitcnt lgkmcnt(4)
    v_mfma_f32_32x32x16_bf16 v[128:143], v[232:235], v[8:11], v[128:143]
    v_exp_f32 v165, v165
    v_exp_f32 v166, v166
    v_exp_f32 v167, v167
    v_mfma_f32_32x32x16_bf16 v[144:159], v[232:235], v[72:75], v[144:159]
    ds_read_b128 v[232:235], v244 offset:768
    v_add_f32 v252, v252, v164
    v_add_f32 v252, v252, v165
    v_add_f32 v252, v252, v166
    s_waitcnt lgkmcnt(4)
    v_mfma_f32_32x32x16_bf16 v[128:143], v[236:239], v[12:15], v[128:143]
    v_add_f32 v252, v252, v167
    v_cvt_pk_bf16_f32 v162, v164, v165
    v_cvt_pk_bf16_f32 v163, v166, v167
    v_exp_f32 v168, v168
    v_mfma_f32_32x32x16_bf16 v[144:159], v[236:239], v[76:79], v[144:159]
    ds_read_b128 v[236:239], v244 offset:800
    v_exp_f32 v169, v169
    v_exp_f32 v170, v170
    s_waitcnt lgkmcnt(3)
    v_mfma_f32_32x32x16_bf16 v[128:143], v[224:227], v[16:19], v[128:143]
    v_exp_f32 v171, v171
    v_add_f32 v252, v252, v168
    v_add_f32 v252, v252, v169
    v_add_f32 v252, v252, v170
    v_mfma_f32_32x32x16_bf16 v[144:159], v[224:227], v[80:83], v[144:159]
    ds_read_b128 v[224:227], v244 offset:8320
    v_add_f32 v252, v252, v171
    v_cvt_pk_bf16_f32 v164, v168, v169
    v_cvt_pk_bf16_f32 v165, v170, v171
    s_waitcnt lgkmcnt(3)
    v_mfma_f32_32x32x16_bf16 v[128:143], v[228:231], v[20:23], v[128:143]
    v_exp_f32 v172, v172
    v_exp_f32 v173, v173
    v_exp_f32 v174, v174
    v_mfma_f32_32x32x16_bf16 v[144:159], v[228:231], v[84:87], v[144:159]
    ds_read_b128 v[228:231], v244 offset:8352
    v_exp_f32 v175, v175
    v_add_f32 v252, v252, v172
    s_waitcnt lgkmcnt(3)
    v_mfma_f32_32x32x16_bf16 v[128:143], v[232:235], v[24:27], v[128:143]
    v_add_f32 v252, v252, v173
    v_add_f32 v252, v252, v174
    v_add_f32 v252, v252, v175
    v_cvt_pk_bf16_f32 v166, v172, v173
    v_cvt_pk_bf16_f32 v167, v174, v175
    v_mfma_f32_32x32x16_bf16 v[144:159], v[232:235], v[88:91], v[144:159]
    ds_read_b128 v[232:235], v244 offset:8576
    v_exp_f32 v176, v176
    v_exp_f32 v177, v177
    s_waitcnt lgkmcnt(3)
    v_mfma_f32_32x32x16_bf16 v[128:143], v[236:239], v[28:31], v[128:143]
    v_exp_f32 v178, v178
    v_exp_f32 v179, v179
    v_mfma_f32_32x32x16_bf16 v[144:159], v[236:239], v[92:95], v[144:159]
    ds_read_b128 v[236:239], v244 offset:8608
    v_add_f32 v253, v253, v176
    v_add_f32 v253, v253, v177
    v_add_f32 v253, v253, v178
    s_waitcnt lgkmcnt(3)
    v_mfma_f32_32x32x16_bf16 v[128:143], v[224:227], v[32:35], v[128:143]
    v_add_f32 v253, v253, v179
    v_cvt_pk_bf16_f32 v176, v176, v177
    v_cvt_pk_bf16_f32 v177, v178, v179
    v_exp_f32 v180, v180
    v_mfma_f32_32x32x16_bf16 v[144:159], v[224:227], v[96:99], v[144:159]
    ds_read_b128 v[224:227], v244 offset:8832
    v_exp_f32 v181, v181
    s_waitcnt lgkmcnt(3)
    v_mfma_f32_32x32x16_bf16 v[128:143], v[228:231], v[36:39], v[128:143]
    v_exp_f32 v182, v182
    v_exp_f32 v183, v183
    v_add_f32 v253, v253, v180
    v_mfma_f32_32x32x16_bf16 v[144:159], v[228:231], v[100:103], v[144:159]
    ds_read_b128 v[228:231], v244 offset:8864
    v_add_f32 v253, v253, v181
    v_add_f32 v253, v253, v182
    v_add_f32 v253, v253, v183
    s_waitcnt lgkmcnt(3)
    v_mfma_f32_32x32x16_bf16 v[128:143], v[232:235], v[40:43], v[128:143]
    v_cvt_pk_bf16_f32 v178, v180, v181
    v_cvt_pk_bf16_f32 v179, v182, v183
    v_exp_f32 v184, v184
    v_mfma_f32_32x32x16_bf16 v[144:159], v[232:235], v[104:107], v[144:159]
    ds_read_b128 v[232:235], v244 offset:9088
    v_exp_f32 v185, v185
    v_exp_f32 v186, v186
    s_waitcnt lgkmcnt(3)
    v_mfma_f32_32x32x16_bf16 v[128:143], v[236:239], v[44:47], v[128:143]
    v_exp_f32 v187, v187
    v_add_f32 v253, v253, v184
    v_add_f32 v253, v253, v185
    v_mfma_f32_32x32x16_bf16 v[144:159], v[236:239], v[108:111], v[144:159]
    ds_read_b128 v[236:239], v244 offset:9120
    v_add_f32 v253, v253, v186
    v_add_f32 v253, v253, v187
    v_cvt_pk_bf16_f32 v180, v184, v185
    s_waitcnt lgkmcnt(3)
    v_mfma_f32_32x32x16_bf16 v[128:143], v[224:227], v[48:51], v[128:143]
    v_cvt_pk_bf16_f32 v181, v186, v187
    v_exp_f32 v188, v188
    v_exp_f32 v189, v189
    v_mfma_f32_32x32x16_bf16 v[144:159], v[224:227], v[112:115], v[144:159]
    s_waitcnt vmcnt(16)
    s_waitcnt lgkmcnt(0)
    s_barrier
    v_mfma_f32_32x32x16_bf16 v[128:143], v[228:231], v[52:55], v[128:143]
    ds_read_b64_tr_b16 v[168:169], v246 offset:49920
    ds_read_b64_tr_b16 v[170:171], v246 offset:52000
    s_add_u32 m0, s34, 24576
    v_exp_f32 v190, v190
    v_exp_f32 v191, v191
    v_mfma_f32_32x32x16_bf16 v[144:159], v[228:231], v[116:119], v[144:159]
    ds_read_b64_tr_b16 v[172:173], v246 offset:54080
    ds_read_b64_tr_b16 v[174:175], v246 offset:56160
    buffer_load_dwordx4 v249, s[8:11], s32 offen nt lds
    s_add_u32 m0, s34, 32640
    v_mfma_f32_32x32x16_bf16 v[128:143], v[232:235], v[56:59], v[128:143]
    buffer_load_dwordx4 v249, s[8:11], s32 offen offset:256 nt lds
    s_add_u32 m0, s34, 23568
    v_add_f32 v253, v253, v188
    v_add_f32 v253, v253, v189
    v_add_f32 v253, v253, v190
    v_mfma_f32_32x32x16_bf16 v[144:159], v[232:235], v[120:123], v[144:159]
    buffer_load_dwordx4 v249, s[8:11], s32 offen offset:2048 nt lds
    s_add_u32 m0, s34, 31632
    v_add_f32 v253, v253, v191
    v_cvt_pk_bf16_f32 v182, v188, v189
    v_cvt_pk_bf16_f32 v183, v190, v191
    v_mfma_f32_32x32x16_bf16 v[128:143], v[236:239], v[60:63], v[128:143]
    ds_read_b64_tr_b16 v[184:185], v246 offset:50176
    ds_read_b64_tr_b16 v[186:187], v246 offset:52256
    buffer_load_dwordx4 v249, s[8:11], s32 offen offset:2304 nt lds
    v_mfma_f32_32x32x16_bf16 v[144:159], v[236:239], v[124:127], v[144:159]
    s_add_u32 s87, s87, 16384
    s_and_b32 s87, s87, 0x7ffff
    s_add_u32 s32, s86, s87
    v_subrev_u32 v188, s41, v247
    ds_read_b32 v189, v188 offset:22532
    ds_read_b128 v[224:227], v188 offset:18432
    ds_read_b128 v[228:231], v188 offset:19456
    v_add_u32 v188, s42, v246
    s_waitcnt lgkmcnt(7)
    v_mfma_f32_32x32x16_bf16 a[0:15], v[168:171], v[160:163], a[0:15]
    ds_read_b64_tr_b16 v[232:233], v188 offset:49920
    ds_read_b64_tr_b16 v[234:235], v188 offset:52000
    ds_read_b64_tr_b16 v[236:237], v188 offset:50176
    ds_read_b64_tr_b16 v[238:239], v188 offset:52256
    v_mfma_f32_32x32x16_bf16 a[128:143], v[168:171], v[176:179], a[128:143]
    ds_read_b64_tr_b16 v[168:169], v246 offset:54336
    ds_read_b64_tr_b16 v[170:171], v246 offset:56416
    v_and_b32 v190, 0xfffffbff, v248
    s_waitcnt lgkmcnt(11)
    v_mfma_f32_32x32x16_bf16 a[0:15], v[172:175], v[164:167], a[0:15]
    ds_read2st64_b32 v[190:191], v190 offset0:80 offset1:84
    v_fma_f32 v128, v128, s31, v250
    v_fma_f32 v129, v129, s31, v250
    v_fma_f32 v130, v130, s31, v250
    v_mfma_f32_32x32x16_bf16 a[128:143], v[172:175], v[180:183], a[128:143]
    ds_read_b64_tr_b16 v[172:173], v246 offset:50432
    ds_read_b64_tr_b16 v[174:175], v246 offset:52512
    s_waitcnt lgkmcnt(11)
    v_cmp_neq_f32 vcc, 0x3f800000, v189
    s_cbranch_vccz L_skip9_3
    v_mul_f32 v192, v192, v189
    v_mul_f32 v193, v193, v189
    v_mul_f32 v194, v194, v189
    v_mul_f32 v195, v195, v189
    v_mul_f32 v196, v196, v189
    v_mul_f32 v197, v197, v189
    v_mul_f32 v198, v198, v189
    v_mul_f32 v199, v199, v189
    v_mul_f32 v200, v200, v189
    v_mul_f32 v201, v201, v189
    v_mul_f32 v202, v202, v189
    v_mul_f32 v203, v203, v189
    v_mul_f32 v204, v204, v189
    v_mul_f32 v205, v205, v189
    v_mul_f32 v206, v206, v189
    v_mul_f32 v207, v207, v189
    v_mul_f32 v208, v208, v189
    v_mul_f32 v209, v209, v189
    v_mul_f32 v210, v210, v189
    v_mul_f32 v211, v211, v189
    v_mul_f32 v212, v212, v189
    v_mul_f32 v213, v213, v189
    v_mul_f32 v214, v214, v189
    v_mul_f32 v215, v215, v189
    v_mul_f32 v216, v216, v189
    v_mul_f32 v217, v217, v189
    v_mul_f32 v218, v218, v189
    v_mul_f32 v219, v219, v189
    v_mul_f32 v220, v220, v189
    v_mul_f32 v221, v221, v189
    v_mul_f32 v222, v222, v189
    v_mul_f32 v223, v223, v189
L_skip9_3:
    v_mfma_f32_32x32x16_bf16 a[16:31], v[184:187], v[160:163], a[16:31]
    v_fma_f32 v131, v131, s31, v250
    v_fma_f32 v132, v132, s31, v250
    v_fma_f32 v133, v133, s31, v250
    s_waitcnt lgkmcnt(7)
    v_mfma_f32_32x32x16_bf16 v[192:207], v[232:235], v[224:227], v[192:207]
    v_fma_f32 v134, v134, s31, v250
    v_fma_f32 v135, v135, s31, v250
    v_fma_f32 v136, v136, s31, v250
    v_mfma_f32_32x32x16_bf16 a[144:159], v[184:187], v[176:179], a[144:159]
    ds_read_b64_tr_b16 v[184:185], v246 offset:54592
    ds_read_b64_tr_b16 v[186:187], v246 offset:56672
    s_waitcnt lgkmcnt(4)
    v_max_f32 v190, v190, v191
    v_mul_f32 v190, s31, v190
    v_add_f32 v191, s46, v254
    v_mfma_f32_32x32x16_bf16 v[208:223], v[236:239], v[224:227], v[208:223]
    ds_read_b64_tr_b16 v[232:233], v188 offset:54080
    ds_read_b64_tr_b16 v[234:235], v188 offset:56160
    ds_read_b64_tr_b16 v[236:237], v188 offset:54336
    ds_read_b64_tr_b16 v[238:239], v188 offset:56416
    s_add_u32 m0, s34, 124416
    v_cmp_gt_f32 vcc, v190, v191
    v_mfma_f32_32x32x16_bf16 a[16:31], v[168:171], v[164:167], a[16:31]
    buffer_load_dwordx4 v249, s[12:15], s33 offen nt lds
    v_cndmask_b32 v191, v254, v190, vcc
    v_sub_f32 v189, v254, v191
    v_mov_b32 v254, v191
    v_fma_f32 v137, v137, s31, v250
    v_mfma_f32_32x32x16_bf16 a[144:159], v[168:171], v[180:183], a[144:159]
    ds_read_b64_tr_b16 v[168:169], v246 offset:50688
    ds_read_b64_tr_b16 v[170:171], v246 offset:52768
    v_exp_f32 v189, v189
    v_fma_f32 v240, v240, s31, -v254
    s_waitcnt lgkmcnt(8)
    v_mfma_f32_32x32x16_bf16 a[32:47], v[172:175], v[160:163], a[32:47]
    v_fma_f32 v241, v241, s31, -v254
    v_fma_f32 v242, v242, s31, -v254
    v_fma_f32 v243, v243, s31, -v254
    v_exp_f32 v240, v240
    s_waitcnt lgkmcnt(4)
    v_mfma_f32_32x32x16_bf16 v[192:207], v[232:235], v[228:231], v[192:207]
    ds_read_b128 v[224:227], v245 offset:16640
    v_exp_f32 v241, v241
    v_exp_f32 v242, v242
    v_exp_f32 v243, v243
    v_mfma_f32_32x32x16_bf16 a[160:175], v[172:175], v[176:179], a[160:175]
    ds_read_b64_tr_b16 v[172:173], v246 offset:54848
    ds_read_b64_tr_b16 v[174:175], v246 offset:56928
    v_fma_f32 v255, v255, v189, v240
    v_add_f32 v255, v255, v241
    v_fma_f32 v138, v138, s31, v250
    s_waitcnt lgkmcnt(5)
    v_mfma_f32_32x32x16_bf16 v[208:223], v[236:239], v[228:231], v[208:223]
    ds_read_b128 v[228:231], v247
    s_add_u32 m0, s34, 132480
    v_add_f32 v255, v255, v242
    v_add_f32 v255, v255, v243
    v_cvt_pk_bf16_f32 v240, v240, v241
    v_cvt_pk_bf16_f32 v241, v242, v243
    v_mfma_f32_32x32x16_bf16 a[32:47], v[184:187], v[164:167], a[32:47]
    ds_read_b128 v[232:235], v245 offset:16896
    ds_read_b128 v[236:239], v247 offset:1024
    buffer_load_dwordx4 v249, s[12:15], s33 offen offset:256 nt lds
    ds_write_b64 v248, v[240:241] offset:16384
    ds_write_b32 v248, v189 offset:20484
    v_mfma_f32_32x32x16_bf16 a[160:175], v[184:187], v[180:183], a[160:175]
    ds_read_b64_tr_b16 v[184:185], v246 offset:58240
    ds_read_b64_tr_b16 v[186:187], v246 offset:60320
    s_add_u32 m0, s34, 123408
    v_fma_f32 v139, v139, s31, v250
    s_waitcnt lgkmcnt(10)
    v_mfma_f32_32x32x16_bf16 a[48:63], v[168:171], v[160:163], a[48:63]
    buffer_load_dwordx4 v249, s[12:15], s33 offen offset:2048 nt lds
    v_fma_f32 v140, v140, s31, v250
    v_fma_f32 v141, v141, s31, v250
    s_waitcnt lgkmcnt(6)
    v_mfma_f32_16x16x32_bf16 v[240:243], v[224:227], v[228:231], 0
    ds_read_b128 v[224:227], v245 offset:17152
    ds_read_b128 v[228:231], v247 offset:2048
    v_mfma_f32_32x32x16_bf16 a[176:191], v[168:171], v[176:179], a[176:191]
    ds_read_b64_tr_b16 v[168:169], v246 offset:62400
    ds_read_b64_tr_b16 v[170:171], v246 offset:64480
    s_add_u32 m0, s34, 131472
    v_fma_f32 v142, v142, s31, v250
    v_mfma_f32_32x32x16_bf16 a[48:63], v[172:175], v[164:167], a[48:63]
    buffer_load_dwordx4 v249, s[12:15], s33 offen offset:2304 nt lds
    v_fma_f32 v143, v143, s31, v250
    v_fma_f32 v144, v144, s31, v251
    s_waitcnt lgkmcnt(8)
    v_mfma_f32_16x16x32_bf16 v[240:243], v[232:235], v[236:239], v[240:243]
    ds_read_b128 v[232:235], v245 offset:17408
    ds_read_b128 v[236:239], v247 offset:3072
    v_mfma_f32_32x32x16_bf16 a[176:191], v[172:175], v[180:183], a[176:191]
    ds_read_b64_tr_b16 v[172:173], v246 offset:58496
    ds_read_b64_tr_b16 v[174:175], v246 offset:60576
    s_add_u32 s88, s88, 16384
    s_and_b32 s88, s88, 0x7ffff
    s_add_u32 s33, s86, s88
    s_waitcnt lgkmcnt(8)
    v_mfma_f32_32x32x16_bf16 a[64:79], v[184:187], v[160:163], a[64:79]
    v_fma_f32 v145, v145, s31, v251
    v_fma_f32 v146, v146, s31, v251
    v_fma_f32 v147, v147, s31, v251
    s_waitcnt lgkmcnt(6)
    v_mfma_f32_16x16x32_bf16 v[240:243], v[224:227], v[228:231], v[240:243]
    ds_read_b128 v[224:227], v245 offset:24960
    ds_read_b128 v[228:231], v247 offset:4096
    v_mfma_f32_32x32x16_bf16 a[192:207], v[184:187], v[176:179], a[192:207]
    ds_read_b64_tr_b16 v[184:185], v246 offset:62656
    ds_read_b64_tr_b16 v[186:187], v246 offset:64736
    v_fma_f32 v148, v148, s31, v251
    v_fma_f32 v149, v149, s31, v251
    s_waitcnt lgkmcnt(8)
    v_mfma_f32_32x32x16_bf16 a[64:79], v[168:171], v[164:167], a[64:79]
    v_fma_f32 v150, v150, s31, v251
    v_fma_f32 v151, v151, s31, v251
    v_fma_f32 v152, v152, s31, v251
    s_waitcnt lgkmcnt(6)
    v_mfma_f32_16x16x32_bf16 v[240:243], v[232:235], v[236:239], v[240:243]
    ds_read_b128 v[232:235], v245 offset:25216
    ds_read_b128 v[236:239], v247 offset:5120
    v_mfma_f32_32x32x16_bf16 a[192:207], v[168:171], v[180:183], a[192:207]
    ds_read_b64_tr_b16 v[168:169], v246 offset:58752
    ds_read_b64_tr_b16 v[170:171], v246 offset:60832
    v_fma_f32 v153, v153, s31, v251
    s_waitcnt lgkmcnt(8)
    v_mfma_f32_32x32x16_bf16 a[80:95], v[172:175], v[160:163], a[80:95]
    v_fma_f32 v154, v154, s31, v251
    v_fma_f32 v155, v155, s31, v251
    v_fma_f32 v156, v156, s31, v251
    v_fma_f32 v157, v157, s31, v251
    s_waitcnt lgkmcnt(6)
    v_mfma_f32_16x16x32_bf16 v[240:243], v[224:227], v[228:231], v[240:243]
    ds_read_b128 v[224:227], v245 offset:25472
    ds_read_b128 v[228:231], v247 offset:6144
    v_mfma_f32_32x32x16_bf16 a[208:223], v[172:175], v[176:179], a[208:223]
    ds_read_b64_tr_b16 v[172:173], v246 offset:62912
    ds_read_b64_tr_b16 v[174:175], v246 offset:64992
    v_fma_f32 v158, v158, s31, v251
    s_waitcnt lgkmcnt(8)
    v_mfma_f32_32x32x16_bf16 a[80:95], v[184:187], v[164:167], a[80:95]
    v_fma_f32 v159, v159, s31, v251
    v_max3_f32 v189, v128, v129, v130
    v_max3_f32 v189, v189, v131, v132
    s_waitcnt lgkmcnt(6)
    v_mfma_f32_16x16x32_bf16 v[240:243], v[232:235], v[236:239], v[240:243]
    ds_read_b128 v[232:235], v245 offset:25728
    ds_read_b128 v[236:239], v247 offset:7168
    v_mfma_f32_32x32x16_bf16 a[208:223], v[184:187], v[180:183], a[208:223]
    ds_read_b64_tr_b16 v[184:185], v246 offset:59008
    ds_read_b64_tr_b16 v[186:187], v246 offset:61088
    v_max3_f32 v189, v189, v133, v134
    v_max3_f32 v189, v189, v135, v136
    s_waitcnt lgkmcnt(6)
    v_mfma_f32_16x16x32_bf16 v[240:243], v[224:227], v[228:231], v[240:243]
    ds_read_b128 v[224:227], v244 offset:16640
    v_mfma_f32_32x32x16_bf16 a[96:111], v[168:171], v[160:163], a[96:111]
    ds_read_b128 v[228:231], v244 offset:16672
    v_max3_f32 v189, v189, v137, v138
    v_max3_f32 v189, v189, v139, v140
    v_max3_f32 v189, v189, v141, v142
    v_mfma_f32_32x32x16_bf16 a[224:239], v[168:171], v[176:179], a[224:239]
    ds_read_b64_tr_b16 v[168:169], v246 offset:63168
    ds_read_b64_tr_b16 v[170:171], v246 offset:65248
    v_max3_f32 v189, v189, v143, v144
    s_waitcnt lgkmcnt(6)
    v_mfma_f32_16x16x32_bf16 v[240:243], v[232:235], v[236:239], v[240:243]
    ds_read_b128 v[232:235], v244 offset:16896
    v_max3_f32 v189, v189, v145, v146
    v_mfma_f32_32x32x16_bf16 a[96:111], v[172:175], v[164:167], a[96:111]
    ds_read_b128 v[236:239], v244 offset:16928
    v_max3_f32 v189, v189, v147, v148
    v_max3_f32 v189, v189, v149, v150
    v_mfma_f32_32x32x16_bf16 a[224:239], v[172:175], v[180:183], a[224:239]
    s_nop 0
    v_max3_f32 v190, v240, v241, v242
    v_max_f32 v190, v190, v243
    v_mov_b32 v191, v190
    v_max3_f32 v189, v189, v151, v152
    v_max3_f32 v189, v189, v153, v154
    s_waitcnt lgkmcnt(6)
    v_mfma_f32_32x32x16_bf16 a[112:127], v[184:187], v[160:163], a[112:127]
    v_permlane32_swap_b32 v190, v191
    v_max_f32 v190, v190, v191
    v_mov_b32 v191, v190
    v_max3_f32 v189, v189, v155, v156
    v_mfma_f32_32x32x16_bf16 a[240:255], v[184:187], v[176:179], a[240:255]
    v_permlane16_swap_b32 v190, v191
    v_max_f32 v190, v190, v191
    ds_write_b32 v248, v190 offset:22528
    v_max3_f32 v189, v189, v157, v158
    v_max_f32 v189, v189, v159
    s_waitcnt lgkmcnt(3)
    v_mfma_f32_32x32x16_bf16 a[112:127], v[168:171], v[164:167], a[112:127]
    v_cmp_lt_f32 vcc, s46, v189
    v_mfma_f32_32x32x16_bf16 a[240:255], v[168:171], v[180:183], a[240:255]
    s_cbranch_vccz L_norare_4
    s_call_b64 s[44:45], L_rare1
L_norare_4:
    v_mfma_f32_32x32x16_bf16 v[160:175], v[224:227], v[0:3], 0
    v_exp_f32 v128, v128
    v_exp_f32 v129, v129
    v_exp_f32 v130, v130
    v_mfma_f32_32x32x16_bf16 v[176:191], v[224:227], v[64:67], 0
    ds_read_b128 v[224:227], v244 offset:17152
    v_exp_f32 v131, v131
    v_mfma_f32_32x32x16_bf16 v[160:175], v[228:231], v[4:7], v[160:175]
    v_add_f32 v252, v252, v128
    v_add_f32 v252, v252, v129
    v_add_f32 v252, v252, v130
    v_add_f32 v252, v252, v131
    v_cvt_pk_bf16_f32 v128, v128, v129
    v_cvt_pk_bf16_f32 v129, v130, v131
    v_mfma_f32_32x32x16_bf16 v[176:191], v[228:231], v[68:71], v[176:191]
    ds_read_b128 v[228:231], v244 offset:17184
    v_exp_f32 v132, v132
    s_waitcnt lgkmcnt(4)
    v_mfma_f32_32x32x16_bf16 v[160:175], v[232:235], v[8:11], v[160:175]
    v_exp_f32 v133, v133
    v_exp_f32 v134, v134
    v_exp_f32 v135, v135
    v_mfma_f32_32x32x16_bf16 v[176:191], v[232:235], v[72:75], v[176:191]
    ds_read_b128 v[232:235], v244 offset:17408
    v_add_f32 v252, v252, v132
    v_add_f32 v252, v252, v133
    v_add_f32 v252, v252, v134
    s_waitcnt lgkmcnt(4)
    v_mfma_f32_32x32x16_bf16 v[160:175], v[236:239], v[12:15], v[160:175]
    v_add_f32 v252, v252, v135
    v_cvt_pk_bf16_f32 v130, v132, v133
    v_cvt_pk_bf16_f32 v131, v134, v135
    v_exp_f32 v136, v136
    v_mfma_f32_32x32x16_bf16 v[176:191], v[236:239], v[76:79], v[176:191]
    ds_read_b128 v[236:239], v244 offset:17440
    v_exp_f32 v137, v137
    v_exp_f32 v138, v138
    s_waitcnt lgkmcnt(3)
    v_mfma_f32_32x32x16_bf16 v[160:175], v[224:227], v[16:19], v[160:175]
    v_exp_f32 v139, v139
    v_add_f32 v252, v252, v136
    v_add_f32 v252, v252, v137
    v_add_f32 v252, v252, v138
    v_mfma_f32_32x32x16_bf16 v[176:191], v[224:227], v[80:83], v[176:191]
    ds_read_b128 v[224:227], v244 offset:24960
    v_add_f32 v252, v252, v139
    v_cvt_pk_bf16_f32 v132, v136, v137
    v_cvt_pk_bf16_f32 v133, v138, v139
    s_waitcnt lgkmcnt(3)
    v_mfma_f32_32x32x16_bf16 v[160:175], v[228:231], v[20:23], v[160:175]
    v_exp_f32 v140, v140
    v_exp_f32 v141, v141
    v_exp_f32 v142, v142
    v_mfma_f32_32x32x16_bf16 v[176:191], v[228:231], v[84:87], v[176:191]
    ds_read_b128 v[228:231], v244 offset:24992
    v_exp_f32 v143, v143
    v_add_f32 v252, v252, v140
    s_waitcnt lgkmcnt(3)
    v_mfma_f32_32x32x16_bf16 v[160:175], v[232:235], v[24:27], v[160:175]
    v_add_f32 v252, v252, v141
    v_add_f32 v252, v252, v142
    v_add_f32 v252, v252, v143
    v_cvt_pk_bf16_f32 v134, v140, v141
    v_cvt_pk_bf16_f32 v135, v142, v143
    v_mfma_f32_32x32x16_bf16 v[176:191], v[232:235], v[88:91], v[176:191]
    ds_read_b128 v[232:235], v244 offset:25216
    v_exp_f32 v144, v144
    v_exp_f32 v145, v145
    s_waitcnt lgkmcnt(3)
    v_mfma_f32_32x32x16_bf16 v[160:175], v[236:239], v[28:31], v[160:175]
    v_exp_f32 v146, v146
    v_exp_f32 v147, v147
    v_mfma_f32_32x32x16_bf16 v[176:191], v[236:239], v[92:95], v[176:191]
    ds_read_b128 v[236:239], v244 offset:25248
    v_add_f32 v253, v253, v144
    v_add_f32 v253, v253, v145
    v_add_f32 v253, v253, v146
    s_waitcnt lgkmcnt(3)
    v_mfma_f32_32x32x16_bf16 v[160:175], v[224:227], v[32:35], v[160:175]
    v_add_f32 v253, v253, v147
    v_cvt_pk_bf16_f32 v144, v144, v145
    v_cvt_pk_bf16_f32 v145, v146, v147
    v_exp_f32 v148, v148
    v_mfma_f32_32x32x16_bf16 v[176:191], v[224:227], v[96:99], v[176:191]
    ds_read_b128 v[224:227], v244 offset:25472
    v_exp_f32 v149, v149
    s_waitcnt lgkmcnt(3)
    v_mfma_f32_32x32x16_bf16 v[160:175], v[228:231], v[36:39], v[160:175]
    v_exp_f32 v150, v150
    v_exp_f32 v151, v151
    v_add_f32 v253, v253, v148
    v_mfma_f32_32x32x16_bf16 v[176:191], v[228:231], v[100:103], v[176:191]
    ds_read_b128 v[228:231], v244 offset:25504
    v_add_f32 v253, v253, v149
    v_add_f32 v253, v253, v150
    v_add_f32 v253, v253, v151
    s_waitcnt lgkmcnt(3)
    v_mfma_f32_32x32x16_bf16 v[160:175], v[232:235], v[40:43], v[160:175]
    v_cvt_pk_bf16_f32 v146, v148, v149
    v_cvt_pk_bf16_f32 v147, v150, v151
    v_exp_f32 v152, v152
    v_mfma_f32_32x32x16_bf16 v[176:191], v[232:235], v[104:107], v[176:191]
    ds_read_b128 v[232:235], v244 offset:25728
    v_exp_f32 v153, v153
    v_exp_f32 v154, v154
    s_waitcnt lgkmcnt(3)
    v_mfma_f32_32x32x16_bf16 v[160:175], v[236:239], v[44:47], v[160:175]
    v_exp_f32 v155, v155
    v_add_f32 v253, v253, v152
    v_add_f32 v253, v253, v153
    v_mfma_f32_32x32x16_bf16 v[176:191], v[236:239], v[108:111], v[176:191]
    ds_read_b128 v[236:239], v244 offset:25760
    v_add_f32 v253, v253, v154
    v_add_f32 v253, v253, v155
    v_cvt_pk_bf16_f32 v148, v152, v153
    s_waitcnt lgkmcnt(3)
    v_mfma_f32_32x32x16_bf16 v[160:175], v[224:227], v[48:51], v[160:175]
    v_cvt_pk_bf16_f32 v149, v154, v155
    v_exp_f32 v156, v156
    v_exp_f32 v157, v157
    v_mfma_f32_32x32x16_bf16 v[176:191], v[224:227], v[112:115], v[176:191]
    s_waitcnt vmcnt(16)
    s_waitcnt lgkmcnt(0)
    s_barrier
    v_mfma_f32_32x32x16_bf16 v[160:175], v[228:231], v[52:55], v[160:175]
    ds_read_b64_tr_b16 v[136:137], v246
    ds_read_b64_tr_b16 v[138:139], v246 offset:2080
    s_add_u32 m0, s34, 41216
    v_exp_f32 v158, v158
    v_exp_f32 v159, v159
    v_mfma_f32_32x32x16_bf16 v[176:191], v[228:231], v[116:119], v[176:191]
    ds_read_b64_tr_b16 v[140:141], v246 offset:4160
    ds_read_b64_tr_b16 v[142:143], v246 offset:6240
    buffer_load_dwordx4 v249, s[8:11], s32 offen nt lds
    s_add_u32 m0, s34, 49280
    v_mfma_f32_32x32x16_bf16 v[160:175], v[232:235], v[56:59], v[160:175]
    buffer_load_dwordx4 v249, s[8:11], s32 offen offset:256 nt lds
    s_add_u32 m0, s34, 40208
    v_add_f32 v253, v253, v156
    v_add_f32 v253, v253, v157
    v_add_f32 v253, v253, v158
    v_mfma_f32_32x32x16_bf16 v[176:191], v[232:235], v[120:123], v[176:191]
    buffer_load_dwordx4 v249, s[8:11], s32 offen offset:2048 nt lds
    s_add_u32 m0, s34, 48272
    v_add_f32 v253, v253, v159
    v_cvt_pk_bf16_f32 v150, v156, v157
    v_cvt_pk_bf16_f32 v151, v158, v159
    v_mfma_f32_32x32x16_bf16 v[160:175], v[236:239], v[60:63], v[160:175]
    ds_read_b64_tr_b16 v[152:153], v246 offset:256
    ds_read_b64_tr_b16 v[154:155], v246 offset:2336
    buffer_load_dwordx4 v249, s[8:11], s32 offen offset:2304 nt lds
    v_mfma_f32_32x32x16_bf16 v[176:191], v[236:239], v[124:127], v[176:191]
    s_add_u32 s87, s87, 16384
    s_and_b32 s87, s87, 0x7ffff
    s_add_u32 s32, s86, s87
    v_subrev_u32 v156, s41, v247
    ds_read_b32 v157, v156 offset:20484
    ds_read_b128 v[224:227], v156 offset:16384
    ds_read_b128 v[228:231], v156 offset:17408
    v_add_u32 v156, s42, v246
    s_waitcnt lgkmcnt(7)
    v_mfma_f32_32x32x16_bf16 a[0:15], v[136:139], v[128:131], a[0:15]
    ds_read_b64_tr_b16 v[232:233], v156
    ds_read_b64_tr_b16 v[234:235], v156 offset:2080
    ds_read_b64_tr_b16 v[236:237], v156 offset:256
    ds_read_b64_tr_b16 v[238:239], v156 offset:2336
    v_mfma_f32_32x32x16_bf16 a[128:143], v[136:139], v[144:147], a[128:143]
    ds_read_b64_tr_b16 v[136:137], v246 offset:4416
    ds_read_b64_tr_b16 v[138:139], v246 offset:6496
    v_and_b32 v158, 0xfffffbff, v248
    s_waitcnt lgkmcnt(11)
    v_mfma_f32_32x32x16_bf16 a[0:15], v[140:143], v[132:135], a[0:15]
    ds_read2st64_b32 v[158:159], v158 offset0:88 offset1:92
    v_fma_f32 v160, v160, s31, v250
    v_fma_f32 v161, v161, s31, v250
    v_fma_f32 v162, v162, s31, v250
    v_mfma_f32_32x32x16_bf16 a[128:143], v[140:143], v[148:151], a[128:143]
    ds_read_b64_tr_b16 v[140:141], v246 offset:512
    ds_read_b64_tr_b16 v[142:143], v246 offset:2592
    s_waitcnt lgkmcnt(11)
    v_cmp_neq_f32 vcc, 0x3f800000, v157
    s_cbranch_vccz L_skip9_5
    v_mul_f32 v192, v192, v157
    v_mul_f32 v193, v193, v157
    v_mul_f32 v194, v194, v157
    v_mul_f32 v195, v195, v157
    v_mul_f32 v196, v196, v157
    v_mul_f32 v197, v197, v157
    v_mul_f32 v198, v198, v157
    v_mul_f32 v199, v199, v157
    v_mul_f32 v200, v200, v157
    v_mul_f32 v201, v201, v157
    v_mul_f32 v202, v202, v157
    v_mul_f32 v203, v203, v157
    v_mul_f32 v204, v204, v157
    v_mul_f32 v205, v205, v157
    v_mul_f32 v206, v206, v157
    v_mul_f32 v207, v207, v157
    v_mul_f32 v208, v208, v157
    v_mul_f32 v209, v209, v157
    v_mul_f32 v210, v210, v157
    v_mul_f32 v211, v211, v157
    v_mul_f32 v212, v212, v157
    v_mul_f32 v213, v213, v157
    v_mul_f32 v214, v214, v157
    v_mul_f32 v215, v215, v157
    v_mul_f32 v216, v216, v157
    v_mul_f32 v217, v217, v157
    v_mul_f32 v218, v218, v157
    v_mul_f32 v219, v219, v157
    v_mul_f32 v220, v220, v157
    v_mul_f32 v221, v221, v157
    v_mul_f32 v222, v222, v157
    v_mul_f32 v223, v223, v157
L_skip9_5:
    v_mfma_f32_32x32x16_bf16 a[16:31], v[152:155], v[128:131], a[16:31]
    v_fma_f32 v163, v163, s31, v250
    v_fma_f32 v164, v164, s31, v250
    v_fma_f32 v165, v165, s31, v250
    s_waitcnt lgkmcnt(7)
    v_mfma_f32_32x32x16_bf16 v[192:207], v[232:235], v[224:227], v[192:207]
    v_fma_f32 v166, v166, s31, v250
    v_fma_f32 v167, v167, s31, v250
    v_fma_f32 v168, v168, s31, v250
    v_mfma_f32_32x32x16_bf16 a[144:159], v[152:155], v[144:147], a[144:159]
    ds_read_b64_tr_b16 v[152:153], v246 offset:4672
    ds_read_b64_tr_b16 v[154:155], v246 offset:6752
    s_waitcnt lgkmcnt(4)
    v_max_f32 v158, v158, v159
    v_mul_f32 v158, s31, v158
    v_add_f32 v159, s46, v254
    v_mfma_f32_32x32x16_bf16 v[208:223], v[236:239], v[224:227], v[208:223]
    ds_read_b64_tr_b16 v[232:233], v156 offset:4160
    ds_read_b64_tr_b16 v[234:235], v156 offset:6240
    ds_read_b64_tr_b16 v[236:237], v156 offset:4416
    ds_read_b64_tr_b16 v[238:239], v156 offset:6496
    s_add_u32 m0, s34, 141056
    v_cmp_gt_f32 vcc, v158, v159
    v_mfma_f32_32x32x16_bf16 a[16:31], v[136:139], v[132:135], a[16:31]
    buffer_load_dwordx4 v249, s[12:15], s33 offen nt lds
    v_cndmask_b32 v159, v254, v158, vcc
    v_sub_f32 v157, v254, v159
    v_mov_b32 v254, v159
    v_fma_f32 v169, v169, s31, v250
    v_mfma_f32_32x32x16_bf16 a[144:159], v[136:139], v[148:151], a[144:159]
    ds_read_b64_tr_b16 v[136:137], v246 offset:768
    ds_read_b64_tr_b16 v[138:139], v246 offset:2848
    v_exp_f32 v157, v157
    v_fma_f32 v240, v240, s31, -v254
    s_waitcnt lgkmcnt(8)
    v_mfma_f32_32x32x16_bf16 a[32:47], v[140:143], v[128:131], a[32:47]
    v_fma_f32 v241, v241, s31, -v254
    v_fma_f32 v242, v242, s31, -v254
    v_fma_f32 v243, v243, s31, -v254
    v_exp_f32 v240, v240
    s_waitcnt lgkmcnt(4)
    v_mfma_f32_32x32x16_bf16 v[192:207], v[232:235], v[228:231], v[192:207]
    ds_read_b128 v[224:227], v245 offset:33280
    v_exp_f32 v241, v241
    v_exp_f32 v242, v242
    v_exp_f32 v243, v243
    v_mfma_f32_32x32x16_bf16 a[160:175], v[140:143], v[144:147], a[160:175]
    ds_read_b64_tr_b16 v[140:141], v246 offset:4928
    ds_read_b64_tr_b16 v[142:143], v246 offset:7008
    v_fma_f32 v255, v255, v157, v240
    v_add_f32 v255, v255, v241
    v_fma_f32 v170, v170, s31, v250
    s_waitcnt lgkmcnt(5)
    v_mfma_f32_32x32x16_bf16 v[208:223], v[236:239], v[228:231], v[208:223]
    ds_read_b128 v[228:231], v247
    s_add_u32 m0, s34, 149120
    v_add_f32 v255, v255, v242
    v_add_f32 v255, v255, v243
    v_cvt_pk_bf16_f32 v240, v240, v241
    v_cvt_pk_bf16_f32 v241, v242, v243
    v_mfma_f32_32x32x16_bf16 a[32:47], v[152:155], v[132:135], a[32:47]
    ds_read_b128 v[232:235], v245 offset:33536
    ds_read_b128 v[236:239], v247 offset:1024
    buffer_load_dwordx4 v249, s[12:15], s33 offen offset:256 nt lds
    ds_write_b64 v248, v[240:241] offset:18432
    ds_write_b32 v248, v157 offset:22532
    v_mfma_f32_32x32x16_bf16 a[160:175], v[152:155], v[148:151], a[160:175]
    ds_read_b64_tr_b16 v[152:153], v246 offset:8320
    ds_read_b64_tr_b16 v[154:155], v246 offset:10400
    s_add_u32 m0, s34, 140048
    v_fma_f32 v171, v171, s31, v250
    s_waitcnt lgkmcnt(10)
    v_mfma_f32_32x32x16_bf16 a[48:63], v[136:139], v[128:131], a[48:63]
    buffer_load_dwordx4 v249, s[12:15], s33 offen offset:2048 nt lds
    v_fma_f32 v172, v172, s31, v250
    v_fma_f32 v173, v173, s31, v250
    s_waitcnt lgkmcnt(6)
    v_mfma_f32_16x16x32_bf16 v[240:243], v[224:227], v[228:231], 0
    ds_read_b128 v[224:227], v245 offset:33792
    ds_read_b128 v[228:231], v247 offset:2048
    v_mfma_f32_32x32x16_bf16 a[176:191], v[136:139], v[144:147], a[176:191]
    ds_read_b64_tr_b16 v[136:137], v246 offset:12480
    ds_read_b64_tr_b16 v[138:139], v246 offset:14560
    s_add_u32 m0, s34, 148112
    v_fma_f32 v174, v174, s31, v250
    v_mfma_f32_32x32x16_bf16 a[48:63], v[140:143], v[132:135], a[48:63]
    buffer_load_dwordx4 v249, s[12:15], s33 offen offset:2304 nt lds
    v_fma_f32 v175, v175, s31, v250
    v_fma_f32 v176, v176, s31, v251
    s_waitcnt lgkmcnt(8)
    v_mfma_f32_16x16x32_bf16 v[240:243], v[232:235], v[236:239], v[240:243]
    ds_read_b128 v[232:235], v245 offset:34048
    ds_read_b128 v[236:239], v247 offset:3072
    v_mfma_f32_32x32x16_bf16 a[176:191], v[140:143], v[148:151], a[176:191]
    ds_read_b64_tr_b16 v[140:141], v246 offset:8576
    ds_read_b64_tr_b16 v[142:143], v246 offset:10656
    s_add_u32 s88, s88, 16384
    s_and_b32 s88, s88, 0x7ffff
    s_add_u32 s33, s86, s88
    s_waitcnt lgkmcnt(8)
    v_mfma_f32_32x32x16_bf16 a[64:79], v[152:155], v[128:131], a[64:79]
    v_fma_f32 v177, v177, s31, v251
    v_fma_f32 v178, v178, s31, v251
    v_fma_f32 v179, v179, s31, v251
    s_waitcnt lgkmcnt(6)
    v_mfma_f32_16x16x32_bf16 v[240:243], v[224:227], v[228:231], v[240:243]
    ds_read_b128 v[224:227], v245 offset:41600
    ds_read_b128 v[228:231], v247 offset:4096
    v_mfma_f32_32x32x16_bf16 a[192:207], v[152:155], v[144:147], a[192:207]
    ds_read_b64_tr_b16 v[152:153], v246 offset:12736
    ds_read_b64_tr_b16 v[154:155], v246 offset:14816
    v_fma_f32 v180, v180, s31, v251
    v_fma_f32 v181, v181, s31, v251
    s_waitcnt lgkmcnt(8)
    v_mfma_f32_32x32x16_bf16 a[64:79], v[136:139], v[132:135], a[64:79]
    v_fma_f32 v182, v182, s31, v251
    v_fma_f32 v183, v183, s31, v251
    v_fma_f32 v184, v184, s31, v251
    s_waitcnt lgkmcnt(6)
    v_mfma_f32_16x16x32_bf16 v[240:243], v[232:235], v[236:239], v[240:243]
    ds_read_b128 v[232:235], v245 offset:41856
    ds_read_b128 v[236:239], v247 offset:5120
    v_mfma_f32_32x32x16_bf16 a[192:207], v[136:139], v[148:151], a[192:207]
    ds_read_b64_tr_b16 v[136:137], v246 offset:8832
    ds_read_b64_tr_b16 v[138:139], v246 offset:10912
    v_fma_f32 v185, v185, s31, v251
    s_waitcnt lgkmcnt(8)
    v_mfma_f32_32x32x16_bf16 a[80:95], v[140:143], v[128:131], a[80:95]
    v_fma_f32 v186, v186, s31, v251
    v_fma_f32 v187, v187, s31, v251
    v_fma_f32 v188, v188, s31, v251
    v_fma_f32 v189, v189, s31, v251
    s_waitcnt lgkmcnt(6)
    v_mfma_f32_16x16x32_bf16 v[240:243], v[224:227], v[228:231], v[240:243]
    ds_read_b128 v[224:227], v245 offset:42112
    ds_read_b128 v[228:231], v247 offset:6144
    v_mfma_f32_32x32x16_bf16 a[208:223], v[140:143], v[144:147], a[208:223]
    ds_read_b64_tr_b16 v[140:141], v246 offset:12992
    ds_read_b64_tr_b16 v[142:143], v246 offset:15072
    v_fma_f32 v190, v190, s31, v251
    s_waitcnt lgkmcnt(8)
    v_mfma_f32_32x32x16_bf16 a[80:95], v[152:155], v[132:135], a[80:95]
    v_fma_f32 v191, v191, s31, v251
    v_max3_f32 v157, v160, v161, v162
    v_max3_f32 v157, v157, v163, v164
    s_waitcnt lgkmcnt(6)
    v_mfma_f32_16x16x32_bf16 v[240:243], v[232:235], v[236:239], v[240:243]
    ds_read_b128 v[232:235], v245 offset:42368
    ds_read_b128 v[236:239], v247 offset:7168
    v_mfma_f32_32x32x16_bf16 a[208:223], v[152:155], v[148:151], a[208:223]
    ds_read_b64_tr_b16 v[152:153], v246 offset:9088
    ds_read_b64_tr_b16 v[154:155], v246 offset:11168
    v_max3_f32 v157, v157, v165, v166
    v_max3_f32 v157, v157, v167, v168
    s_waitcnt lgkmcnt(6)
    v_mfma_f32_16x16x32_bf16 v[240:243], v[224:227], v[228:231], v[240:243]
    ds_read_b128 v[224:227], v244 offset:33280
    v_mfma_f32_32x32x16_bf16 a[96:111], v[136:139], v[128:131], a[96:111]
    ds_read_b128 v[228:231], v244 offset:33312
    v_max3_f32 v157, v157, v169, v170
    v_max3_f32 v157, v157, v171, v172
    v_max3_f32 v157, v157, v173, v174
    v_mfma_f32_32x32x16_bf16 a[224:239], v[136:139], v[144:147], a[224:239]
    ds_read_b64_tr_b16 v[136:137], v246 offset:13248
    ds_read_b64_tr_b16 v[138:139], v246 offset:15328
    v_max3_f32 v157, v157, v175, v176
    s_waitcnt lgkmcnt(6)
    v_mfma_f32_16x16x32_bf16 v[240:243], v[232:235], v[236:239], v[240:243]
    ds_read_b128 v[232:235], v244 offset:33536
    v_max3_f32 v157, v157, v177, v178
    v_mfma_f32_32x32x16_bf16 a[96:111], v[140:143], v[132:135], a[96:111]
    ds_read_b128 v[236:239], v244 offset:33568
    v_max3_f32 v157, v157, v179, v180
    v_max3_f32 v157, v157, v181, v182
    v_mfma_f32_32x32x16_bf16 a[224:239], v[140:143], v[148:151], a[224:239]
    s_nop 0
    v_max3_f32 v158, v240, v241, v242
    v_max_f32 v158, v158, v243
    v_mov_b32 v159, v158
    v_max3_f32 v157, v157, v183, v184
    v_max3_f32 v157, v157, v185, v186
    s_waitcnt lgkmcnt(6)
    v_mfma_f32_32x32x16_bf16 a[112:127], v[152:155], v[128:131], a[112:127]
    v_permlane32_swap_b32 v158, v159
    v_max_f32 v158, v158, v159
    v_mov_b32 v159, v158
    v_max3_f32 v157, v157, v187, v188
    v_mfma_f32_32x32x16_bf16 a[240:255], v[152:155], v[144:147], a[240:255]
    v_permlane16_swap_b32 v158, v159
    v_max_f32 v158, v158, v159
    ds_write_b32 v248, v158 offset:20480
    v_max3_f32 v157, v157, v189, v190
    v_max_f32 v157, v157, v191
    s_waitcnt lgkmcnt(3)
    v_mfma_f32_32x32x16_bf16 a[112:127], v[136:139], v[132:135], a[112:127]
    v_cmp_lt_f32 vcc, s46, v157
    v_mfma_f32_32x32x16_bf16 a[240:255], v[136:139], v[148:151], a[240:255]
    s_cbranch_vccz L_norare_6
    s_call_b64 s[44:45], L_rare0
L_norare_6:
    v_mfma_f32_32x32x16_bf16 v[128:143], v[224:227], v[0:3], 0
    v_exp_f32 v160, v160
    v_exp_f32 v161, v161
    v_exp_f32 v162, v162
    v_mfma_f32_32x32x16_bf16 v[144:159], v[224:227], v[64:67], 0
    ds_read_b128 v[224:227], v244 offset:33792
    v_exp_f32 v163, v163
    v_mfma_f32_32x32x16_bf16 v[128:143], v[228:231], v[4:7], v[128:143]
    v_add_f32 v252, v252, v160
    v_add_f32 v252, v252, v161
    v_add_f32 v252, v252, v162
    v_add_f32 v252, v252, v163
    v_cvt_pk_bf16_f32 v160, v160, v161
    v_cvt_pk_bf16_f32 v161, v162, v163
    v_mfma_f32_32x32x16_bf16 v[144:159], v[228:231], v[68:71], v[144:159]
    ds_read_b128 v[228:231], v244 offset:33824
    v_exp_f32 v164, v164
    s_waitcnt lgkmcnt(4)
    v_mfma_f32_32x32x16_bf16 v[128:143], v[232:235], v[8:11], v[128:143]
    v_exp_f32 v165, v165
    v_exp_f32 v166, v166
    v_exp_f32 v167, v167
    v_mfma_f32_32x32x16_bf16 v[144:159], v[232:235], v[72:75], v[144:159]
    ds_read_b128 v[232:235], v244 offset:34048
    v_add_f32 v252, v252, v164
    v_add_f32 v252, v252, v165
    v_add_f32 v252, v252, v166
    s_waitcnt lgkmcnt(4)
    v_mfma_f32_32x32x16_bf16 v[128:143], v[236:239], v[12:15], v[128:143]
    v_add_f32 v252, v252, v167
    v_cvt_pk_bf16_f32 v162, v164, v165
    v_cvt_pk_bf16_f32 v163, v166, v167
    v_exp_f32 v168, v168
    v_mfma_f32_32x32x16_bf16 v[144:159], v[236:239], v[76:79], v[144:159]
    ds_read_b128 v[236:239], v244 offset:34080
    v_exp_f32 v169, v169
    v_exp_f32 v170, v170
    s_waitcnt lgkmcnt(3)
    v_mfma_f32_32x32x16_bf16 v[128:143], v[224:227], v[16:19], v[128:143]
    v_exp_f32 v171, v171
    v_add_f32 v252, v252, v168
    v_add_f32 v252, v252, v169
    v_add_f32 v252, v252, v170
    v_mfma_f32_32x32x16_bf16 v[144:159], v[224:227], v[80:83], v[144:159]
    ds_read_b128 v[224:227], v244 offset:41600
    v_add_f32 v252, v252, v171
    v_cvt_pk_bf16_f32 v164, v168, v169
    v_cvt_pk_bf16_f32 v165, v170, v171
    s_waitcnt lgkmcnt(3)
    v_mfma_f32_32x32x16_bf16 v[128:143], v[228:231], v[20:23], v[128:143]
    v_exp_f32 v172, v172
    v_exp_f32 v173, v173
    v_exp_f32 v174, v174
    v_mfma_f32_32x32x16_bf16 v[144:159], v[228:231], v[84:87], v[144:159]
    ds_read_b128 v[228:231], v244 offset:41632
    v_exp_f32 v175, v175
    v_add_f32 v252, v252, v172
    s_waitcnt lgkmcnt(3)
    v_mfma_f32_32x32x16_bf16 v[128:143], v[232:235], v[24:27], v[128:143]
    v_add_f32 v252, v252, v173
    v_add_f32 v252, v252, v174
    v_add_f32 v252, v252, v175
    v_cvt_pk_bf16_f32 v166, v172, v173
    v_cvt_pk_bf16_f32 v167, v174, v175
    v_mfma_f32_32x32x16_bf16 v[144:159], v[232:235], v[88:91], v[144:159]
    ds_read_b128 v[232:235], v244 offset:41856
    v_exp_f32 v176, v176
    v_exp_f32 v177, v177
    s_waitcnt lgkmcnt(3)
    v_mfma_f32_32x32x16_bf16 v[128:143], v[236:239], v[28:31], v[128:143]
    v_exp_f32 v178, v178
    v_exp_f32 v179, v179
    v_mfma_f32_32x32x16_bf16 v[144:159], v[236:239], v[92:95], v[144:159]
    ds_read_b128 v[236:239], v244 offset:41888
    v_add_f32 v253, v253, v176
    v_add_f32 v253, v253, v177
    v_add_f32 v253, v253, v178
    s_waitcnt lgkmcnt(3)
    v_mfma_f32_32x32x16_bf16 v[128:143], v[224:227], v[32:35], v[128:143]
    v_add_f32 v253, v253, v179
    v_cvt_pk_bf16_f32 v176, v176, v177
    v_cvt_pk_bf16_f32 v177, v178, v179
    v_exp_f32 v180, v180
    v_mfma_f32_32x32x16_bf16 v[144:159], v[224:227], v[96:99], v[144:159]
    ds_read_b128 v[224:227], v244 offset:42112
    v_exp_f32 v181, v181
    s_waitcnt lgkmcnt(3)
    v_mfma_f32_32x32x16_bf16 v[128:143], v[228:231], v[36:39], v[128:143]
    v_exp_f32 v182, v182
    v_exp_f32 v183, v183
    v_add_f32 v253, v253, v180
    v_mfma_f32_32x32x16_bf16 v[144:159], v[228:231], v[100:103], v[144:159]
    ds_read_b128 v[228:231], v244 offset:42144
    v_add_f32 v253, v253, v181
    v_add_f32 v253, v253, v182
    v_add_f32 v253, v253, v183
    s_waitcnt lgkmcnt(3)
    v_mfma_f32_32x32x16_bf16 v[128:143], v[232:235], v[40:43], v[128:143]
    v_cvt_pk_bf16_f32 v178, v180, v181
    v_cvt_pk_bf16_f32 v179, v182, v183
    v_exp_f32 v184, v184
    v_mfma_f32_32x32x16_bf16 v[144:159], v[232:235], v[104:107], v[144:159]
    ds_read_b128 v[232:235], v244 offset:42368
    v_exp_f32 v185, v185
    v_exp_f32 v186, v186
    s_waitcnt lgkmcnt(3)
    v_mfma_f32_32x32x16_bf16 v[128:143], v[236:239], v[44:47], v[128:143]
    v_exp_f32 v187, v187
    v_add_f32 v253, v253, v184
    v_add_f32 v253, v253, v185
    v_mfma_f32_32x32x16_bf16 v[144:159], v[236:239], v[108:111], v[144:159]
    ds_read_b128 v[236:239], v244 offset:42400
    v_add_f32 v253, v253, v186
    v_add_f32 v253, v253, v187
    v_cvt_pk_bf16_f32 v180, v184, v185
    s_waitcnt lgkmcnt(3)
    v_mfma_f32_32x32x16_bf16 v[128:143], v[224:227], v[48:51], v[128:143]
    v_cvt_pk_bf16_f32 v181, v186, v187
    v_exp_f32 v188, v188
    v_exp_f32 v189, v189
    v_mfma_f32_32x32x16_bf16 v[144:159], v[224:227], v[112:115], v[144:159]
    s_waitcnt vmcnt(16)
    s_waitcnt lgkmcnt(0)
    s_barrier
    v_mfma_f32_32x32x16_bf16 v[128:143], v[228:231], v[52:55], v[128:143]
    ds_read_b64_tr_b16 v[168:169], v246 offset:16640
    ds_read_b64_tr_b16 v[170:171], v246 offset:18720
    s_add_u32 m0, s34, 57856
    v_exp_f32 v190, v190
    v_exp_f32 v191, v191
    v_mfma_f32_32x32x16_bf16 v[144:159], v[228:231], v[116:119], v[144:159]
    ds_read_b64_tr_b16 v[172:173], v246 offset:20800
    ds_read_b64_tr_b16 v[174:175], v246 offset:22880
    buffer_load_dwordx4 v249, s[8:11], s32 offen nt lds
    s_add_u32 m0, s34, 65920
    v_mfma_f32_32x32x16_bf16 v[128:143], v[232:235], v[56:59], v[128:143]
    buffer_load_dwordx4 v249, s[8:11], s32 offen offset:256 nt lds
    s_add_u32 m0, s34, 56848
    v_add_f32 v253, v253, v188
    v_add_f32 v253, v253, v189
    v_add_f32 v253, v253, v190
    v_mfma_f32_32x32x16_bf16 v[144:159], v[232:235], v[120:123], v[144:159]
    buffer_load_dwordx4 v249, s[8:11], s32 offen offset:2048 nt lds
    s_add_u32 m0, s34, 64912
    v_add_f32 v253, v253, v191
    v_cvt_pk_bf16_f32 v182, v188, v189
    v_cvt_pk_bf16_f32 v183, v190, v191
    v_mfma_f32_32x32x16_bf16 v[128:143], v[236:239], v[60:63], v[128:143]
    ds_read_b64_tr_b16 v[184:185], v246 offset:16896
    ds_read_b64_tr_b16 v[186:187], v246 offset:18976
    buffer_load_dwordx4 v249, s[8:11], s32 offen offset:2304 nt lds
    v_mfma_f32_32x32x16_bf16 v[144:159], v[236:239], v[124:127], v[144:159]
    s_add_u32 s87, s87, 16384
    s_and_b32 s87, s87, 0x7ffff
    s_add_u32 s32, s86, s87
    v_subrev_u32 v188, s41, v247
    ds_read_b32 v189, v188 offset:22532
    ds_read_b128 v[224:227], v188 offset:18432
    ds_read_b128 v[228:231], v188 offset:19456
    v_add_u32 v188, s42, v246
    s_waitcnt lgkmcnt(7)
    v_mfma_f32_32x32x16_bf16 a[0:15], v[168:171], v[160:163], a[0:15]
    ds_read_b64_tr_b16 v[232:233], v188 offset:16640
    ds_read_b64_tr_b16 v[234:235], v188 offset:18720
    ds_read_b64_tr_b16 v[236:237], v188 offset:16896
    ds_read_b64_tr_b16 v[238:239], v188 offset:18976
    v_mfma_f32_32x32x16_bf16 a[128:143], v[168:171], v[176:179], a[128:143]
    ds_read_b64_tr_b16 v[168:169], v246 offset:21056
    ds_read_b64_tr_b16 v[170:171], v246 offset:23136
    v_and_b32 v190, 0xfffffbff, v248
    s_waitcnt lgkmcnt(11)
    v_mfma_f32_32x32x16_bf16 a[0:15], v[172:175], v[164:167], a[0:15]
    ds_read2st64_b32 v[190:191], v190 offset0:80 offset1:84
    v_fma_f32 v128, v128, s31, v250
    v_fma_f32 v129, v129, s31, v250
    v_fma_f32 v130, v130, s31, v250
    v_mfma_f32_32x32x16_bf16 a[128:143], v[172:175], v[180:183], a[128:143]
    ds_read_b64_tr_b16 v[172:173], v246 offset:17152
    ds_read_b64_tr_b16 v[174:175], v246 offset:19232
    s_waitcnt lgkmcnt(11)
    v_cmp_neq_f32 vcc, 0x3f800000, v189
    s_cbranch_vccz L_skip9_7
    v_mul_f32 v192, v192, v189
    v_mul_f32 v193, v193, v189
    v_mul_f32 v194, v194, v189
    v_mul_f32 v195, v195, v189
    v_mul_f32 v196, v196, v189
    v_mul_f32 v197, v197, v189
    v_mul_f32 v198, v198, v189
    v_mul_f32 v199, v199, v189
    v_mul_f32 v200, v200, v189
    v_mul_f32 v201, v201, v189
    v_mul_f32 v202, v202, v189
    v_mul_f32 v203, v203, v189
    v_mul_f32 v204, v204, v189
    v_mul_f32 v205, v205, v189
    v_mul_f32 v206, v206, v189
    v_mul_f32 v207, v207, v189
    v_mul_f32 v208, v208, v189
    v_mul_f32 v209, v209, v189
    v_mul_f32 v210, v210, v189
    v_mul_f32 v211, v211, v189
    v_mul_f32 v212, v212, v189
    v_mul_f32 v213, v213, v189
    v_mul_f32 v214, v214, v189
    v_mul_f32 v215, v215, v189
    v_mul_f32 v216, v216, v189
    v_mul_f32 v217, v217, v189
    v_mul_f32 v218, v218, v189
    v_mul_f32 v219, v219, v189
    v_mul_f32 v220, v220, v189
    v_mul_f32 v221, v221, v189
    v_mul_f32 v222, v222, v189
    v_mul_f32 v223, v223, v189
L_skip9_7:
    v_mfma_f32_32x32x16_bf16 a[16:31], v[184:187], v[160:163], a[16:31]
    v_fma_f32 v131, v131, s31, v250
    v_fma_f32 v132, v132, s31, v250
    v_fma_f32 v133, v133, s31, v250
    s_waitcnt lgkmcnt(7)
    v_mfma_f32_32x32x16_bf16 v[192:207], v[232:235], v[224:227], v[192:207]
    v_fma_f32 v134, v134, s31, v250
    v_fma_f32 v135, v135, s31, v250
    v_fma_f32 v136, v136, s31, v250
    v_mfma_f32_32x32x16_bf16 a[144:159], v[184:187], v[176:179], a[144:159]
    ds_read_b64_tr_b16 v[184:185], v246 offset:21312
    ds_read_b64_tr_b16 v[186:187], v246 offset:23392
    s_waitcnt lgkmcnt(4)
    v_max_f32 v190, v190, v191
    v_mul_f32 v190, s31, v190
    v_add_f32 v191, s46, v254
    v_mfma_f32_32x32x16_bf16 v[208:223], v[236:239], v[224:227], v[208:223]
    ds_read_b64_tr_b16 v[232:233], v188 offset:20800
    ds_read_b64_tr_b16 v[234:235], v188 offset:22880
    ds_read_b64_tr_b16 v[236:237], v188 offset:21056
    ds_read_b64_tr_b16 v[238:239], v188 offset:23136
    s_add_u32 m0, s34, 91136
    v_cmp_gt_f32 vcc, v190, v191
    v_mfma_f32_32x32x16_bf16 a[16:31], v[168:171], v[164:167], a[16:31]
    buffer_load_dwordx4 v249, s[12:15], s33 offen nt lds
    v_cndmask_b32 v191, v254, v190, vcc
    v_sub_f32 v189, v254, v191
    v_mov_b32 v254, v191
    v_fma_f32 v137, v137, s31, v250
    v_mfma_f32_32x32x16_bf16 a[144:159], v[168:171], v[180:183], a[144:159]
    ds_read_b64_tr_b16 v[168:169], v246 offset:17408
    ds_read_b64_tr_b16 v[170:171], v246 offset:19488
    v_exp_f32 v189, v189
    v_fma_f32 v240, v240, s31, -v254
    s_waitcnt lgkmcnt(8)
    v_mfma_f32_32x32x16_bf16 a[32:47], v[172:175], v[160:163], a[32:47]
    v_fma_f32 v241, v241, s31, -v254
    v_fma_f32 v242, v242, s31, -v254
    v_fma_f32 v243, v243, s31, -v254
    v_exp_f32 v240, v240
    s_waitcnt lgkmcnt(4)
    v_mfma_f32_32x32x16_bf16 v[192:207], v[232:235], v[228:231], v[192:207]
    ds_read_b128 v[224:227], v245 offset:49920
    v_exp_f32 v241, v241
    v_exp_f32 v242, v242
    v_exp_f32 v243, v243
    v_mfma_f32_32x32x16_bf16 a[160:175], v[172:175], v[176:179], a[160:175]
    ds_read_b64_tr_b16 v[172:173], v246 offset:21568
    ds_read_b64_tr_b16 v[174:175], v246 offset:23648
    v_fma_f32 v255, v255, v189, v240
    v_add_f32 v255, v255, v241
    v_fma_f32 v138, v138, s31, v250
    s_waitcnt lgkmcnt(5)
    v_mfma_f32_32x32x16_bf16 v[208:223], v[236:239], v[228:231], v[208:223]
    ds_read_b128 v[228:231], v247
    s_add_u32 m0, s34, 99200
    v_add_f32 v255, v255, v242
    v_add_f32 v255, v255, v243
    v_cvt_pk_bf16_f32 v240, v240, v241
    v_cvt_pk_bf16_f32 v241, v242, v243
    v_mfma_f32_32x32x16_bf16 a[32:47], v[184:187], v[164:167], a[32:47]
    ds_read_b128 v[232:235], v245 offset:50176
    ds_read_b128 v[236:239], v247 offset:1024
    buffer_load_dwordx4 v249, s[12:15], s33 offen offset:256 nt lds
    ds_write_b64 v248, v[240:241] offset:16384
    ds_write_b32 v248, v189 offset:20484
    v_mfma_f32_32x32x16_bf16 a[160:175], v[184:187], v[180:183], a[160:175]
    ds_read_b64_tr_b16 v[184:185], v246 offset:24960
    ds_read_b64_tr_b16 v[186:187], v246 offset:27040
    s_add_u32 m0, s34, 90128
    v_fma_f32 v139, v139, s31, v250
    s_waitcnt lgkmcnt(10)
    v_mfma_f32_32x32x16_bf16 a[48:63], v[168:171], v[160:163], a[48:63]
    buffer_load_dwordx4 v249, s[12:15], s33 offen offset:2048 nt lds
    v_fma_f32 v140, v140, s31, v250
    v_fma_f32 v141, v141, s31, v250
    s_waitcnt lgkmcnt(6)
    v_mfma_f32_16x16x32_bf16 v[240:243], v[224:227], v[228:231], 0
    ds_read_b128 v[224:227], v245 offset:50432
    ds_read_b128 v[228:231], v247 offset:2048
    v_mfma_f32_32x32x16_bf16 a[176:191], v[168:171], v[176:179], a[176:191]
    ds_read_b64_tr_b16 v[168:169], v246 offset:29120
    ds_read_b64_tr_b16 v[170:171], v246 offset:31200
    s_add_u32 m0, s34, 98192
    v_fma_f32 v142, v142, s31, v250
    v_mfma_f32_32x32x16_bf16 a[48:63], v[172:175], v[164:167], a[48:63]
    buffer_load_dwordx4 v249, s[12:15], s33 offen offset:2304 nt lds
    v_fma_f32 v143, v143, s31, v250
    v_fma_f32 v144, v144, s31, v251
    s_waitcnt lgkmcnt(8)
    v_mfma_f32_16x16x32_bf16 v[240:243], v[232:235], v[236:239], v[240:243]
    ds_read_b128 v[232:235], v245 offset:50688
    ds_read_b128 v[236:239], v247 offset:3072
    v_mfma_f32_32x32x16_bf16 a[176:191], v[172:175], v[180:183], a[176:191]
    ds_read_b64_tr_b16 v[172:173], v246 offset:25216
    ds_read_b64_tr_b16 v[174:175], v246 offset:27296
    s_add_u32 s88, s88, 16384
    s_and_b32 s88, s88, 0x7ffff
    s_add_u32 s33, s86, s88
    s_waitcnt lgkmcnt(8)
    v_mfma_f32_32x32x16_bf16 a[64:79], v[184:187], v[160:163], a[64:79]
    v_fma_f32 v145, v145, s31, v251
    v_fma_f32 v146, v146, s31, v251
    v_fma_f32 v147, v147, s31, v251
    s_waitcnt lgkmcnt(6)
    v_mfma_f32_16x16x32_bf16 v[240:243], v[224:227], v[228:231], v[240:243]
    ds_read_b128 v[224:227], v245 offset:58240
    ds_read_b128 v[228:231], v247 offset:4096
    v_mfma_f32_32x32x16_bf16 a[192:207], v[184:187], v[176:179], a[192:207]
    ds_read_b64_tr_b16 v[184:185], v246 offset:29376
    ds_read_b64_tr_b16 v[186:187], v246 offset:31456
    v_fma_f32 v148, v148, s31, v251
    v_fma_f32 v149, v149, s31, v251
    s_waitcnt lgkmcnt(8)
    v_mfma_f32_32x32x16_bf16 a[64:79], v[168:171], v[164:167], a[64:79]
    v_fma_f32 v150, v150, s31, v251
    v_fma_f32 v151, v151, s31, v251
    v_fma_f32 v152, v152, s31, v251
    s_waitcnt lgkmcnt(6)
    v_mfma_f32_16x16x32_bf16 v[240:243], v[232:235], v[236:239], v[240:243]
    ds_read_b128 v[232:235], v245 offset:58496
    ds_read_b128 v[236:239], v247 offset:5120
    v_mfma_f32_32x32x16_bf16 a[192:207], v[168:171], v[180:183], a[192:207]
    ds_read_b64_tr_b16 v[168:169], v246 offset:25472
    ds_read_b64_tr_b16 v[170:171], v246 offset:27552
    v_fma_f32 v153, v153, s31, v251
    s_waitcnt lgkmcnt(8)
    v_mfma_f32_32x32x16_bf16 a[80:95], v[172:175], v[160:163], a[80:95]
    v_fma_f32 v154, v154, s31, v251
    v_fma_f32 v155, v155, s31, v251
    v_fma_f32 v156, v156, s31, v251
    v_fma_f32 v157, v157, s31, v251
    s_waitcnt lgkmcnt(6)
    v_mfma_f32_16x16x32_bf16 v[240:243], v[224:227], v[228:231], v[240:243]
    ds_read_b128 v[224:227], v245 offset:58752
    ds_read_b128 v[228:231], v247 offset:6144
    v_mfma_f32_32x32x16_bf16 a[208:223], v[172:175], v[176:179], a[208:223]
    ds_read_b64_tr_b16 v[172:173], v246 offset:29632
    ds_read_b64_tr_b16 v[174:175], v246 offset:31712
    v_fma_f32 v158, v158, s31, v251
    s_waitcnt lgkmcnt(8)
    v_mfma_f32_32x32x16_bf16 a[80:95], v[184:187], v[164:167], a[80:95]
    v_fma_f32 v159, v159, s31, v251
    v_max3_f32 v189, v128, v129, v130
    v_max3_f32 v189, v189, v131, v132
    s_waitcnt lgkmcnt(6)
    v_mfma_f32_16x16x32_bf16 v[240:243], v[232:235], v[236:239], v[240:243]
    ds_read_b128 v[232:235], v245 offset:59008
    ds_read_b128 v[236:239], v247 offset:7168
    v_mfma_f32_32x32x16_bf16 a[208:223], v[184:187], v[180:183], a[208:223]
    ds_read_b64_tr_b16 v[184:185], v246 offset:25728
    ds_read_b64_tr_b16 v[186:187], v246 offset:27808
    v_max3_f32 v189, v189, v133, v134
    v_max3_f32 v189, v189, v135, v136
    s_waitcnt lgkmcnt(6)
    v_mfma_f32_16x16x32_bf16 v[240:243], v[224:227], v[228:231], v[240:243]
    ds_read_b128 v[224:227], v244 offset:49920
    v_mfma_f32_32x32x16_bf16 a[96:111], v[168:171], v[160:163], a[96:111]
    ds_read_b128 v[228:231], v244 offset:49952
    v_max3_f32 v189, v189, v137, v138
    v_max3_f32 v189, v189, v139, v140
    v_max3_f32 v189, v189, v141, v142
    v_mfma_f32_32x32x16_bf16 a[224:239], v[168:171], v[176:179], a[224:239]
    ds_read_b64_tr_b16 v[168:169], v246 offset:29888
    ds_read_b64_tr_b16 v[170:171], v246 offset:31968
    v_max3_f32 v189, v189, v143, v144
    s_waitcnt lgkmcnt(6)
    v_mfma_f32_16x16x32_bf16 v[240:243], v[232:235], v[236:239], v[240:243]
    ds_read_b128 v[232:235], v244 offset:50176
    v_max3_f32 v189, v189, v145, v146
    v_mfma_f32_32x32x16_bf16 a[96:111], v[172:175], v[164:167], a[96:111]
    ds_read_b128 v[236:239], v244 offset:50208
    v_max3_f32 v189, v189, v147, v148
    v_max3_f32 v189, v189, v149, v150
    v_mfma_f32_32x32x16_bf16 a[224:239], v[172:175], v[180:183], a[224:239]
    s_nop 0
    v_max3_f32 v190, v240, v241, v242
    v_max_f32 v190, v190, v243
    v_mov_b32 v191, v190
    v_max3_f32 v189, v189, v151, v152
    v_max3_f32 v189, v189, v153, v154
    s_waitcnt lgkmcnt(6)
    v_mfma_f32_32x32x16_bf16 a[112:127], v[184:187], v[160:163], a[112:127]
    v_permlane32_swap_b32 v190, v191
    v_max_f32 v190, v190, v191
    v_mov_b32 v191, v190
    v_max3_f32 v189, v189, v155, v156
    v_mfma_f32_32x32x16_bf16 a[240:255], v[184:187], v[176:179], a[240:255]
    v_permlane16_swap_b32 v190, v191
    v_max_f32 v190, v190, v191
    ds_write_b32 v248, v190 offset:22528
    v_max3_f32 v189, v189, v157, v158
    v_max_f32 v189, v189, v159
    s_waitcnt lgkmcnt(3)
    v_mfma_f32_32x32x16_bf16 a[112:127], v[168:171], v[164:167], a[112:127]
    v_cmp_lt_f32 vcc, s46, v189
    v_mfma_f32_32x32x16_bf16 a[240:255], v[168:171], v[180:183], a[240:255]
    s_cbranch_vccz L_norare_8
    s_call_b64 s[44:45], L_rare1
L_norare_8:
    v_mfma_f32_32x32x16_bf16 v[160:175], v[224:227], v[0:3], 0
    v_exp_f32 v128, v128
    v_exp_f32 v129, v129
    v_exp_f32 v130, v130
    v_mfma_f32_32x32x16_bf16 v[176:191], v[224:227], v[64:67], 0
    ds_read_b128 v[224:227], v244 offset:50432
    v_exp_f32 v131, v131
    v_mfma_f32_32x32x16_bf16 v[160:175], v[228:231], v[4:7], v[160:175]
    v_add_f32 v252, v252, v128
    v_add_f32 v252, v252, v129
    v_add_f32 v252, v252, v130
    v_add_f32 v252, v252, v131
    v_cvt_pk_bf16_f32 v128, v128, v129
    v_cvt_pk_bf16_f32 v129, v130, v131
    v_mfma_f32_32x32x16_bf16 v[176:191], v[228:231], v[68:71], v[176:191]
    ds_read_b128 v[228:231], v244 offset:50464
    v_exp_f32 v132, v132
    s_waitcnt lgkmcnt(4)
    v_mfma_f32_32x32x16_bf16 v[160:175], v[232:235], v[8:11], v[160:175]
    v_exp_f32 v133, v133
    v_exp_f32 v134, v134
    v_exp_f32 v135, v135
    v_mfma_f32_32x32x16_bf16 v[176:191], v[232:235], v[72:75], v[176:191]
    ds_read_b128 v[232:235], v244 offset:50688
    v_add_f32 v252, v252, v132
    v_add_f32 v252, v252, v133
    v_add_f32 v252, v252, v134
    s_waitcnt lgkmcnt(4)
    v_mfma_f32_32x32x16_bf16 v[160:175], v[236:239], v[12:15], v[160:175]
    v_add_f32 v252, v252, v135
    v_cvt_pk_bf16_f32 v130, v132, v133
    v_cvt_pk_bf16_f32 v131, v134, v135
    v_exp_f32 v136, v136
    v_mfma_f32_32x32x16_bf16 v[176:191], v[236:239], v[76:79], v[176:191]
    ds_read_b128 v[236:239], v244 offset:50720
    v_exp_f32 v137, v137
    v_exp_f32 v138, v138
    s_waitcnt lgkmcnt(3)
    v_mfma_f32_32x32x16_bf16 v[160:175], v[224:227], v[16:19], v[160:175]
    v_exp_f32 v139, v139
    v_add_f32 v252, v252, v136
    v_add_f32 v252, v252, v137
    v_add_f32 v252, v252, v138
    v_mfma_f32_32x32x16_bf16 v[176:191], v[224:227], v[80:83], v[176:191]
    ds_read_b128 v[224:227], v244 offset:58240
    v_add_f32 v252, v252, v139
    v_cvt_pk_bf16_f32 v132, v136, v137
    v_cvt_pk_bf16_f32 v133, v138, v139
    s_waitcnt lgkmcnt(3)
    v_mfma_f32_32x32x16_bf16 v[160:175], v[228:231], v[20:23], v[160:175]
    v_exp_f32 v140, v140
    v_exp_f32 v141, v141
    v_exp_f32 v142, v142
    v_mfma_f32_32x32x16_bf16 v[176:191], v[228:231], v[84:87], v[176:191]
    ds_read_b128 v[228:231], v244 offset:58272
    v_exp_f32 v143, v143
    v_add_f32 v252, v252, v140
    s_waitcnt lgkmcnt(3)
    v_mfma_f32_32x32x16_bf16 v[160:175], v[232:235], v[24:27], v[160:175]
    v_add_f32 v252, v252, v141
    v_add_f32 v252, v252, v142
    v_add_f32 v252, v252, v143
    v_cvt_pk_bf16_f32 v134, v140, v141
    v_cvt_pk_bf16_f32 v135, v142, v143
    v_mfma_f32_32x32x16_bf16 v[176:191], v[232:235], v[88:91], v[176:191]
    ds_read_b128 v[232:235], v244 offset:58496
    v_exp_f32 v144, v144
    v_exp_f32 v145, v145
    s_waitcnt lgkmcnt(3)
    v_mfma_f32_32x32x16_bf16 v[160:175], v[236:239], v[28:31], v[160:175]
    v_exp_f32 v146, v146
    v_exp_f32 v147, v147
    v_mfma_f32_32x32x16_bf16 v[176:191], v[236:239], v[92:95], v[176:191]
    ds_read_b128 v[236:239], v244 offset:58528
    v_add_f32 v253, v253, v144
    v_add_f32 v253, v253, v145
    v_add_f32 v253, v253, v146
    s_waitcnt lgkmcnt(3)
    v_mfma_f32_32x32x16_bf16 v[160:175], v[224:227], v[32:35], v[160:175]
    v_add_f32 v253, v253, v147
    v_cvt_pk_bf16_f32 v144, v144, v145
    v_cvt_pk_bf16_f32 v145, v146, v147
    v_exp_f32 v148, v148
    v_mfma_f32_32x32x16_bf16 v[176:191], v[224:227], v[96:99], v[176:191]
    ds_read_b128 v[224:227], v244 offset:58752
    v_exp_f32 v149, v149
    s_waitcnt lgkmcnt(3)
    v_mfma_f32_32x32x16_bf16 v[160:175], v[228:231], v[36:39], v[160:175]
    v_exp_f32 v150, v150
    v_exp_f32 v151, v151
    v_add_f32 v253, v253, v148
    v_mfma_f32_32x32x16_bf16 v[176:191], v[228:231], v[100:103], v[176:191]
    ds_read_b128 v[228:231], v244 offset:58784
    v_add_f32 v253, v253, v149
    v_add_f32 v253, v253, v150
    v_add_f32 v253, v253, v151
    s_waitcnt lgkmcnt(3)
    v_mfma_f32_32x32x16_bf16 v[160:175], v[232:235], v[40:43], v[160:175]
    v_cvt_pk_bf16_f32 v146, v148, v149
    v_cvt_pk_bf16_f32 v147, v150, v151
    v_exp_f32 v152, v152
    v_mfma_f32_32x32x16_bf16 v[176:191], v[232:235], v[104:107], v[176:191]
    ds_read_b128 v[232:235], v244 offset:59008
    v_exp_f32 v153, v153
    v_exp_f32 v154, v154
    s_waitcnt lgkmcnt(3)
    v_mfma_f32_32x32x16_bf16 v[160:175], v[236:239], v[44:47], v[160:175]
    v_exp_f32 v155, v155
    v_add_f32 v253, v253, v152
    v_add_f32 v253, v253, v153
    v_mfma_f32_32x32x16_bf16 v[176:191], v[236:239], v[108:111], v[176:191]
    ds_read_b128 v[236:239], v244 offset:59040
    v_add_f32 v253, v253, v154
    v_add_f32 v253, v253, v155
    v_cvt_pk_bf16_f32 v148, v152, v153
    s_waitcnt lgkmcnt(3)
    v_mfma_f32_32x32x16_bf16 v[160:175], v[224:227], v[48:51], v[160:175]
    v_cvt_pk_bf16_f32 v149, v154, v155
    v_exp_f32 v156, v156
    v_exp_f32 v157, v157
    v_mfma_f32_32x32x16_bf16 v[176:191], v[224:227], v[112:115], v[176:191]
    s_sub_u32 s43, s43, 1
    s_cmp_lg_u32 s43, 0
    s_waitcnt vmcnt(16)
    s_waitcnt lgkmcnt(0)
    s_barrier
    s_cbranch_scc1 L_loop
    v_mfma_f32_32x32x16_bf16 v[160:175], v[228:231], v[52:55], v[160:175]
    ds_read_b64_tr_b16 v[136:137], v246 offset:33280
    ds_read_b64_tr_b16 v[138:139], v246 offset:35360
    v_exp_f32 v158, v158
    v_mfma_f32_32x32x16_bf16 v[176:191], v[228:231], v[116:119], v[176:191]
    ds_read_b64_tr_b16 v[140:141], v246 offset:37440
    ds_read_b64_tr_b16 v[142:143], v246 offset:39520
    v_exp_f32 v159, v159
    v_mfma_f32_32x32x16_bf16 v[160:175], v[232:235], v[56:59], v[160:175]
    v_add_f32 v253, v253, v156
    v_add_f32 v253, v253, v157
    v_add_f32 v253, v253, v158
    v_mfma_f32_32x32x16_bf16 v[176:191], v[232:235], v[120:123], v[176:191]
    v_add_f32 v253, v253, v159
    v_cvt_pk_bf16_f32 v150, v156, v157
    v_cvt_pk_bf16_f32 v151, v158, v159
    v_mfma_f32_32x32x16_bf16 v[160:175], v[236:239], v[60:63], v[160:175]
    ds_read_b64_tr_b16 v[152:153], v246 offset:33536
    ds_read_b64_tr_b16 v[154:155], v246 offset:35616
    v_mfma_f32_32x32x16_bf16 v[176:191], v[236:239], v[124:127], v[176:191]
    v_subrev_u32 v156, s41, v247
    ds_read_b32 v157, v156 offset:20484
    ds_read_b128 v[224:227], v156 offset:16384
    ds_read_b128 v[228:231], v156 offset:17408
    v_add_u32 v156, s42, v246
    s_waitcnt lgkmcnt(7)
    v_mfma_f32_32x32x16_bf16 a[0:15], v[136:139], v[128:131], a[0:15]
    ds_read_b64_tr_b16 v[232:233], v156 offset:33280
    ds_read_b64_tr_b16 v[234:235], v156 offset:35360
    ds_read_b64_tr_b16 v[236:237], v156 offset:33536
    ds_read_b64_tr_b16 v[238:239], v156 offset:35616
    v_mfma_f32_32x32x16_bf16 a[128:143], v[136:139], v[144:147], a[128:143]
    ds_read_b64_tr_b16 v[136:137], v246 offset:37696
    ds_read_b64_tr_b16 v[138:139], v246 offset:39776
    v_and_b32 v158, 0xfffffbff, v248
    s_waitcnt lgkmcnt(11)
    v_mfma_f32_32x32x16_bf16 a[0:15], v[140:143], v[132:135], a[0:15]
    ds_read2st64_b32 v[158:159], v158 offset0:88 offset1:92
    v_fma_f32 v160, v160, s31, v250
    v_fma_f32 v161, v161, s31, v250
    v_fma_f32 v162, v162, s31, v250
    v_mfma_f32_32x32x16_bf16 a[128:143], v[140:143], v[148:151], a[128:143]
    ds_read_b64_tr_b16 v[140:141], v246 offset:33792
    ds_read_b64_tr_b16 v[142:143], v246 offset:35872
    s_waitcnt lgkmcnt(11)
    v_cmp_neq_f32 vcc, 0x3f800000, v157
    s_cbranch_vccz L_skip9_9
    v_mul_f32 v192, v192, v157
    v_mul_f32 v193, v193, v157
    v_mul_f32 v194, v194, v157
    v_mul_f32 v195, v195, v157
    v_mul_f32 v196, v196, v157
    v_mul_f32 v197, v197, v157
    v_mul_f32 v198, v198, v157
    v_mul_f32 v199, v199, v157
    v_mul_f32 v200, v200, v157
    v_mul_f32 v201, v201, v157
    v_mul_f32 v202, v202, v157
    v_mul_f32 v203, v203, v157
    v_mul_f32 v204, v204, v157
    v_mul_f32 v205, v205, v157
    v_mul_f32 v206, v206, v157
    v_mul_f32 v207, v207, v157
    v_mul_f32 v208, v208, v157
    v_mul_f32 v209, v209, v157
    v_mul_f32 v210, v210, v157
    v_mul_f32 v211, v211, v157
    v_mul_f32 v212, v212, v157
    v_mul_f32 v213, v213, v157
    v_mul_f32 v214, v214, v157
    v_mul_f32 v215, v215, v157
    v_mul_f32 v216, v216, v157
    v_mul_f32 v217, v217, v157
    v_mul_f32 v218, v218, v157
    v_mul_f32 v219, v219, v157
    v_mul_f32 v220, v220, v157
    v_mul_f32 v221, v221, v157
    v_mul_f32 v222, v222, v157
    v_mul_f32 v223, v223, v157
L_skip9_9:
    v_mfma_f32_32x32x16_bf16 a[16:31], v[152:155], v[128:131], a[16:31]
    v_fma_f32 v163, v163, s31, v250
    v_fma_f32 v164, v164, s31, v250
    v_fma_f32 v165, v165, s31, v250
    s_waitcnt lgkmcnt(7)
    v_mfma_f32_32x32x16_bf16 v[192:207], v[232:235], v[224:227], v[192:207]
    v_fma_f32 v166, v166, s31, v250
    v_fma_f32 v167, v167, s31, v250
    v_fma_f32 v168, v168, s31, v250
    v_mfma_f32_32x32x16_bf16 a[144:159], v[152:155], v[144:147], a[144:159]
    ds_read_b64_tr_b16 v[152:153], v246 offset:37952
    ds_read_b64_tr_b16 v[154:155], v246 offset:40032
    s_waitcnt lgkmcnt(4)
    v_max_f32 v158, v158, v159
    v_mul_f32 v158, s31, v158
    v_add_f32 v159, s46, v254
    v_mfma_f32_32x32x16_bf16 v[208:223], v[236:239], v[224:227], v[208:223]
    ds_read_b64_tr_b16 v[232:233], v156 offset:37440
    ds_read_b64_tr_b16 v[234:235], v156 offset:39520
    ds_read_b64_tr_b16 v[236:237], v156 offset:37696
    ds_read_b64_tr_b16 v[238:239], v156 offset:39776
    s_add_u32 m0, s34, 107776
    v_cmp_gt_f32 vcc, v158, v159
    v_mfma_f32_32x32x16_bf16 a[16:31], v[136:139], v[132:135], a[16:31]
    buffer_load_dwordx4 v249, s[12:15], s33 offen nt lds
    v_cndmask_b32 v159, v254, v158, vcc
    v_sub_f32 v157, v254, v159
    v_mov_b32 v254, v159
    v_fma_f32 v169, v169, s31, v250
    v_mfma_f32_32x32x16_bf16 a[144:159], v[136:139], v[148:151], a[144:159]
    ds_read_b64_tr_b16 v[136:137], v246 offset:34048
    ds_read_b64_tr_b16 v[138:139], v246 offset:36128
    v_exp_f32 v157, v157
    v_fma_f32 v240, v240, s31, -v254
    s_waitcnt lgkmcnt(8)
    v_mfma_f32_32x32x16_bf16 a[32:47], v[140:143], v[128:131], a[32:47]
    v_fma_f32 v241, v241, s31, -v254
    v_fma_f32 v242, v242, s31, -v254
    v_fma_f32 v243, v243, s31, -v254
    v_exp_f32 v240, v240
    s_waitcnt lgkmcnt(4)
    v_mfma_f32_32x32x16_bf16 v[192:207], v[232:235], v[228:231], v[192:207]
    ds_read_b128 v[224:227], v245
    v_exp_f32 v241, v241
    v_exp_f32 v242, v242
    v_exp_f32 v243, v243
    v_mfma_f32_32x32x16_bf16 a[160:175], v[140:143], v[144:147], a[160:175]
    ds_read_b64_tr_b16 v[140:141], v246 offset:38208
    ds_read_b64_tr_b16 v[142:143], v246 offset:40288
    v_fma_f32 v255, v255, v157, v240
    v_add_f32 v255, v255, v241
    v_fma_f32 v170, v170, s31, v250
    s_waitcnt lgkmcnt(5)
    v_mfma_f32_32x32x16_bf16 v[208:223], v[236:239], v[228:231], v[208:223]
    ds_read_b128 v[228:231], v247
    s_add_u32 m0, s34, 115840
    v_add_f32 v255, v255, v242
    v_add_f32 v255, v255, v243
    v_cvt_pk_bf16_f32 v240, v240, v241
    v_cvt_pk_bf16_f32 v241, v242, v243
    v_mfma_f32_32x32x16_bf16 a[32:47], v[152:155], v[132:135], a[32:47]
    ds_read_b128 v[232:235], v245 offset:256
    ds_read_b128 v[236:239], v247 offset:1024
    buffer_load_dwordx4 v249, s[12:15], s33 offen offset:256 nt lds
    ds_write_b64 v248, v[240:241] offset:18432
    ds_write_b32 v248, v157 offset:22532
    v_mfma_f32_32x32x16_bf16 a[160:175], v[152:155], v[148:151], a[160:175]
    ds_read_b64_tr_b16 v[152:153], v246 offset:41600
    ds_read_b64_tr_b16 v[154:155], v246 offset:43680
    s_add_u32 m0, s34, 106768
    v_fma_f32 v171, v171, s31, v250
    s_waitcnt lgkmcnt(10)
    v_mfma_f32_32x32x16_bf16 a[48:63], v[136:139], v[128:131], a[48:63]
    buffer_load_dwordx4 v249, s[12:15], s33 offen offset:2048 nt lds
    v_fma_f32 v172, v172, s31, v250
    v_fma_f32 v173, v173, s31, v250
    s_waitcnt lgkmcnt(6)
    v_mfma_f32_16x16x32_bf16 v[240:243], v[224:227], v[228:231], 0
    ds_read_b128 v[224:227], v245 offset:512
    ds_read_b128 v[228:231], v247 offset:2048
    v_mfma_f32_32x32x16_bf16 a[176:191], v[136:139], v[144:147], a[176:191]
    ds_read_b64_tr_b16 v[136:137], v246 offset:45760
    ds_read_b64_tr_b16 v[138:139], v246 offset:47840
    s_add_u32 m0, s34, 114832
    v_fma_f32 v174, v174, s31, v250
    v_mfma_f32_32x32x16_bf16 a[48:63], v[140:143], v[132:135], a[48:63]
    buffer_load_dwordx4 v249, s[12:15], s33 offen offset:2304 nt lds
    v_fma_f32 v175, v175, s31, v250
    v_fma_f32 v176, v176, s31, v251
    s_waitcnt lgkmcnt(8)
    v_mfma_f32_16x16x32_bf16 v[240:243], v[232:235], v[236:239], v[240:243]
    ds_read_b128 v[232:235], v245 offset:768
    ds_read_b128 v[236:239], v247 offset:3072
    v_mfma_f32_32x32x16_bf16 a[176:191], v[140:143], v[148:151], a[176:191]
    ds_read_b64_tr_b16 v[140:141], v246 offset:41856
    ds_read_b64_tr_b16 v[142:143], v246 offset:43936
    s_add_u32 s88, s88, 16384
    s_and_b32 s88, s88, 0x7ffff
    s_add_u32 s33, s86, s88
    s_waitcnt lgkmcnt(8)
    v_mfma_f32_32x32x16_bf16 a[64:79], v[152:155], v[128:131], a[64:79]
    v_fma_f32 v177, v177, s31, v251
    v_fma_f32 v178, v178, s31, v251
    v_fma_f32 v179, v179, s31, v251
    s_waitcnt lgkmcnt(6)
    v_mfma_f32_16x16x32_bf16 v[240:243], v[224:227], v[228:231], v[240:243]
    ds_read_b128 v[224:227], v245 offset:8320
    ds_read_b128 v[228:231], v247 offset:4096
    v_mfma_f32_32x32x16_bf16 a[192:207], v[152:155], v[144:147], a[192:207]
    ds_read_b64_tr_b16 v[152:153], v246 offset:46016
    ds_read_b64_tr_b16 v[154:155], v246 offset:48096
    v_fma_f32 v180, v180, s31, v251
    v_fma_f32 v181, v181, s31, v251
    s_waitcnt lgkmcnt(8)
    v_mfma_f32_32x32x16_bf16 a[64:79], v[136:139], v[132:135], a[64:79]
    v_fma_f32 v182, v182, s31, v251
    v_fma_f32 v183, v183, s31, v251
    v_fma_f32 v184, v184, s31, v251
    s_waitcnt lgkmcnt(6)
    v_mfma_f32_16x16x32_bf16 v[240:243], v[232:235], v[236:239], v[240:243]
    ds_read_b128 v[232:235], v245 offset:8576
    ds_read_b128 v[236:239], v247 offset:5120
    v_mfma_f32_32x32x16_bf16 a[192:207], v[136:139], v[148:151], a[192:207]
    ds_read_b64_tr_b16 v[136:137], v246 offset:42112
    ds_read_b64_tr_b16 v[138:139], v246 offset:44192
    v_fma_f32 v185, v185, s31, v251
    s_waitcnt lgkmcnt(8)
    v_mfma_f32_32x32x16_bf16 a[80:95], v[140:143], v[128:131], a[80:95]
    v_fma_f32 v186, v186, s31, v251
    v_fma_f32 v187, v187, s31, v251
    v_fma_f32 v188, v188, s31, v251
    v_fma_f32 v189, v189, s31, v251
    s_waitcnt lgkmcnt(6)
    v_mfma_f32_16x16x32_bf16 v[240:243], v[224:227], v[228:231], v[240:243]
    ds_read_b128 v[224:227], v245 offset:8832
    ds_read_b128 v[228:231], v247 offset:6144
    v_mfma_f32_32x32x16_bf16 a[208:223], v[140:143], v[144:147], a[208:223]
    ds_read_b64_tr_b16 v[140:141], v246 offset:46272
    ds_read_b64_tr_b16 v[142:143], v246 offset:48352
    v_fma_f32 v190, v190, s31, v251
    s_waitcnt lgkmcnt(8)
    v_mfma_f32_32x32x16_bf16 a[80:95], v[152:155], v[132:135], a[80:95]
    v_fma_f32 v191, v191, s31, v251
    v_max3_f32 v157, v160, v161, v162
    v_max3_f32 v157, v157, v163, v164
    s_waitcnt lgkmcnt(6)
    v_mfma_f32_16x16x32_bf16 v[240:243], v[232:235], v[236:239], v[240:243]
    ds_read_b128 v[232:235], v245 offset:9088
    ds_read_b128 v[236:239], v247 offset:7168
    v_mfma_f32_32x32x16_bf16 a[208:223], v[152:155], v[148:151], a[208:223]
    ds_read_b64_tr_b16 v[152:153], v246 offset:42368
    ds_read_b64_tr_b16 v[154:155], v246 offset:44448
    v_max3_f32 v157, v157, v165, v166
    v_max3_f32 v157, v157, v167, v168
    s_waitcnt lgkmcnt(6)
    v_mfma_f32_16x16x32_bf16 v[240:243], v[224:227], v[228:231], v[240:243]
    ds_read_b128 v[224:227], v244
    v_mfma_f32_32x32x16_bf16 a[96:111], v[136:139], v[128:131], a[96:111]
    ds_read_b128 v[228:231], v244 offset:32
    v_max3_f32 v157, v157, v169, v170
    v_max3_f32 v157, v157, v171, v172
    v_max3_f32 v157, v157, v173, v174
    v_mfma_f32_32x32x16_bf16 a[224:239], v[136:139], v[144:147], a[224:239]
    ds_read_b64_tr_b16 v[136:137], v246 offset:46528
    ds_read_b64_tr_b16 v[138:139], v246 offset:48608
    v_max3_f32 v157, v157, v175, v176
    s_waitcnt lgkmcnt(6)
    v_mfma_f32_16x16x32_bf16 v[240:243], v[232:235], v[236:239], v[240:243]
    ds_read_b128 v[232:235], v244 offset:256
    v_max3_f32 v157, v157, v177, v178
    v_mfma_f32_32x32x16_bf16 a[96:111], v[140:143], v[132:135], a[96:111]
    ds_read_b128 v[236:239], v244 offset:288
    v_max3_f32 v157, v157, v179, v180
    v_max3_f32 v157, v157, v181, v182
    v_mfma_f32_32x32x16_bf16 a[224:239], v[140:143], v[148:151], a[224:239]
    s_nop 0
    v_max3_f32 v158, v240, v241, v242
    v_max_f32 v158, v158, v243
    v_mov_b32 v159, v158
    v_max3_f32 v157, v157, v183, v184
    v_max3_f32 v157, v157, v185, v186
    s_waitcnt lgkmcnt(6)
    v_mfma_f32_32x32x16_bf16 a[112:127], v[152:155], v[128:131], a[112:127]
    v_permlane32_swap_b32 v158, v159
    v_max_f32 v158, v158, v159
    v_mov_b32 v159, v158
    v_max3_f32 v157, v157, v187, v188
    v_mfma_f32_32x32x16_bf16 a[240:255], v[152:155], v[144:147], a[240:255]
    v_permlane16_swap_b32 v158, v159
    v_max_f32 v158, v158, v159
    ds_write_b32 v248, v158 offset:20480
    v_max3_f32 v157, v157, v189, v190
    v_max_f32 v157, v157, v191
    s_waitcnt lgkmcnt(3)
    v_mfma_f32_32x32x16_bf16 a[112:127], v[136:139], v[132:135], a[112:127]
    v_cmp_lt_f32 vcc, s46, v157
    v_mfma_f32_32x32x16_bf16 a[240:255], v[136:139], v[148:151], a[240:255]
    s_cbranch_vccz L_norare_10
    s_call_b64 s[44:45], L_rare0
L_norare_10:
    v_lshrrev_b32 v156, 9, v249
    v_mul_u32_u24 v156, 384, v156
    v_add_u32 v249, v249, v156
    s_lshl_b32 s39, s47, 8
    s_lshl_b32 s40, s28, 4
    s_add_u32 s39, s39, s40
    s_mul_i32 s38, s39, 896
    s_lshl_b32 s34, s34, 1
    s_lshr_b32 s39, s2, 3
    s_lshl_b32 s39, s39, 2
    s_add_u32 s39, s39, s28
    s_mul_hi_u32 s40, s39, 858993460
    s_mul_i32 s40, s40, 5
    s_sub_u32 s39, s39, s40
    s_add_u32 s39, s39, 4
    s_lshl_b32 s39, s39, 13
    v_mbcnt_lo_u32_b32 v156, -1, 0
    v_mbcnt_hi_u32_b32 v156, -1, v156
    v_lshlrev_b32 v156, 7, v156
    v_add_u32 v156, s39, v156
    s_lshl_b32 s40, s28, 8
    s_add_u32 m0, s40, 157696
    s_nop 0
    global_load_lds_dword v156, s[50:51]
    v_mfma_f32_32x32x16_bf16 v[128:143], v[224:227], v[0:3], 0
    v_exp_f32 v160, v160
    v_exp_f32 v161, v161
    v_exp_f32 v162, v162
    v_mfma_f32_32x32x16_bf16 v[144:159], v[224:227], v[64:67], 0
    ds_read_b128 v[224:227], v244 offset:512
    v_exp_f32 v163, v163
    v_mfma_f32_32x32x16_bf16 v[128:143], v[228:231], v[4:7], v[128:143]
    v_add_f32 v252, v252, v160
    v_add_f32 v252, v252, v161
    v_add_f32 v252, v252, v162
    v_add_f32 v252, v252, v163
    v_cvt_pk_bf16_f32 v160, v160, v161
    v_cvt_pk_bf16_f32 v161, v162, v163
    v_mfma_f32_32x32x16_bf16 v[144:159], v[228:231], v[68:71], v[144:159]
    ds_read_b128 v[228:231], v244 offset:544
    v_exp_f32 v164, v164
    s_waitcnt lgkmcnt(4)
    v_mfma_f32_32x32x16_bf16 v[128:143], v[232:235], v[8:11], v[128:143]
    v_exp_f32 v165, v165
    v_exp_f32 v166, v166
    v_exp_f32 v167, v167
    v_mfma_f32_32x32x16_bf16 v[144:159], v[232:235], v[72:75], v[144:159]
    ds_read_b128 v[232:235], v244 offset:768
    v_add_f32 v252, v252, v164
    v_add_f32 v252, v252, v165
    v_add_f32 v252, v252, v166
    s_waitcnt lgkmcnt(4)
    v_mfma_f32_32x32x16_bf16 v[128:143], v[236:239], v[12:15], v[128:143]
    v_add_f32 v252, v252, v167
    v_cvt_pk_bf16_f32 v162, v164, v165
    v_cvt_pk_bf16_f32 v163, v166, v167
    v_exp_f32 v168, v168
    v_mfma_f32_32x32x16_bf16 v[144:159], v[236:239], v[76:79], v[144:159]
    ds_read_b128 v[236:239], v244 offset:800
    v_exp_f32 v169, v169
    v_exp_f32 v170, v170
    s_waitcnt lgkmcnt(3)
    v_mfma_f32_32x32x16_bf16 v[128:143], v[224:227], v[16:19], v[128:143]
    v_exp_f32 v171, v171
    v_add_f32 v252, v252, v168
    v_add_f32 v252, v252, v169
    v_add_f32 v252, v252, v170
    v_mfma_f32_32x32x16_bf16 v[144:159], v[224:227], v[80:83], v[144:159]
    ds_read_b128 v[224:227], v244 offset:8320
    v_add_f32 v252, v252, v171
    v_cvt_pk_bf16_f32 v164, v168, v169
    v_cvt_pk_bf16_f32 v165, v170, v171
    s_waitcnt lgkmcnt(3)
    v_mfma_f32_32x32x16_bf16 v[128:143], v[228:231], v[20:23], v[128:143]
    v_exp_f32 v172, v172
    v_exp_f32 v173, v173
    v_exp_f32 v174, v174
    v_mfma_f32_32x32x16_bf16 v[144:159], v[228:231], v[84:87], v[144:159]
    ds_read_b128 v[228:231], v244 offset:8352
    v_exp_f32 v175, v175
    v_add_f32 v252, v252, v172
    s_waitcnt lgkmcnt(3)
    v_mfma_f32_32x32x16_bf16 v[128:143], v[232:235], v[24:27], v[128:143]
    v_add_f32 v252, v252, v173
    v_add_f32 v252, v252, v174
    v_add_f32 v252, v252, v175
    v_cvt_pk_bf16_f32 v166, v172, v173
    v_cvt_pk_bf16_f32 v167, v174, v175
    v_mfma_f32_32x32x16_bf16 v[144:159], v[232:235], v[88:91], v[144:159]
    ds_read_b128 v[232:235], v244 offset:8576
    v_exp_f32 v176, v176
    v_exp_f32 v177, v177
    s_waitcnt lgkmcnt(3)
    v_mfma_f32_32x32x16_bf16 v[128:143], v[236:239], v[28:31], v[128:143]
    v_exp_f32 v178, v178
    v_exp_f32 v179, v179
    v_mfma_f32_32x32x16_bf16 v[144:159], v[236:239], v[92:95], v[144:159]
    ds_read_b128 v[236:239], v244 offset:8608
    v_add_f32 v253, v253, v176
    v_add_f32 v253, v253, v177
    v_add_f32 v253, v253, v178
    s_waitcnt lgkmcnt(3)
    v_mfma_f32_32x32x16_bf16 v[128:143], v[224:227], v[32:35], v[128:143]
    v_add_f32 v253, v253, v179
    v_cvt_pk_bf16_f32 v176, v176, v177
    v_cvt_pk_bf16_f32 v177, v178, v179
    v_exp_f32 v180, v180
    v_mfma_f32_32x32x16_bf16 v[144:159], v[224:227], v[96:99], v[144:159]
    ds_read_b128 v[224:227], v244 offset:8832
    v_exp_f32 v181, v181
    s_waitcnt lgkmcnt(3)
    v_mfma_f32_32x32x16_bf16 v[128:143], v[228:231], v[36:39], v[128:143]
    v_exp_f32 v182, v182
    v_exp_f32 v183, v183
    v_add_f32 v253, v253, v180
    v_mfma_f32_32x32x16_bf16 v[144:159], v[228:231], v[100:103], v[144:159]
    ds_read_b128 v[228:231], v244 offset:8864
    v_add_f32 v253, v253, v181
    v_add_f32 v253, v253, v182
    v_add_f32 v253, v253, v183
    s_waitcnt lgkmcnt(3)
    v_mfma_f32_32x32x16_bf16 v[128:143], v[232:235], v[40:43], v[128:143]
    v_cvt_pk_bf16_f32 v178, v180, v181
    v_cvt_pk_bf16_f32 v179, v182, v183
    v_exp_f32 v184, v184
    v_mfma_f32_32x32x16_bf16 v[144:159], v[232:235], v[104:107], v[144:159]
    ds_read_b128 v[232:235], v244 offset:9088
    v_exp_f32 v185, v185
    v_exp_f32 v186, v186
    s_waitcnt lgkmcnt(3)
    v_mfma_f32_32x32x16_bf16 v[128:143], v[236:239], v[44:47], v[128:143]
    v_exp_f32 v187, v187
    v_add_f32 v253, v253, v184
    v_add_f32 v253, v253, v185
    v_mfma_f32_32x32x16_bf16 v[144:159], v[236:239], v[108:111], v[144:159]
    ds_read_b128 v[236:239], v244 offset:9120
    v_add_f32 v253, v253, v186
    v_add_f32 v253, v253, v187
    v_cvt_pk_bf16_f32 v180, v184, v185
    s_waitcnt lgkmcnt(3)
    v_mfma_f32_32x32x16_bf16 v[128:143], v[224:227], v[48:51], v[128:143]
    v_cvt_pk_bf16_f32 v181, v186, v187
    v_exp_f32 v188, v188
    v_exp_f32 v189, v189
    v_mfma_f32_32x32x16_bf16 v[144:159], v[224:227], v[112:115], v[144:159]
    s_waitcnt vmcnt(9)
    s_waitcnt lgkmcnt(0)
    s_barrier
    v_mfma_f32_32x32x16_bf16 v[128:143], v[228:231], v[52:55], v[128:143]
    ds_read_b64_tr_b16 v[168:169], v246 offset:49920
    ds_read_b64_tr_b16 v[170:171], v246 offset:52000
    s_add_u32 m0, s34, 74496
    s_add_u32 s40, s38, 172032
    v_exp_f32 v190, v190
    v_exp_f32 v191, v191
    v_mfma_f32_32x32x16_bf16 v[144:159], v[228:231], v[116:119], v[144:159]
    ds_read_b64_tr_b16 v[172:173], v246 offset:54080
    ds_read_b64_tr_b16 v[174:175], v246 offset:56160
    buffer_load_dwordx4 v249, s[52:55], s40 offen lds
    s_add_u32 m0, s34, 75536
    s_add_u32 s40, s38, 175616
    v_mfma_f32_32x32x16_bf16 v[128:143], v[232:235], v[56:59], v[128:143]
    buffer_load_dwordx4 v249, s[52:55], s40 offen lds
    s_add_u32 m0, s34, 76576
    s_add_u32 s40, s38, 179200
    v_add_f32 v253, v253, v188
    v_add_f32 v253, v253, v189
    v_add_f32 v253, v253, v190
    v_mfma_f32_32x32x16_bf16 v[144:159], v[232:235], v[120:123], v[144:159]
    buffer_load_dwordx4 v249, s[52:55], s40 offen lds
    s_add_u32 m0, s34, 77616
    s_add_u32 s40, s38, 182784
    v_add_f32 v253, v253, v191
    v_cvt_pk_bf16_f32 v182, v188, v189
    v_cvt_pk_bf16_f32 v183, v190, v191
    v_mfma_f32_32x32x16_bf16 v[128:143], v[236:239], v[60:63], v[128:143]
    ds_read_b64_tr_b16 v[184:185], v246 offset:50176
    ds_read_b64_tr_b16 v[186:187], v246 offset:52256
    buffer_load_dwordx4 v249, s[52:55], s40 offen lds
    v_mfma_f32_32x32x16_bf16 v[144:159], v[236:239], v[124:127], v[144:159]
    v_subrev_u32 v188, s41, v247
    ds_read_b32 v189, v188 offset:22532
    ds_read_b128 v[224:227], v188 offset:18432
    ds_read_b128 v[228:231], v188 offset:19456
    v_add_u32 v188, s42, v246
    s_waitcnt lgkmcnt(7)
    v_mfma_f32_32x32x16_bf16 a[0:15], v[168:171], v[160:163], a[0:15]
    ds_read_b64_tr_b16 v[232:233], v188 offset:49920
    ds_read_b64_tr_b16 v[234:235], v188 offset:52000
    ds_read_b64_tr_b16 v[236:237], v188 offset:50176
    ds_read_b64_tr_b16 v[238:239], v188 offset:52256
    v_mfma_f32_32x32x16_bf16 a[128:143], v[168:171], v[176:179], a[128:143]
    ds_read_b64_tr_b16 v[168:169], v246 offset:54336
    ds_read_b64_tr_b16 v[170:171], v246 offset:56416
    v_and_b32 v190, 0xfffffbff, v248
    s_waitcnt lgkmcnt(11)
    v_mfma_f32_32x32x16_bf16 a[0:15], v[172:175], v[164:167], a[0:15]
    ds_read2st64_b32 v[190:191], v190 offset0:80 offset1:84
    v_fma_f32 v128, v128, s31, v250
    v_fma_f32 v129, v129, s31, v250
    v_fma_f32 v130, v130, s31, v250
    v_mfma_f32_32x32x16_bf16 a[128:143], v[172:175], v[180:183], a[128:143]
    ds_read_b64_tr_b16 v[172:173], v246 offset:50432
    ds_read_b64_tr_b16 v[174:175], v246 offset:52512
    s_waitcnt lgkmcnt(11)
    v_cmp_neq_f32 vcc, 0x3f800000, v189
    s_cbranch_vccz L_skip9_11
    v_mul_f32 v192, v192, v189
    v_mul_f32 v193, v193, v189
    v_mul_f32 v194, v194, v189
    v_mul_f32 v195, v195, v189
    v_mul_f32 v196, v196, v189
    v_mul_f32 v197, v197, v189
    v_mul_f32 v198, v198, v189
    v_mul_f32 v199, v199, v189
    v_mul_f32 v200, v200, v189
    v_mul_f32 v201, v201, v189
    v_mul_f32 v202, v202, v189
    v_mul_f32 v203, v203, v189
    v_mul_f32 v204, v204, v189
    v_mul_f32 v205, v205, v189
    v_mul_f32 v206, v206, v189
    v_mul_f32 v207, v207, v189
    v_mul_f32 v208, v208, v189
    v_mul_f32 v209, v209, v189
    v_mul_f32 v210, v210, v189
    v_mul_f32 v211, v211, v189
    v_mul_f32 v212, v212, v189
    v_mul_f32 v213, v213, v189
    v_mul_f32 v214, v214, v189
    v_mul_f32 v215, v215, v189
    v_mul_f32 v216, v216, v189
    v_mul_f32 v217, v217, v189
    v_mul_f32 v218, v218, v189
    v_mul_f32 v219, v219, v189
    v_mul_f32 v220, v220, v189
    v_mul_f32 v221, v221, v189
    v_mul_f32 v222, v222, v189
    v_mul_f32 v223, v223, v189
L_skip9_11:
    v_mfma_f32_32x32x16_bf16 a[16:31], v[184:187], v[160:163], a[16:31]
    v_fma_f32 v131, v131, s31, v250
    v_fma_f32 v132, v132, s31, v250
    v_fma_f32 v133, v133, s31, v250
    v_fma_f32 v134, v134, s31, v250
    s_waitcnt lgkmcnt(7)
    v_mfma_f32_32x32x16_bf16 v[192:207], v[232:235], v[224:227], v[192:207]
    v_fma_f32 v135, v135, s31, v250
    v_fma_f32 v136, v136, s31, v250
    v_fma_f32 v137, v137, s31, v250
    v_mfma_f32_32x32x16_bf16 a[144:159], v[184:187], v[176:179], a[144:159]
    ds_read_b64_tr_b16 v[184:185], v246 offset:54592
    ds_read_b64_tr_b16 v[186:187], v246 offset:56672
    s_waitcnt lgkmcnt(4)
    v_max_f32 v190, v190, v191
    v_mul_f32 v190, s31, v190
    v_add_f32 v191, s46, v254
    v_mfma_f32_32x32x16_bf16 v[208:223], v[236:239], v[224:227], v[208:223]
    ds_read_b64_tr_b16 v[232:233], v188 offset:54080
    ds_read_b64_tr_b16 v[234:235], v188 offset:56160
    ds_read_b64_tr_b16 v[236:237], v188 offset:54336
    ds_read_b64_tr_b16 v[238:239], v188 offset:56416
    s_add_u32 m0, s34, 24576
    s_add_u32 s40, s38, 0
    v_mfma_f32_32x32x16_bf16 a[16:31], v[168:171], v[164:167], a[16:31]
    buffer_load_dwordx4 v249, s[52:55], s40 offen lds
    v_cmp_gt_f32 vcc, v190, v191
    s_nop 1
    v_cndmask_b32 v191, v254, v190, vcc
    v_sub_f32 v189, v254, v191
    v_mov_b32 v254, v191
    v_mfma_f32_32x32x16_bf16 a[144:159], v[168:171], v[180:183], a[144:159]
    ds_read_b64_tr_b16 v[168:169], v246 offset:50688
    ds_read_b64_tr_b16 v[170:171], v246 offset:52768
    v_exp_f32 v189, v189
    v_fma_f32 v240, v240, s31, -v254
    s_waitcnt lgkmcnt(8)
    v_mfma_f32_32x32x16_bf16 a[32:47], v[172:175], v[160:163], a[32:47]
    v_fma_f32 v241, v241, s31, -v254
    v_fma_f32 v242, v242, s31, -v254
    v_fma_f32 v243, v243, s31, -v254
    v_exp_f32 v240, v240
    v_exp_f32 v241, v241
    s_waitcnt lgkmcnt(4)
    v_mfma_f32_32x32x16_bf16 v[192:207], v[232:235], v[228:231], v[192:207]
    ds_read_b128 v[224:227], v245 offset:16640
    v_exp_f32 v242, v242
    v_exp_f32 v243, v243
    v_fma_f32 v138, v138, s31, v250
    v_mfma_f32_32x32x16_bf16 a[160:175], v[172:175], v[176:179], a[160:175]
    ds_read_b64_tr_b16 v[172:173], v246 offset:54848
    ds_read_b64_tr_b16 v[174:175], v246 offset:56928
    v_fma_f32 v255, v255, v189, v240
    v_add_f32 v255, v255, v241
    v_add_f32 v255, v255, v242
    s_waitcnt lgkmcnt(5)
    v_mfma_f32_32x32x16_bf16 v[208:223], v[236:239], v[228:231], v[208:223]
    ds_read_b128 v[228:231], v247
    s_add_u32 m0, s34, 25616
    s_add_u32 s40, s38, 3584
    v_add_f32 v255, v255, v243
    v_cvt_pk_bf16_f32 v240, v240, v241
    v_cvt_pk_bf16_f32 v241, v242, v243
    v_mfma_f32_32x32x16_bf16 a[32:47], v[184:187], v[164:167], a[32:47]
    ds_read_b128 v[232:235], v245 offset:16896
    ds_read_b128 v[236:239], v247 offset:1024
    buffer_load_dwordx4 v249, s[52:55], s40 offen lds
    ds_write_b64 v248, v[240:241] offset:16384
    ds_write_b32 v248, v189 offset:20484
    v_mfma_f32_32x32x16_bf16 a[160:175], v[184:187], v[180:183], a[160:175]
    ds_read_b64_tr_b16 v[184:185], v246 offset:58240
    ds_read_b64_tr_b16 v[186:187], v246 offset:60320
    s_add_u32 m0, s34, 26656
    s_add_u32 s40, s38, 7168
    v_fma_f32 v139, v139, s31, v250
    s_waitcnt lgkmcnt(10)
    v_mfma_f32_32x32x16_bf16 a[48:63], v[168:171], v[160:163], a[48:63]
    buffer_load_dwordx4 v249, s[52:55], s40 offen lds
    v_fma_f32 v140, v140, s31, v250
    v_fma_f32 v141, v141, s31, v250
    v_fma_f32 v142, v142, s31, v250
    s_waitcnt lgkmcnt(6)
    v_mfma_f32_16x16x32_bf16 v[240:243], v[224:227], v[228:231], 0
    ds_read_b128 v[224:227], v245 offset:17152
    ds_read_b128 v[228:231], v247 offset:2048
    v_mfma_f32_32x32x16_bf16 a[176:191], v[168:171], v[176:179], a[176:191]
    ds_read_b64_tr_b16 v[168:169], v246 offset:62400
    ds_read_b64_tr_b16 v[170:171], v246 offset:64480
    s_add_u32 m0, s34, 27696
    s_add_u32 s40, s38, 10752
    v_fma_f32 v143, v143, s31, v250
    v_mfma_f32_32x32x16_bf16 a[48:63], v[172:175], v[164:167], a[48:63]
    buffer_load_dwordx4 v249, s[52:55], s40 offen lds
    v_fma_f32 v144, v144, s31, v251
    v_fma_f32 v145, v145, s31, v251
    v_fma_f32 v146, v146, s31, v251
    s_waitcnt lgkmcnt(8)
    v_mfma_f32_16x16x32_bf16 v[240:243], v[232:235], v[236:239], v[240:243]
    ds_read_b128 v[232:235], v245 offset:17408
    ds_read_b128 v[236:239], v247 offset:3072
    v_mfma_f32_32x32x16_bf16 a[176:191], v[172:175], v[180:183], a[176:191]
    ds_read_b64_tr_b16 v[172:173], v246 offset:58496
    ds_read_b64_tr_b16 v[174:175], v246 offset:60576
    s_add_u32 m0, s34, 57856
    s_add_u32 s40, s38, 114688
    v_fma_f32 v147, v147, s31, v251
    s_waitcnt lgkmcnt(8)
    v_mfma_f32_32x32x16_bf16 a[64:79], v[184:187], v[160:163], a[64:79]
    buffer_load_dwordx4 v249, s[52:55], s40 offen lds
    v_fma_f32 v148, v148, s31, v251
    v_fma_f32 v149, v149, s31, v251
    v_fma_f32 v150, v150, s31, v251
    s_waitcnt lgkmcnt(6)
    v_mfma_f32_16x16x32_bf16 v[240:243], v[224:227], v[228:231], v[240:243]
    ds_read_b128 v[224:227], v245 offset:24960
    ds_read_b128 v[228:231], v247 offset:4096
    v_mfma_f32_32x32x16_bf16 a[192:207], v[184:187], v[176:179], a[192:207]
    ds_read_b64_tr_b16 v[184:185], v246 offset:62656
    ds_read_b64_tr_b16 v[186:187], v246 offset:64736
    s_add_u32 m0, s34, 58896
    s_add_u32 s40, s38, 118272
    v_fma_f32 v151, v151, s31, v251
    s_waitcnt lgkmcnt(8)
    v_mfma_f32_32x32x16_bf16 a[64:79], v[168:171], v[164:167], a[64:79]
    buffer_load_dwordx4 v249, s[52:55], s40 offen lds
    v_fma_f32 v152, v152, s31, v251
    v_fma_f32 v153, v153, s31, v251
    v_fma_f32 v154, v154, s31, v251
    s_waitcnt lgkmcnt(6)
    v_mfma_f32_16x16x32_bf16 v[240:243], v[232:235], v[236:239], v[240:243]
    ds_read_b128 v[232:235], v245 offset:25216
    ds_read_b128 v[236:239], v247 offset:5120
    v_mfma_f32_32x32x16_bf16 a[192:207], v[168:171], v[180:183], a[192:207]
    ds_read_b64_tr_b16 v[168:169], v246 offset:58752
    ds_read_b64_tr_b16 v[170:171], v246 offset:60832
    s_add_u32 m0, s34, 59936
    s_add_u32 s40, s38, 121856
    v_fma_f32 v155, v155, s31, v251
    s_waitcnt lgkmcnt(8)
    v_mfma_f32_32x32x16_bf16 a[80:95], v[172:175], v[160:163], a[80:95]
    buffer_load_dwordx4 v249, s[52:55], s40 offen lds
    v_fma_f32 v156, v156, s31, v251
    v_fma_f32 v157, v157, s31, v251
    v_fma_f32 v158, v158, s31, v251
    v_fma_f32 v159, v159, s31, v251
    s_waitcnt lgkmcnt(6)
    v_mfma_f32_16x16x32_bf16 v[240:243], v[224:227], v[228:231], v[240:243]
    ds_read_b128 v[224:227], v245 offset:25472
    ds_read_b128 v[228:231], v247 offset:6144
    v_mfma_f32_32x32x16_bf16 a[208:223], v[172:175], v[176:179], a[208:223]
    ds_read_b64_tr_b16 v[172:173], v246 offset:62912
    ds_read_b64_tr_b16 v[174:175], v246 offset:64992
    s_add_u32 m0, s34, 60976
    s_add_u32 s40, s38, 125440
    s_waitcnt lgkmcnt(8)
    v_mfma_f32_32x32x16_bf16 a[80:95], v[184:187], v[164:167], a[80:95]
    buffer_load_dwordx4 v249, s[52:55], s40 offen lds
    v_max3_f32 v189, v128, v129, v130
    v_max3_f32 v189, v189, v131, v132
    v_max3_f32 v189, v189, v133, v134
    v_max3_f32 v189, v189, v135, v136
    s_waitcnt lgkmcnt(6)
    v_mfma_f32_16x16x32_bf16 v[240:243], v[232:235], v[236:239], v[240:243]
    ds_read_b128 v[232:235], v245 offset:25728
    ds_read_b128 v[236:239], v247 offset:7168
    v_mfma_f32_32x32x16_bf16 a[208:223], v[184:187], v[180:183], a[208:223]
    ds_read_b64_tr_b16 v[184:185], v246 offset:59008
    ds_read_b64_tr_b16 v[186:187], v246 offset:61088
    v_max3_f32 v189, v189, v137, v138
    v_max3_f32 v189, v189, v139, v140
    s_waitcnt lgkmcnt(6)
    v_mfma_f32_16x16x32_bf16 v[240:243], v[224:227], v[228:231], v[240:243]
    ds_read_b128 v[224:227], v244 offset:16640
    s_add_u32 m0, s34, 124416
    s_add_u32 s40, s38, 114944
    v_mfma_f32_32x32x16_bf16 a[96:111], v[168:171], v[160:163], a[96:111]
    ds_read_b128 v[228:231], v244 offset:16672
    buffer_load_dwordx4 v249, s[52:55], s40 offen lds
    v_max3_f32 v189, v189, v141, v142
    v_max3_f32 v189, v189, v143, v144
    v_max3_f32 v189, v189, v145, v146
    v_mfma_f32_32x32x16_bf16 a[224:239], v[168:171], v[176:179], a[224:239]
    ds_read_b64_tr_b16 v[168:169], v246 offset:63168
    ds_read_b64_tr_b16 v[170:171], v246 offset:65248
    v_max3_f32 v189, v189, v147, v148
    v_max3_f32 v189, v189, v149, v150
    s_waitcnt lgkmcnt(6)
    v_mfma_f32_16x16x32_bf16 v[240:243], v[232:235], v[236:239], v[240:243]
    ds_read_b128 v[232:235], v244 offset:16896
    s_add_u32 m0, s34, 125456
    s_add_u32 s40, s38, 118528
    v_mfma_f32_32x32x16_bf16 a[96:111], v[172:175], v[164:167], a[96:111]
    ds_read_b128 v[236:239], v244 offset:16928
    buffer_load_dwordx4 v249, s[52:55], s40 offen lds
    v_max3_f32 v189, v189, v151, v152
    v_max3_f32 v189, v189, v153, v154
    v_max3_f32 v189, v189, v155, v156
    v_mfma_f32_32x32x16_bf16 a[224:239], v[172:175], v[180:183], a[224:239]
    s_add_u32 m0, s34, 126496
    s_add_u32 s40, s38, 122112
    v_max3_f32 v190, v240, v241, v242
    v_max_f32 v190, v190, v243
    v_mov_b32 v191, v190
    s_waitcnt lgkmcnt(6)
    v_mfma_f32_32x32x16_bf16 a[112:127], v[184:187], v[160:163], a[112:127]
    buffer_load_dwordx4 v249, s[52:55], s40 offen lds
    v_permlane32_swap_b32 v190, v191
    v_max_f32 v190, v190, v191
    v_mov_b32 v191, v190
    v_max3_f32 v189, v189, v157, v158
    v_mfma_f32_32x32x16_bf16 a[240:255], v[184:187], v[176:179], a[240:255]
    s_add_u32 m0, s34, 127536
    s_add_u32 s40, s38, 125696
    v_permlane16_swap_b32 v190, v191
    v_max_f32 v190, v190, v191
    ds_write_b32 v248, v190 offset:22528
    v_max_f32 v189, v189, v159
    s_waitcnt lgkmcnt(3)
    v_mfma_f32_32x32x16_bf16 a[112:127], v[168:171], v[164:167], a[112:127]
    buffer_load_dwordx4 v249, s[52:55], s40 offen lds
    v_cmp_lt_f32 vcc, s46, v189
    v_mfma_f32_32x32x16_bf16 a[240:255], v[168:171], v[180:183], a[240:255]
    s_cbranch_vccz L_norare_12
    s_call_b64 s[44:45], L_rare1
L_norare_12:
    v_mfma_f32_32x32x16_bf16 v[160:175], v[224:227], v[0:3], 0
    v_exp_f32 v128, v128
    v_exp_f32 v129, v129
    v_exp_f32 v130, v130
    v_mfma_f32_32x32x16_bf16 v[176:191], v[224:227], v[64:67], 0
    ds_read_b128 v[224:227], v244 offset:17152
    v_exp_f32 v131, v131
    v_mfma_f32_32x32x16_bf16 v[160:175], v[228:231], v[4:7], v[160:175]
    v_add_f32 v252, v252, v128
    v_add_f32 v252, v252, v129
    v_add_f32 v252, v252, v130
    v_add_f32 v252, v252, v131
    v_cvt_pk_bf16_f32 v128, v128, v129
    v_cvt_pk_bf16_f32 v129, v130, v131
    v_mfma_f32_32x32x16_bf16 v[176:191], v[228:231], v[68:71], v[176:191]
    ds_read_b128 v[228:231], v244 offset:17184
    v_exp_f32 v132, v132
    s_waitcnt lgkmcnt(4)
    v_mfma_f32_32x32x16_bf16 v[160:175], v[232:235], v[8:11], v[160:175]
    v_exp_f32 v133, v133
    v_exp_f32 v134, v134
    v_exp_f32 v135, v135
    v_mfma_f32_32x32x16_bf16 v[176:191], v[232:235], v[72:75], v[176:191]
    ds_read_b128 v[232:235], v244 offset:17408
    v_add_f32 v252, v252, v132
    v_add_f32 v252, v252, v133
    v_add_f32 v252, v252, v134
    s_waitcnt lgkmcnt(4)
    v_mfma_f32_32x32x16_bf16 v[160:175], v[236:239], v[12:15], v[160:175]
    v_add_f32 v252, v252, v135
    v_cvt_pk_bf16_f32 v130, v132, v133
    v_cvt_pk_bf16_f32 v131, v134, v135
    v_exp_f32 v136, v136
    v_mfma_f32_32x32x16_bf16 v[176:191], v[236:239], v[76:79], v[176:191]
    ds_read_b128 v[236:239], v244 offset:17440
    v_exp_f32 v137, v137
    v_exp_f32 v138, v138
    s_waitcnt lgkmcnt(3)
    v_mfma_f32_32x32x16_bf16 v[160:175], v[224:227], v[16:19], v[160:175]
    v_exp_f32 v139, v139
    v_add_f32 v252, v252, v136
    v_add_f32 v252, v252, v137
    v_add_f32 v252, v252, v138
    v_mfma_f32_32x32x16_bf16 v[176:191], v[224:227], v[80:83], v[176:191]
    ds_read_b128 v[224:227], v244 offset:24960
    v_add_f32 v252, v252, v139
    v_cvt_pk_bf16_f32 v132, v136, v137
    v_cvt_pk_bf16_f32 v133, v138, v139
    s_waitcnt lgkmcnt(3)
    v_mfma_f32_32x32x16_bf16 v[160:175], v[228:231], v[20:23], v[160:175]
    v_exp_f32 v140, v140
    v_exp_f32 v141, v141
    v_exp_f32 v142, v142
    v_mfma_f32_32x32x16_bf16 v[176:191], v[228:231], v[84:87], v[176:191]
    ds_read_b128 v[228:231], v244 offset:24992
    v_exp_f32 v143, v143
    v_add_f32 v252, v252, v140
    s_waitcnt lgkmcnt(3)
    v_mfma_f32_32x32x16_bf16 v[160:175], v[232:235], v[24:27], v[160:175]
    v_add_f32 v252, v252, v141
    v_add_f32 v252, v252, v142
    v_add_f32 v252, v252, v143
    v_cvt_pk_bf16_f32 v134, v140, v141
    v_cvt_pk_bf16_f32 v135, v142, v143
    v_mfma_f32_32x32x16_bf16 v[176:191], v[232:235], v[88:91], v[176:191]
    ds_read_b128 v[232:235], v244 offset:25216
    v_exp_f32 v144, v144
    v_exp_f32 v145, v145
    s_waitcnt lgkmcnt(3)
    v_mfma_f32_32x32x16_bf16 v[160:175], v[236:239], v[28:31], v[160:175]
    v_exp_f32 v146, v146
    v_exp_f32 v147, v147
    v_mfma_f32_32x32x16_bf16 v[176:191], v[236:239], v[92:95], v[176:191]
    ds_read_b128 v[236:239], v244 offset:25248
    v_add_f32 v253, v253, v144
    v_add_f32 v253, v253, v145
    v_add_f32 v253, v253, v146
    s_waitcnt lgkmcnt(3)
    v_mfma_f32_32x32x16_bf16 v[160:175], v[224:227], v[32:35], v[160:175]
    v_add_f32 v253, v253, v147
    v_cvt_pk_bf16_f32 v144, v144, v145
    v_cvt_pk_bf16_f32 v145, v146, v147
    v_exp_f32 v148, v148
    v_mfma_f32_32x32x16_bf16 v[176:191], v[224:227], v[96:99], v[176:191]
    ds_read_b128 v[224:227], v244 offset:25472
    v_exp_f32 v149, v149
    s_waitcnt lgkmcnt(3)
    v_mfma_f32_32x32x16_bf16 v[160:175], v[228:231], v[36:39], v[160:175]
    v_exp_f32 v150, v150
    v_exp_f32 v151, v151
    v_add_f32 v253, v253, v148
    v_mfma_f32_32x32x16_bf16 v[176:191], v[228:231], v[100:103], v[176:191]
    ds_read_b128 v[228:231], v244 offset:25504
    v_add_f32 v253, v253, v149
    v_add_f32 v253, v253, v150
    v_add_f32 v253, v253, v151
    s_waitcnt lgkmcnt(3)
    v_mfma_f32_32x32x16_bf16 v[160:175], v[232:235], v[40:43], v[160:175]
    v_cvt_pk_bf16_f32 v146, v148, v149
    v_cvt_pk_bf16_f32 v147, v150, v151
    v_exp_f32 v152, v152
    v_mfma_f32_32x32x16_bf16 v[176:191], v[232:235], v[104:107], v[176:191]
    ds_read_b128 v[232:235], v244 offset:25728
    v_exp_f32 v153, v153
    v_exp_f32 v154, v154
    s_waitcnt lgkmcnt(3)
    v_mfma_f32_32x32x16_bf16 v[160:175], v[236:239], v[44:47], v[160:175]
    v_exp_f32 v155, v155
    v_add_f32 v253, v253, v152
    v_add_f32 v253, v253, v153
    v_mfma_f32_32x32x16_bf16 v[176:191], v[236:239], v[108:111], v[176:191]
    ds_read_b128 v[236:239], v244 offset:25760
    v_add_f32 v253, v253, v154
    v_add_f32 v253, v253, v155
    v_cvt_pk_bf16_f32 v148, v152, v153
    s_waitcnt lgkmcnt(3)
    v_mfma_f32_32x32x16_bf16 v[160:175], v[224:227], v[48:51], v[160:175]
    v_cvt_pk_bf16_f32 v149, v154, v155
    v_exp_f32 v156, v156
    v_exp_f32 v157, v157
    v_mfma_f32_32x32x16_bf16 v[176:191], v[224:227], v[112:115], v[176:191]
    s_waitcnt vmcnt(21)
    s_waitcnt lgkmcnt(0)
    s_barrier
    v_mfma_f32_32x32x16_bf16 v[160:175], v[228:231], v[52:55], v[160:175]
    ds_read_b64_tr_b16 v[136:137], v246
    ds_read_b64_tr_b16 v[138:139], v246 offset:2080
    s_add_u32 m0, s34, 41216
    s_add_u32 s40, s38, 57344
    v_exp_f32 v158, v158
    v_exp_f32 v159, v159
    v_mfma_f32_32x32x16_bf16 v[176:191], v[228:231], v[116:119], v[176:191]
    ds_read_b64_tr_b16 v[140:141], v246 offset:4160
    ds_read_b64_tr_b16 v[142:143], v246 offset:6240
    buffer_load_dwordx4 v249, s[52:55], s40 offen lds
    s_add_u32 m0, s34, 42256
    s_add_u32 s40, s38, 60928
    v_mfma_f32_32x32x16_bf16 v[160:175], v[232:235], v[56:59], v[160:175]
    buffer_load_dwordx4 v249, s[52:55], s40 offen lds
    s_add_u32 m0, s34, 43296
    s_add_u32 s40, s38, 64512
    v_add_f32 v253, v253, v156
    v_add_f32 v253, v253, v157
    v_add_f32 v253, v253, v158
    v_mfma_f32_32x32x16_bf16 v[176:191], v[232:235], v[120:123], v[176:191]
    buffer_load_dwordx4 v249, s[52:55], s40 offen lds
    s_add_u32 m0, s34, 44336
    s_add_u32 s40, s38, 68096
    v_add_f32 v253, v253, v159
    v_cvt_pk_bf16_f32 v150, v156, v157
    v_cvt_pk_bf16_f32 v151, v158, v159
    v_mfma_f32_32x32x16_bf16 v[160:175], v[236:239], v[60:63], v[160:175]
    ds_read_b64_tr_b16 v[152:153], v246 offset:256
    ds_read_b64_tr_b16 v[154:155], v246 offset:2336
    buffer_load_dwordx4 v249, s[52:55], s40 offen lds
    v_mfma_f32_32x32x16_bf16 v[176:191], v[236:239], v[124:127], v[176:191]
    v_subrev_u32 v156, s41, v247
    ds_read_b32 v157, v156 offset:20484
    ds_read_b128 v[224:227], v156 offset:16384
    ds_read_b128 v[228:231], v156 offset:17408
    v_add_u32 v156, s42, v246
    s_waitcnt lgkmcnt(7)
    v_mfma_f32_32x32x16_bf16 a[0:15], v[136:139], v[128:131], a[0:15]
    ds_read_b64_tr_b16 v[232:233], v156
    ds_read_b64_tr_b16 v[234:235], v156 offset:2080
    ds_read_b64_tr_b16 v[236:237], v156 offset:256
    ds_read_b64_tr_b16 v[238:239], v156 offset:2336
    v_mfma_f32_32x32x16_bf16 a[128:143], v[136:139], v[144:147], a[128:143]
    ds_read_b64_tr_b16 v[136:137], v246 offset:4416
    ds_read_b64_tr_b16 v[138:139], v246 offset:6496
    v_and_b32 v158, 0xfffffbff, v248
    s_waitcnt lgkmcnt(11)
    v_mfma_f32_32x32x16_bf16 a[0:15], v[140:143], v[132:135], a[0:15]
    ds_read2st64_b32 v[158:159], v158 offset0:88 offset1:92
    v_fma_f32 v160, v160, s31, v250
    v_fma_f32 v161, v161, s31, v250
    v_fma_f32 v162, v162, s31, v250
    v_mfma_f32_32x32x16_bf16 a[128:143], v[140:143], v[148:151], a[128:143]
    ds_read_b64_tr_b16 v[140:141], v246 offset:512
    ds_read_b64_tr_b16 v[142:143], v246 offset:2592
    s_waitcnt lgkmcnt(11)
    v_cmp_neq_f32 vcc, 0x3f800000, v157
    s_cbranch_vccz L_skip9_13
    v_mul_f32 v192, v192, v157
    v_mul_f32 v193, v193, v157
    v_mul_f32 v194, v194, v157
    v_mul_f32 v195, v195, v157
    v_mul_f32 v196, v196, v157
    v_mul_f32 v197, v197, v157
    v_mul_f32 v198, v198, v157
    v_mul_f32 v199, v199, v157
    v_mul_f32 v200, v200, v157
    v_mul_f32 v201, v201, v157
    v_mul_f32 v202, v202, v157
    v_mul_f32 v203, v203, v157
    v_mul_f32 v204, v204, v157
    v_mul_f32 v205, v205, v157
    v_mul_f32 v206, v206, v157
    v_mul_f32 v207, v207, v157
    v_mul_f32 v208, v208, v157
    v_mul_f32 v209, v209, v157
    v_mul_f32 v210, v210, v157
    v_mul_f32 v211, v211, v157
    v_mul_f32 v212, v212, v157
    v_mul_f32 v213, v213, v157
    v_mul_f32 v214, v214, v157
    v_mul_f32 v215, v215, v157
    v_mul_f32 v216, v216, v157
    v_mul_f32 v217, v217, v157
    v_mul_f32 v218, v218, v157
    v_mul_f32 v219, v219, v157
    v_mul_f32 v220, v220, v157
    v_mul_f32 v221, v221, v157
    v_mul_f32 v222, v222, v157
    v_mul_f32 v223, v223, v157
L_skip9_13:
    v_mfma_f32_32x32x16_bf16 a[16:31], v[152:155], v[128:131], a[16:31]
    v_fma_f32 v163, v163, s31, v250
    v_fma_f32 v164, v164, s31, v250
    v_fma_f32 v165, v165, s31, v250
    s_waitcnt lgkmcnt(7)
    v_mfma_f32_32x32x16_bf16 v[192:207], v[232:235], v[224:227], v[192:207]
    v_fma_f32 v166, v166, s31, v250
    v_fma_f32 v167, v167, s31, v250
    v_fma_f32 v168, v168, s31, v250
    v_mfma_f32_32x32x16_bf16 a[144:159], v[152:155], v[144:147], a[144:159]
    ds_read_b64_tr_b16 v[152:153], v246 offset:4672
    ds_read_b64_tr_b16 v[154:155], v246 offset:6752
    s_waitcnt lgkmcnt(4)
    v_max_f32 v158, v158, v159
    v_mul_f32 v158, s31, v158
    v_add_f32 v159, s46, v254
    v_mfma_f32_32x32x16_bf16 v[208:223], v[236:239], v[224:227], v[208:223]
    ds_read_b64_tr_b16 v[232:233], v156 offset:4160
    ds_read_b64_tr_b16 v[234:235], v156 offset:6240
    ds_read_b64_tr_b16 v[236:237], v156 offset:4416
    ds_read_b64_tr_b16 v[238:239], v156 offset:6496
    s_add_u32 m0, s34, 141056
    s_add_u32 s40, s38, 172288
    v_mfma_f32_32x32x16_bf16 a[16:31], v[136:139], v[132:135], a[16:31]
    buffer_load_dwordx4 v249, s[52:55], s40 offen lds
    v_cmp_gt_f32 vcc, v158, v159
    s_nop 1
    v_cndmask_b32 v159, v254, v158, vcc
    v_sub_f32 v157, v254, v159
    v_mfma_f32_32x32x16_bf16 a[144:159], v[136:139], v[148:151], a[144:159]
    ds_read_b64_tr_b16 v[136:137], v246 offset:768
    ds_read_b64_tr_b16 v[138:139], v246 offset:2848
    v_mov_b32 v254, v159
    v_exp_f32 v157, v157
    s_waitcnt lgkmcnt(8)
    v_mfma_f32_32x32x16_bf16 a[32:47], v[140:143], v[128:131], a[32:47]
    v_fma_f32 v240, v240, s31, -v254
    v_fma_f32 v241, v241, s31, -v254
    v_fma_f32 v242, v242, s31, -v254
    v_fma_f32 v243, v243, s31, -v254
    v_exp_f32 v240, v240
    s_waitcnt lgkmcnt(4)
    v_mfma_f32_32x32x16_bf16 v[192:207], v[232:235], v[228:231], v[192:207]
    v_exp_f32 v241, v241
    v_exp_f32 v242, v242
    v_fma_f32 v169, v169, s31, v250
    v_mfma_f32_32x32x16_bf16 a[160:175], v[140:143], v[144:147], a[160:175]
    ds_read_b64_tr_b16 v[140:141], v246 offset:4928
    ds_read_b64_tr_b16 v[142:143], v246 offset:7008
    v_exp_f32 v243, v243
    v_fma_f32 v255, v255, v157, v240
    s_waitcnt lgkmcnt(4)
    v_mfma_f32_32x32x16_bf16 v[208:223], v[236:239], v[228:231], v[208:223]
    s_add_u32 m0, s34, 142096
    s_add_u32 s40, s38, 175872
    v_add_f32 v255, v255, v241
    v_add_f32 v255, v255, v242
    v_add_f32 v255, v255, v243
    v_fma_f32 v170, v170, s31, v250
    v_mfma_f32_32x32x16_bf16 a[32:47], v[152:155], v[132:135], a[32:47]
    buffer_load_dwordx4 v249, s[52:55], s40 offen lds
    v_cvt_pk_bf16_f32 v240, v240, v241
    v_cvt_pk_bf16_f32 v241, v242, v243
    ds_write_b64 v248, v[240:241] offset:18432
    ds_write_b32 v248, v157 offset:22532
    v_mfma_f32_32x32x16_bf16 a[160:175], v[152:155], v[148:151], a[160:175]
    ds_read_b64_tr_b16 v[152:153], v246 offset:8320
    ds_read_b64_tr_b16 v[154:155], v246 offset:10400
    s_add_u32 m0, s34, 143136
    s_add_u32 s40, s38, 179456
    s_waitcnt lgkmcnt(6)
    v_mfma_f32_32x32x16_bf16 a[48:63], v[136:139], v[128:131], a[48:63]
    buffer_load_dwordx4 v249, s[52:55], s40 offen lds
    v_fma_f32 v171, v171, s31, v250
    v_fma_f32 v172, v172, s31, v250
    v_mfma_f32_32x32x16_bf16 a[176:191], v[136:139], v[144:147], a[176:191]
    ds_read_b64_tr_b16 v[136:137], v246 offset:12480
    ds_read_b64_tr_b16 v[138:139], v246 offset:14560
    s_add_u32 m0, s34, 144176
    s_add_u32 s40, s38, 183040
    v_fma_f32 v173, v173, s31, v250
    s_waitcnt lgkmcnt(6)
    v_mfma_f32_32x32x16_bf16 a[48:63], v[140:143], v[132:135], a[48:63]
    buffer_load_dwordx4 v249, s[52:55], s40 offen lds
    v_fma_f32 v174, v174, s31, v250
    v_fma_f32 v175, v175, s31, v250
    v_mfma_f32_32x32x16_bf16 a[176:191], v[140:143], v[148:151], a[176:191]
    ds_read_b64_tr_b16 v[140:141], v246 offset:8576
    ds_read_b64_tr_b16 v[142:143], v246 offset:10656
    v_fma_f32 v176, v176, s31, v251
    s_waitcnt lgkmcnt(4)
    v_mfma_f32_32x32x16_bf16 a[64:79], v[152:155], v[128:131], a[64:79]
    v_fma_f32 v177, v177, s31, v251
    v_fma_f32 v178, v178, s31, v251
    v_fma_f32 v179, v179, s31, v251
    v_mfma_f32_32x32x16_bf16 a[192:207], v[152:155], v[144:147], a[192:207]
    ds_read_b64_tr_b16 v[152:153], v246 offset:12736
    ds_read_b64_tr_b16 v[154:155], v246 offset:14816
    v_fma_f32 v180, v180, s31, v251
    s_waitcnt lgkmcnt(4)
    v_mfma_f32_32x32x16_bf16 a[64:79], v[136:139], v[132:135], a[64:79]
    v_fma_f32 v181, v181, s31, v251
    v_fma_f32 v182, v182, s31, v251
    v_fma_f32 v183, v183, s31, v251
    v_mfma_f32_32x32x16_bf16 a[192:207], v[136:139], v[148:151], a[192:207]
    ds_read_b64_tr_b16 v[136:137], v246 offset:8832
    ds_read_b64_tr_b16 v[138:139], v246 offset:10912
    v_fma_f32 v184, v184, s31, v251
    s_waitcnt lgkmcnt(4)
    v_mfma_f32_32x32x16_bf16 a[80:95], v[140:143], v[128:131], a[80:95]
    v_fma_f32 v185, v185, s31, v251
    v_fma_f32 v186, v186, s31, v251
    v_fma_f32 v187, v187, s31, v251
    v_mfma_f32_32x32x16_bf16 a[208:223], v[140:143], v[144:147], a[208:223]
    ds_read_b64_tr_b16 v[140:141], v246 offset:12992
    ds_read_b64_tr_b16 v[142:143], v246 offset:15072
    v_fma_f32 v188, v188, s31, v251
    s_waitcnt lgkmcnt(4)
    v_mfma_f32_32x32x16_bf16 a[80:95], v[152:155], v[132:135], a[80:95]
    v_fma_f32 v189, v189, s31, v251
    v_fma_f32 v190, v190, s31, v251
    v_fma_f32 v191, v191, s31, v251
    v_mfma_f32_32x32x16_bf16 a[208:223], v[152:155], v[148:151], a[208:223]
    ds_read_b64_tr_b16 v[152:153], v246 offset:9088
    ds_read_b64_tr_b16 v[154:155], v246 offset:11168
    v_max3_f32 v157, v160, v161, v162
    s_waitcnt lgkmcnt(4)
    v_mfma_f32_32x32x16_bf16 a[96:111], v[136:139], v[128:131], a[96:111]
    v_max3_f32 v157, v157, v163, v164
    v_max3_f32 v157, v157, v165, v166
    v_max3_f32 v157, v157, v167, v168
    v_mfma_f32_32x32x16_bf16 a[224:239], v[136:139], v[144:147], a[224:239]
    ds_read_b64_tr_b16 v[136:137], v246 offset:13248
    ds_read_b64_tr_b16 v[138:139], v246 offset:15328
    v_max3_f32 v157, v157, v169, v170
    s_waitcnt lgkmcnt(4)
    v_mfma_f32_32x32x16_bf16 a[96:111], v[140:143], v[132:135], a[96:111]
    v_max3_f32 v157, v157, v171, v172
    v_max3_f32 v157, v157, v173, v174
    v_max3_f32 v157, v157, v175, v176
    v_mfma_f32_32x32x16_bf16 a[224:239], v[140:143], v[148:151], a[224:239]
    v_max3_f32 v157, v157, v177, v178
    v_max3_f32 v157, v157, v179, v180
    v_max3_f32 v157, v157, v181, v182
    s_waitcnt lgkmcnt(2)
    v_mfma_f32_32x32x16_bf16 a[112:127], v[152:155], v[128:131], a[112:127]
    v_max3_f32 v157, v157, v183, v184
    v_max3_f32 v157, v157, v185, v186
    v_mfma_f32_32x32x16_bf16 a[240:255], v[152:155], v[144:147], a[240:255]
    v_max3_f32 v157, v157, v187, v188
    v_max3_f32 v157, v157, v189, v190
    v_max_f32 v157, v157, v191
    s_waitcnt lgkmcnt(0)
    v_mfma_f32_32x32x16_bf16 a[112:127], v[136:139], v[132:135], a[112:127]
    v_cmp_lt_f32 vcc, s46, v157
    v_mfma_f32_32x32x16_bf16 a[240:255], v[136:139], v[148:151], a[240:255]
    s_cbranch_vccz L_norare_14
    s_call_b64 s[44:45], L_rare0
L_norare_14:
    v_exp_f32 v160, v160
    v_exp_f32 v161, v161
    v_exp_f32 v162, v162
    v_exp_f32 v163, v163
    v_add_f32 v252, v252, v160
    v_add_f32 v252, v252, v161
    v_add_f32 v252, v252, v162
    v_add_f32 v252, v252, v163
    v_cvt_pk_bf16_f32 v160, v160, v161
    v_cvt_pk_bf16_f32 v161, v162, v163
    v_exp_f32 v164, v164
    v_exp_f32 v165, v165
    v_exp_f32 v166, v166
    v_exp_f32 v167, v167
    v_add_f32 v252, v252, v164
    v_add_f32 v252, v252, v165
    v_add_f32 v252, v252, v166
    v_add_f32 v252, v252, v167
    v_cvt_pk_bf16_f32 v162, v164, v165
    v_cvt_pk_bf16_f32 v163, v166, v167
    v_exp_f32 v168, v168
    v_exp_f32 v169, v169
    v_exp_f32 v170, v170
    v_exp_f32 v171, v171
    v_add_f32 v252, v252, v168
    v_add_f32 v252, v252, v169
    v_add_f32 v252, v252, v170
    v_add_f32 v252, v252, v171
    v_cvt_pk_bf16_f32 v164, v168, v169
    v_cvt_pk_bf16_f32 v165, v170, v171
    v_exp_f32 v172, v172
    v_exp_f32 v173, v173
    v_exp_f32 v174, v174
    v_exp_f32 v175, v175
    v_add_f32 v252, v252, v172
    v_add_f32 v252, v252, v173
    v_add_f32 v252, v252, v174
    v_add_f32 v252, v252, v175
    v_cvt_pk_bf16_f32 v166, v172, v173
    v_cvt_pk_bf16_f32 v167, v174, v175
    s_waitcnt vmcnt(25)
    s_barrier
    ds_read_b64_tr_b16 v[168:169], v246 offset:16640
    ds_read_b64_tr_b16 v[170:171], v246 offset:18720
    ds_read_b64_tr_b16 v[172:173], v246 offset:20800
    ds_read_b64_tr_b16 v[174:175], v246 offset:22880
    s_add_u32 m0, s34, 91136
    s_add_u32 s40, s38, 256
    buffer_load_dwordx4 v249, s[52:55], s40 offen lds
    s_add_u32 m0, s34, 92176
    s_add_u32 s40, s38, 3840
    buffer_load_dwordx4 v249, s[52:55], s40 offen lds
    s_add_u32 m0, s34, 93216
    s_add_u32 s40, s38, 7424
    buffer_load_dwordx4 v249, s[52:55], s40 offen lds
    s_add_u32 m0, s34, 94256
    s_add_u32 s40, s38, 11008
    buffer_load_dwordx4 v249, s[52:55], s40 offen lds
    v_exp_f32 v176, v176
    v_exp_f32 v177, v177
    v_exp_f32 v178, v178
    v_exp_f32 v179, v179
    v_add_f32 v253, v253, v176
    v_add_f32 v253, v253, v177
    v_add_f32 v253, v253, v178
    v_add_f32 v253, v253, v179
    v_cvt_pk_bf16_f32 v176, v176, v177
    v_cvt_pk_bf16_f32 v177, v178, v179
    v_exp_f32 v180, v180
    v_exp_f32 v181, v181
    v_exp_f32 v182, v182
    v_exp_f32 v183, v183
    v_add_f32 v253, v253, v180
    v_add_f32 v253, v253, v181
    v_add_f32 v253, v253, v182
    v_add_f32 v253, v253, v183
    v_cvt_pk_bf16_f32 v178, v180, v181
    v_cvt_pk_bf16_f32 v179, v182, v183
    v_exp_f32 v184, v184
    v_exp_f32 v185, v185
    v_exp_f32 v186, v186
    v_exp_f32 v187, v187
    v_add_f32 v253, v253, v184
    v_add_f32 v253, v253, v185
    v_add_f32 v253, v253, v186
    v_add_f32 v253, v253, v187
    v_cvt_pk_bf16_f32 v180, v184, v185
    v_cvt_pk_bf16_f32 v181, v186, v187
    v_exp_f32 v188, v188
    v_exp_f32 v189, v189
    v_exp_f32 v190, v190
    v_exp_f32 v191, v191
    v_add_f32 v253, v253, v188
    v_add_f32 v253, v253, v189
    v_add_f32 v253, v253, v190
    v_add_f32 v253, v253, v191
    v_cvt_pk_bf16_f32 v182, v188, v189
    v_cvt_pk_bf16_f32 v183, v190, v191
    ds_read_b64_tr_b16 v[184:185], v246 offset:16896
    ds_read_b64_tr_b16 v[186:187], v246 offset:18976
    v_subrev_u32 v188, s41, v247
    ds_read_b32 v189, v188 offset:22532
    ds_read_b128 v[224:227], v188 offset:18432
    ds_read_b128 v[228:231], v188 offset:19456
    v_add_u32 v188, s42, v246
    s_waitcnt lgkmcnt(7)
    v_mfma_f32_32x32x16_bf16 a[0:15], v[168:171], v[160:163], a[0:15]
    ds_read_b64_tr_b16 v[232:233], v188 offset:16640
    ds_read_b64_tr_b16 v[234:235], v188 offset:18720
    ds_read_b64_tr_b16 v[236:237], v188 offset:16896
    ds_read_b64_tr_b16 v[238:239], v188 offset:18976
    v_mfma_f32_32x32x16_bf16 a[128:143], v[168:171], v[176:179], a[128:143]
    ds_read_b64_tr_b16 v[168:169], v246 offset:21056
    ds_read_b64_tr_b16 v[170:171], v246 offset:23136
    v_mov_b32 v136, v252
    s_waitcnt lgkmcnt(11)
    v_mfma_f32_32x32x16_bf16 a[0:15], v[172:175], v[164:167], a[0:15]
    v_mov_b32 v137, 0
    v_permlane32_swap_b32 v252, v136
    v_mfma_f32_32x32x16_bf16 a[128:143], v[172:175], v[180:183], a[128:143]
    ds_read_b64_tr_b16 v[172:173], v246 offset:17152
    ds_read_b64_tr_b16 v[174:175], v246 offset:19232
    s_waitcnt lgkmcnt(10)
    v_cmp_neq_f32 vcc, 0x3f800000, v189
    s_cbranch_vccz L_skip9_15
    v_mul_f32 v192, v192, v189
    v_mul_f32 v193, v193, v189
    v_mul_f32 v194, v194, v189
    v_mul_f32 v195, v195, v189
    v_mul_f32 v196, v196, v189
    v_mul_f32 v197, v197, v189
    v_mul_f32 v198, v198, v189
    v_mul_f32 v199, v199, v189
    v_mul_f32 v200, v200, v189
    v_mul_f32 v201, v201, v189
    v_mul_f32 v202, v202, v189
    v_mul_f32 v203, v203, v189
    v_mul_f32 v204, v204, v189
    v_mul_f32 v205, v205, v189
    v_mul_f32 v206, v206, v189
    v_mul_f32 v207, v207, v189
    v_mul_f32 v208, v208, v189
    v_mul_f32 v209, v209, v189
    v_mul_f32 v210, v210, v189
    v_mul_f32 v211, v211, v189
    v_mul_f32 v212, v212, v189
    v_mul_f32 v213, v213, v189
    v_mul_f32 v214, v214, v189
    v_mul_f32 v215, v215, v189
    v_mul_f32 v216, v216, v189
    v_mul_f32 v217, v217, v189
    v_mul_f32 v218, v218, v189
    v_mul_f32 v219, v219, v189
    v_mul_f32 v220, v220, v189
    v_mul_f32 v221, v221, v189
    v_mul_f32 v222, v222, v189
    v_mul_f32 v223, v223, v189
L_skip9_15:
    v_mfma_f32_32x32x16_bf16 a[16:31], v[184:187], v[160:163], a[16:31]
    v_add_f32 v252, v252, v136
    v_rcp_f32 v252, v252
    s_waitcnt lgkmcnt(6)
    v_mfma_f32_32x32x16_bf16 v[192:207], v[232:235], v[224:227], v[192:207]
    v_mov_b32 v136, v253
    v_mov_b32 v138, 0
    v_mfma_f32_32x32x16_bf16 a[144:159], v[184:187], v[176:179], a[144:159]
    ds_read_b64_tr_b16 v[184:185], v246 offset:21312
    ds_read_b64_tr_b16 v[186:187], v246 offset:23392
    v_permlane32_swap_b32 v253, v136
    s_waitcnt lgkmcnt(6)
    v_mfma_f32_32x32x16_bf16 v[208:223], v[236:239], v[224:227], v[208:223]
    ds_read_b64_tr_b16 v[232:233], v188 offset:20800
    ds_read_b64_tr_b16 v[234:235], v188 offset:22880
    ds_read_b64_tr_b16 v[236:237], v188 offset:21056
    ds_read_b64_tr_b16 v[238:239], v188 offset:23136
    v_add_f32 v253, v253, v136
    s_waitcnt lgkmcnt(8)
    v_mfma_f32_32x32x16_bf16 a[16:31], v[168:171], v[164:167], a[16:31]
    v_rcp_f32 v253, v253
    v_mfma_f32_32x32x16_bf16 a[144:159], v[168:171], v[180:183], a[144:159]
    ds_read_b64_tr_b16 v[168:169], v246 offset:17408
    ds_read_b64_tr_b16 v[170:171], v246 offset:19488
    v_accvgpr_read_b32 v128, a0
    v_accvgpr_read_b32 v129, a1
    v_accvgpr_read_b32 v130, a2
    s_waitcnt lgkmcnt(8)
    v_mfma_f32_32x32x16_bf16 a[32:47], v[172:175], v[160:163], a[32:47]
    v_accvgpr_read_b32 v131, a3
    v_accvgpr_read_b32 v132, a4
    v_accvgpr_read_b32 v133, a5
    v_accvgpr_read_b32 v134, a6
    v_accvgpr_read_b32 v135, a7
    v_mul_f32 v128, v128, v252
    v_mul_f32 v129, v129, v252
    s_waitcnt lgkmcnt(4)
    v_mfma_f32_32x32x16_bf16 v[192:207], v[232:235], v[228:231], v[192:207]
    v_mul_f32 v130, v130, v252
    v_mul_f32 v131, v131, v252
    v_mul_f32 v132, v132, v252
    v_mul_f32 v133, v133, v252
    v_mul_f32 v134, v134, v252
    v_mul_f32 v135, v135, v252
    v_cvt_pk_bf16_f32 v0, v128, v129
    v_mfma_f32_32x32x16_bf16 a[160:175], v[172:175], v[176:179], a[160:175]
    ds_read_b64_tr_b16 v[172:173], v246 offset:21568
    ds_read_b64_tr_b16 v[174:175], v246 offset:23648
    v_cvt_pk_bf16_f32 v1, v130, v131
    v_cvt_pk_bf16_f32 v2, v132, v133
    v_cvt_pk_bf16_f32 v3, v134, v135
    v_accvgpr_read_b32 v128, a8
    s_waitcnt lgkmcnt(4)
    v_mfma_f32_32x32x16_bf16 v[208:223], v[236:239], v[228:231], v[208:223]
    v_accvgpr_read_b32 v129, a9
    v_accvgpr_read_b32 v130, a10
    v_accvgpr_read_b32 v131, a11
    v_accvgpr_read_b32 v132, a12
    v_accvgpr_read_b32 v133, a13
    v_accvgpr_read_b32 v134, a14
    v_accvgpr_read_b32 v135, a15
    v_mfma_f32_32x32x16_bf16 a[32:47], v[184:187], v[164:167], a[32:47]
    v_mul_f32 v128, v128, v252
    v_mul_f32 v129, v129, v252
    v_mul_f32 v130, v130, v252
    v_mul_f32 v131, v131, v252
    v_mul_f32 v132, v132, v252
    v_mul_f32 v133, v133, v252
    v_mul_f32 v134, v134, v252
    v_mfma_f32_32x32x16_bf16 a[160:175], v[184:187], v[180:183], a[160:175]
    ds_read_b64_tr_b16 v[184:185], v246 offset:24960
    ds_read_b64_tr_b16 v[186:187], v246 offset:27040
    v_mul_f32 v135, v135, v252
    v_cvt_pk_bf16_f32 v4, v128, v129
    v_cvt_pk_bf16_f32 v5, v130, v131
    s_waitcnt lgkmcnt(4)
    v_mfma_f32_32x32x16_bf16 a[48:63], v[168:171], v[160:163], a[48:63]
    v_cvt_pk_bf16_f32 v6, v132, v133
    v_cvt_pk_bf16_f32 v7, v134, v135
    v_accvgpr_read_b32 v128, a128
    v_accvgpr_read_b32 v129, a129
    v_accvgpr_read_b32 v130, a130
    v_accvgpr_read_b32 v131, a131
    v_accvgpr_read_b32 v132, a132
    v_mfma_f32_32x32x16_bf16 a[176:191], v[168:171], v[176:179], a[176:191]
    ds_read_b64_tr_b16 v[168:169], v246 offset:29120
    ds_read_b64_tr_b16 v[170:171], v246 offset:31200
    v_accvgpr_read_b32 v133, a133
    v_accvgpr_read_b32 v134, a134
    v_accvgpr_read_b32 v135, a135
    v_mul_f32 v128, v128, v253
    s_waitcnt lgkmcnt(4)
    v_mfma_f32_32x32x16_bf16 a[48:63], v[172:175], v[164:167], a[48:63]
    v_mul_f32 v129, v129, v253
    v_mul_f32 v130, v130, v253
    v_mul_f32 v131, v131, v253
    v_mul_f32 v132, v132, v253
    v_mul_f32 v133, v133, v253
    v_mul_f32 v134, v134, v253
    v_mul_f32 v135, v135, v253
    v_mfma_f32_32x32x16_bf16 a[176:191], v[172:175], v[180:183], a[176:191]
    ds_read_b64_tr_b16 v[172:173], v246 offset:25216
    ds_read_b64_tr_b16 v[174:175], v246 offset:27296
    v_cvt_pk_bf16_f32 v64, v128, v129
    v_cvt_pk_bf16_f32 v65, v130, v131
    v_cvt_pk_bf16_f32 v66, v132, v133
    s_waitcnt lgkmcnt(4)
    v_mfma_f32_32x32x16_bf16 a[64:79], v[184:187], v[160:163], a[64:79]
    v_cvt_pk_bf16_f32 v67, v134, v135
    v_accvgpr_read_b32 v128, a136
    v_accvgpr_read_b32 v129, a137
    v_accvgpr_read_b32 v130, a138
    v_accvgpr_read_b32 v131, a139
    v_accvgpr_read_b32 v132, a140
    v_accvgpr_read_b32 v133, a141
    v_mfma_f32_32x32x16_bf16 a[192:207], v[184:187], v[176:179], a[192:207]
    ds_read_b64_tr_b16 v[184:185], v246 offset:29376
    ds_read_b64_tr_b16 v[186:187], v246 offset:31456
    v_accvgpr_read_b32 v134, a142
    v_accvgpr_read_b32 v135, a143
    v_mul_f32 v128, v128, v253
    v_mul_f32 v129, v129, v253
    s_waitcnt lgkmcnt(4)
    v_mfma_f32_32x32x16_bf16 a[64:79], v[168:171], v[164:167], a[64:79]
    v_mul_f32 v130, v130, v253
    v_mul_f32 v131, v131, v253
    v_mul_f32 v132, v132, v253
    v_mul_f32 v133, v133, v253
    v_mul_f32 v134, v134, v253
    v_mul_f32 v135, v135, v253
    v_cvt_pk_bf16_f32 v68, v128, v129
    v_mfma_f32_32x32x16_bf16 a[192:207], v[168:171], v[180:183], a[192:207]
    ds_read_b64_tr_b16 v[168:169], v246 offset:25472
    ds_read_b64_tr_b16 v[170:171], v246 offset:27552
    v_cvt_pk_bf16_f32 v69, v130, v131
    v_cvt_pk_bf16_f32 v70, v132, v133
    v_cvt_pk_bf16_f32 v71, v134, v135
    s_waitcnt lgkmcnt(4)
    v_mfma_f32_32x32x16_bf16 a[80:95], v[172:175], v[160:163], a[80:95]
    v_accvgpr_read_b32 v128, a16
    v_accvgpr_read_b32 v129, a17
    v_accvgpr_read_b32 v130, a18
    v_accvgpr_read_b32 v131, a19
    v_accvgpr_read_b32 v132, a20
    v_accvgpr_read_b32 v133, a21
    v_accvgpr_read_b32 v134, a22
    v_accvgpr_read_b32 v135, a23
    v_mfma_f32_32x32x16_bf16 a[208:223], v[172:175], v[176:179], a[208:223]
    ds_read_b64_tr_b16 v[172:173], v246 offset:29632
    ds_read_b64_tr_b16 v[174:175], v246 offset:31712
    v_mul_f32 v128, v128, v252
    v_mul_f32 v129, v129, v252
    v_mul_f32 v130, v130, v252
    s_waitcnt lgkmcnt(4)
    v_mfma_f32_32x32x16_bf16 a[80:95], v[184:187], v[164:167], a[80:95]
    v_mul_f32 v131, v131, v252
    v_mul_f32 v132, v132, v252
    v_mul_f32 v133, v133, v252
    v_mul_f32 v134, v134, v252
    v_mul_f32 v135, v135, v252
    v_cvt_pk_bf16_f32 v8, v128, v129
    v_cvt_pk_bf16_f32 v9, v130, v131
    v_cvt_pk_bf16_f32 v10, v132, v133
    v_mfma_f32_32x32x16_bf16 a[208:223], v[184:187], v[180:183], a[208:223]
    ds_read_b64_tr_b16 v[184:185], v246 offset:25728
    ds_read_b64_tr_b16 v[186:187], v246 offset:27808
    v_cvt_pk_bf16_f32 v11, v134, v135
    v_accvgpr_read_b32 v128, a24
    v_accvgpr_read_b32 v129, a25
    v_accvgpr_read_b32 v130, a26
    s_waitcnt lgkmcnt(4)
    v_mfma_f32_32x32x16_bf16 a[96:111], v[168:171], v[160:163], a[96:111]
    v_accvgpr_read_b32 v131, a27
    v_accvgpr_read_b32 v132, a28
    v_accvgpr_read_b32 v133, a29
    v_accvgpr_read_b32 v134, a30
    v_accvgpr_read_b32 v135, a31
    v_mul_f32 v128, v128, v252
    v_mul_f32 v129, v129, v252
    v_mfma_f32_32x32x16_bf16 a[224:239], v[168:171], v[176:179], a[224:239]
    ds_read_b64_tr_b16 v[168:169], v246 offset:29888
    ds_read_b64_tr_b16 v[170:171], v246 offset:31968
    v_mul_f32 v130, v130, v252
    v_mul_f32 v131, v131, v252
    v_mul_f32 v132, v132, v252
    v_mul_f32 v133, v133, v252
    s_waitcnt lgkmcnt(4)
    v_mfma_f32_32x32x16_bf16 a[96:111], v[172:175], v[164:167], a[96:111]
    v_mul_f32 v134, v134, v252
    v_mul_f32 v135, v135, v252
    v_cvt_pk_bf16_f32 v12, v128, v129
    v_cvt_pk_bf16_f32 v13, v130, v131
    v_cvt_pk_bf16_f32 v14, v132, v133
    v_cvt_pk_bf16_f32 v15, v134, v135
    v_accvgpr_read_b32 v128, a144
    v_accvgpr_read_b32 v129, a145
    v_mfma_f32_32x32x16_bf16 a[224:239], v[172:175], v[180:183], a[224:239]
    v_accvgpr_read_b32 v130, a146
    v_accvgpr_read_b32 v131, a147
    v_accvgpr_read_b32 v132, a148
    v_accvgpr_read_b32 v133, a149
    v_accvgpr_read_b32 v134, a150
    v_accvgpr_read_b32 v135, a151
    v_mul_f32 v128, v128, v253
    v_mul_f32 v129, v129, v253
    s_waitcnt lgkmcnt(2)
    v_mfma_f32_32x32x16_bf16 a[112:127], v[184:187], v[160:163], a[112:127]
    v_mul_f32 v130, v130, v253
    v_mul_f32 v131, v131, v253
    v_mul_f32 v132, v132, v253
    v_mul_f32 v133, v133, v253
    v_mul_f32 v134, v134, v253
    v_mul_f32 v135, v135, v253
    v_cvt_pk_bf16_f32 v72, v128, v129
    v_mfma_f32_32x32x16_bf16 a[240:255], v[184:187], v[176:179], a[240:255]
    v_cvt_pk_bf16_f32 v73, v130, v131
    v_cvt_pk_bf16_f32 v74, v132, v133
    v_cvt_pk_bf16_f32 v75, v134, v135
    v_accvgpr_read_b32 v128, a152
    v_accvgpr_read_b32 v129, a153
    v_accvgpr_read_b32 v130, a154
    v_accvgpr_read_b32 v131, a155
    v_accvgpr_read_b32 v132, a156
    s_waitcnt lgkmcnt(0)
    v_mfma_f32_32x32x16_bf16 a[112:127], v[168:171], v[164:167], a[112:127]
    v_accvgpr_read_b32 v133, a157
    v_accvgpr_read_b32 v134, a158
    v_accvgpr_read_b32 v135, a159
    v_mul_f32 v128, v128, v253
    v_mul_f32 v129, v129, v253
    v_mul_f32 v130, v130, v253
    v_mul_f32 v131, v131, v253
    v_mfma_f32_32x32x16_bf16 a[240:255], v[168:171], v[180:183], a[240:255]
    v_mul_f32 v132, v132, v253
    v_mul_f32 v133, v133, v253
    v_mul_f32 v134, v134, v253
    v_mul_f32 v135, v135, v253
    v_cvt_pk_bf16_f32 v76, v128, v129
    v_cvt_pk_bf16_f32 v77, v130, v131
    v_cvt_pk_bf16_f32 v78, v132, v133
    v_cvt_pk_bf16_f32 v79, v134, v135
    v_mov_b32 v240, v255
    s_nop 1
    v_permlane32_swap_b32 v255, v240
    v_add_f32 v255, v255, v240
    v_mov_b32 v240, v255
    s_nop 1
    v_permlane16_swap_b32 v255, v240
    v_add_f32 v255, v255, v240
    ds_write_b32 v248, v255 offset:20480
    v_subrev_u32 v245, s41, v247
    v_bfe_u32 v241, v245, 4, 2
    v_and_b32 v242, 1, v241
    v_lshrrev_b32 v243, 1, v241
    v_lshl_add_u32 v242, v242, 1, v243
    v_sub_u32 v242, v242, v241
    v_lshlrev_b32 v242, 3, v242
    v_add_u32 v246, v246, v242
    v_subrev_u32 v244, 66560, v246
    s_lshl_b32 s57, s28, 8
    v_add_u32 v247, s57, v244
    v_add_u32 v248, s57, v246
    s_lshl_b32 s39, s47, 9
    s_add_u32 s39, s56, s39
    s_mul_i32 s40, s28, 131072
    s_add_u32 s58, s39, s40
    s_add_u32 s39, s39, 3670016
    s_mul_i32 s40, s29, 65536
    s_add_u32 s50, s39, s40
    s_lshl_b32 s40, s30, 8
    s_add_u32 s50, s50, s40
    s_add_u32 s51, s39, s40
    buffer_load_dwordx2 v[236:237], off, s[96:99], s90 offset:8 sc1
    s_mov_b32 s32, 0x00003f80
    s_mov_b32 s33, 0x3f800000
    s_mul_i32 s35, s48, 516096
    s_mul_i32 s39, s49, 896
    s_add_u32 s35, s35, s39
    s_lshl_b32 s36, s47, 2
    s_add_u32 s36, s36, s28
    s_lshl_b32 s37, s36, 13
    s_add_u32 s37, s37, s56
    s_mul_i32 s42, s36, 7168
    s_add_u32 s42, s42, s35
    s_and_b32 s39, s36, 7
    s_mul_i32 s43, s39, 7168
    s_lshr_b32 s39, s36, 3
    s_lshl_b32 s39, s39, 7
    s_add_u32 s43, s43, s39
    s_add_u32 s43, s43, s35
    s_add_u32 s43, s43, 458752
    s_add_u32 s46, s37, 3670016
    s_cmp_lt_u32 s36, 56
    s_cselect_b32 s43, s43, 0x7fff0000
    s_cselect_b32 s46, s46, 0x7fff0000
    s_mov_b32 s86, 0
    s_mov_b32 s87, 0x7fff0000
    s_waitcnt vmcnt(0)
    v_readfirstlane_b32 s4, v236
    v_readfirstlane_b32 s5, v237
    s_nop 0
    s_lshr_b64 s[4:5], s[4:5], s59
    s_and_b32 s12, s4, 31
    v_mov_b32 v236, 161792
    v_mov_b32 v237, 0
    ds_write_b32 v236, v237 offset:256
    s_waitcnt lgkmcnt(0)
    s_barrier
    s_add_u32 m0, s34, 107776
    s_add_u32 s40, s38, 57600
    buffer_load_dwordx4 v249, s[52:55], s40 offen lds
    s_add_u32 m0, s34, 108816
    s_add_u32 s40, s38, 61184
    buffer_load_dwordx4 v249, s[52:55], s40 offen lds
    s_add_u32 m0, s34, 109856
    s_add_u32 s40, s38, 64768
    buffer_load_dwordx4 v249, s[52:55], s40 offen lds
    s_add_u32 m0, s34, 110896
    s_add_u32 s40, s38, 68352
    buffer_load_dwordx4 v249, s[52:55], s40 offen lds
    ds_read_b32 v240, v245 offset:20480
    ds_read_b32 v241, v245 offset:21504
    s_waitcnt lgkmcnt(0)
    v_add_f32 v240, v240, v241
    v_rcp_f32 v240, v240
    s_lshl_b32 s39, s28, 12
    v_add_u32 v241, s39, v245
    v_mul_f32 v192, v192, v240
    v_mul_f32 v193, v193, v240
    v_mul_f32 v194, v194, v240
    v_mul_f32 v195, v195, v240
    v_mul_f32 v196, v196, v240
    v_mul_f32 v197, v197, v240
    v_mul_f32 v198, v198, v240
    v_mul_f32 v199, v199, v240
    v_mul_f32 v200, v200, v240
    v_mul_f32 v201, v201, v240
    v_mul_f32 v202, v202, v240
    v_mul_f32 v203, v203, v240
    v_mul_f32 v204, v204, v240
    v_mul_f32 v205, v205, v240
    v_mul_f32 v206, v206, v240
    v_mul_f32 v207, v207, v240
    v_cvt_pk_bf16_f32 v128, v192, v193
    v_cvt_pk_bf16_f32 v129, v194, v195
    v_cvt_pk_bf16_f32 v130, v196, v197
    v_cvt_pk_bf16_f32 v131, v198, v199
    ds_write_b128 v241, v[128:131]
    v_cvt_pk_bf16_f32 v132, v200, v201
    v_cvt_pk_bf16_f32 v133, v202, v203
    v_cvt_pk_bf16_f32 v134, v204, v205
    v_cvt_pk_bf16_f32 v135, v206, v207
    ds_write_b128 v241, v[132:135] offset:1024
    v_mul_f32 v208, v208, v240
    v_mul_f32 v209, v209, v240
    v_mul_f32 v210, v210, v240
    v_mul_f32 v211, v211, v240
    v_mul_f32 v212, v212, v240
    v_mul_f32 v213, v213, v240
    v_mul_f32 v214, v214, v240
    v_mul_f32 v215, v215, v240
    v_mul_f32 v216, v216, v240
    v_mul_f32 v217, v217, v240
    v_mul_f32 v218, v218, v240
    v_mul_f32 v219, v219, v240
    v_mul_f32 v220, v220, v240
    v_mul_f32 v221, v221, v240
    v_mul_f32 v222, v222, v240
    v_mul_f32 v223, v223, v240
    v_cvt_pk_bf16_f32 v136, v208, v209
    v_cvt_pk_bf16_f32 v137, v210, v211
    v_cvt_pk_bf16_f32 v138, v212, v213
    v_cvt_pk_bf16_f32 v139, v214, v215
    ds_write_b128 v241, v[136:139] offset:2048
    v_cvt_pk_bf16_f32 v140, v216, v217
    v_cvt_pk_bf16_f32 v141, v218, v219
    v_cvt_pk_bf16_f32 v142, v220, v221
    v_cvt_pk_bf16_f32 v143, v222, v223
    ds_write_b128 v241, v[140:143] offset:3072
    v_lshrrev_b32 v250, 9, v245
    v_bfe_u32 v251, v245, 6, 3
    v_bfe_u32 v242, v245, 4, 2
    v_lshlrev_b32 v240, 13, v251
    v_lshl_add_u32 v240, v250, 6, v240
    v_lshl_add_u32 v240, v242, 4, v240
    v_mul_u32_u24 v241, 1792, v242
    v_lshl_add_u32 v241, v251, 4, v241
    v_lshl_add_u32 v241, v250, 3, v241
    v_lshrrev_b32 v242, 2, v245
    v_add_u32 v250, 161792, v242
    ds_read_b32 v243, v250
    s_waitcnt lgkmcnt(0)
    v_readlane_b32 s13, v243, s36
    s_lshl_b32 s41, s36, 2
    s_add_u32 s41, s41, s91
    ds_read_b64_tr_b16 v[224:225], v244
    ds_read_b64_tr_b16 v[226:227], v244 offset:2080
    ds_read_b64_tr_b16 v[228:229], v244 offset:256
    ds_read_b64_tr_b16 v[230:231], v244 offset:2336
    ds_read_b64_tr_b16 v[232:233], v244 offset:4160
    ds_read_b64_tr_b16 v[234:235], v244 offset:6240
    s_waitcnt lgkmcnt(4)
    v_mfma_f32_32x32x16_bf16 v[128:143], v[224:227], v[0:3], 0
    ds_read_b64_tr_b16 v[236:237], v244 offset:4416
    ds_read_b64_tr_b16 v[238:239], v244 offset:6496
    v_accvgpr_read_b32 v200, a32
    v_accvgpr_read_b32 v201, a33
    v_accvgpr_read_b32 v202, a34
    v_accvgpr_read_b32 v203, a35
    v_accvgpr_read_b32 v204, a36
    v_accvgpr_read_b32 v205, a37
    v_mfma_f32_32x32x16_bf16 v[144:159], v[224:227], v[64:67], 0
    s_add_u32 s40, s38, 512
    buffer_load_dwordx4 a[128:131], v249, s[52:55], s40 offen
    v_accvgpr_read_b32 v206, a38
    v_accvgpr_read_b32 v207, a39
    v_mul_f32 v200, v200, v252
    v_mul_f32 v201, v201, v252
    v_mul_f32 v202, v202, v252
    v_mul_f32 v203, v203, v252
    v_mul_f32 v204, v204, v252
    v_mul_f32 v205, v205, v252
    v_mul_f32 v206, v206, v252
    v_mul_f32 v207, v207, v252
    v_cvt_pk_bf16_f32 v16, v200, v201
    v_cvt_pk_bf16_f32 v17, v202, v203
    s_waitcnt lgkmcnt(4)
    v_mfma_f32_32x32x16_bf16 v[160:175], v[228:231], v[0:3], 0
    ds_read_b64_tr_b16 v[224:225], v244 offset:8320
    ds_read_b64_tr_b16 v[226:227], v244 offset:10400
    s_add_u32 s40, s38, 4096
    buffer_load_dwordx4 a[132:135], v249, s[52:55], s40 offen
    v_cvt_pk_bf16_f32 v18, v204, v205
    v_cvt_pk_bf16_f32 v19, v206, v207
    v_accvgpr_read_b32 v200, a40
    v_accvgpr_read_b32 v201, a41
    v_accvgpr_read_b32 v202, a42
    v_accvgpr_read_b32 v203, a43
    v_accvgpr_read_b32 v204, a44
    v_mfma_f32_32x32x16_bf16 v[176:191], v[228:231], v[64:67], 0
    s_add_u32 s40, s38, 7680
    buffer_load_dwordx4 a[136:139], v249, s[52:55], s40 offen
    v_accvgpr_read_b32 v205, a45
    v_accvgpr_read_b32 v206, a46
    v_accvgpr_read_b32 v207, a47
    v_mul_f32 v200, v200, v252
    v_mul_f32 v201, v201, v252
    v_mul_f32 v202, v202, v252
    v_mul_f32 v203, v203, v252
    v_mul_f32 v204, v204, v252
    v_mul_f32 v205, v205, v252
    v_mul_f32 v206, v206, v252
    v_mul_f32 v207, v207, v252
    v_cvt_pk_bf16_f32 v20, v200, v201
    s_waitcnt lgkmcnt(4)
    v_mfma_f32_32x32x16_bf16 v[128:143], v[232:235], v[4:7], v[128:143]
    ds_read_b64_tr_b16 v[228:229], v244 offset:8576
    ds_read_b64_tr_b16 v[230:231], v244 offset:10656
    s_add_u32 s40, s38, 11264
    buffer_load_dwordx4 a[140:143], v249, s[52:55], s40 offen
    v_cvt_pk_bf16_f32 v21, v202, v203
    v_cvt_pk_bf16_f32 v22, v204, v205
    v_cvt_pk_bf16_f32 v23, v206, v207
    v_accvgpr_read_b32 v200, a160
    v_accvgpr_read_b32 v201, a161
    v_accvgpr_read_b32 v202, a162
    v_mfma_f32_32x32x16_bf16 v[144:159], v[232:235], v[68:71], v[144:159]
    s_add_u32 s40, s38, 57856
    buffer_load_dwordx4 a[144:147], v249, s[52:55], s40 offen
    v_accvgpr_read_b32 v203, a163
    v_accvgpr_read_b32 v204, a164
    v_accvgpr_read_b32 v205, a165
    v_accvgpr_read_b32 v206, a166
    v_accvgpr_read_b32 v207, a167
    v_mul_f32 v200, v200, v253
    v_mul_f32 v201, v201, v253
    v_mul_f32 v202, v202, v253
    v_mul_f32 v203, v203, v253
    v_mul_f32 v204, v204, v253
    v_mul_f32 v205, v205, v253
    v_mul_f32 v206, v206, v253
    s_waitcnt lgkmcnt(4)
    v_mfma_f32_32x32x16_bf16 v[160:175], v[236:239], v[4:7], v[160:175]
    ds_read_b64_tr_b16 v[232:233], v244 offset:12480
    ds_read_b64_tr_b16 v[234:235], v244 offset:14560
    s_add_u32 s40, s38, 61440
    buffer_load_dwordx4 a[148:151], v249, s[52:55], s40 offen
    v_mul_f32 v207, v207, v253
    v_cvt_pk_bf16_f32 v80, v200, v201
    v_cvt_pk_bf16_f32 v81, v202, v203
    v_cvt_pk_bf16_f32 v82, v204, v205
    v_cvt_pk_bf16_f32 v83, v206, v207
    v_accvgpr_read_b32 v200, a168
    v_accvgpr_read_b32 v201, a169
    v_mfma_f32_32x32x16_bf16 v[176:191], v[236:239], v[68:71], v[176:191]
    s_add_u32 s40, s38, 65024
    buffer_load_dwordx4 a[152:155], v249, s[52:55], s40 offen
    v_accvgpr_read_b32 v202, a170
    v_accvgpr_read_b32 v203, a171
    v_accvgpr_read_b32 v204, a172
    v_accvgpr_read_b32 v205, a173
    v_accvgpr_read_b32 v206, a174
    v_accvgpr_read_b32 v207, a175
    v_mul_f32 v200, v200, v253
    v_mul_f32 v201, v201, v253
    v_mul_f32 v202, v202, v253
    v_mul_f32 v203, v203, v253
    v_mul_f32 v204, v204, v253
    v_mul_f32 v205, v205, v253
    s_waitcnt lgkmcnt(4)
    v_mfma_f32_32x32x16_bf16 v[128:143], v[224:227], v[8:11], v[128:143]
    ds_read_b64_tr_b16 v[236:237], v244 offset:12736
    ds_read_b64_tr_b16 v[238:239], v244 offset:14816
    s_add_u32 s40, s38, 68608
    buffer_load_dwordx4 a[156:159], v249, s[52:55], s40 offen
    v_mul_f32 v206, v206, v253
    v_mul_f32 v207, v207, v253
    v_cvt_pk_bf16_f32 v84, v200, v201
    v_cvt_pk_bf16_f32 v85, v202, v203
    v_cvt_pk_bf16_f32 v86, v204, v205
    v_cvt_pk_bf16_f32 v87, v206, v207
    v_mfma_f32_32x32x16_bf16 v[144:159], v[224:227], v[72:75], v[144:159]
    s_add_u32 s40, s38, 115200
    buffer_load_dwordx4 a[160:163], v249, s[52:55], s40 offen
    v_accvgpr_read_b32 v200, a48
    v_accvgpr_read_b32 v201, a49
    v_accvgpr_read_b32 v202, a50
    v_accvgpr_read_b32 v203, a51
    v_accvgpr_read_b32 v204, a52
    v_accvgpr_read_b32 v205, a53
    v_accvgpr_read_b32 v206, a54
    v_accvgpr_read_b32 v207, a55
    v_mul_f32 v200, v200, v252
    s_waitcnt lgkmcnt(4)
    v_mfma_f32_32x32x16_bf16 v[160:175], v[228:231], v[8:11], v[160:175]
    ds_read_b64_tr_b16 v[224:225], v244 offset:16640
    ds_read_b64_tr_b16 v[226:227], v244 offset:18720
    s_add_u32 s40, s38, 118784
    buffer_load_dwordx4 a[164:167], v249, s[52:55], s40 offen
    v_mul_f32 v201, v201, v252
    v_mul_f32 v202, v202, v252
    v_mul_f32 v203, v203, v252
    v_mfma_f32_32x32x16_bf16 v[176:191], v[228:231], v[72:75], v[176:191]
    s_add_u32 s40, s38, 122368
    buffer_load_dwordx4 a[168:171], v249, s[52:55], s40 offen
    v_mul_f32 v204, v204, v252
    v_mul_f32 v205, v205, v252
    v_mul_f32 v206, v206, v252
    v_mul_f32 v207, v207, v252
    v_cvt_pk_bf16_f32 v24, v200, v201
    v_cvt_pk_bf16_f32 v25, v202, v203
    v_cvt_pk_bf16_f32 v26, v204, v205
    v_cvt_pk_bf16_f32 v27, v206, v207
    v_accvgpr_read_b32 v200, a56
    s_waitcnt lgkmcnt(4)
    v_mfma_f32_32x32x16_bf16 v[128:143], v[232:235], v[12:15], v[128:143]
    ds_read_b64_tr_b16 v[228:229], v244 offset:16896
    ds_read_b64_tr_b16 v[230:231], v244 offset:18976
    s_add_u32 s40, s38, 125952
    buffer_load_dwordx4 a[172:175], v249, s[52:55], s40 offen
    v_accvgpr_read_b32 v201, a57
    v_accvgpr_read_b32 v202, a58
    v_accvgpr_read_b32 v203, a59
    v_mfma_f32_32x32x16_bf16 v[144:159], v[232:235], v[76:79], v[144:159]
    v_accvgpr_read_b32 v204, a60
    v_accvgpr_read_b32 v205, a61
    v_accvgpr_read_b32 v206, a62
    v_accvgpr_read_b32 v207, a63
    v_mul_f32 v200, v200, v252
    v_mul_f32 v201, v201, v252
    v_mul_f32 v202, v202, v252
    v_mul_f32 v203, v203, v252
    v_mul_f32 v204, v204, v252
    v_mul_f32 v205, v205, v252
    v_mul_f32 v206, v206, v252
    v_mul_f32 v207, v207, v252
    v_cvt_pk_bf16_f32 v28, v200, v201
    v_cvt_pk_bf16_f32 v29, v202, v203
    s_waitcnt lgkmcnt(4)
    v_mfma_f32_32x32x16_bf16 v[160:175], v[236:239], v[12:15], v[160:175]
    ds_read_b64_tr_b16 v[232:233], v244 offset:20800
    ds_read_b64_tr_b16 v[234:235], v244 offset:22880
    v_cvt_pk_bf16_f32 v30, v204, v205
    v_cvt_pk_bf16_f32 v31, v206, v207
    v_accvgpr_read_b32 v200, a176
    v_accvgpr_read_b32 v201, a177
    v_accvgpr_read_b32 v202, a178
    v_accvgpr_read_b32 v203, a179
    v_accvgpr_read_b32 v204, a180
    v_mfma_f32_32x32x16_bf16 v[176:191], v[236:239], v[76:79], v[176:191]
    v_accvgpr_read_b32 v205, a181
    v_accvgpr_read_b32 v206, a182
    v_accvgpr_read_b32 v207, a183
    v_mul_f32 v200, v200, v253
    v_mul_f32 v201, v201, v253
    v_mul_f32 v202, v202, v253
    v_mul_f32 v203, v203, v253
    v_mul_f32 v204, v204, v253
    v_mul_f32 v205, v205, v253
    v_mul_f32 v206, v206, v253
    v_mul_f32 v207, v207, v253
    v_cvt_pk_bf16_f32 v88, v200, v201
    v_cvt_pk_bf16_f32 v89, v202, v203
    v_cvt_pk_bf16_f32 v90, v204, v205
    s_waitcnt lgkmcnt(4)
    v_mfma_f32_32x32x16_bf16 v[128:143], v[224:227], v[16:19], v[128:143]
    ds_read_b64_tr_b16 v[236:237], v244 offset:21056
    ds_read_b64_tr_b16 v[238:239], v244 offset:23136
    v_cvt_pk_bf16_f32 v91, v206, v207
    v_accvgpr_read_b32 v200, a184
    v_accvgpr_read_b32 v201, a185
    v_accvgpr_read_b32 v202, a186
    v_accvgpr_read_b32 v203, a187
    v_accvgpr_read_b32 v204, a188
    v_accvgpr_read_b32 v205, a189
    v_mfma_f32_32x32x16_bf16 v[144:159], v[224:227], v[80:83], v[144:159]
    v_accvgpr_read_b32 v206, a190
    v_accvgpr_read_b32 v207, a191
    v_mul_f32 v200, v200, v253
    v_mul_f32 v201, v201, v253
    v_mul_f32 v202, v202, v253
    v_mul_f32 v203, v203, v253
    v_mul_f32 v204, v204, v253
    v_mul_f32 v205, v205, v253
    v_mul_f32 v206, v206, v253
    v_mul_f32 v207, v207, v253
    v_cvt_pk_bf16_f32 v92, v200, v201
    v_cvt_pk_bf16_f32 v93, v202, v203
    v_cvt_pk_bf16_f32 v94, v204, v205
    v_cvt_pk_bf16_f32 v95, v206, v207
    s_waitcnt lgkmcnt(4)
    v_mfma_f32_32x32x16_bf16 v[160:175], v[228:231], v[16:19], v[160:175]
    ds_read_b64_tr_b16 v[224:225], v244 offset:24960
    ds_read_b64_tr_b16 v[226:227], v244 offset:27040
    s_add_u32 s40, s38, 172544
    buffer_load_dwordx4 a[176:179], v249, s[52:55], s40 offen
    v_accvgpr_read_b32 v200, a64
    v_accvgpr_read_b32 v201, a65
    v_mfma_f32_32x32x16_bf16 v[176:191], v[228:231], v[80:83], v[176:191]
    s_add_u32 s40, s38, 176128
    buffer_load_dwordx4 a[180:183], v249, s[52:55], s40 offen
    v_accvgpr_read_b32 v202, a66
    v_accvgpr_read_b32 v203, a67
    v_accvgpr_read_b32 v204, a68
    v_accvgpr_read_b32 v205, a69
    v_accvgpr_read_b32 v206, a70
    v_accvgpr_read_b32 v207, a71
    v_mul_f32 v200, v200, v252
    v_mul_f32 v201, v201, v252
    v_mul_f32 v202, v202, v252
    s_waitcnt lgkmcnt(4)
    v_mfma_f32_32x32x16_bf16 v[128:143], v[232:235], v[20:23], v[128:143]
    ds_read_b64_tr_b16 v[228:229], v244 offset:25216
    ds_read_b64_tr_b16 v[230:231], v244 offset:27296
    s_add_u32 s40, s38, 179712
    buffer_load_dwordx4 a[184:187], v249, s[52:55], s40 offen
    v_mul_f32 v203, v203, v252
    v_mul_f32 v204, v204, v252
    v_mfma_f32_32x32x16_bf16 v[144:159], v[232:235], v[84:87], v[144:159]
    s_add_u32 s40, s38, 183296
    buffer_load_dwordx4 a[188:191], v249, s[52:55], s40 offen
    v_mul_f32 v205, v205, v252
    v_mul_f32 v206, v206, v252
    v_mul_f32 v207, v207, v252
    v_cvt_pk_bf16_f32 v32, v200, v201
    v_cvt_pk_bf16_f32 v33, v202, v203
    v_cvt_pk_bf16_f32 v34, v204, v205
    v_cvt_pk_bf16_f32 v35, v206, v207
    v_accvgpr_read_b32 v200, a72
    v_accvgpr_read_b32 v201, a73
    s_waitcnt lgkmcnt(4)
    v_mfma_f32_32x32x16_bf16 v[160:175], v[236:239], v[20:23], v[160:175]
    ds_read_b64_tr_b16 v[232:233], v244 offset:29120
    ds_read_b64_tr_b16 v[234:235], v244 offset:31200
    v_accvgpr_read_b32 v202, a74
    v_accvgpr_read_b32 v203, a75
    v_accvgpr_read_b32 v204, a76
    v_accvgpr_read_b32 v205, a77
    v_accvgpr_read_b32 v206, a78
    v_accvgpr_read_b32 v207, a79
    v_mfma_f32_32x32x16_bf16 v[176:191], v[236:239], v[84:87], v[176:191]
    v_mul_f32 v200, v200, v252
    v_mul_f32 v201, v201, v252
    v_mul_f32 v202, v202, v252
    v_mul_f32 v203, v203, v252
    v_mul_f32 v204, v204, v252
    v_mul_f32 v205, v205, v252
    v_mul_f32 v206, v206, v252
    v_mul_f32 v207, v207, v252
    v_cvt_pk_bf16_f32 v36, v200, v201
    v_cvt_pk_bf16_f32 v37, v202, v203
    v_cvt_pk_bf16_f32 v38, v204, v205
    v_cvt_pk_bf16_f32 v39, v206, v207
    v_accvgpr_read_b32 v200, a192
    s_waitcnt lgkmcnt(4)
    v_mfma_f32_32x32x16_bf16 v[128:143], v[224:227], v[24:27], v[128:143]
    ds_read_b64_tr_b16 v[236:237], v244 offset:29376
    ds_read_b64_tr_b16 v[238:239], v244 offset:31456
    v_accvgpr_read_b32 v201, a193
    v_accvgpr_read_b32 v202, a194
    v_accvgpr_read_b32 v203, a195
    v_accvgpr_read_b32 v204, a196
    v_accvgpr_read_b32 v205, a197
    v_accvgpr_read_b32 v206, a198
    v_accvgpr_read_b32 v207, a199
    v_mfma_f32_32x32x16_bf16 v[144:159], v[224:227], v[88:91], v[144:159]
    v_mul_f32 v200, v200, v253
    v_mul_f32 v201, v201, v253
    v_mul_f32 v202, v202, v253
    v_mul_f32 v203, v203, v253
    v_mul_f32 v204, v204, v253
    v_mul_f32 v205, v205, v253
    v_mul_f32 v206, v206, v253
    v_mul_f32 v207, v207, v253
    v_cvt_pk_bf16_f32 v96, v200, v201
    v_cvt_pk_bf16_f32 v97, v202, v203
    v_cvt_pk_bf16_f32 v98, v204, v205
    v_cvt_pk_bf16_f32 v99, v206, v207
    v_accvgpr_read_b32 v200, a200
    s_waitcnt lgkmcnt(4)
    v_mfma_f32_32x32x16_bf16 v[160:175], v[228:231], v[24:27], v[160:175]
    ds_read_b64_tr_b16 v[224:225], v244 offset:33280
    ds_read_b64_tr_b16 v[226:227], v244 offset:35360
    v_accvgpr_read_b32 v201, a201
    v_accvgpr_read_b32 v202, a202
    v_accvgpr_read_b32 v203, a203
    v_accvgpr_read_b32 v204, a204
    v_accvgpr_read_b32 v205, a205
    v_accvgpr_read_b32 v206, a206
    v_mfma_f32_32x32x16_bf16 v[176:191], v[228:231], v[88:91], v[176:191]
    v_accvgpr_read_b32 v207, a207
    v_mul_f32 v200, v200, v253
    v_mul_f32 v201, v201, v253
    v_mul_f32 v202, v202, v253
    v_mul_f32 v203, v203, v253
    v_mul_f32 v204, v204, v253
    v_mul_f32 v205, v205, v253
    v_mul_f32 v206, v206, v253
    v_mul_f32 v207, v207, v253
    v_cvt_pk_bf16_f32 v100, v200, v201
    v_cvt_pk_bf16_f32 v101, v202, v203
    v_cvt_pk_bf16_f32 v102, v204, v205
    v_cvt_pk_bf16_f32 v103, v206, v207
    s_waitcnt lgkmcnt(4)
    v_mfma_f32_32x32x16_bf16 v[128:143], v[232:235], v[28:31], v[128:143]
    ds_read_b64_tr_b16 v[228:229], v244 offset:33536
    ds_read_b64_tr_b16 v[230:231], v244 offset:35616
    s_add_u32 s40, s38, 768
    s_mov_b32 exec_hi, 0
    buffer_load_dwordx4 a[192:195], v249, s[52:55], s40 offen
    s_mov_b32 exec_hi, -1
    v_accvgpr_read_b32 v200, a80
    v_accvgpr_read_b32 v201, a81
    v_accvgpr_read_b32 v202, a82
    v_mfma_f32_32x32x16_bf16 v[144:159], v[232:235], v[92:95], v[144:159]
    s_add_u32 s40, s38, 4352
    s_mov_b32 exec_hi, 0
    buffer_load_dwordx4 a[196:199], v249, s[52:55], s40 offen
    s_mov_b32 exec_hi, -1
    v_accvgpr_read_b32 v203, a83
    v_accvgpr_read_b32 v204, a84
    v_accvgpr_read_b32 v205, a85
    v_accvgpr_read_b32 v206, a86
    v_accvgpr_read_b32 v207, a87
    v_mul_f32 v200, v200, v252
    v_mul_f32 v201, v201, v252
    v_mul_f32 v202, v202, v252
    v_mul_f32 v203, v203, v252
    v_mul_f32 v204, v204, v252
    s_waitcnt lgkmcnt(4)
    v_mfma_f32_32x32x16_bf16 v[160:175], v[236:239], v[28:31], v[160:175]
    ds_read_b64_tr_b16 v[232:233], v244 offset:37440
    ds_read_b64_tr_b16 v[234:235], v244 offset:39520
    s_add_u32 s40, s38, 7936
    s_mov_b32 exec_hi, 0
    buffer_load_dwordx4 a[200:203], v249, s[52:55], s40 offen
    s_mov_b32 exec_hi, -1
    v_mul_f32 v205, v205, v252
    v_mul_f32 v206, v206, v252
    v_mfma_f32_32x32x16_bf16 v[176:191], v[236:239], v[92:95], v[176:191]
    s_add_u32 s40, s38, 11520
    s_mov_b32 exec_hi, 0
    buffer_load_dwordx4 a[204:207], v249, s[52:55], s40 offen
    s_mov_b32 exec_hi, -1
    v_mul_f32 v207, v207, v252
    v_cvt_pk_bf16_f32 v40, v200, v201
    v_cvt_pk_bf16_f32 v41, v202, v203
    v_cvt_pk_bf16_f32 v42, v204, v205
    v_cvt_pk_bf16_f32 v43, v206, v207
    v_accvgpr_read_b32 v200, a88
    v_accvgpr_read_b32 v201, a89
    v_accvgpr_read_b32 v202, a90
    v_accvgpr_read_b32 v203, a91
    v_accvgpr_read_b32 v204, a92
    v_accvgpr_read_b32 v205, a93
    s_waitcnt lgkmcnt(4)
    v_mfma_f32_32x32x16_bf16 v[128:143], v[224:227], v[32:35], v[128:143]
    ds_read_b64_tr_b16 v[236:237], v244 offset:37696
    ds_read_b64_tr_b16 v[238:239], v244 offset:39776
    v_accvgpr_read_b32 v206, a94
    v_accvgpr_read_b32 v207, a95
    v_mul_f32 v200, v200, v252
    v_mul_f32 v201, v201, v252
    v_mul_f32 v202, v202, v252
    v_mul_f32 v203, v203, v252
    v_mul_f32 v204, v204, v252
    v_mul_f32 v205, v205, v252
    v_mfma_f32_32x32x16_bf16 v[144:159], v[224:227], v[96:99], v[144:159]
    v_mul_f32 v206, v206, v252
    v_mul_f32 v207, v207, v252
    v_cvt_pk_bf16_f32 v44, v200, v201
    v_cvt_pk_bf16_f32 v45, v202, v203
    v_cvt_pk_bf16_f32 v46, v204, v205
    v_cvt_pk_bf16_f32 v47, v206, v207
    v_accvgpr_read_b32 v200, a208
    v_accvgpr_read_b32 v201, a209
    v_accvgpr_read_b32 v202, a210
    v_accvgpr_read_b32 v203, a211
    v_accvgpr_read_b32 v204, a212
    v_accvgpr_read_b32 v205, a213
    v_accvgpr_read_b32 v206, a214
    v_accvgpr_read_b32 v207, a215
    v_mul_f32 v200, v200, v253
    s_waitcnt lgkmcnt(4)
    v_mfma_f32_32x32x16_bf16 v[160:175], v[228:231], v[32:35], v[160:175]
    ds_read_b64_tr_b16 v[224:225], v244 offset:41600
    ds_read_b64_tr_b16 v[226:227], v244 offset:43680
    v_mul_f32 v201, v201, v253
    v_mul_f32 v202, v202, v253
    v_mul_f32 v203, v203, v253
    v_mul_f32 v204, v204, v253
    v_mul_f32 v205, v205, v253
    v_mul_f32 v206, v206, v253
    v_mul_f32 v207, v207, v253
    v_cvt_pk_bf16_f32 v104, v200, v201
    v_mfma_f32_32x32x16_bf16 v[176:191], v[228:231], v[96:99], v[176:191]
    v_cvt_pk_bf16_f32 v105, v202, v203
    v_cvt_pk_bf16_f32 v106, v204, v205
    v_cvt_pk_bf16_f32 v107, v206, v207
    v_accvgpr_read_b32 v200, a216
    v_accvgpr_read_b32 v201, a217
    v_accvgpr_read_b32 v202, a218
    v_accvgpr_read_b32 v203, a219
    v_accvgpr_read_b32 v204, a220
    v_accvgpr_read_b32 v205, a221
    v_accvgpr_read_b32 v206, a222
    v_accvgpr_read_b32 v207, a223
    v_mul_f32 v200, v200, v253
    v_mul_f32 v201, v201, v253
    v_mul_f32 v202, v202, v253
    v_mul_f32 v203, v203, v253
    s_waitcnt lgkmcnt(4)
    v_mfma_f32_32x32x16_bf16 v[128:143], v[232:235], v[36:39], v[128:143]
    ds_read_b64_tr_b16 v[228:229], v244 offset:41856
    ds_read_b64_tr_b16 v[230:231], v244 offset:43936
    v_mul_f32 v204, v204, v253
    v_mul_f32 v205, v205, v253
    v_mul_f32 v206, v206, v253
    v_mul_f32 v207, v207, v253
    v_cvt_pk_bf16_f32 v108, v200, v201
    v_cvt_pk_bf16_f32 v109, v202, v203
    v_cvt_pk_bf16_f32 v110, v204, v205
    v_cvt_pk_bf16_f32 v111, v206, v207
    v_mfma_f32_32x32x16_bf16 v[144:159], v[232:235], v[100:103], v[144:159]
    s_add_u32 s40, s38, 58112
    s_mov_b32 exec_hi, 0
    buffer_load_dwordx4 a[208:211], v249, s[52:55], s40 offen
    s_mov_b32 exec_hi, -1
    v_accvgpr_read_b32 v200, a96
    v_accvgpr_read_b32 v201, a97
    v_accvgpr_read_b32 v202, a98
    v_accvgpr_read_b32 v203, a99
    v_accvgpr_read_b32 v204, a100
    v_accvgpr_read_b32 v205, a101
    v_accvgpr_read_b32 v206, a102
    v_accvgpr_read_b32 v207, a103
    v_mul_f32 v200, v200, v252
    s_waitcnt lgkmcnt(4)
    v_mfma_f32_32x32x16_bf16 v[160:175], v[236:239], v[36:39], v[160:175]
    ds_read_b64_tr_b16 v[232:233], v244 offset:45760
    ds_read_b64_tr_b16 v[234:235], v244 offset:47840
    s_add_u32 s40, s38, 61696
    s_mov_b32 exec_hi, 0
    buffer_load_dwordx4 a[212:215], v249, s[52:55], s40 offen
    s_mov_b32 exec_hi, -1
    v_mul_f32 v201, v201, v252
    v_mul_f32 v202, v202, v252
    v_mul_f32 v203, v203, v252
    v_mfma_f32_32x32x16_bf16 v[176:191], v[236:239], v[100:103], v[176:191]
    s_add_u32 s40, s38, 65280
    s_mov_b32 exec_hi, 0
    buffer_load_dwordx4 a[216:219], v249, s[52:55], s40 offen
    s_mov_b32 exec_hi, -1
    v_mul_f32 v204, v204, v252
    v_mul_f32 v205, v205, v252
    v_mul_f32 v206, v206, v252
    v_mul_f32 v207, v207, v252
    v_cvt_pk_bf16_f32 v48, v200, v201
    v_cvt_pk_bf16_f32 v49, v202, v203
    v_cvt_pk_bf16_f32 v50, v204, v205
    v_cvt_pk_bf16_f32 v51, v206, v207
    v_accvgpr_read_b32 v200, a104
    s_waitcnt lgkmcnt(4)
    v_mfma_f32_32x32x16_bf16 v[128:143], v[224:227], v[40:43], v[128:143]
    ds_read_b64_tr_b16 v[236:237], v244 offset:46016
    ds_read_b64_tr_b16 v[238:239], v244 offset:48096
    s_add_u32 s40, s38, 68864
    s_mov_b32 exec_hi, 0
    buffer_load_dwordx4 a[220:223], v249, s[52:55], s40 offen
    s_mov_b32 exec_hi, -1
    v_accvgpr_read_b32 v201, a105
    v_accvgpr_read_b32 v202, a106
    v_accvgpr_read_b32 v203, a107
    v_mfma_f32_32x32x16_bf16 v[144:159], v[224:227], v[104:107], v[144:159]
    v_accvgpr_read_b32 v204, a108
    v_accvgpr_read_b32 v205, a109
    v_accvgpr_read_b32 v206, a110
    v_accvgpr_read_b32 v207, a111
    v_mul_f32 v200, v200, v252
    v_mul_f32 v201, v201, v252
    v_mul_f32 v202, v202, v252
    v_mul_f32 v203, v203, v252
    v_mul_f32 v204, v204, v252
    v_mul_f32 v205, v205, v252
    v_mul_f32 v206, v206, v252
    v_mul_f32 v207, v207, v252
    v_cvt_pk_bf16_f32 v52, v200, v201
    v_cvt_pk_bf16_f32 v53, v202, v203
    s_waitcnt lgkmcnt(4)
    v_mfma_f32_32x32x16_bf16 v[160:175], v[228:231], v[40:43], v[160:175]
    ds_read_b64_tr_b16 v[224:225], v244 offset:49920
    ds_read_b64_tr_b16 v[226:227], v244 offset:52000
    v_cvt_pk_bf16_f32 v54, v204, v205
    v_cvt_pk_bf16_f32 v55, v206, v207
    v_accvgpr_read_b32 v200, a224
    v_accvgpr_read_b32 v201, a225
    v_accvgpr_read_b32 v202, a226
    v_accvgpr_read_b32 v203, a227
    v_accvgpr_read_b32 v204, a228
    v_mfma_f32_32x32x16_bf16 v[176:191], v[228:231], v[104:107], v[176:191]
    v_accvgpr_read_b32 v205, a229
    v_accvgpr_read_b32 v206, a230
    v_accvgpr_read_b32 v207, a231
    v_mul_f32 v200, v200, v253
    v_mul_f32 v201, v201, v253
    v_mul_f32 v202, v202, v253
    v_mul_f32 v203, v203, v253
    v_mul_f32 v204, v204, v253
    v_mul_f32 v205, v205, v253
    v_mul_f32 v206, v206, v253
    v_mul_f32 v207, v207, v253
    v_cvt_pk_bf16_f32 v112, v200, v201
    v_cvt_pk_bf16_f32 v113, v202, v203
    v_cvt_pk_bf16_f32 v114, v204, v205
    s_waitcnt lgkmcnt(4)
    v_mfma_f32_32x32x16_bf16 v[128:143], v[232:235], v[44:47], v[128:143]
    ds_read_b64_tr_b16 v[228:229], v244 offset:50176
    ds_read_b64_tr_b16 v[230:231], v244 offset:52256
    v_cvt_pk_bf16_f32 v115, v206, v207
    v_accvgpr_read_b32 v200, a232
    v_accvgpr_read_b32 v201, a233
    v_accvgpr_read_b32 v202, a234
    v_accvgpr_read_b32 v203, a235
    v_accvgpr_read_b32 v204, a236
    v_accvgpr_read_b32 v205, a237
    v_mfma_f32_32x32x16_bf16 v[144:159], v[232:235], v[108:111], v[144:159]
    v_accvgpr_read_b32 v206, a238
    v_accvgpr_read_b32 v207, a239
    v_mul_f32 v200, v200, v253
    v_mul_f32 v201, v201, v253
    v_mul_f32 v202, v202, v253
    v_mul_f32 v203, v203, v253
    v_mul_f32 v204, v204, v253
    v_mul_f32 v205, v205, v253
    v_mul_f32 v206, v206, v253
    v_mul_f32 v207, v207, v253
    v_cvt_pk_bf16_f32 v116, v200, v201
    v_cvt_pk_bf16_f32 v117, v202, v203
    v_cvt_pk_bf16_f32 v118, v204, v205
    v_cvt_pk_bf16_f32 v119, v206, v207
    s_waitcnt lgkmcnt(4)
    v_mfma_f32_32x32x16_bf16 v[160:175], v[236:239], v[44:47], v[160:175]
    ds_read_b64_tr_b16 v[232:233], v244 offset:54080
    ds_read_b64_tr_b16 v[234:235], v244 offset:56160
    s_add_u32 s40, s38, 115456
    s_mov_b32 exec_hi, 0
    buffer_load_dwordx4 a[224:227], v249, s[52:55], s40 offen
    s_mov_b32 exec_hi, -1
    v_accvgpr_read_b32 v200, a112
    v_accvgpr_read_b32 v201, a113
    v_mfma_f32_32x32x16_bf16 v[176:191], v[236:239], v[108:111], v[176:191]
    s_add_u32 s40, s38, 119040
    s_mov_b32 exec_hi, 0
    buffer_load_dwordx4 a[228:231], v249, s[52:55], s40 offen
    s_mov_b32 exec_hi, -1
    v_accvgpr_read_b32 v202, a114
    v_accvgpr_read_b32 v203, a115
    v_accvgpr_read_b32 v204, a116
    v_accvgpr_read_b32 v205, a117
    v_accvgpr_read_b32 v206, a118
    v_accvgpr_read_b32 v207, a119
    v_mul_f32 v200, v200, v252
    v_mul_f32 v201, v201, v252
    v_mul_f32 v202, v202, v252
    s_waitcnt lgkmcnt(4)
    v_mfma_f32_32x32x16_bf16 v[128:143], v[224:227], v[48:51], v[128:143]
    ds_read_b64_tr_b16 v[236:237], v244 offset:54336
    ds_read_b64_tr_b16 v[238:239], v244 offset:56416
    s_add_u32 s40, s38, 122624
    s_mov_b32 exec_hi, 0
    buffer_load_dwordx4 a[232:235], v249, s[52:55], s40 offen
    s_mov_b32 exec_hi, -1
    v_mul_f32 v203, v203, v252
    v_mul_f32 v204, v204, v252
    v_mfma_f32_32x32x16_bf16 v[144:159], v[224:227], v[112:115], v[144:159]
    s_add_u32 s40, s38, 126208
    s_mov_b32 exec_hi, 0
    buffer_load_dwordx4 a[236:239], v249, s[52:55], s40 offen
    s_mov_b32 exec_hi, -1
    v_mul_f32 v205, v205, v252
    v_mul_f32 v206, v206, v252
    v_mul_f32 v207, v207, v252
    v_cvt_pk_bf16_f32 v56, v200, v201
    v_cvt_pk_bf16_f32 v57, v202, v203
    v_cvt_pk_bf16_f32 v58, v204, v205
    v_cvt_pk_bf16_f32 v59, v206, v207
    v_accvgpr_read_b32 v200, a120
    v_accvgpr_read_b32 v201, a121
    s_waitcnt lgkmcnt(4)
    v_mfma_f32_32x32x16_bf16 v[160:175], v[228:231], v[48:51], v[160:175]
    ds_read_b64_tr_b16 v[224:225], v244 offset:58240
    ds_read_b64_tr_b16 v[226:227], v244 offset:60320
    v_accvgpr_read_b32 v202, a122
    v_accvgpr_read_b32 v203, a123
    v_accvgpr_read_b32 v204, a124
    v_accvgpr_read_b32 v205, a125
    v_accvgpr_read_b32 v206, a126
    v_accvgpr_read_b32 v207, a127
    v_mfma_f32_32x32x16_bf16 v[176:191], v[228:231], v[112:115], v[176:191]
    v_mul_f32 v200, v200, v252
    v_mul_f32 v201, v201, v252
    v_mul_f32 v202, v202, v252
    v_mul_f32 v203, v203, v252
    v_mul_f32 v204, v204, v252
    v_mul_f32 v205, v205, v252
    v_mul_f32 v206, v206, v252
    v_mul_f32 v207, v207, v252
    v_cvt_pk_bf16_f32 v60, v200, v201
    v_cvt_pk_bf16_f32 v61, v202, v203
    v_cvt_pk_bf16_f32 v62, v204, v205
    v_cvt_pk_bf16_f32 v63, v206, v207
    v_accvgpr_read_b32 v200, a240
    s_waitcnt lgkmcnt(4)
    v_mfma_f32_32x32x16_bf16 v[128:143], v[232:235], v[52:55], v[128:143]
    ds_read_b64_tr_b16 v[228:229], v244 offset:58496
    ds_read_b64_tr_b16 v[230:231], v244 offset:60576
    v_accvgpr_read_b32 v201, a241
    v_accvgpr_read_b32 v202, a242
    v_accvgpr_read_b32 v203, a243
    v_accvgpr_read_b32 v204, a244
    v_accvgpr_read_b32 v205, a245
    v_accvgpr_read_b32 v206, a246
    v_accvgpr_read_b32 v207, a247
    v_mfma_f32_32x32x16_bf16 v[144:159], v[232:235], v[116:119], v[144:159]
    v_mul_f32 v200, v200, v253
    v_mul_f32 v201, v201, v253
    v_mul_f32 v202, v202, v253
    v_mul_f32 v203, v203, v253
    v_mul_f32 v204, v204, v253
    v_mul_f32 v205, v205, v253
    v_mul_f32 v206, v206, v253
    v_mul_f32 v207, v207, v253
    v_cvt_pk_bf16_f32 v120, v200, v201
    v_cvt_pk_bf16_f32 v121, v202, v203
    v_cvt_pk_bf16_f32 v122, v204, v205
    v_cvt_pk_bf16_f32 v123, v206, v207
    v_accvgpr_read_b32 v200, a248
    s_waitcnt lgkmcnt(4)
    v_mfma_f32_32x32x16_bf16 v[160:175], v[236:239], v[52:55], v[160:175]
    ds_read_b64_tr_b16 v[232:233], v244 offset:62400
    ds_read_b64_tr_b16 v[234:235], v244 offset:64480
    v_accvgpr_read_b32 v201, a249
    v_accvgpr_read_b32 v202, a250
    v_accvgpr_read_b32 v203, a251
    v_accvgpr_read_b32 v204, a252
    v_accvgpr_read_b32 v205, a253
    v_accvgpr_read_b32 v206, a254
    v_mfma_f32_32x32x16_bf16 v[176:191], v[236:239], v[116:119], v[176:191]
    v_accvgpr_read_b32 v207, a255
    v_mul_f32 v200, v200, v253
    v_mul_f32 v201, v201, v253
    v_mul_f32 v202, v202, v253
    v_mul_f32 v203, v203, v253
    v_mul_f32 v204, v204, v253
    v_mul_f32 v205, v205, v253
    v_mul_f32 v206, v206, v253
    v_mul_f32 v207, v207, v253
    v_cvt_pk_bf16_f32 v124, v200, v201
    v_cvt_pk_bf16_f32 v125, v202, v203
    v_cvt_pk_bf16_f32 v126, v204, v205
    v_cvt_pk_bf16_f32 v127, v206, v207
    s_waitcnt lgkmcnt(4)
    v_mfma_f32_32x32x16_bf16 v[128:143], v[224:227], v[56:59], v[128:143]
    ds_read_b64_tr_b16 v[236:237], v244 offset:62656
    ds_read_b64_tr_b16 v[238:239], v244 offset:64736
    s_add_u32 s40, s38, 172800
    s_mov_b32 exec_hi, 0
    buffer_load_dwordx4 a[240:243], v249, s[52:55], s40 offen
    s_mov_b32 exec_hi, -1
    v_mfma_f32_32x32x16_bf16 v[144:159], v[224:227], v[120:123], v[144:159]
    s_add_u32 s40, s38, 176384
    s_mov_b32 exec_hi, 0
    buffer_load_dwordx4 a[244:247], v249, s[52:55], s40 offen
    s_mov_b32 exec_hi, -1
    s_waitcnt lgkmcnt(4)
    v_mfma_f32_32x32x16_bf16 v[160:175], v[228:231], v[56:59], v[160:175]
    s_add_u32 s40, s38, 179968
    s_mov_b32 exec_hi, 0
    buffer_load_dwordx4 a[248:251], v249, s[52:55], s40 offen
    s_mov_b32 exec_hi, -1
    v_mfma_f32_32x32x16_bf16 v[176:191], v[228:231], v[120:123], v[176:191]
    s_add_u32 s40, s38, 183552
    s_mov_b32 exec_hi, 0
    buffer_load_dwordx4 a[252:255], v249, s[52:55], s40 offen
    s_mov_b32 exec_hi, -1
    s_waitcnt lgkmcnt(2)
    v_mfma_f32_32x32x16_bf16 v[128:143], v[232:235], v[60:63], v[128:143]
    v_mfma_f32_32x32x16_bf16 v[144:159], v[232:235], v[124:127], v[144:159]
    s_waitcnt lgkmcnt(0)
    v_mfma_f32_32x32x16_bf16 v[160:175], v[236:239], v[60:63], v[160:175]
    v_mfma_f32_32x32x16_bf16 v[176:191], v[236:239], v[124:127], v[176:191]
    s_barrier
    ds_read_b64_tr_b16 v[224:225], v244 offset:512
    ds_read_b64_tr_b16 v[226:227], v244 offset:2592
    ds_read_b64_tr_b16 v[228:229], v244 offset:768
    ds_read_b64_tr_b16 v[230:231], v244 offset:2848
    ds_read_b64_tr_b16 v[232:233], v247
    ds_read_b64_tr_b16 v[234:235], v247 offset:2080
    ds_read_b128 v[192:195], v245
    ds_read_b128 v[196:199], v245 offset:1024
    s_waitcnt lgkmcnt(6)
    v_mfma_f32_32x32x16_bf16 a[0:15], v[224:227], v[0:3], 0
    ds_read_b64_tr_b16 v[236:237], v244 offset:4672
    ds_read_b64_tr_b16 v[238:239], v244 offset:6752
    v_mfma_f32_32x32x16_bf16 a[16:31], v[224:227], v[64:67], 0
    s_waitcnt lgkmcnt(6)
    v_mfma_f32_32x32x16_bf16 a[32:47], v[228:231], v[0:3], 0
    ds_read_b64_tr_b16 v[224:225], v244 offset:4928
    ds_read_b64_tr_b16 v[226:227], v244 offset:7008
    v_mfma_f32_32x32x16_bf16 a[48:63], v[228:231], v[64:67], 0
    v_cvt_pk_bf16_f32 v252, v128, v129
    v_cvt_pk_bf16_f32 v253, v130, v131
    s_waitcnt lgkmcnt(5)
    v_mfma_f32_32x32x16_bf16 v[208:223], v[232:235], v[192:195], 0
    ds_read_b64_tr_b16 v[228:229], v247 offset:4160
    ds_read_b64_tr_b16 v[230:231], v247 offset:6240
    ds_read_b128 v[192:195], v245 offset:2048
    v_cvt_pk_bf16_f32 v254, v132, v133
    s_waitcnt lgkmcnt(5)
    v_mfma_f32_32x32x16_bf16 a[0:15], v[236:239], v[4:7], a[0:15]
    ds_read_b64_tr_b16 v[232:233], v244 offset:8832
    ds_read_b64_tr_b16 v[234:235], v244 offset:10912
    v_cvt_pk_bf16_f32 v255, v134, v135
    v_mfma_f32_32x32x16_bf16 a[16:31], v[236:239], v[68:71], a[16:31]
    s_add_u32 s39, s58, 0
    buffer_store_dwordx4 v[252:255], v240, s[24:27], s39 offen sc1
    v_cvt_pk_bf16_f32 v204, v136, v137
    s_waitcnt lgkmcnt(5)
    v_mfma_f32_32x32x16_bf16 a[32:47], v[224:227], v[4:7], a[32:47]
    ds_read_b64_tr_b16 v[236:237], v244 offset:9088
    ds_read_b64_tr_b16 v[238:239], v244 offset:11168
    v_cvt_pk_bf16_f32 v205, v138, v139
    v_mfma_f32_32x32x16_bf16 a[48:63], v[224:227], v[68:71], a[48:63]
    v_cvt_pk_bf16_f32 v206, v140, v141
    v_cvt_pk_bf16_f32 v207, v142, v143
    s_waitcnt lgkmcnt(5)
    v_mfma_f32_32x32x16_bf16 v[208:223], v[228:231], v[196:199], v[208:223]
    ds_read_b64_tr_b16 v[224:225], v247 offset:8320
    ds_read_b64_tr_b16 v[226:227], v247 offset:10400
    ds_read_b128 v[196:199], v245 offset:3072
    s_add_u32 s39, s58, 0
    buffer_store_dwordx4 v[204:207], v240, s[24:27], s39 offen offset:128 sc1
    s_waitcnt lgkmcnt(5)
    v_mfma_f32_32x32x16_bf16 a[0:15], v[232:235], v[8:11], a[0:15]
    ds_read_b64_tr_b16 v[228:229], v244 offset:12992
    ds_read_b64_tr_b16 v[230:231], v244 offset:15072
    v_mfma_f32_32x32x16_bf16 a[16:31], v[232:235], v[72:75], a[16:31]
    v_cvt_pk_bf16_f32 v252, v144, v145
    v_cvt_pk_bf16_f32 v253, v146, v147
    v_cvt_pk_bf16_f32 v254, v148, v149
    s_waitcnt lgkmcnt(5)
    v_mfma_f32_32x32x16_bf16 a[32:47], v[236:239], v[8:11], a[32:47]
    ds_read_b64_tr_b16 v[232:233], v244 offset:13248
    ds_read_b64_tr_b16 v[234:235], v244 offset:15328
    v_cvt_pk_bf16_f32 v255, v150, v151
    v_mfma_f32_32x32x16_bf16 a[48:63], v[236:239], v[72:75], a[48:63]
    s_add_u32 s39, s58, 65536
    buffer_store_dwordx4 v[252:255], v240, s[24:27], s39 offen sc1
    s_waitcnt lgkmcnt(5)
    v_mfma_f32_32x32x16_bf16 v[208:223], v[224:227], v[192:195], v[208:223]
    ds_read_b64_tr_b16 v[236:237], v247 offset:12480
    ds_read_b64_tr_b16 v[238:239], v247 offset:14560
    ds_read_b128 v[192:195], v245 offset:4096
    v_cvt_pk_bf16_f32 v204, v152, v153
    s_waitcnt lgkmcnt(5)
    v_mfma_f32_32x32x16_bf16 a[0:15], v[228:231], v[12:15], a[0:15]
    ds_read_b64_tr_b16 v[224:225], v244 offset:17152
    ds_read_b64_tr_b16 v[226:227], v244 offset:19232
    v_cvt_pk_bf16_f32 v205, v154, v155
    v_mfma_f32_32x32x16_bf16 a[16:31], v[228:231], v[76:79], a[16:31]
    v_cvt_pk_bf16_f32 v206, v156, v157
    v_cvt_pk_bf16_f32 v207, v158, v159
    s_waitcnt lgkmcnt(5)
    v_mfma_f32_32x32x16_bf16 a[32:47], v[232:235], v[12:15], a[32:47]
    ds_read_b64_tr_b16 v[228:229], v244 offset:17408
    ds_read_b64_tr_b16 v[230:231], v244 offset:19488
    s_add_u32 s39, s58, 65536
    buffer_store_dwordx4 v[204:207], v240, s[24:27], s39 offen offset:128 sc1
    v_mfma_f32_32x32x16_bf16 a[48:63], v[232:235], v[76:79], a[48:63]
    v_cvt_pk_bf16_f32 v252, v160, v161
    v_cvt_pk_bf16_f32 v253, v162, v163
    s_waitcnt lgkmcnt(5)
    v_mfma_f32_32x32x16_bf16 v[208:223], v[236:239], v[196:199], v[208:223]
    ds_read_b64_tr_b16 v[232:233], v247 offset:16640
    ds_read_b64_tr_b16 v[234:235], v247 offset:18720
    ds_read_b128 v[196:199], v245 offset:5120
    v_cvt_pk_bf16_f32 v254, v164, v165
    s_waitcnt lgkmcnt(5)
    v_mfma_f32_32x32x16_bf16 a[0:15], v[224:227], v[16:19], a[0:15]
    ds_read_b64_tr_b16 v[236:237], v244 offset:21312
    ds_read_b64_tr_b16 v[238:239], v244 offset:23392
    v_cvt_pk_bf16_f32 v255, v166, v167
    v_mfma_f32_32x32x16_bf16 a[16:31], v[224:227], v[80:83], a[16:31]
    s_add_u32 s39, s58, 0
    buffer_store_dwordx4 v[252:255], v240, s[24:27], s39 offen offset:256 sc1
    v_cvt_pk_bf16_f32 v204, v168, v169
    s_waitcnt lgkmcnt(5)
    v_mfma_f32_32x32x16_bf16 a[32:47], v[228:231], v[16:19], a[32:47]
    ds_read_b64_tr_b16 v[224:225], v244 offset:21568
    ds_read_b64_tr_b16 v[226:227], v244 offset:23648
    v_cvt_pk_bf16_f32 v205, v170, v171
    v_mfma_f32_32x32x16_bf16 a[48:63], v[228:231], v[80:83], a[48:63]
    v_cvt_pk_bf16_f32 v206, v172, v173
    v_cvt_pk_bf16_f32 v207, v174, v175
    s_waitcnt lgkmcnt(5)
    v_mfma_f32_32x32x16_bf16 v[208:223], v[232:235], v[192:195], v[208:223]
    ds_read_b64_tr_b16 v[228:229], v247 offset:20800
    ds_read_b64_tr_b16 v[230:231], v247 offset:22880
    ds_read_b128 v[192:195], v245 offset:6144
    s_add_u32 s39, s58, 0
    buffer_store_dwordx4 v[204:207], v240, s[24:27], s39 offen offset:384 sc1
    s_waitcnt lgkmcnt(5)
    v_mfma_f32_32x32x16_bf16 a[0:15], v[236:239], v[20:23], a[0:15]
    ds_read_b64_tr_b16 v[232:233], v244 offset:25472
    ds_read_b64_tr_b16 v[234:235], v244 offset:27552
    v_mfma_f32_32x32x16_bf16 a[16:31], v[236:239], v[84:87], a[16:31]
    v_cvt_pk_bf16_f32 v252, v176, v177
    v_cvt_pk_bf16_f32 v253, v178, v179
    v_cvt_pk_bf16_f32 v254, v180, v181
    s_waitcnt lgkmcnt(5)
    v_mfma_f32_32x32x16_bf16 a[32:47], v[224:227], v[20:23], a[32:47]
    ds_read_b64_tr_b16 v[236:237], v244 offset:25728
    ds_read_b64_tr_b16 v[238:239], v244 offset:27808
    v_cvt_pk_bf16_f32 v255, v182, v183
    v_mfma_f32_32x32x16_bf16 a[48:63], v[224:227], v[84:87], a[48:63]
    s_add_u32 s39, s58, 65536
    buffer_store_dwordx4 v[252:255], v240, s[24:27], s39 offen offset:256 sc1
    s_waitcnt lgkmcnt(5)
    v_mfma_f32_32x32x16_bf16 v[208:223], v[228:231], v[196:199], v[208:223]
    ds_read_b64_tr_b16 v[224:225], v247 offset:24960
    ds_read_b64_tr_b16 v[226:227], v247 offset:27040
    ds_read_b128 v[196:199], v245 offset:7168
    v_cvt_pk_bf16_f32 v204, v184, v185
    s_waitcnt lgkmcnt(5)
    v_mfma_f32_32x32x16_bf16 a[0:15], v[232:235], v[24:27], a[0:15]
    ds_read_b64_tr_b16 v[228:229], v244 offset:29632
    ds_read_b64_tr_b16 v[230:231], v244 offset:31712
    v_cvt_pk_bf16_f32 v205, v186, v187
    v_mfma_f32_32x32x16_bf16 a[16:31], v[232:235], v[88:91], a[16:31]
    v_cvt_pk_bf16_f32 v206, v188, v189
    v_cvt_pk_bf16_f32 v207, v190, v191
    s_waitcnt lgkmcnt(5)
    v_mfma_f32_32x32x16_bf16 a[32:47], v[236:239], v[24:27], a[32:47]
    ds_read_b64_tr_b16 v[232:233], v244 offset:29888
    ds_read_b64_tr_b16 v[234:235], v244 offset:31968
    s_add_u32 s39, s58, 65536
    buffer_store_dwordx4 v[204:207], v240, s[24:27], s39 offen offset:384 sc1
    v_mfma_f32_32x32x16_bf16 a[48:63], v[236:239], v[88:91], a[48:63]
    s_waitcnt lgkmcnt(5)
    v_mfma_f32_32x32x16_bf16 v[208:223], v[224:227], v[192:195], v[208:223]
    ds_read_b64_tr_b16 v[236:237], v247 offset:29120
    ds_read_b64_tr_b16 v[238:239], v247 offset:31200
    ds_read_b128 v[192:195], v245 offset:8192
    s_waitcnt lgkmcnt(5)
    v_mfma_f32_32x32x16_bf16 a[0:15], v[228:231], v[28:31], a[0:15]
    ds_read_b64_tr_b16 v[224:225], v244 offset:33792
    ds_read_b64_tr_b16 v[226:227], v244 offset:35872
    v_mfma_f32_32x32x16_bf16 a[16:31], v[228:231], v[92:95], a[16:31]
    s_waitcnt lgkmcnt(5)
    v_mfma_f32_32x32x16_bf16 a[32:47], v[232:235], v[28:31], a[32:47]
    ds_read_b64_tr_b16 v[228:229], v244 offset:34048
    ds_read_b64_tr_b16 v[230:231], v244 offset:36128
    v_mfma_f32_32x32x16_bf16 a[48:63], v[232:235], v[92:95], a[48:63]
    s_waitcnt lgkmcnt(5)
    v_mfma_f32_32x32x16_bf16 v[208:223], v[236:239], v[196:199], v[208:223]
    ds_read_b64_tr_b16 v[232:233], v247 offset:33280
    ds_read_b64_tr_b16 v[234:235], v247 offset:35360
    ds_read_b128 v[196:199], v245 offset:9216
    s_waitcnt lgkmcnt(5)
    v_mfma_f32_32x32x16_bf16 a[0:15], v[224:227], v[32:35], a[0:15]
    ds_read_b64_tr_b16 v[236:237], v244 offset:37952
    ds_read_b64_tr_b16 v[238:239], v244 offset:40032
    v_mfma_f32_32x32x16_bf16 a[16:31], v[224:227], v[96:99], a[16:31]
    s_waitcnt lgkmcnt(5)
    v_mfma_f32_32x32x16_bf16 a[32:47], v[228:231], v[32:35], a[32:47]
    ds_read_b64_tr_b16 v[224:225], v244 offset:38208
    ds_read_b64_tr_b16 v[226:227], v244 offset:40288
    v_mfma_f32_32x32x16_bf16 a[48:63], v[228:231], v[96:99], a[48:63]
    s_waitcnt lgkmcnt(5)
    v_mfma_f32_32x32x16_bf16 v[208:223], v[232:235], v[192:195], v[208:223]
    ds_read_b64_tr_b16 v[228:229], v247 offset:37440
    ds_read_b64_tr_b16 v[230:231], v247 offset:39520
    ds_read_b128 v[192:195], v245 offset:10240
    s_waitcnt lgkmcnt(5)
    v_mfma_f32_32x32x16_bf16 a[0:15], v[236:239], v[36:39], a[0:15]
    ds_read_b64_tr_b16 v[232:233], v244 offset:42112
    ds_read_b64_tr_b16 v[234:235], v244 offset:44192
    v_mfma_f32_32x32x16_bf16 a[16:31], v[236:239], v[100:103], a[16:31]
    s_waitcnt lgkmcnt(5)
    v_mfma_f32_32x32x16_bf16 a[32:47], v[224:227], v[36:39], a[32:47]
    ds_read_b64_tr_b16 v[236:237], v244 offset:42368
    ds_read_b64_tr_b16 v[238:239], v244 offset:44448
    v_mfma_f32_32x32x16_bf16 a[48:63], v[224:227], v[100:103], a[48:63]
    s_waitcnt lgkmcnt(5)
    v_mfma_f32_32x32x16_bf16 v[208:223], v[228:231], v[196:199], v[208:223]
    ds_read_b64_tr_b16 v[224:225], v247 offset:41600
    ds_read_b64_tr_b16 v[226:227], v247 offset:43680
    ds_read_b128 v[196:199], v245 offset:11264
    s_waitcnt lgkmcnt(5)
    v_mfma_f32_32x32x16_bf16 a[0:15], v[232:235], v[40:43], a[0:15]
    ds_read_b64_tr_b16 v[228:229], v244 offset:46272
    ds_read_b64_tr_b16 v[230:231], v244 offset:48352
    v_mfma_f32_32x32x16_bf16 a[16:31], v[232:235], v[104:107], a[16:31]
    s_waitcnt lgkmcnt(5)
    v_mfma_f32_32x32x16_bf16 a[32:47], v[236:239], v[40:43], a[32:47]
    ds_read_b64_tr_b16 v[232:233], v244 offset:46528
    ds_read_b64_tr_b16 v[234:235], v244 offset:48608
    v_mfma_f32_32x32x16_bf16 a[48:63], v[236:239], v[104:107], a[48:63]
    s_waitcnt lgkmcnt(5)
    v_mfma_f32_32x32x16_bf16 v[208:223], v[224:227], v[192:195], v[208:223]
    ds_read_b64_tr_b16 v[236:237], v247 offset:45760
    ds_read_b64_tr_b16 v[238:239], v247 offset:47840
    ds_read_b128 v[192:195], v245 offset:12288
    s_waitcnt lgkmcnt(5)
    v_mfma_f32_32x32x16_bf16 a[0:15], v[228:231], v[44:47], a[0:15]
    ds_read_b64_tr_b16 v[224:225], v244 offset:50432
    ds_read_b64_tr_b16 v[226:227], v244 offset:52512
    v_mfma_f32_32x32x16_bf16 a[16:31], v[228:231], v[108:111], a[16:31]
    s_waitcnt lgkmcnt(5)
    v_mfma_f32_32x32x16_bf16 a[32:47], v[232:235], v[44:47], a[32:47]
    ds_read_b64_tr_b16 v[228:229], v244 offset:50688
    ds_read_b64_tr_b16 v[230:231], v244 offset:52768
    v_mfma_f32_32x32x16_bf16 a[48:63], v[232:235], v[108:111], a[48:63]
    s_waitcnt lgkmcnt(5)
    v_mfma_f32_32x32x16_bf16 v[208:223], v[236:239], v[196:199], v[208:223]
    ds_read_b64_tr_b16 v[232:233], v247 offset:49920
    ds_read_b64_tr_b16 v[234:235], v247 offset:52000
    ds_read_b128 v[196:199], v245 offset:13312
    s_waitcnt lgkmcnt(5)
    v_mfma_f32_32x32x16_bf16 a[0:15], v[224:227], v[48:51], a[0:15]
    ds_read_b64_tr_b16 v[236:237], v244 offset:54592
    ds_read_b64_tr_b16 v[238:239], v244 offset:56672
    v_mfma_f32_32x32x16_bf16 a[16:31], v[224:227], v[112:115], a[16:31]
    s_waitcnt lgkmcnt(5)
    v_mfma_f32_32x32x16_bf16 a[32:47], v[228:231], v[48:51], a[32:47]
    ds_read_b64_tr_b16 v[224:225], v244 offset:54848
    ds_read_b64_tr_b16 v[226:227], v244 offset:56928
    v_mfma_f32_32x32x16_bf16 a[48:63], v[228:231], v[112:115], a[48:63]
    s_waitcnt lgkmcnt(5)
    v_mfma_f32_32x32x16_bf16 v[208:223], v[232:235], v[192:195], v[208:223]
    ds_read_b64_tr_b16 v[228:229], v247 offset:54080
    ds_read_b64_tr_b16 v[230:231], v247 offset:56160
    ds_read_b128 v[192:195], v245 offset:14336
    s_waitcnt lgkmcnt(5)
    v_mfma_f32_32x32x16_bf16 a[0:15], v[236:239], v[52:55], a[0:15]
    ds_read_b64_tr_b16 v[232:233], v244 offset:58752
    ds_read_b64_tr_b16 v[234:235], v244 offset:60832
    v_mfma_f32_32x32x16_bf16 a[16:31], v[236:239], v[116:119], a[16:31]
    s_waitcnt lgkmcnt(5)
    v_mfma_f32_32x32x16_bf16 a[32:47], v[224:227], v[52:55], a[32:47]
    ds_read_b64_tr_b16 v[236:237], v244 offset:59008
    ds_read_b64_tr_b16 v[238:239], v244 offset:61088
    v_mfma_f32_32x32x16_bf16 a[48:63], v[224:227], v[116:119], a[48:63]
    s_waitcnt lgkmcnt(5)
    v_mfma_f32_32x32x16_bf16 v[208:223], v[228:231], v[196:199], v[208:223]
    ds_read_b64_tr_b16 v[224:225], v247 offset:58240
    ds_read_b64_tr_b16 v[226:227], v247 offset:60320
    ds_read_b128 v[196:199], v245 offset:15360
    s_waitcnt lgkmcnt(5)
    v_mfma_f32_32x32x16_bf16 a[0:15], v[232:235], v[56:59], a[0:15]
    ds_read_b64_tr_b16 v[228:229], v244 offset:62912
    ds_read_b64_tr_b16 v[230:231], v244 offset:64992
    v_mfma_f32_32x32x16_bf16 a[16:31], v[232:235], v[120:123], a[16:31]
    s_waitcnt lgkmcnt(5)
    v_mfma_f32_32x32x16_bf16 a[32:47], v[236:239], v[56:59], a[32:47]
    ds_read_b64_tr_b16 v[232:233], v244 offset:63168
    ds_read_b64_tr_b16 v[234:235], v244 offset:65248
    v_mfma_f32_32x32x16_bf16 a[48:63], v[236:239], v[120:123], a[48:63]
    s_waitcnt vmcnt(0)
    s_add_u32 s39, s13, 1
    s_mov_b64 exec, 1
    v_mov_b32 v187, s39
    s_cmp_eq_u32 s12, 16
    s_cbranch_scc1 L_arf1
    buffer_store_dword v187, off, s[24:27], s41 sc1
    s_branch L_are1
L_arf1:
    buffer_store_dword v187, off, s[24:27], s41
L_are1:
    s_mov_b64 exec, -1
    s_waitcnt lgkmcnt(5)
    v_mfma_f32_32x32x16_bf16 v[208:223], v[224:227], v[192:195], v[208:223]
    ds_read_b64_tr_b16 v[236:237], v247 offset:62400
    ds_read_b64_tr_b16 v[238:239], v247 offset:64480
    s_waitcnt lgkmcnt(4)
    v_mfma_f32_32x32x16_bf16 a[0:15], v[228:231], v[60:63], a[0:15]
    v_mfma_f32_32x32x16_bf16 a[16:31], v[228:231], v[124:127], a[16:31]
    s_waitcnt lgkmcnt(2)
    v_mfma_f32_32x32x16_bf16 a[32:47], v[232:235], v[60:63], a[32:47]
    v_mfma_f32_32x32x16_bf16 a[48:63], v[232:235], v[124:127], a[48:63]
    s_waitcnt lgkmcnt(0)
    v_mfma_f32_32x32x16_bf16 v[208:223], v[236:239], v[196:199], v[208:223]
    s_barrier
    ds_read_b64_tr_b16 v[224:225], v246
    ds_read_b64_tr_b16 v[226:227], v246 offset:2080
    ds_read_b64_tr_b16 v[228:229], v246 offset:256
    ds_read_b64_tr_b16 v[230:231], v246 offset:2336
    ds_read_b64_tr_b16 v[232:233], v246 offset:4160
    ds_read_b64_tr_b16 v[234:235], v246 offset:6240
    s_waitcnt lgkmcnt(4)
    v_mfma_f32_32x32x16_bf16 a[64:79], v[224:227], v[0:3], 0
    ds_read_b64_tr_b16 v[236:237], v246 offset:4416
    ds_read_b64_tr_b16 v[238:239], v246 offset:6496
    s_add_u32 s40, s34, 24576
    v_add_u32 v191, s40, v245
    v_mfma_f32_32x32x16_bf16 a[80:95], v[224:227], v[64:67], 0
    s_waitcnt lgkmcnt(4)
    v_mfma_f32_32x32x16_bf16 a[96:111], v[228:231], v[0:3], 0
    ds_read_b64_tr_b16 v[224:225], v246 offset:8320
    ds_read_b64_tr_b16 v[226:227], v246 offset:10400
    v_mfma_f32_32x32x16_bf16 a[112:127], v[228:231], v[64:67], 0
    v_accvgpr_read_b32 v250, a0
    v_accvgpr_read_b32 v251, a1
    v_cvt_pk_bf16_f32 v252, v250, v251
    v_accvgpr_read_b32 v250, a2
    v_accvgpr_read_b32 v251, a3
    v_cvt_pk_bf16_f32 v253, v250, v251
    v_accvgpr_read_b32 v250, a4
    s_waitcnt lgkmcnt(4)
    v_mfma_f32_32x32x16_bf16 a[64:79], v[232:235], v[4:7], a[64:79]
    ds_read_b64_tr_b16 v[228:229], v246 offset:8576
    ds_read_b64_tr_b16 v[230:231], v246 offset:10656
    v_accvgpr_read_b32 v251, a5
    v_cvt_pk_bf16_f32 v254, v250, v251
    v_accvgpr_read_b32 v250, a6
    v_accvgpr_read_b32 v251, a7
    v_mfma_f32_32x32x16_bf16 a[80:95], v[232:235], v[68:71], a[80:95]
    v_cvt_pk_bf16_f32 v255, v250, v251
    s_add_u32 s39, s58, 524288
    buffer_store_dwordx4 v[252:255], v240, s[24:27], s39 offen sc1
    v_accvgpr_read_b32 v250, a8
    v_accvgpr_read_b32 v251, a9
    v_cvt_pk_bf16_f32 v204, v250, v251
    v_accvgpr_read_b32 v250, a10
    s_waitcnt lgkmcnt(4)
    v_mfma_f32_32x32x16_bf16 a[96:111], v[236:239], v[4:7], a[96:111]
    ds_read_b64_tr_b16 v[232:233], v246 offset:12480
    ds_read_b64_tr_b16 v[234:235], v246 offset:14560
    v_accvgpr_read_b32 v251, a11
    v_cvt_pk_bf16_f32 v205, v250, v251
    v_accvgpr_read_b32 v250, a12
    v_mfma_f32_32x32x16_bf16 a[112:127], v[236:239], v[68:71], a[112:127]
    v_accvgpr_read_b32 v251, a13
    v_cvt_pk_bf16_f32 v206, v250, v251
    v_accvgpr_read_b32 v250, a14
    v_accvgpr_read_b32 v251, a15
    v_cvt_pk_bf16_f32 v207, v250, v251
    s_add_u32 s39, s58, 524288
    buffer_store_dwordx4 v[204:207], v240, s[24:27], s39 offen offset:128 sc1
    s_waitcnt lgkmcnt(4)
    v_mfma_f32_32x32x16_bf16 a[64:79], v[224:227], v[8:11], a[64:79]
    ds_read_b64_tr_b16 v[236:237], v246 offset:12736
    ds_read_b64_tr_b16 v[238:239], v246 offset:14816
    v_accvgpr_read_b32 v250, a16
    v_accvgpr_read_b32 v251, a17
    v_cvt_pk_bf16_f32 v252, v250, v251
    v_accvgpr_read_b32 v250, a18
    v_mfma_f32_32x32x16_bf16 a[80:95], v[224:227], v[72:75], a[80:95]
    v_accvgpr_read_b32 v251, a19
    v_cvt_pk_bf16_f32 v253, v250, v251
    v_accvgpr_read_b32 v250, a20
    v_accvgpr_read_b32 v251, a21
    v_cvt_pk_bf16_f32 v254, v250, v251
    v_accvgpr_read_b32 v250, a22
    v_accvgpr_read_b32 v251, a23
    s_waitcnt lgkmcnt(4)
    v_mfma_f32_32x32x16_bf16 a[96:111], v[228:231], v[8:11], a[96:111]
    ds_read_b64_tr_b16 v[224:225], v246 offset:16640
    ds_read_b64_tr_b16 v[226:227], v246 offset:18720
    v_cvt_pk_bf16_f32 v255, v250, v251
    s_add_u32 s39, s58, 589824
    buffer_store_dwordx4 v[252:255], v240, s[24:27], s39 offen sc1
    v_accvgpr_read_b32 v250, a24
    v_mfma_f32_32x32x16_bf16 a[112:127], v[228:231], v[72:75], a[112:127]
    v_accvgpr_read_b32 v251, a25
    v_cvt_pk_bf16_f32 v204, v250, v251
    v_accvgpr_read_b32 v250, a26
    v_accvgpr_read_b32 v251, a27
    v_cvt_pk_bf16_f32 v205, v250, v251
    v_accvgpr_read_b32 v250, a28
    v_accvgpr_read_b32 v251, a29
    s_waitcnt lgkmcnt(4)
    v_mfma_f32_32x32x16_bf16 a[64:79], v[232:235], v[12:15], a[64:79]
    ds_read_b64_tr_b16 v[228:229], v246 offset:16896
    ds_read_b64_tr_b16 v[230:231], v246 offset:18976
    v_cvt_pk_bf16_f32 v206, v250, v251
    v_accvgpr_read_b32 v250, a30
    v_accvgpr_read_b32 v251, a31
    v_mfma_f32_32x32x16_bf16 a[80:95], v[232:235], v[76:79], a[80:95]
    v_cvt_pk_bf16_f32 v207, v250, v251
    s_add_u32 s39, s58, 589824
    buffer_store_dwordx4 v[204:207], v240, s[24:27], s39 offen offset:128 sc1
    v_accvgpr_read_b32 v250, a32
    v_accvgpr_read_b32 v251, a33
    v_cvt_pk_bf16_f32 v252, v250, v251
    v_accvgpr_read_b32 v250, a34
    s_waitcnt lgkmcnt(4)
    v_mfma_f32_32x32x16_bf16 a[96:111], v[236:239], v[12:15], a[96:111]
    ds_read_b64_tr_b16 v[232:233], v246 offset:20800
    ds_read_b64_tr_b16 v[234:235], v246 offset:22880
    v_accvgpr_read_b32 v251, a35
    v_cvt_pk_bf16_f32 v253, v250, v251
    v_accvgpr_read_b32 v250, a36
    v_accvgpr_read_b32 v251, a37
    v_mfma_f32_32x32x16_bf16 a[112:127], v[236:239], v[76:79], a[112:127]
    v_cvt_pk_bf16_f32 v254, v250, v251
    v_accvgpr_read_b32 v250, a38
    v_accvgpr_read_b32 v251, a39
    v_cvt_pk_bf16_f32 v255, v250, v251
    s_add_u32 s39, s58, 524288
    buffer_store_dwordx4 v[252:255], v240, s[24:27], s39 offen offset:256 sc1
    v_accvgpr_read_b32 v250, a40
    s_waitcnt lgkmcnt(4)
    v_mfma_f32_32x32x16_bf16 a[64:79], v[224:227], v[16:19], a[64:79]
    ds_read_b64_tr_b16 v[236:237], v246 offset:21056
    ds_read_b64_tr_b16 v[238:239], v246 offset:23136
    v_accvgpr_read_b32 v251, a41
    v_cvt_pk_bf16_f32 v204, v250, v251
    v_accvgpr_read_b32 v250, a42
    v_mfma_f32_32x32x16_bf16 a[80:95], v[224:227], v[80:83], a[80:95]
    v_accvgpr_read_b32 v251, a43
    v_cvt_pk_bf16_f32 v205, v250, v251
    v_accvgpr_read_b32 v250, a44
    v_accvgpr_read_b32 v251, a45
    v_cvt_pk_bf16_f32 v206, v250, v251
    v_accvgpr_read_b32 v250, a46
    v_accvgpr_read_b32 v251, a47
    s_waitcnt lgkmcnt(4)
    v_mfma_f32_32x32x16_bf16 a[96:111], v[228:231], v[16:19], a[96:111]
    ds_read_b64_tr_b16 v[224:225], v246 offset:24960
    ds_read_b64_tr_b16 v[226:227], v246 offset:27040
    v_cvt_pk_bf16_f32 v207, v250, v251
    s_add_u32 s39, s58, 524288
    buffer_store_dwordx4 v[204:207], v240, s[24:27], s39 offen offset:384 sc1
    v_accvgpr_read_b32 v250, a48
    v_mfma_f32_32x32x16_bf16 a[112:127], v[228:231], v[80:83], a[112:127]
    v_accvgpr_read_b32 v251, a49
    v_cvt_pk_bf16_f32 v252, v250, v251
    v_accvgpr_read_b32 v250, a50
    v_accvgpr_read_b32 v251, a51
    v_cvt_pk_bf16_f32 v253, v250, v251
    v_accvgpr_read_b32 v250, a52
    v_accvgpr_read_b32 v251, a53
    s_waitcnt lgkmcnt(4)
    v_mfma_f32_32x32x16_bf16 a[64:79], v[232:235], v[20:23], a[64:79]
    ds_read_b64_tr_b16 v[228:229], v246 offset:25216
    ds_read_b64_tr_b16 v[230:231], v246 offset:27296
    v_cvt_pk_bf16_f32 v254, v250, v251
    v_accvgpr_read_b32 v250, a54
    v_accvgpr_read_b32 v251, a55
    v_cvt_pk_bf16_f32 v255, v250, v251
    v_mfma_f32_32x32x16_bf16 a[80:95], v[232:235], v[84:87], a[80:95]
    s_add_u32 s39, s58, 589824
    buffer_store_dwordx4 v[252:255], v240, s[24:27], s39 offen offset:256 sc1
    v_accvgpr_read_b32 v250, a56
    v_accvgpr_read_b32 v251, a57
    v_cvt_pk_bf16_f32 v204, v250, v251
    v_accvgpr_read_b32 v250, a58
    v_accvgpr_read_b32 v251, a59
    s_waitcnt lgkmcnt(4)
    v_mfma_f32_32x32x16_bf16 a[96:111], v[236:239], v[20:23], a[96:111]
    ds_read_b64_tr_b16 v[232:233], v246 offset:29120
    ds_read_b64_tr_b16 v[234:235], v246 offset:31200
    v_cvt_pk_bf16_f32 v205, v250, v251
    v_accvgpr_read_b32 v250, a60
    v_accvgpr_read_b32 v251, a61
    v_mfma_f32_32x32x16_bf16 a[112:127], v[236:239], v[84:87], a[112:127]
    v_cvt_pk_bf16_f32 v206, v250, v251
    v_accvgpr_read_b32 v250, a62
    v_accvgpr_read_b32 v251, a63
    v_cvt_pk_bf16_f32 v207, v250, v251
    s_add_u32 s39, s58, 589824
    buffer_store_dwordx4 v[204:207], v240, s[24:27], s39 offen offset:384 sc1
    v_cvt_pk_bf16_f32 v252, v208, v209
    s_waitcnt lgkmcnt(4)
    v_mfma_f32_32x32x16_bf16 a[64:79], v[224:227], v[24:27], a[64:79]
    ds_read_b64_tr_b16 v[236:237], v246 offset:29376
    ds_read_b64_tr_b16 v[238:239], v246 offset:31456
    v_cvt_pk_bf16_f32 v253, v210, v211
    v_cvt_pk_bf16_f32 v254, v212, v213
    v_cvt_pk_bf16_f32 v255, v214, v215
    v_mfma_f32_32x32x16_bf16 a[80:95], v[224:227], v[88:91], a[80:95]
    s_add_u32 s39, s50, 0
    buffer_store_dwordx4 v[252:255], v240, s[24:27], s39 offen sc1
    v_cvt_pk_bf16_f32 v204, v216, v217
    v_cvt_pk_bf16_f32 v205, v218, v219
    v_cvt_pk_bf16_f32 v206, v220, v221
    v_cvt_pk_bf16_f32 v207, v222, v223
    s_add_u32 s39, s50, 0
    buffer_store_dwordx4 v[204:207], v240, s[24:27], s39 offen offset:128 sc1
    s_waitcnt lgkmcnt(4)
    v_mfma_f32_32x32x16_bf16 a[96:111], v[228:231], v[24:27], a[96:111]
    ds_read_b64_tr_b16 v[224:225], v246 offset:33280
    ds_read_b64_tr_b16 v[226:227], v246 offset:35360
    v_mfma_f32_32x32x16_bf16 a[112:127], v[228:231], v[88:91], a[112:127]
    s_waitcnt lgkmcnt(4)
    v_mfma_f32_32x32x16_bf16 a[64:79], v[232:235], v[28:31], a[64:79]
    ds_read_b64_tr_b16 v[228:229], v246 offset:33536
    ds_read_b64_tr_b16 v[230:231], v246 offset:35616
    v_mfma_f32_32x32x16_bf16 a[80:95], v[232:235], v[92:95], a[80:95]
    s_waitcnt lgkmcnt(4)
    v_mfma_f32_32x32x16_bf16 a[96:111], v[236:239], v[28:31], a[96:111]
    ds_read_b64_tr_b16 v[232:233], v246 offset:37440
    ds_read_b64_tr_b16 v[234:235], v246 offset:39520
    v_mfma_f32_32x32x16_bf16 a[112:127], v[236:239], v[92:95], a[112:127]
    s_waitcnt lgkmcnt(4)
    v_mfma_f32_32x32x16_bf16 a[64:79], v[224:227], v[32:35], a[64:79]
    ds_read_b64_tr_b16 v[236:237], v246 offset:37696
    ds_read_b64_tr_b16 v[238:239], v246 offset:39776
    v_mfma_f32_32x32x16_bf16 a[80:95], v[224:227], v[96:99], a[80:95]
    s_waitcnt lgkmcnt(4)
    v_mfma_f32_32x32x16_bf16 a[96:111], v[228:231], v[32:35], a[96:111]
    ds_read_b64_tr_b16 v[224:225], v246 offset:41600
    ds_read_b64_tr_b16 v[226:227], v246 offset:43680
    v_mfma_f32_32x32x16_bf16 a[112:127], v[228:231], v[96:99], a[112:127]
    s_waitcnt lgkmcnt(4)
    v_mfma_f32_32x32x16_bf16 a[64:79], v[232:235], v[36:39], a[64:79]
    ds_read_b64_tr_b16 v[228:229], v246 offset:41856
    ds_read_b64_tr_b16 v[230:231], v246 offset:43936
    v_mfma_f32_32x32x16_bf16 a[80:95], v[232:235], v[100:103], a[80:95]
    s_waitcnt lgkmcnt(4)
    v_mfma_f32_32x32x16_bf16 a[96:111], v[236:239], v[36:39], a[96:111]
    ds_read_b64_tr_b16 v[232:233], v246 offset:45760
    ds_read_b64_tr_b16 v[234:235], v246 offset:47840
    v_mfma_f32_32x32x16_bf16 a[112:127], v[236:239], v[100:103], a[112:127]
    s_waitcnt lgkmcnt(4)
    v_mfma_f32_32x32x16_bf16 a[64:79], v[224:227], v[40:43], a[64:79]
    ds_read_b64_tr_b16 v[236:237], v246 offset:46016
    ds_read_b64_tr_b16 v[238:239], v246 offset:48096
    v_mfma_f32_32x32x16_bf16 a[80:95], v[224:227], v[104:107], a[80:95]
    buffer_load_dword v186, v242, s[24:27], s91 offen sc1
    s_waitcnt lgkmcnt(4)
    v_mfma_f32_32x32x16_bf16 a[96:111], v[228:231], v[40:43], a[96:111]
    ds_read_b64_tr_b16 v[224:225], v246 offset:49920
    ds_read_b64_tr_b16 v[226:227], v246 offset:52000
    ds_write_b128 v191, a[128:131]
    v_mfma_f32_32x32x16_bf16 a[112:127], v[228:231], v[104:107], a[112:127]
    ds_write_b128 v191, a[132:135] offset:1040
    s_waitcnt lgkmcnt(6)
    v_mfma_f32_32x32x16_bf16 a[64:79], v[232:235], v[44:47], a[64:79]
    ds_read_b64_tr_b16 v[228:229], v246 offset:50176
    ds_read_b64_tr_b16 v[230:231], v246 offset:52256
    ds_write_b128 v191, a[136:139] offset:2080
    v_mfma_f32_32x32x16_bf16 a[80:95], v[232:235], v[108:111], a[80:95]
    ds_write_b128 v191, a[140:143] offset:3120
    s_waitcnt lgkmcnt(8)
    v_mfma_f32_32x32x16_bf16 a[96:111], v[236:239], v[44:47], a[96:111]
    ds_read_b64_tr_b16 v[232:233], v246 offset:54080
    ds_read_b64_tr_b16 v[234:235], v246 offset:56160
    ds_write_b128 v191, a[144:147] offset:16640
    v_mfma_f32_32x32x16_bf16 a[112:127], v[236:239], v[108:111], a[112:127]
    ds_write_b128 v191, a[148:151] offset:17680
    s_waitcnt lgkmcnt(10)
    v_mfma_f32_32x32x16_bf16 a[64:79], v[224:227], v[48:51], a[64:79]
    ds_read_b64_tr_b16 v[236:237], v246 offset:54336
    ds_read_b64_tr_b16 v[238:239], v246 offset:56416
    ds_write_b128 v191, a[152:155] offset:18720
    v_mfma_f32_32x32x16_bf16 a[80:95], v[224:227], v[112:115], a[80:95]
    ds_write_b128 v191, a[156:159] offset:19760
    s_waitcnt lgkmcnt(10)
    v_mfma_f32_32x32x16_bf16 a[96:111], v[228:231], v[48:51], a[96:111]
    ds_read_b64_tr_b16 v[224:225], v246 offset:58240
    ds_read_b64_tr_b16 v[226:227], v246 offset:60320
    ds_write_b128 v191, a[160:163] offset:33280
    v_mfma_f32_32x32x16_bf16 a[112:127], v[228:231], v[112:115], a[112:127]
    ds_write_b128 v191, a[164:167] offset:34320
    s_waitcnt lgkmcnt(10)
    v_mfma_f32_32x32x16_bf16 a[64:79], v[232:235], v[52:55], a[64:79]
    ds_read_b64_tr_b16 v[228:229], v246 offset:58496
    ds_read_b64_tr_b16 v[230:231], v246 offset:60576
    ds_write_b128 v191, a[168:171] offset:35360
    v_mfma_f32_32x32x16_bf16 a[80:95], v[232:235], v[116:119], a[80:95]
    ds_write_b128 v191, a[172:175] offset:36400
    s_waitcnt lgkmcnt(10)
    v_mfma_f32_32x32x16_bf16 a[96:111], v[236:239], v[52:55], a[96:111]
    ds_read_b64_tr_b16 v[232:233], v246 offset:62400
    ds_read_b64_tr_b16 v[234:235], v246 offset:64480
    ds_write_b128 v191, a[176:179] offset:49920
    v_mfma_f32_32x32x16_bf16 a[112:127], v[236:239], v[116:119], a[112:127]
    ds_write_b128 v191, a[180:183] offset:50960
    s_waitcnt lgkmcnt(10)
    v_mfma_f32_32x32x16_bf16 a[64:79], v[224:227], v[56:59], a[64:79]
    ds_read_b64_tr_b16 v[236:237], v246 offset:62656
    ds_read_b64_tr_b16 v[238:239], v246 offset:64736
    ds_write_b128 v191, a[184:187] offset:52000
    v_mfma_f32_32x32x16_bf16 a[80:95], v[224:227], v[120:123], a[80:95]
    ds_write_b128 v191, a[188:191] offset:53040
    s_waitcnt lgkmcnt(10)
    v_mfma_f32_32x32x16_bf16 a[96:111], v[228:231], v[56:59], a[96:111]
    s_waitcnt vmcnt(0)
    s_add_u32 s39, s13, 2
    s_mov_b64 exec, 1
    v_mov_b32 v187, s39
    s_cmp_eq_u32 s12, 16
    s_cbranch_scc1 L_arf2
    buffer_store_dword v187, off, s[24:27], s41 sc1
    s_branch L_are2
L_arf2:
    buffer_store_dword v187, off, s[24:27], s41
L_are2:
    s_mov_b64 exec, -1
    s_lshl_b32 s88, s86, 19
    s_add_u32 s88, s88, s37
    s_lshl_b32 s87, s86, 7
    s_add_u32 s87, s87, s42
    v_sub_u32 v186, v186, v243
    v_cmp_lt_u32 vcc, s86, v186
    s_nop 0
    s_cmp_eq_u64 vcc, -1
    s_cselect_b32 s88, s88, 0x7fff0000
    s_cselect_b32 s87, s87, 0x7fff0000
    s_addc_u32 s86, s86, 0
    v_mfma_f32_32x32x16_bf16 a[112:127], v[228:231], v[120:123], a[112:127]
    buffer_load_dwordx4 v[144:147], v245, s[24:27], s88 offen sc1
    buffer_load_dwordx4 v[148:151], v245, s[24:27], s88 offen offset:1024 sc1
    s_waitcnt lgkmcnt(6)
    v_mfma_f32_32x32x16_bf16 a[64:79], v[232:235], v[60:63], a[64:79]
    buffer_load_dwordx4 v[152:155], v245, s[24:27], s88 offen offset:2048 sc1
    buffer_load_dwordx4 v[156:159], v245, s[24:27], s88 offen offset:3072 sc1
    v_mfma_f32_32x32x16_bf16 a[80:95], v[232:235], v[124:127], a[80:95]
    s_add_u32 s88, s88, 4096
    buffer_load_dwordx4 v[160:163], v245, s[24:27], s88 offen sc1
    s_waitcnt lgkmcnt(2)
    v_mfma_f32_32x32x16_bf16 a[96:111], v[236:239], v[60:63], a[96:111]
    buffer_load_dwordx4 v[164:167], v245, s[24:27], s88 offen offset:1024 sc1
    buffer_load_dwordx4 v[168:171], v245, s[24:27], s88 offen offset:2048 sc1
    v_mfma_f32_32x32x16_bf16 a[112:127], v[236:239], v[124:127], a[112:127]
    buffer_load_dwordx4 v[172:175], v245, s[24:27], s88 offen offset:3072 sc1
    ds_read_b64_tr_b16 v[224:225], v246 offset:512
    ds_read_b64_tr_b16 v[226:227], v246 offset:2592
    ds_read_b64_tr_b16 v[228:229], v246 offset:768
    ds_read_b64_tr_b16 v[230:231], v246 offset:2848
    ds_read_b64_tr_b16 v[232:233], v248
    ds_read_b64_tr_b16 v[234:235], v248 offset:2080
    ds_read_b128 v[192:195], v245
    ds_read_b128 v[196:199], v245 offset:1024
    s_waitcnt lgkmcnt(6)
    v_mfma_f32_32x32x16_bf16 a[0:15], v[224:227], v[0:3], 0
    ds_read_b64_tr_b16 v[236:237], v246 offset:4672
    ds_read_b64_tr_b16 v[238:239], v246 offset:6752
    v_mfma_f32_32x32x16_bf16 a[16:31], v[224:227], v[64:67], 0
    s_waitcnt lgkmcnt(6)
    v_mfma_f32_32x32x16_bf16 a[32:47], v[228:231], v[0:3], 0
    ds_read_b64_tr_b16 v[224:225], v246 offset:4928
    ds_read_b64_tr_b16 v[226:227], v246 offset:7008
    v_mfma_f32_32x32x16_bf16 a[48:63], v[228:231], v[64:67], 0
    v_accvgpr_read_b32 v250, a64
    v_accvgpr_read_b32 v251, a65
    v_cvt_pk_bf16_f32 v252, v250, v251
    v_accvgpr_read_b32 v250, a66
    v_accvgpr_read_b32 v251, a67
    v_cvt_pk_bf16_f32 v253, v250, v251
    s_waitcnt lgkmcnt(5)
    v_mfma_f32_32x32x16_bf16 v[208:223], v[232:235], v[192:195], 0
    ds_read_b64_tr_b16 v[228:229], v248 offset:4160
    ds_read_b64_tr_b16 v[230:231], v248 offset:6240
    ds_read_b128 v[192:195], v245 offset:2048
    v_accvgpr_read_b32 v250, a68
    s_waitcnt lgkmcnt(5)
    v_mfma_f32_32x32x16_bf16 a[0:15], v[236:239], v[4:7], a[0:15]
    ds_read_b64_tr_b16 v[232:233], v246 offset:8832
    ds_read_b64_tr_b16 v[234:235], v246 offset:10912
    v_accvgpr_read_b32 v251, a69
    v_cvt_pk_bf16_f32 v254, v250, v251
    v_accvgpr_read_b32 v250, a70
    v_mfma_f32_32x32x16_bf16 a[16:31], v[236:239], v[68:71], a[16:31]
    v_accvgpr_read_b32 v251, a71
    v_cvt_pk_bf16_f32 v255, v250, v251
    s_add_u32 s39, s58, 1048576
    buffer_store_dwordx4 v[252:255], v240, s[24:27], s39 offen sc1
    v_accvgpr_read_b32 v250, a72
    v_accvgpr_read_b32 v251, a73
    s_waitcnt lgkmcnt(5)
    v_mfma_f32_32x32x16_bf16 a[32:47], v[224:227], v[4:7], a[32:47]
    ds_read_b64_tr_b16 v[236:237], v246 offset:9088
    ds_read_b64_tr_b16 v[238:239], v246 offset:11168
    v_cvt_pk_bf16_f32 v204, v250, v251
    v_accvgpr_read_b32 v250, a74
    v_accvgpr_read_b32 v251, a75
    v_mfma_f32_32x32x16_bf16 a[48:63], v[224:227], v[68:71], a[48:63]
    v_cvt_pk_bf16_f32 v205, v250, v251
    v_accvgpr_read_b32 v250, a76
    v_accvgpr_read_b32 v251, a77
    v_cvt_pk_bf16_f32 v206, v250, v251
    v_accvgpr_read_b32 v250, a78
    s_waitcnt lgkmcnt(5)
    v_mfma_f32_32x32x16_bf16 v[208:223], v[228:231], v[196:199], v[208:223]
    ds_read_b64_tr_b16 v[224:225], v248 offset:8320
    ds_read_b64_tr_b16 v[226:227], v248 offset:10400
    ds_read_b128 v[196:199], v245 offset:3072
    v_accvgpr_read_b32 v251, a79
    v_cvt_pk_bf16_f32 v207, v250, v251
    s_waitcnt lgkmcnt(5)
    v_mfma_f32_32x32x16_bf16 a[0:15], v[232:235], v[8:11], a[0:15]
    ds_read_b64_tr_b16 v[228:229], v246 offset:12992
    ds_read_b64_tr_b16 v[230:231], v246 offset:15072
    s_add_u32 s39, s58, 1048576
    buffer_store_dwordx4 v[204:207], v240, s[24:27], s39 offen offset:128 sc1
    v_accvgpr_read_b32 v250, a80
    v_mfma_f32_32x32x16_bf16 a[16:31], v[232:235], v[72:75], a[16:31]
    v_accvgpr_read_b32 v251, a81
    v_cvt_pk_bf16_f32 v252, v250, v251
    v_accvgpr_read_b32 v250, a82
    v_accvgpr_read_b32 v251, a83
    v_cvt_pk_bf16_f32 v253, v250, v251
    v_accvgpr_read_b32 v250, a84
    s_waitcnt lgkmcnt(5)
    v_mfma_f32_32x32x16_bf16 a[32:47], v[236:239], v[8:11], a[32:47]
    ds_read_b64_tr_b16 v[232:233], v246 offset:13248
    ds_read_b64_tr_b16 v[234:235], v246 offset:15328
    v_accvgpr_read_b32 v251, a85
    v_cvt_pk_bf16_f32 v254, v250, v251
    v_mfma_f32_32x32x16_bf16 a[48:63], v[236:239], v[72:75], a[48:63]
    v_accvgpr_read_b32 v250, a86
    v_accvgpr_read_b32 v251, a87
    v_cvt_pk_bf16_f32 v255, v250, v251
    s_add_u32 s39, s58, 1114112
    buffer_store_dwordx4 v[252:255], v240, s[24:27], s39 offen sc1
    v_accvgpr_read_b32 v250, a88
    s_waitcnt lgkmcnt(5)
    v_mfma_f32_32x32x16_bf16 v[208:223], v[224:227], v[192:195], v[208:223]
    ds_read_b64_tr_b16 v[236:237], v248 offset:12480
    ds_read_b64_tr_b16 v[238:239], v248 offset:14560
    ds_read_b128 v[192:195], v245 offset:4096
    v_accvgpr_read_b32 v251, a89
    v_cvt_pk_bf16_f32 v204, v250, v251
    s_waitcnt lgkmcnt(5)
    v_mfma_f32_32x32x16_bf16 a[0:15], v[228:231], v[12:15], a[0:15]
    ds_read_b64_tr_b16 v[224:225], v246 offset:17152
    ds_read_b64_tr_b16 v[226:227], v246 offset:19232
    v_accvgpr_read_b32 v250, a90
    v_accvgpr_read_b32 v251, a91
    v_cvt_pk_bf16_f32 v205, v250, v251
    v_mfma_f32_32x32x16_bf16 a[16:31], v[228:231], v[76:79], a[16:31]
    v_accvgpr_read_b32 v250, a92
    v_accvgpr_read_b32 v251, a93
    v_cvt_pk_bf16_f32 v206, v250, v251
    v_accvgpr_read_b32 v250, a94
    v_accvgpr_read_b32 v251, a95
    s_waitcnt lgkmcnt(5)
    v_mfma_f32_32x32x16_bf16 a[32:47], v[232:235], v[12:15], a[32:47]
    ds_read_b64_tr_b16 v[228:229], v246 offset:17408
    ds_read_b64_tr_b16 v[230:231], v246 offset:19488
    v_cvt_pk_bf16_f32 v207, v250, v251
    s_add_u32 s39, s58, 1114112
    buffer_store_dwordx4 v[204:207], v240, s[24:27], s39 offen offset:128 sc1
    v_mfma_f32_32x32x16_bf16 a[48:63], v[232:235], v[76:79], a[48:63]
    v_accvgpr_read_b32 v250, a96
    v_accvgpr_read_b32 v251, a97
    v_cvt_pk_bf16_f32 v252, v250, v251
    v_accvgpr_read_b32 v250, a98
    v_accvgpr_read_b32 v251, a99
    v_cvt_pk_bf16_f32 v253, v250, v251
    s_waitcnt lgkmcnt(5)
    v_mfma_f32_32x32x16_bf16 v[208:223], v[236:239], v[196:199], v[208:223]
    ds_read_b64_tr_b16 v[232:233], v248 offset:16640
    ds_read_b64_tr_b16 v[234:235], v248 offset:18720
    ds_read_b128 v[196:199], v245 offset:5120
    v_accvgpr_read_b32 v250, a100
    s_waitcnt lgkmcnt(5)
    v_mfma_f32_32x32x16_bf16 a[0:15], v[224:227], v[16:19], a[0:15]
    ds_read_b64_tr_b16 v[236:237], v246 offset:21312
    ds_read_b64_tr_b16 v[238:239], v246 offset:23392
    v_accvgpr_read_b32 v251, a101
    v_cvt_pk_bf16_f32 v254, v250, v251
    v_accvgpr_read_b32 v250, a102
    v_mfma_f32_32x32x16_bf16 a[16:31], v[224:227], v[80:83], a[16:31]
    v_accvgpr_read_b32 v251, a103
    v_cvt_pk_bf16_f32 v255, v250, v251
    s_add_u32 s39, s58, 1048576
    buffer_store_dwordx4 v[252:255], v240, s[24:27], s39 offen offset:256 sc1
    v_accvgpr_read_b32 v250, a104
    v_accvgpr_read_b32 v251, a105
    s_waitcnt lgkmcnt(5)
    v_mfma_f32_32x32x16_bf16 a[32:47], v[228:231], v[16:19], a[32:47]
    ds_read_b64_tr_b16 v[224:225], v246 offset:21568
    ds_read_b64_tr_b16 v[226:227], v246 offset:23648
    v_cvt_pk_bf16_f32 v204, v250, v251
    v_accvgpr_read_b32 v250, a106
    v_accvgpr_read_b32 v251, a107
    v_mfma_f32_32x32x16_bf16 a[48:63], v[228:231], v[80:83], a[48:63]
    v_cvt_pk_bf16_f32 v205, v250, v251
    v_accvgpr_read_b32 v250, a108
    v_accvgpr_read_b32 v251, a109
    v_cvt_pk_bf16_f32 v206, v250, v251
    v_accvgpr_read_b32 v250, a110
    s_waitcnt lgkmcnt(5)
    v_mfma_f32_32x32x16_bf16 v[208:223], v[232:235], v[192:195], v[208:223]
    ds_read_b64_tr_b16 v[228:229], v248 offset:20800
    ds_read_b64_tr_b16 v[230:231], v248 offset:22880
    ds_read_b128 v[192:195], v245 offset:6144
    v_accvgpr_read_b32 v251, a111
    v_cvt_pk_bf16_f32 v207, v250, v251
    s_waitcnt lgkmcnt(5)
    v_mfma_f32_32x32x16_bf16 a[0:15], v[236:239], v[20:23], a[0:15]
    ds_read_b64_tr_b16 v[232:233], v246 offset:25472
    ds_read_b64_tr_b16 v[234:235], v246 offset:27552
    s_add_u32 s39, s58, 1048576
    buffer_store_dwordx4 v[204:207], v240, s[24:27], s39 offen offset:384 sc1
    v_accvgpr_read_b32 v250, a112
    v_mfma_f32_32x32x16_bf16 a[16:31], v[236:239], v[84:87], a[16:31]
    v_accvgpr_read_b32 v251, a113
    v_cvt_pk_bf16_f32 v252, v250, v251
    v_accvgpr_read_b32 v250, a114
    v_accvgpr_read_b32 v251, a115
    v_cvt_pk_bf16_f32 v253, v250, v251
    v_accvgpr_read_b32 v250, a116
    s_waitcnt lgkmcnt(5)
    v_mfma_f32_32x32x16_bf16 a[32:47], v[224:227], v[20:23], a[32:47]
    ds_read_b64_tr_b16 v[236:237], v246 offset:25728
    ds_read_b64_tr_b16 v[238:239], v246 offset:27808
    v_accvgpr_read_b32 v251, a117
    v_cvt_pk_bf16_f32 v254, v250, v251
    v_mfma_f32_32x32x16_bf16 a[48:63], v[224:227], v[84:87], a[48:63]
    v_accvgpr_read_b32 v250, a118
    v_accvgpr_read_b32 v251, a119
    v_cvt_pk_bf16_f32 v255, v250, v251
    s_add_u32 s39, s58, 1114112
    buffer_store_dwordx4 v[252:255], v240, s[24:27], s39 offen offset:256 sc1
    v_accvgpr_read_b32 v250, a120
    s_waitcnt lgkmcnt(5)
    v_mfma_f32_32x32x16_bf16 v[208:223], v[228:231], v[196:199], v[208:223]
    ds_read_b64_tr_b16 v[224:225], v248 offset:24960
    ds_read_b64_tr_b16 v[226:227], v248 offset:27040
    ds_read_b128 v[196:199], v245 offset:7168
    v_accvgpr_read_b32 v251, a121
    v_cvt_pk_bf16_f32 v204, v250, v251
    s_waitcnt lgkmcnt(5)
    v_mfma_f32_32x32x16_bf16 a[0:15], v[232:235], v[24:27], a[0:15]
    ds_read_b64_tr_b16 v[228:229], v246 offset:29632
    ds_read_b64_tr_b16 v[230:231], v246 offset:31712
    v_accvgpr_read_b32 v250, a122
    v_accvgpr_read_b32 v251, a123
    v_cvt_pk_bf16_f32 v205, v250, v251
    v_mfma_f32_32x32x16_bf16 a[16:31], v[232:235], v[88:91], a[16:31]
    v_accvgpr_read_b32 v250, a124
    v_accvgpr_read_b32 v251, a125
    v_cvt_pk_bf16_f32 v206, v250, v251
    v_accvgpr_read_b32 v250, a126
    v_accvgpr_read_b32 v251, a127
    s_waitcnt lgkmcnt(5)
    v_mfma_f32_32x32x16_bf16 a[32:47], v[236:239], v[24:27], a[32:47]
    ds_read_b64_tr_b16 v[232:233], v246 offset:29888
    ds_read_b64_tr_b16 v[234:235], v246 offset:31968
    v_cvt_pk_bf16_f32 v207, v250, v251
    s_add_u32 s39, s58, 1114112
    buffer_store_dwordx4 v[204:207], v240, s[24:27], s39 offen offset:384 sc1
    v_mfma_f32_32x32x16_bf16 a[48:63], v[236:239], v[88:91], a[48:63]
    s_waitcnt vmcnt(15)
    v_lshlrev_b32 v176, 16, v144
    v_and_b32 v177, 0xffff0000, v144
    v_lshlrev_b32 v178, 16, v145
    v_and_b32 v179, 0xffff0000, v145
    v_lshlrev_b32 v180, 16, v146
    v_and_b32 v181, 0xffff0000, v146
    s_waitcnt lgkmcnt(5)
    v_mfma_f32_32x32x16_bf16 v[208:223], v[224:227], v[192:195], v[208:223]
    ds_read_b64_tr_b16 v[236:237], v248 offset:29120
    ds_read_b64_tr_b16 v[238:239], v248 offset:31200
    ds_read_b128 v[192:195], v245 offset:8192
    v_lshlrev_b32 v182, 16, v147
    v_and_b32 v183, 0xffff0000, v147
    s_waitcnt lgkmcnt(5)
    v_mfma_f32_32x32x16_bf16 a[0:15], v[228:231], v[28:31], a[0:15]
    ds_read_b64_tr_b16 v[224:225], v246 offset:33792
    ds_read_b64_tr_b16 v[226:227], v246 offset:35872
    s_waitcnt vmcnt(14)
    v_dot2c_f32_bf16 v176, s32, v148
    v_dot2c_f32_bf16 v177, s33, v148
    v_dot2c_f32_bf16 v178, s32, v149
    v_mfma_f32_32x32x16_bf16 a[16:31], v[228:231], v[92:95], a[16:31]
    v_dot2c_f32_bf16 v179, s33, v149
    v_dot2c_f32_bf16 v180, s32, v150
    v_dot2c_f32_bf16 v181, s33, v150
    v_dot2c_f32_bf16 v182, s32, v151
    v_dot2c_f32_bf16 v183, s33, v151
    s_waitcnt vmcnt(13)
    v_dot2c_f32_bf16 v176, s32, v152
    s_waitcnt lgkmcnt(5)
    v_mfma_f32_32x32x16_bf16 a[32:47], v[232:235], v[28:31], a[32:47]
    ds_read_b64_tr_b16 v[228:229], v246 offset:34048
    ds_read_b64_tr_b16 v[230:231], v246 offset:36128
    v_dot2c_f32_bf16 v177, s33, v152
    v_dot2c_f32_bf16 v178, s32, v153
    v_dot2c_f32_bf16 v179, s33, v153
    v_mfma_f32_32x32x16_bf16 a[48:63], v[232:235], v[92:95], a[48:63]
    v_dot2c_f32_bf16 v180, s32, v154
    v_dot2c_f32_bf16 v181, s33, v154
    v_dot2c_f32_bf16 v182, s32, v155
    v_dot2c_f32_bf16 v183, s33, v155
    s_waitcnt vmcnt(12)
    v_dot2c_f32_bf16 v176, s32, v156
    v_dot2c_f32_bf16 v177, s33, v156
    s_waitcnt lgkmcnt(5)
    v_mfma_f32_32x32x16_bf16 v[208:223], v[236:239], v[196:199], v[208:223]
    ds_read_b64_tr_b16 v[232:233], v248 offset:33280
    ds_read_b64_tr_b16 v[234:235], v248 offset:35360
    ds_read_b128 v[196:199], v245 offset:9216
    v_dot2c_f32_bf16 v178, s32, v157
    v_dot2c_f32_bf16 v179, s33, v157
    s_waitcnt lgkmcnt(5)
    v_mfma_f32_32x32x16_bf16 a[0:15], v[224:227], v[32:35], a[0:15]
    ds_read_b64_tr_b16 v[236:237], v246 offset:37952
    ds_read_b64_tr_b16 v[238:239], v246 offset:40032
    v_dot2c_f32_bf16 v180, s32, v158
    v_dot2c_f32_bf16 v181, s33, v158
    v_dot2c_f32_bf16 v182, s32, v159
    v_mfma_f32_32x32x16_bf16 a[16:31], v[224:227], v[96:99], a[16:31]
    v_dot2c_f32_bf16 v183, s33, v159
    s_waitcnt vmcnt(11)
    v_dot2c_f32_bf16 v176, s32, v160
    v_dot2c_f32_bf16 v177, s33, v160
    v_dot2c_f32_bf16 v178, s32, v161
    v_dot2c_f32_bf16 v179, s33, v161
    v_dot2c_f32_bf16 v180, s32, v162
    s_waitcnt lgkmcnt(5)
    v_mfma_f32_32x32x16_bf16 a[32:47], v[228:231], v[32:35], a[32:47]
    ds_read_b64_tr_b16 v[224:225], v246 offset:38208
    ds_read_b64_tr_b16 v[226:227], v246 offset:40288
    v_dot2c_f32_bf16 v181, s33, v162
    v_dot2c_f32_bf16 v182, s32, v163
    v_mfma_f32_32x32x16_bf16 a[48:63], v[228:231], v[96:99], a[48:63]
    v_dot2c_f32_bf16 v183, s33, v163
    s_waitcnt vmcnt(10)
    v_dot2c_f32_bf16 v176, s32, v164
    v_dot2c_f32_bf16 v177, s33, v164
    v_dot2c_f32_bf16 v178, s32, v165
    v_dot2c_f32_bf16 v179, s33, v165
    v_dot2c_f32_bf16 v180, s32, v166
    s_waitcnt lgkmcnt(5)
    v_mfma_f32_32x32x16_bf16 v[208:223], v[232:235], v[192:195], v[208:223]
    ds_read_b64_tr_b16 v[228:229], v248 offset:37440
    ds_read_b64_tr_b16 v[230:231], v248 offset:39520
    ds_read_b128 v[192:195], v245 offset:10240
    v_dot2c_f32_bf16 v181, s33, v166
    v_dot2c_f32_bf16 v182, s32, v167
    s_waitcnt lgkmcnt(5)
    v_mfma_f32_32x32x16_bf16 a[0:15], v[236:239], v[36:39], a[0:15]
    ds_read_b64_tr_b16 v[232:233], v246 offset:42112
    ds_read_b64_tr_b16 v[234:235], v246 offset:44192
    v_dot2c_f32_bf16 v183, s33, v167
    s_waitcnt vmcnt(9)
    v_dot2c_f32_bf16 v176, s32, v168
    v_dot2c_f32_bf16 v177, s33, v168
    v_mfma_f32_32x32x16_bf16 a[16:31], v[236:239], v[100:103], a[16:31]
    v_dot2c_f32_bf16 v178, s32, v169
    v_dot2c_f32_bf16 v179, s33, v169
    v_dot2c_f32_bf16 v180, s32, v170
    v_dot2c_f32_bf16 v181, s33, v170
    v_dot2c_f32_bf16 v182, s32, v171
    v_dot2c_f32_bf16 v183, s33, v171
    s_waitcnt lgkmcnt(5)
    v_mfma_f32_32x32x16_bf16 a[32:47], v[224:227], v[36:39], a[32:47]
    ds_read_b64_tr_b16 v[236:237], v246 offset:42368
    ds_read_b64_tr_b16 v[238:239], v246 offset:44448
    s_waitcnt vmcnt(8)
    v_dot2c_f32_bf16 v176, s32, v172
    v_dot2c_f32_bf16 v177, s33, v172
    v_dot2c_f32_bf16 v178, s32, v173
    v_mfma_f32_32x32x16_bf16 a[48:63], v[224:227], v[100:103], a[48:63]
    v_dot2c_f32_bf16 v179, s33, v173
    v_dot2c_f32_bf16 v180, s32, v174
    v_dot2c_f32_bf16 v181, s33, v174
    v_dot2c_f32_bf16 v182, s32, v175
    v_dot2c_f32_bf16 v183, s33, v175
    s_nop 2
    s_waitcnt lgkmcnt(5)
    v_mfma_f32_32x32x16_bf16 v[208:223], v[228:231], v[196:199], v[208:223]
    ds_read_b64_tr_b16 v[224:225], v248 offset:41600
    ds_read_b64_tr_b16 v[226:227], v248 offset:43680
    ds_read_b128 v[196:199], v245 offset:11264
    v_permlane32_swap_b32 v176, v180
    v_permlane32_swap_b32 v177, v181
    s_waitcnt lgkmcnt(5)
    v_mfma_f32_32x32x16_bf16 a[0:15], v[232:235], v[40:43], a[0:15]
    ds_read_b64_tr_b16 v[228:229], v246 offset:46272
    ds_read_b64_tr_b16 v[230:231], v246 offset:48352
    v_permlane32_swap_b32 v178, v182
    v_permlane32_swap_b32 v179, v183
    v_add_f32 v176, v176, v180
    v_mfma_f32_32x32x16_bf16 a[16:31], v[232:235], v[104:107], a[16:31]
    v_add_f32 v177, v177, v181
    v_add_f32 v178, v178, v182
    v_add_f32 v179, v179, v183
    v_cvt_pk_bf16_f32 v184, v176, v177
    v_cvt_pk_bf16_f32 v185, v178, v179
    buffer_store_dwordx2 v[184:185], v241, s[92:95], s87 offen
    s_waitcnt lgkmcnt(5)
    v_mfma_f32_32x32x16_bf16 a[32:47], v[236:239], v[40:43], a[32:47]
    ds_read_b64_tr_b16 v[232:233], v246 offset:46528
    ds_read_b64_tr_b16 v[234:235], v246 offset:48608
    buffer_load_dword v186, v242, s[24:27], s91 offen sc1
    v_mfma_f32_32x32x16_bf16 a[48:63], v[236:239], v[104:107], a[48:63]
    s_waitcnt lgkmcnt(5)
    v_mfma_f32_32x32x16_bf16 v[208:223], v[224:227], v[192:195], v[208:223]
    ds_read_b64_tr_b16 v[236:237], v248 offset:45760
    ds_read_b64_tr_b16 v[238:239], v248 offset:47840
    ds_read_b128 v[192:195], v245 offset:12288
    s_waitcnt lgkmcnt(5)
    v_mfma_f32_32x32x16_bf16 a[0:15], v[228:231], v[44:47], a[0:15]
    ds_read_b64_tr_b16 v[224:225], v246 offset:50432
    ds_read_b64_tr_b16 v[226:227], v246 offset:52512
    v_mfma_f32_32x32x16_bf16 a[16:31], v[228:231], v[108:111], a[16:31]
    s_waitcnt lgkmcnt(5)
    v_mfma_f32_32x32x16_bf16 a[32:47], v[232:235], v[44:47], a[32:47]
    ds_read_b64_tr_b16 v[228:229], v246 offset:50688
    ds_read_b64_tr_b16 v[230:231], v246 offset:52768
    v_mfma_f32_32x32x16_bf16 a[48:63], v[232:235], v[108:111], a[48:63]
    s_waitcnt lgkmcnt(5)
    v_mfma_f32_32x32x16_bf16 v[208:223], v[236:239], v[196:199], v[208:223]
    ds_read_b64_tr_b16 v[232:233], v248 offset:49920
    ds_read_b64_tr_b16 v[234:235], v248 offset:52000
    ds_read_b128 v[196:199], v245 offset:13312
    s_waitcnt lgkmcnt(5)
    v_mfma_f32_32x32x16_bf16 a[0:15], v[224:227], v[48:51], a[0:15]
    ds_read_b64_tr_b16 v[236:237], v246 offset:54592
    ds_read_b64_tr_b16 v[238:239], v246 offset:56672
    v_mfma_f32_32x32x16_bf16 a[16:31], v[224:227], v[112:115], a[16:31]
    s_waitcnt lgkmcnt(5)
    v_mfma_f32_32x32x16_bf16 a[32:47], v[228:231], v[48:51], a[32:47]
    ds_read_b64_tr_b16 v[224:225], v246 offset:54848
    ds_read_b64_tr_b16 v[226:227], v246 offset:56928
    v_mfma_f32_32x32x16_bf16 a[48:63], v[228:231], v[112:115], a[48:63]
    s_waitcnt lgkmcnt(5)
    v_mfma_f32_32x32x16_bf16 v[208:223], v[232:235], v[192:195], v[208:223]
    ds_read_b64_tr_b16 v[228:229], v248 offset:54080
    ds_read_b64_tr_b16 v[230:231], v248 offset:56160
    ds_read_b128 v[192:195], v245 offset:14336
    s_waitcnt lgkmcnt(5)
    v_mfma_f32_32x32x16_bf16 a[0:15], v[236:239], v[52:55], a[0:15]
    ds_read_b64_tr_b16 v[232:233], v246 offset:58752
    ds_read_b64_tr_b16 v[234:235], v246 offset:60832
    v_mfma_f32_32x32x16_bf16 a[16:31], v[236:239], v[116:119], a[16:31]
    s_waitcnt lgkmcnt(5)
    v_mfma_f32_32x32x16_bf16 a[32:47], v[224:227], v[52:55], a[32:47]
    ds_read_b64_tr_b16 v[236:237], v246 offset:59008
    ds_read_b64_tr_b16 v[238:239], v246 offset:61088
    v_mfma_f32_32x32x16_bf16 a[48:63], v[224:227], v[116:119], a[48:63]
    s_waitcnt lgkmcnt(5)
    v_mfma_f32_32x32x16_bf16 v[208:223], v[228:231], v[196:199], v[208:223]
    ds_read_b64_tr_b16 v[224:225], v248 offset:58240
    ds_read_b64_tr_b16 v[226:227], v248 offset:60320
    ds_read_b128 v[196:199], v245 offset:15360
    s_waitcnt lgkmcnt(5)
    v_mfma_f32_32x32x16_bf16 a[0:15], v[232:235], v[56:59], a[0:15]
    ds_read_b64_tr_b16 v[228:229], v246 offset:62912
    ds_read_b64_tr_b16 v[230:231], v246 offset:64992
    v_mfma_f32_32x32x16_bf16 a[16:31], v[232:235], v[120:123], a[16:31]
    s_waitcnt lgkmcnt(5)
    v_mfma_f32_32x32x16_bf16 a[32:47], v[236:239], v[56:59], a[32:47]
    ds_read_b64_tr_b16 v[232:233], v246 offset:63168
    ds_read_b64_tr_b16 v[234:235], v246 offset:65248
    v_mfma_f32_32x32x16_bf16 a[48:63], v[236:239], v[120:123], a[48:63]
    s_waitcnt vmcnt(0)
    s_add_u32 s39, s13, 3
    s_mov_b64 exec, 1
    v_mov_b32 v187, s39
    s_cmp_eq_u32 s12, 16
    s_cbranch_scc1 L_arf3
    buffer_store_dword v187, off, s[24:27], s41 sc1
    s_branch L_are3
L_arf3:
    buffer_store_dword v187, off, s[24:27], s41
L_are3:
    s_mov_b64 exec, -1
    s_lshl_b32 s88, s86, 19
    s_add_u32 s88, s88, s37
    s_lshl_b32 s87, s86, 7
    s_add_u32 s87, s87, s42
    v_sub_u32 v186, v186, v243
    v_cmp_lt_u32 vcc, s86, v186
    s_nop 0
    s_cmp_eq_u64 vcc, -1
    s_cselect_b32 s88, s88, 0x7fff0000
    s_cselect_b32 s87, s87, 0x7fff0000
    s_addc_u32 s86, s86, 0
    s_waitcnt lgkmcnt(5)
    v_mfma_f32_32x32x16_bf16 v[208:223], v[224:227], v[192:195], v[208:223]
    ds_read_b64_tr_b16 v[236:237], v248 offset:62400
    ds_read_b64_tr_b16 v[238:239], v248 offset:64480
    buffer_load_dwordx4 v[144:147], v245, s[24:27], s88 offen sc1
    buffer_load_dwordx4 v[148:151], v245, s[24:27], s88 offen offset:1024 sc1
    s_waitcnt lgkmcnt(4)
    v_mfma_f32_32x32x16_bf16 a[0:15], v[228:231], v[60:63], a[0:15]
    buffer_load_dwordx4 v[152:155], v245, s[24:27], s88 offen offset:2048 sc1
    buffer_load_dwordx4 v[156:159], v245, s[24:27], s88 offen offset:3072 sc1
    v_mfma_f32_32x32x16_bf16 a[16:31], v[228:231], v[124:127], a[16:31]
    s_add_u32 s88, s88, 4096
    buffer_load_dwordx4 v[160:163], v245, s[24:27], s88 offen sc1
    s_waitcnt lgkmcnt(2)
    v_mfma_f32_32x32x16_bf16 a[32:47], v[232:235], v[60:63], a[32:47]
    buffer_load_dwordx4 v[164:167], v245, s[24:27], s88 offen offset:1024 sc1
    buffer_load_dwordx4 v[168:171], v245, s[24:27], s88 offen offset:2048 sc1
    v_mfma_f32_32x32x16_bf16 a[48:63], v[232:235], v[124:127], a[48:63]
    buffer_load_dwordx4 v[172:175], v245, s[24:27], s88 offen offset:3072 sc1
    s_waitcnt lgkmcnt(0)
    v_mfma_f32_32x32x16_bf16 v[208:223], v[236:239], v[196:199], v[208:223]
    s_barrier
    ds_read_b64_tr_b16 v[224:225], v244
    ds_read_b64_tr_b16 v[226:227], v244 offset:2080
    ds_read_b64_tr_b16 v[228:229], v244 offset:256
    ds_read_b64_tr_b16 v[230:231], v244 offset:2336
    ds_read_b64_tr_b16 v[232:233], v244 offset:4160
    ds_read_b64_tr_b16 v[234:235], v244 offset:6240
    s_waitcnt lgkmcnt(4)
    v_mfma_f32_32x32x16_bf16 a[64:79], v[224:227], v[0:3], 0
    ds_read_b64_tr_b16 v[236:237], v244 offset:4416
    ds_read_b64_tr_b16 v[238:239], v244 offset:6496
    s_add_u32 s40, s34, 91136
    v_add_u32 v191, s40, v245
    v_mfma_f32_32x32x16_bf16 a[80:95], v[224:227], v[64:67], 0
    s_waitcnt lgkmcnt(4)
    v_mfma_f32_32x32x16_bf16 a[96:111], v[228:231], v[0:3], 0
    ds_read_b64_tr_b16 v[224:225], v244 offset:8320
    ds_read_b64_tr_b16 v[226:227], v244 offset:10400
    v_mfma_f32_32x32x16_bf16 a[112:127], v[228:231], v[64:67], 0
    v_accvgpr_read_b32 v250, a0
    v_accvgpr_read_b32 v251, a1
    v_cvt_pk_bf16_f32 v252, v250, v251
    v_accvgpr_read_b32 v250, a2
    v_accvgpr_read_b32 v251, a3
    v_cvt_pk_bf16_f32 v253, v250, v251
    v_accvgpr_read_b32 v250, a4
    s_waitcnt lgkmcnt(4)
    v_mfma_f32_32x32x16_bf16 a[64:79], v[232:235], v[4:7], a[64:79]
    ds_read_b64_tr_b16 v[228:229], v244 offset:8576
    ds_read_b64_tr_b16 v[230:231], v244 offset:10656
    v_accvgpr_read_b32 v251, a5
    v_cvt_pk_bf16_f32 v254, v250, v251
    v_accvgpr_read_b32 v250, a6
    v_accvgpr_read_b32 v251, a7
    v_mfma_f32_32x32x16_bf16 a[80:95], v[232:235], v[68:71], a[80:95]
    v_cvt_pk_bf16_f32 v255, v250, v251
    s_add_u32 s39, s58, 1572864
    buffer_store_dwordx4 v[252:255], v240, s[24:27], s39 offen sc1
    v_accvgpr_read_b32 v250, a8
    v_accvgpr_read_b32 v251, a9
    v_cvt_pk_bf16_f32 v204, v250, v251
    v_accvgpr_read_b32 v250, a10
    s_waitcnt lgkmcnt(4)
    v_mfma_f32_32x32x16_bf16 a[96:111], v[236:239], v[4:7], a[96:111]
    ds_read_b64_tr_b16 v[232:233], v244 offset:12480
    ds_read_b64_tr_b16 v[234:235], v244 offset:14560
    v_accvgpr_read_b32 v251, a11
    v_cvt_pk_bf16_f32 v205, v250, v251
    v_accvgpr_read_b32 v250, a12
    v_mfma_f32_32x32x16_bf16 a[112:127], v[236:239], v[68:71], a[112:127]
    v_accvgpr_read_b32 v251, a13
    v_cvt_pk_bf16_f32 v206, v250, v251
    v_accvgpr_read_b32 v250, a14
    v_accvgpr_read_b32 v251, a15
    v_cvt_pk_bf16_f32 v207, v250, v251
    s_add_u32 s39, s58, 1572864
    buffer_store_dwordx4 v[204:207], v240, s[24:27], s39 offen offset:128 sc1
    s_waitcnt lgkmcnt(4)
    v_mfma_f32_32x32x16_bf16 a[64:79], v[224:227], v[8:11], a[64:79]
    ds_read_b64_tr_b16 v[236:237], v244 offset:12736
    ds_read_b64_tr_b16 v[238:239], v244 offset:14816
    v_accvgpr_read_b32 v250, a16
    v_accvgpr_read_b32 v251, a17
    v_cvt_pk_bf16_f32 v252, v250, v251
    v_accvgpr_read_b32 v250, a18
    v_mfma_f32_32x32x16_bf16 a[80:95], v[224:227], v[72:75], a[80:95]
    v_accvgpr_read_b32 v251, a19
    v_cvt_pk_bf16_f32 v253, v250, v251
    v_accvgpr_read_b32 v250, a20
    v_accvgpr_read_b32 v251, a21
    v_cvt_pk_bf16_f32 v254, v250, v251
    v_accvgpr_read_b32 v250, a22
    v_accvgpr_read_b32 v251, a23
    s_waitcnt lgkmcnt(4)
    v_mfma_f32_32x32x16_bf16 a[96:111], v[228:231], v[8:11], a[96:111]
    ds_read_b64_tr_b16 v[224:225], v244 offset:16640
    ds_read_b64_tr_b16 v[226:227], v244 offset:18720
    v_cvt_pk_bf16_f32 v255, v250, v251
    s_add_u32 s39, s58, 1638400
    buffer_store_dwordx4 v[252:255], v240, s[24:27], s39 offen sc1
    v_accvgpr_read_b32 v250, a24
    v_mfma_f32_32x32x16_bf16 a[112:127], v[228:231], v[72:75], a[112:127]
    v_accvgpr_read_b32 v251, a25
    v_cvt_pk_bf16_f32 v204, v250, v251
    v_accvgpr_read_b32 v250, a26
    v_accvgpr_read_b32 v251, a27
    v_cvt_pk_bf16_f32 v205, v250, v251
    v_accvgpr_read_b32 v250, a28
    v_accvgpr_read_b32 v251, a29
    s_waitcnt lgkmcnt(4)
    v_mfma_f32_32x32x16_bf16 a[64:79], v[232:235], v[12:15], a[64:79]
    ds_read_b64_tr_b16 v[228:229], v244 offset:16896
    ds_read_b64_tr_b16 v[230:231], v244 offset:18976
    v_cvt_pk_bf16_f32 v206, v250, v251
    v_accvgpr_read_b32 v250, a30
    v_accvgpr_read_b32 v251, a31
    v_mfma_f32_32x32x16_bf16 a[80:95], v[232:235], v[76:79], a[80:95]
    v_cvt_pk_bf16_f32 v207, v250, v251
    s_add_u32 s39, s58, 1638400
    buffer_store_dwordx4 v[204:207], v240, s[24:27], s39 offen offset:128 sc1
    v_accvgpr_read_b32 v250, a32
    v_accvgpr_read_b32 v251, a33
    v_cvt_pk_bf16_f32 v252, v250, v251
    v_accvgpr_read_b32 v250, a34
    s_waitcnt lgkmcnt(4)
    v_mfma_f32_32x32x16_bf16 a[96:111], v[236:239], v[12:15], a[96:111]
    ds_read_b64_tr_b16 v[232:233], v244 offset:20800
    ds_read_b64_tr_b16 v[234:235], v244 offset:22880
    v_accvgpr_read_b32 v251, a35
    v_cvt_pk_bf16_f32 v253, v250, v251
    v_accvgpr_read_b32 v250, a36
    v_accvgpr_read_b32 v251, a37
    v_mfma_f32_32x32x16_bf16 a[112:127], v[236:239], v[76:79], a[112:127]
    v_cvt_pk_bf16_f32 v254, v250, v251
    v_accvgpr_read_b32 v250, a38
    v_accvgpr_read_b32 v251, a39
    v_cvt_pk_bf16_f32 v255, v250, v251
    s_add_u32 s39, s58, 1572864
    buffer_store_dwordx4 v[252:255], v240, s[24:27], s39 offen offset:256 sc1
    v_accvgpr_read_b32 v250, a40
    s_waitcnt lgkmcnt(4)
    v_mfma_f32_32x32x16_bf16 a[64:79], v[224:227], v[16:19], a[64:79]
    ds_read_b64_tr_b16 v[236:237], v244 offset:21056
    ds_read_b64_tr_b16 v[238:239], v244 offset:23136
    v_accvgpr_read_b32 v251, a41
    v_cvt_pk_bf16_f32 v204, v250, v251
    v_accvgpr_read_b32 v250, a42
    v_mfma_f32_32x32x16_bf16 a[80:95], v[224:227], v[80:83], a[80:95]
    v_accvgpr_read_b32 v251, a43
    v_cvt_pk_bf16_f32 v205, v250, v251
    v_accvgpr_read_b32 v250, a44
    v_accvgpr_read_b32 v251, a45
    v_cvt_pk_bf16_f32 v206, v250, v251
    v_accvgpr_read_b32 v250, a46
    v_accvgpr_read_b32 v251, a47
    s_waitcnt lgkmcnt(4)
    v_mfma_f32_32x32x16_bf16 a[96:111], v[228:231], v[16:19], a[96:111]
    ds_read_b64_tr_b16 v[224:225], v244 offset:24960
    ds_read_b64_tr_b16 v[226:227], v244 offset:27040
    v_cvt_pk_bf16_f32 v207, v250, v251
    s_add_u32 s39, s58, 1572864
    buffer_store_dwordx4 v[204:207], v240, s[24:27], s39 offen offset:384 sc1
    v_accvgpr_read_b32 v250, a48
    v_mfma_f32_32x32x16_bf16 a[112:127], v[228:231], v[80:83], a[112:127]
    v_accvgpr_read_b32 v251, a49
    v_cvt_pk_bf16_f32 v252, v250, v251
    v_accvgpr_read_b32 v250, a50
    v_accvgpr_read_b32 v251, a51
    v_cvt_pk_bf16_f32 v253, v250, v251
    v_accvgpr_read_b32 v250, a52
    v_accvgpr_read_b32 v251, a53
    s_waitcnt lgkmcnt(4)
    v_mfma_f32_32x32x16_bf16 a[64:79], v[232:235], v[20:23], a[64:79]
    ds_read_b64_tr_b16 v[228:229], v244 offset:25216
    ds_read_b64_tr_b16 v[230:231], v244 offset:27296
    v_cvt_pk_bf16_f32 v254, v250, v251
    v_accvgpr_read_b32 v250, a54
    v_accvgpr_read_b32 v251, a55
    v_cvt_pk_bf16_f32 v255, v250, v251
    v_mfma_f32_32x32x16_bf16 a[80:95], v[232:235], v[84:87], a[80:95]
    s_add_u32 s39, s58, 1638400
    buffer_store_dwordx4 v[252:255], v240, s[24:27], s39 offen offset:256 sc1
    v_accvgpr_read_b32 v250, a56
    v_accvgpr_read_b32 v251, a57
    v_cvt_pk_bf16_f32 v204, v250, v251
    v_accvgpr_read_b32 v250, a58
    v_accvgpr_read_b32 v251, a59
    s_waitcnt lgkmcnt(4)
    v_mfma_f32_32x32x16_bf16 a[96:111], v[236:239], v[20:23], a[96:111]
    ds_read_b64_tr_b16 v[232:233], v244 offset:29120
    ds_read_b64_tr_b16 v[234:235], v244 offset:31200
    v_cvt_pk_bf16_f32 v205, v250, v251
    v_accvgpr_read_b32 v250, a60
    v_accvgpr_read_b32 v251, a61
    v_mfma_f32_32x32x16_bf16 a[112:127], v[236:239], v[84:87], a[112:127]
    v_cvt_pk_bf16_f32 v206, v250, v251
    v_accvgpr_read_b32 v250, a62
    v_accvgpr_read_b32 v251, a63
    v_cvt_pk_bf16_f32 v207, v250, v251
    s_add_u32 s39, s58, 1638400
    buffer_store_dwordx4 v[204:207], v240, s[24:27], s39 offen offset:384 sc1
    v_cvt_pk_bf16_f32 v252, v208, v209
    s_waitcnt lgkmcnt(4)
    v_mfma_f32_32x32x16_bf16 a[64:79], v[224:227], v[24:27], a[64:79]
    ds_read_b64_tr_b16 v[236:237], v244 offset:29376
    ds_read_b64_tr_b16 v[238:239], v244 offset:31456
    v_cvt_pk_bf16_f32 v253, v210, v211
    v_cvt_pk_bf16_f32 v254, v212, v213
    v_cvt_pk_bf16_f32 v255, v214, v215
    v_mfma_f32_32x32x16_bf16 a[80:95], v[224:227], v[88:91], a[80:95]
    s_add_u32 s39, s50, 131072
    buffer_store_dwordx4 v[252:255], v240, s[24:27], s39 offen sc1
    v_cvt_pk_bf16_f32 v204, v216, v217
    v_cvt_pk_bf16_f32 v205, v218, v219
    v_cvt_pk_bf16_f32 v206, v220, v221
    v_cvt_pk_bf16_f32 v207, v222, v223
    s_add_u32 s39, s50, 131072
    buffer_store_dwordx4 v[204:207], v240, s[24:27], s39 offen offset:128 sc1
    s_waitcnt lgkmcnt(4)
    v_mfma_f32_32x32x16_bf16 a[96:111], v[228:231], v[24:27], a[96:111]
    ds_read_b64_tr_b16 v[224:225], v244 offset:33280
    ds_read_b64_tr_b16 v[226:227], v244 offset:35360
    s_waitcnt vmcnt(17)
    v_lshlrev_b32 v176, 16, v144
    v_and_b32 v177, 0xffff0000, v144
    v_lshlrev_b32 v178, 16, v145
    v_mfma_f32_32x32x16_bf16 a[112:127], v[228:231], v[88:91], a[112:127]
    v_and_b32 v179, 0xffff0000, v145
    v_lshlrev_b32 v180, 16, v146
    v_and_b32 v181, 0xffff0000, v146
    v_lshlrev_b32 v182, 16, v147
    v_and_b32 v183, 0xffff0000, v147
    s_waitcnt vmcnt(16)
    v_dot2c_f32_bf16 v176, s32, v148
    v_dot2c_f32_bf16 v177, s33, v148
    s_waitcnt lgkmcnt(4)
    v_mfma_f32_32x32x16_bf16 a[64:79], v[232:235], v[28:31], a[64:79]
    ds_read_b64_tr_b16 v[228:229], v244 offset:33536
    ds_read_b64_tr_b16 v[230:231], v244 offset:35616
    v_dot2c_f32_bf16 v178, s32, v149
    v_dot2c_f32_bf16 v179, s33, v149
    v_dot2c_f32_bf16 v180, s32, v150
    v_dot2c_f32_bf16 v181, s33, v150
    v_mfma_f32_32x32x16_bf16 a[80:95], v[232:235], v[92:95], a[80:95]
    v_dot2c_f32_bf16 v182, s32, v151
    v_dot2c_f32_bf16 v183, s33, v151
    s_waitcnt vmcnt(15)
    v_dot2c_f32_bf16 v176, s32, v152
    v_dot2c_f32_bf16 v177, s33, v152
    v_dot2c_f32_bf16 v178, s32, v153
    v_dot2c_f32_bf16 v179, s33, v153
    v_dot2c_f32_bf16 v180, s32, v154
    s_waitcnt lgkmcnt(4)
    v_mfma_f32_32x32x16_bf16 a[96:111], v[236:239], v[28:31], a[96:111]
    ds_read_b64_tr_b16 v[232:233], v244 offset:37440
    ds_read_b64_tr_b16 v[234:235], v244 offset:39520
    v_dot2c_f32_bf16 v181, s33, v154
    v_dot2c_f32_bf16 v182, s32, v155
    v_dot2c_f32_bf16 v183, s33, v155
    v_mfma_f32_32x32x16_bf16 a[112:127], v[236:239], v[92:95], a[112:127]
    s_waitcnt vmcnt(14)
    v_dot2c_f32_bf16 v176, s32, v156
    v_dot2c_f32_bf16 v177, s33, v156
    v_dot2c_f32_bf16 v178, s32, v157
    v_dot2c_f32_bf16 v179, s33, v157
    v_dot2c_f32_bf16 v180, s32, v158
    v_dot2c_f32_bf16 v181, s33, v158
    v_dot2c_f32_bf16 v182, s32, v159
    s_waitcnt lgkmcnt(4)
    v_mfma_f32_32x32x16_bf16 a[64:79], v[224:227], v[32:35], a[64:79]
    ds_read_b64_tr_b16 v[236:237], v244 offset:37696
    ds_read_b64_tr_b16 v[238:239], v244 offset:39776
    v_dot2c_f32_bf16 v183, s33, v159
    s_waitcnt vmcnt(13)
    v_dot2c_f32_bf16 v176, s32, v160
    v_dot2c_f32_bf16 v177, s33, v160
    v_dot2c_f32_bf16 v178, s32, v161
    v_mfma_f32_32x32x16_bf16 a[80:95], v[224:227], v[96:99], a[80:95]
    v_dot2c_f32_bf16 v179, s33, v161
    v_dot2c_f32_bf16 v180, s32, v162
    v_dot2c_f32_bf16 v181, s33, v162
    v_dot2c_f32_bf16 v182, s32, v163
    v_dot2c_f32_bf16 v183, s33, v163
    s_waitcnt vmcnt(12)
    v_dot2c_f32_bf16 v176, s32, v164
    s_waitcnt lgkmcnt(4)
    v_mfma_f32_32x32x16_bf16 a[96:111], v[228:231], v[32:35], a[96:111]
    ds_read_b64_tr_b16 v[224:225], v244 offset:41600
    ds_read_b64_tr_b16 v[226:227], v244 offset:43680
    v_dot2c_f32_bf16 v177, s33, v164
    v_dot2c_f32_bf16 v178, s32, v165
    v_dot2c_f32_bf16 v179, s33, v165
    v_dot2c_f32_bf16 v180, s32, v166
    v_mfma_f32_32x32x16_bf16 a[112:127], v[228:231], v[96:99], a[112:127]
    v_dot2c_f32_bf16 v181, s33, v166
    v_dot2c_f32_bf16 v182, s32, v167
    v_dot2c_f32_bf16 v183, s33, v167
    s_waitcnt vmcnt(11)
    v_dot2c_f32_bf16 v176, s32, v168
    v_dot2c_f32_bf16 v177, s33, v168
    v_dot2c_f32_bf16 v178, s32, v169
    v_dot2c_f32_bf16 v179, s33, v169
    s_waitcnt lgkmcnt(4)
    v_mfma_f32_32x32x16_bf16 a[64:79], v[232:235], v[36:39], a[64:79]
    ds_read_b64_tr_b16 v[228:229], v244 offset:41856
    ds_read_b64_tr_b16 v[230:231], v244 offset:43936
    v_dot2c_f32_bf16 v180, s32, v170
    v_dot2c_f32_bf16 v181, s33, v170
    v_dot2c_f32_bf16 v182, s32, v171
    v_mfma_f32_32x32x16_bf16 a[80:95], v[232:235], v[100:103], a[80:95]
    v_dot2c_f32_bf16 v183, s33, v171
    s_waitcnt vmcnt(10)
    v_dot2c_f32_bf16 v176, s32, v172
    v_dot2c_f32_bf16 v177, s33, v172
    v_dot2c_f32_bf16 v178, s32, v173
    v_dot2c_f32_bf16 v179, s33, v173
    v_dot2c_f32_bf16 v180, s32, v174
    v_dot2c_f32_bf16 v181, s33, v174
    s_waitcnt lgkmcnt(4)
    v_mfma_f32_32x32x16_bf16 a[96:111], v[236:239], v[36:39], a[96:111]
    ds_read_b64_tr_b16 v[232:233], v244 offset:45760
    ds_read_b64_tr_b16 v[234:235], v244 offset:47840
    v_dot2c_f32_bf16 v182, s32, v175
    v_dot2c_f32_bf16 v183, s33, v175
    s_nop 2
    v_permlane32_swap_b32 v176, v180
    v_mfma_f32_32x32x16_bf16 a[112:127], v[236:239], v[100:103], a[112:127]
    v_permlane32_swap_b32 v177, v181
    v_permlane32_swap_b32 v178, v182
    v_permlane32_swap_b32 v179, v183
    v_add_f32 v176, v176, v180
    v_add_f32 v177, v177, v181
    v_add_f32 v178, v178, v182
    v_add_f32 v179, v179, v183
    s_waitcnt lgkmcnt(4)
    v_mfma_f32_32x32x16_bf16 a[64:79], v[224:227], v[40:43], a[64:79]
    ds_read_b64_tr_b16 v[236:237], v244 offset:46016
    ds_read_b64_tr_b16 v[238:239], v244 offset:48096
    v_cvt_pk_bf16_f32 v184, v176, v177
    v_cvt_pk_bf16_f32 v185, v178, v179
    buffer_store_dwordx2 v[184:185], v241, s[92:95], s87 offen
    v_mfma_f32_32x32x16_bf16 a[80:95], v[224:227], v[104:107], a[80:95]
    buffer_load_dword v186, v242, s[24:27], s91 offen sc1
    s_waitcnt lgkmcnt(4)
    v_mfma_f32_32x32x16_bf16 a[96:111], v[228:231], v[40:43], a[96:111]
    ds_read_b64_tr_b16 v[224:225], v244 offset:49920
    ds_read_b64_tr_b16 v[226:227], v244 offset:52000
    ds_write_b128 v191, a[192:195]
    v_mfma_f32_32x32x16_bf16 a[112:127], v[228:231], v[104:107], a[112:127]
    ds_write_b128 v191, a[196:199] offset:1040
    s_waitcnt lgkmcnt(6)
    v_mfma_f32_32x32x16_bf16 a[64:79], v[232:235], v[44:47], a[64:79]
    ds_read_b64_tr_b16 v[228:229], v244 offset:50176
    ds_read_b64_tr_b16 v[230:231], v244 offset:52256
    ds_write_b128 v191, a[200:203] offset:2080
    v_mfma_f32_32x32x16_bf16 a[80:95], v[232:235], v[108:111], a[80:95]
    ds_write_b128 v191, a[204:207] offset:3120
    s_waitcnt lgkmcnt(8)
    v_mfma_f32_32x32x16_bf16 a[96:111], v[236:239], v[44:47], a[96:111]
    ds_read_b64_tr_b16 v[232:233], v244 offset:54080
    ds_read_b64_tr_b16 v[234:235], v244 offset:56160
    ds_write_b128 v191, a[208:211] offset:16640
    v_mfma_f32_32x32x16_bf16 a[112:127], v[236:239], v[108:111], a[112:127]
    ds_write_b128 v191, a[212:215] offset:17680
    s_waitcnt lgkmcnt(10)
    v_mfma_f32_32x32x16_bf16 a[64:79], v[224:227], v[48:51], a[64:79]
    ds_read_b64_tr_b16 v[236:237], v244 offset:54336
    ds_read_b64_tr_b16 v[238:239], v244 offset:56416
    ds_write_b128 v191, a[216:219] offset:18720
    v_mfma_f32_32x32x16_bf16 a[80:95], v[224:227], v[112:115], a[80:95]
    ds_write_b128 v191, a[220:223] offset:19760
    s_waitcnt lgkmcnt(10)
    v_mfma_f32_32x32x16_bf16 a[96:111], v[228:231], v[48:51], a[96:111]
    ds_read_b64_tr_b16 v[224:225], v244 offset:58240
    ds_read_b64_tr_b16 v[226:227], v244 offset:60320
    ds_write_b128 v191, a[224:227] offset:33280
    v_mfma_f32_32x32x16_bf16 a[112:127], v[228:231], v[112:115], a[112:127]
    ds_write_b128 v191, a[228:231] offset:34320
    s_waitcnt lgkmcnt(10)
    v_mfma_f32_32x32x16_bf16 a[64:79], v[232:235], v[52:55], a[64:79]
    ds_read_b64_tr_b16 v[228:229], v244 offset:58496
    ds_read_b64_tr_b16 v[230:231], v244 offset:60576
    ds_write_b128 v191, a[232:235] offset:35360
    v_mfma_f32_32x32x16_bf16 a[80:95], v[232:235], v[116:119], a[80:95]
    ds_write_b128 v191, a[236:239] offset:36400
    s_waitcnt lgkmcnt(10)
    v_mfma_f32_32x32x16_bf16 a[96:111], v[236:239], v[52:55], a[96:111]
    ds_read_b64_tr_b16 v[232:233], v244 offset:62400
    ds_read_b64_tr_b16 v[234:235], v244 offset:64480
    ds_write_b128 v191, a[240:243] offset:49920
    v_mfma_f32_32x32x16_bf16 a[112:127], v[236:239], v[116:119], a[112:127]
    ds_write_b128 v191, a[244:247] offset:50960
    s_waitcnt lgkmcnt(10)
    v_mfma_f32_32x32x16_bf16 a[64:79], v[224:227], v[56:59], a[64:79]
    ds_read_b64_tr_b16 v[236:237], v244 offset:62656
    ds_read_b64_tr_b16 v[238:239], v244 offset:64736
    ds_write_b128 v191, a[248:251] offset:52000
    v_mfma_f32_32x32x16_bf16 a[80:95], v[224:227], v[120:123], a[80:95]
    ds_write_b128 v191, a[252:255] offset:53040
    s_waitcnt lgkmcnt(10)
    v_mfma_f32_32x32x16_bf16 a[96:111], v[228:231], v[56:59], a[96:111]
    s_waitcnt vmcnt(0)
    s_add_u32 s39, s13, 4
    s_mov_b64 exec, 1
    v_mov_b32 v187, s39
    s_cmp_eq_u32 s12, 16
    s_cbranch_scc1 L_arf4
    buffer_store_dword v187, off, s[24:27], s41 sc1
    s_branch L_are4
L_arf4:
    buffer_store_dword v187, off, s[24:27], s41
L_are4:
    s_mov_b64 exec, -1
    s_lshl_b32 s88, s86, 19
    s_add_u32 s88, s88, s37
    s_lshl_b32 s87, s86, 7
    s_add_u32 s87, s87, s42
    v_sub_u32 v186, v186, v243
    v_cmp_lt_u32 vcc, s86, v186
    s_nop 0
    s_cmp_eq_u64 vcc, -1
    s_cselect_b32 s88, s88, 0x7fff0000
    s_cselect_b32 s87, s87, 0x7fff0000
    s_addc_u32 s86, s86, 0
    v_mfma_f32_32x32x16_bf16 a[112:127], v[228:231], v[120:123], a[112:127]
    buffer_load_dwordx4 v[144:147], v245, s[24:27], s88 offen sc1
    buffer_load_dwordx4 v[148:151], v245, s[24:27], s88 offen offset:1024 sc1
    s_waitcnt lgkmcnt(6)
    v_mfma_f32_32x32x16_bf16 a[64:79], v[232:235], v[60:63], a[64:79]
    buffer_load_dwordx4 v[152:155], v245, s[24:27], s88 offen offset:2048 sc1
    buffer_load_dwordx4 v[156:159], v245, s[24:27], s88 offen offset:3072 sc1
    v_mfma_f32_32x32x16_bf16 a[80:95], v[232:235], v[124:127], a[80:95]
    s_add_u32 s88, s88, 4096
    buffer_load_dwordx4 v[160:163], v245, s[24:27], s88 offen sc1
    s_waitcnt lgkmcnt(2)
    v_mfma_f32_32x32x16_bf16 a[96:111], v[236:239], v[60:63], a[96:111]
    buffer_load_dwordx4 v[164:167], v245, s[24:27], s88 offen offset:1024 sc1
    buffer_load_dwordx4 v[168:171], v245, s[24:27], s88 offen offset:2048 sc1
    v_mfma_f32_32x32x16_bf16 a[112:127], v[236:239], v[124:127], a[112:127]
    buffer_load_dwordx4 v[172:175], v245, s[24:27], s88 offen offset:3072 sc1
    ds_read_b64_tr_b16 v[224:225], v244 offset:512
    ds_read_b64_tr_b16 v[226:227], v244 offset:2592
    ds_read_b64_tr_b16 v[228:229], v244 offset:768
    ds_read_b64_tr_b16 v[230:231], v244 offset:2848
    ds_read_b64_tr_b16 v[232:233], v247
    ds_read_b64_tr_b16 v[234:235], v247 offset:2080
    ds_read_b128 v[192:195], v245
    ds_read_b128 v[196:199], v245 offset:1024
    s_waitcnt lgkmcnt(6)
    v_mfma_f32_32x32x16_bf16 a[0:15], v[224:227], v[0:3], 0
    ds_read_b64_tr_b16 v[236:237], v244 offset:4672
    ds_read_b64_tr_b16 v[238:239], v244 offset:6752
    v_mfma_f32_32x32x16_bf16 a[16:31], v[224:227], v[64:67], 0
    s_waitcnt lgkmcnt(6)
    v_mfma_f32_32x32x16_bf16 a[32:47], v[228:231], v[0:3], 0
    ds_read_b64_tr_b16 v[224:225], v244 offset:4928
    ds_read_b64_tr_b16 v[226:227], v244 offset:7008
    v_mfma_f32_32x32x16_bf16 a[48:63], v[228:231], v[64:67], 0
    v_accvgpr_read_b32 v250, a64
    v_accvgpr_read_b32 v251, a65
    v_cvt_pk_bf16_f32 v252, v250, v251
    v_accvgpr_read_b32 v250, a66
    v_accvgpr_read_b32 v251, a67
    v_cvt_pk_bf16_f32 v253, v250, v251
    s_waitcnt lgkmcnt(5)
    v_mfma_f32_32x32x16_bf16 v[208:223], v[232:235], v[192:195], 0
    ds_read_b64_tr_b16 v[228:229], v247 offset:4160
    ds_read_b64_tr_b16 v[230:231], v247 offset:6240
    ds_read_b128 v[192:195], v245 offset:2048
    v_accvgpr_read_b32 v250, a68
    s_waitcnt lgkmcnt(5)
    v_mfma_f32_32x32x16_bf16 a[0:15], v[236:239], v[4:7], a[0:15]
    ds_read_b64_tr_b16 v[232:233], v244 offset:8832
    ds_read_b64_tr_b16 v[234:235], v244 offset:10912
    v_accvgpr_read_b32 v251, a69
    v_cvt_pk_bf16_f32 v254, v250, v251
    v_accvgpr_read_b32 v250, a70
    v_mfma_f32_32x32x16_bf16 a[16:31], v[236:239], v[68:71], a[16:31]
    v_accvgpr_read_b32 v251, a71
    v_cvt_pk_bf16_f32 v255, v250, v251
    s_add_u32 s39, s58, 2097152
    buffer_store_dwordx4 v[252:255], v240, s[24:27], s39 offen sc1
    v_accvgpr_read_b32 v250, a72
    v_accvgpr_read_b32 v251, a73
    s_waitcnt lgkmcnt(5)
    v_mfma_f32_32x32x16_bf16 a[32:47], v[224:227], v[4:7], a[32:47]
    ds_read_b64_tr_b16 v[236:237], v244 offset:9088
    ds_read_b64_tr_b16 v[238:239], v244 offset:11168
    v_cvt_pk_bf16_f32 v204, v250, v251
    v_accvgpr_read_b32 v250, a74
    v_accvgpr_read_b32 v251, a75
    v_mfma_f32_32x32x16_bf16 a[48:63], v[224:227], v[68:71], a[48:63]
    v_cvt_pk_bf16_f32 v205, v250, v251
    v_accvgpr_read_b32 v250, a76
    v_accvgpr_read_b32 v251, a77
    v_cvt_pk_bf16_f32 v206, v250, v251
    v_accvgpr_read_b32 v250, a78
    s_waitcnt lgkmcnt(5)
    v_mfma_f32_32x32x16_bf16 v[208:223], v[228:231], v[196:199], v[208:223]
    ds_read_b64_tr_b16 v[224:225], v247 offset:8320
    ds_read_b64_tr_b16 v[226:227], v247 offset:10400
    ds_read_b128 v[196:199], v245 offset:3072
    v_accvgpr_read_b32 v251, a79
    v_cvt_pk_bf16_f32 v207, v250, v251
    s_waitcnt lgkmcnt(5)
    v_mfma_f32_32x32x16_bf16 a[0:15], v[232:235], v[8:11], a[0:15]
    ds_read_b64_tr_b16 v[228:229], v244 offset:12992
    ds_read_b64_tr_b16 v[230:231], v244 offset:15072
    s_add_u32 s39, s58, 2097152
    buffer_store_dwordx4 v[204:207], v240, s[24:27], s39 offen offset:128 sc1
    v_accvgpr_read_b32 v250, a80
    v_mfma_f32_32x32x16_bf16 a[16:31], v[232:235], v[72:75], a[16:31]
    v_accvgpr_read_b32 v251, a81
    v_cvt_pk_bf16_f32 v252, v250, v251
    v_accvgpr_read_b32 v250, a82
    v_accvgpr_read_b32 v251, a83
    v_cvt_pk_bf16_f32 v253, v250, v251
    v_accvgpr_read_b32 v250, a84
    s_waitcnt lgkmcnt(5)
    v_mfma_f32_32x32x16_bf16 a[32:47], v[236:239], v[8:11], a[32:47]
    ds_read_b64_tr_b16 v[232:233], v244 offset:13248
    ds_read_b64_tr_b16 v[234:235], v244 offset:15328
    v_accvgpr_read_b32 v251, a85
    v_cvt_pk_bf16_f32 v254, v250, v251
    v_mfma_f32_32x32x16_bf16 a[48:63], v[236:239], v[72:75], a[48:63]
    v_accvgpr_read_b32 v250, a86
    v_accvgpr_read_b32 v251, a87
    v_cvt_pk_bf16_f32 v255, v250, v251
    s_add_u32 s39, s58, 2162688
    buffer_store_dwordx4 v[252:255], v240, s[24:27], s39 offen sc1
    v_accvgpr_read_b32 v250, a88
    s_waitcnt lgkmcnt(5)
    v_mfma_f32_32x32x16_bf16 v[208:223], v[224:227], v[192:195], v[208:223]
    ds_read_b64_tr_b16 v[236:237], v247 offset:12480
    ds_read_b64_tr_b16 v[238:239], v247 offset:14560
    ds_read_b128 v[192:195], v245 offset:4096
    v_accvgpr_read_b32 v251, a89
    v_cvt_pk_bf16_f32 v204, v250, v251
    s_waitcnt lgkmcnt(5)
    v_mfma_f32_32x32x16_bf16 a[0:15], v[228:231], v[12:15], a[0:15]
    ds_read_b64_tr_b16 v[224:225], v244 offset:17152
    ds_read_b64_tr_b16 v[226:227], v244 offset:19232
    v_accvgpr_read_b32 v250, a90
    v_accvgpr_read_b32 v251, a91
    v_cvt_pk_bf16_f32 v205, v250, v251
    v_mfma_f32_32x32x16_bf16 a[16:31], v[228:231], v[76:79], a[16:31]
    v_accvgpr_read_b32 v250, a92
    v_accvgpr_read_b32 v251, a93
    v_cvt_pk_bf16_f32 v206, v250, v251
    v_accvgpr_read_b32 v250, a94
    v_accvgpr_read_b32 v251, a95
    s_waitcnt lgkmcnt(5)
    v_mfma_f32_32x32x16_bf16 a[32:47], v[232:235], v[12:15], a[32:47]
    ds_read_b64_tr_b16 v[228:229], v244 offset:17408
    ds_read_b64_tr_b16 v[230:231], v244 offset:19488
    v_cvt_pk_bf16_f32 v207, v250, v251
    s_add_u32 s39, s58, 2162688
    buffer_store_dwordx4 v[204:207], v240, s[24:27], s39 offen offset:128 sc1
    v_mfma_f32_32x32x16_bf16 a[48:63], v[232:235], v[76:79], a[48:63]
    v_accvgpr_read_b32 v250, a96
    v_accvgpr_read_b32 v251, a97
    v_cvt_pk_bf16_f32 v252, v250, v251
    v_accvgpr_read_b32 v250, a98
    v_accvgpr_read_b32 v251, a99
    v_cvt_pk_bf16_f32 v253, v250, v251
    s_waitcnt lgkmcnt(5)
    v_mfma_f32_32x32x16_bf16 v[208:223], v[236:239], v[196:199], v[208:223]
    ds_read_b64_tr_b16 v[232:233], v247 offset:16640
    ds_read_b64_tr_b16 v[234:235], v247 offset:18720
    ds_read_b128 v[196:199], v245 offset:5120
    v_accvgpr_read_b32 v250, a100
    s_waitcnt lgkmcnt(5)
    v_mfma_f32_32x32x16_bf16 a[0:15], v[224:227], v[16:19], a[0:15]
    ds_read_b64_tr_b16 v[236:237], v244 offset:21312
    ds_read_b64_tr_b16 v[238:239], v244 offset:23392
    v_accvgpr_read_b32 v251, a101
    v_cvt_pk_bf16_f32 v254, v250, v251
    v_accvgpr_read_b32 v250, a102
    v_mfma_f32_32x32x16_bf16 a[16:31], v[224:227], v[80:83], a[16:31]
    v_accvgpr_read_b32 v251, a103
    v_cvt_pk_bf16_f32 v255, v250, v251
    s_add_u32 s39, s58, 2097152
    buffer_store_dwordx4 v[252:255], v240, s[24:27], s39 offen offset:256 sc1
    v_accvgpr_read_b32 v250, a104
    v_accvgpr_read_b32 v251, a105
    s_waitcnt lgkmcnt(5)
    v_mfma_f32_32x32x16_bf16 a[32:47], v[228:231], v[16:19], a[32:47]
    ds_read_b64_tr_b16 v[224:225], v244 offset:21568
    ds_read_b64_tr_b16 v[226:227], v244 offset:23648
    v_cvt_pk_bf16_f32 v204, v250, v251
    v_accvgpr_read_b32 v250, a106
    v_accvgpr_read_b32 v251, a107
    v_mfma_f32_32x32x16_bf16 a[48:63], v[228:231], v[80:83], a[48:63]
    v_cvt_pk_bf16_f32 v205, v250, v251
    v_accvgpr_read_b32 v250, a108
    v_accvgpr_read_b32 v251, a109
    v_cvt_pk_bf16_f32 v206, v250, v251
    v_accvgpr_read_b32 v250, a110
    s_waitcnt lgkmcnt(5)
    v_mfma_f32_32x32x16_bf16 v[208:223], v[232:235], v[192:195], v[208:223]
    ds_read_b64_tr_b16 v[228:229], v247 offset:20800
    ds_read_b64_tr_b16 v[230:231], v247 offset:22880
    ds_read_b128 v[192:195], v245 offset:6144
    v_accvgpr_read_b32 v251, a111
    v_cvt_pk_bf16_f32 v207, v250, v251
    s_waitcnt lgkmcnt(5)
    v_mfma_f32_32x32x16_bf16 a[0:15], v[236:239], v[20:23], a[0:15]
    ds_read_b64_tr_b16 v[232:233], v244 offset:25472
    ds_read_b64_tr_b16 v[234:235], v244 offset:27552
    s_add_u32 s39, s58, 2097152
    buffer_store_dwordx4 v[204:207], v240, s[24:27], s39 offen offset:384 sc1
    v_accvgpr_read_b32 v250, a112
    v_mfma_f32_32x32x16_bf16 a[16:31], v[236:239], v[84:87], a[16:31]
    v_accvgpr_read_b32 v251, a113
    v_cvt_pk_bf16_f32 v252, v250, v251
    v_accvgpr_read_b32 v250, a114
    v_accvgpr_read_b32 v251, a115
    v_cvt_pk_bf16_f32 v253, v250, v251
    v_accvgpr_read_b32 v250, a116
    s_waitcnt lgkmcnt(5)
    v_mfma_f32_32x32x16_bf16 a[32:47], v[224:227], v[20:23], a[32:47]
    ds_read_b64_tr_b16 v[236:237], v244 offset:25728
    ds_read_b64_tr_b16 v[238:239], v244 offset:27808
    v_accvgpr_read_b32 v251, a117
    v_cvt_pk_bf16_f32 v254, v250, v251
    v_mfma_f32_32x32x16_bf16 a[48:63], v[224:227], v[84:87], a[48:63]
    v_accvgpr_read_b32 v250, a118
    v_accvgpr_read_b32 v251, a119
    v_cvt_pk_bf16_f32 v255, v250, v251
    s_add_u32 s39, s58, 2162688
    buffer_store_dwordx4 v[252:255], v240, s[24:27], s39 offen offset:256 sc1
    v_accvgpr_read_b32 v250, a120
    s_waitcnt lgkmcnt(5)
    v_mfma_f32_32x32x16_bf16 v[208:223], v[228:231], v[196:199], v[208:223]
    ds_read_b64_tr_b16 v[224:225], v247 offset:24960
    ds_read_b64_tr_b16 v[226:227], v247 offset:27040
    ds_read_b128 v[196:199], v245 offset:7168
    v_accvgpr_read_b32 v251, a121
    v_cvt_pk_bf16_f32 v204, v250, v251
    s_waitcnt lgkmcnt(5)
    v_mfma_f32_32x32x16_bf16 a[0:15], v[232:235], v[24:27], a[0:15]
    ds_read_b64_tr_b16 v[228:229], v244 offset:29632
    ds_read_b64_tr_b16 v[230:231], v244 offset:31712
    v_accvgpr_read_b32 v250, a122
    v_accvgpr_read_b32 v251, a123
    v_cvt_pk_bf16_f32 v205, v250, v251
    v_mfma_f32_32x32x16_bf16 a[16:31], v[232:235], v[88:91], a[16:31]
    v_accvgpr_read_b32 v250, a124
    v_accvgpr_read_b32 v251, a125
    v_cvt_pk_bf16_f32 v206, v250, v251
    v_accvgpr_read_b32 v250, a126
    v_accvgpr_read_b32 v251, a127
    s_waitcnt lgkmcnt(5)
    v_mfma_f32_32x32x16_bf16 a[32:47], v[236:239], v[24:27], a[32:47]
    ds_read_b64_tr_b16 v[232:233], v244 offset:29888
    ds_read_b64_tr_b16 v[234:235], v244 offset:31968
    v_cvt_pk_bf16_f32 v207, v250, v251
    s_add_u32 s39, s58, 2162688
    buffer_store_dwordx4 v[204:207], v240, s[24:27], s39 offen offset:384 sc1
    v_mfma_f32_32x32x16_bf16 a[48:63], v[236:239], v[88:91], a[48:63]
    s_waitcnt vmcnt(15)
    v_lshlrev_b32 v176, 16, v144
    v_and_b32 v177, 0xffff0000, v144
    v_lshlrev_b32 v178, 16, v145
    v_and_b32 v179, 0xffff0000, v145
    v_lshlrev_b32 v180, 16, v146
    v_and_b32 v181, 0xffff0000, v146
    s_waitcnt lgkmcnt(5)
    v_mfma_f32_32x32x16_bf16 v[208:223], v[224:227], v[192:195], v[208:223]
    ds_read_b64_tr_b16 v[236:237], v247 offset:29120
    ds_read_b64_tr_b16 v[238:239], v247 offset:31200
    ds_read_b128 v[192:195], v245 offset:8192
    v_lshlrev_b32 v182, 16, v147
    v_and_b32 v183, 0xffff0000, v147
    s_waitcnt lgkmcnt(5)
    v_mfma_f32_32x32x16_bf16 a[0:15], v[228:231], v[28:31], a[0:15]
    ds_read_b64_tr_b16 v[224:225], v244 offset:33792
    ds_read_b64_tr_b16 v[226:227], v244 offset:35872
    s_waitcnt vmcnt(14)
    v_dot2c_f32_bf16 v176, s32, v148
    v_dot2c_f32_bf16 v177, s33, v148
    v_dot2c_f32_bf16 v178, s32, v149
    v_mfma_f32_32x32x16_bf16 a[16:31], v[228:231], v[92:95], a[16:31]
    v_dot2c_f32_bf16 v179, s33, v149
    v_dot2c_f32_bf16 v180, s32, v150
    v_dot2c_f32_bf16 v181, s33, v150
    v_dot2c_f32_bf16 v182, s32, v151
    v_dot2c_f32_bf16 v183, s33, v151
    s_waitcnt vmcnt(13)
    v_dot2c_f32_bf16 v176, s32, v152
    s_waitcnt lgkmcnt(5)
    v_mfma_f32_32x32x16_bf16 a[32:47], v[232:235], v[28:31], a[32:47]
    ds_read_b64_tr_b16 v[228:229], v244 offset:34048
    ds_read_b64_tr_b16 v[230:231], v244 offset:36128
    v_dot2c_f32_bf16 v177, s33, v152
    v_dot2c_f32_bf16 v178, s32, v153
    v_dot2c_f32_bf16 v179, s33, v153
    v_mfma_f32_32x32x16_bf16 a[48:63], v[232:235], v[92:95], a[48:63]
    v_dot2c_f32_bf16 v180, s32, v154
    v_dot2c_f32_bf16 v181, s33, v154
    v_dot2c_f32_bf16 v182, s32, v155
    v_dot2c_f32_bf16 v183, s33, v155
    s_waitcnt vmcnt(12)
    v_dot2c_f32_bf16 v176, s32, v156
    v_dot2c_f32_bf16 v177, s33, v156
    s_waitcnt lgkmcnt(5)
    v_mfma_f32_32x32x16_bf16 v[208:223], v[236:239], v[196:199], v[208:223]
    ds_read_b64_tr_b16 v[232:233], v247 offset:33280
    ds_read_b64_tr_b16 v[234:235], v247 offset:35360
    ds_read_b128 v[196:199], v245 offset:9216
    v_dot2c_f32_bf16 v178, s32, v157
    v_dot2c_f32_bf16 v179, s33, v157
    s_waitcnt lgkmcnt(5)
    v_mfma_f32_32x32x16_bf16 a[0:15], v[224:227], v[32:35], a[0:15]
    ds_read_b64_tr_b16 v[236:237], v244 offset:37952
    ds_read_b64_tr_b16 v[238:239], v244 offset:40032
    v_dot2c_f32_bf16 v180, s32, v158
    v_dot2c_f32_bf16 v181, s33, v158
    v_dot2c_f32_bf16 v182, s32, v159
    v_mfma_f32_32x32x16_bf16 a[16:31], v[224:227], v[96:99], a[16:31]
    v_dot2c_f32_bf16 v183, s33, v159
    s_waitcnt vmcnt(11)
    v_dot2c_f32_bf16 v176, s32, v160
    v_dot2c_f32_bf16 v177, s33, v160
    v_dot2c_f32_bf16 v178, s32, v161
    v_dot2c_f32_bf16 v179, s33, v161
    v_dot2c_f32_bf16 v180, s32, v162
    s_waitcnt lgkmcnt(5)
    v_mfma_f32_32x32x16_bf16 a[32:47], v[228:231], v[32:35], a[32:47]
    ds_read_b64_tr_b16 v[224:225], v244 offset:38208
    ds_read_b64_tr_b16 v[226:227], v244 offset:40288
    v_dot2c_f32_bf16 v181, s33, v162
    v_dot2c_f32_bf16 v182, s32, v163
    v_mfma_f32_32x32x16_bf16 a[48:63], v[228:231], v[96:99], a[48:63]
    v_dot2c_f32_bf16 v183, s33, v163
    s_waitcnt vmcnt(10)
    v_dot2c_f32_bf16 v176, s32, v164
    v_dot2c_f32_bf16 v177, s33, v164
    v_dot2c_f32_bf16 v178, s32, v165
    v_dot2c_f32_bf16 v179, s33, v165
    v_dot2c_f32_bf16 v180, s32, v166
    s_waitcnt lgkmcnt(5)
    v_mfma_f32_32x32x16_bf16 v[208:223], v[232:235], v[192:195], v[208:223]
    ds_read_b64_tr_b16 v[228:229], v247 offset:37440
    ds_read_b64_tr_b16 v[230:231], v247 offset:39520
    ds_read_b128 v[192:195], v245 offset:10240
    v_dot2c_f32_bf16 v181, s33, v166
    v_dot2c_f32_bf16 v182, s32, v167
    s_waitcnt lgkmcnt(5)
    v_mfma_f32_32x32x16_bf16 a[0:15], v[236:239], v[36:39], a[0:15]
    ds_read_b64_tr_b16 v[232:233], v244 offset:42112
    ds_read_b64_tr_b16 v[234:235], v244 offset:44192
    v_dot2c_f32_bf16 v183, s33, v167
    s_waitcnt vmcnt(9)
    v_dot2c_f32_bf16 v176, s32, v168
    v_dot2c_f32_bf16 v177, s33, v168
    v_mfma_f32_32x32x16_bf16 a[16:31], v[236:239], v[100:103], a[16:31]
    v_dot2c_f32_bf16 v178, s32, v169
    v_dot2c_f32_bf16 v179, s33, v169
    v_dot2c_f32_bf16 v180, s32, v170
    v_dot2c_f32_bf16 v181, s33, v170
    v_dot2c_f32_bf16 v182, s32, v171
    v_dot2c_f32_bf16 v183, s33, v171
    s_waitcnt lgkmcnt(5)
    v_mfma_f32_32x32x16_bf16 a[32:47], v[224:227], v[36:39], a[32:47]
    ds_read_b64_tr_b16 v[236:237], v244 offset:42368
    ds_read_b64_tr_b16 v[238:239], v244 offset:44448
    s_waitcnt vmcnt(8)
    v_dot2c_f32_bf16 v176, s32, v172
    v_dot2c_f32_bf16 v177, s33, v172
    v_dot2c_f32_bf16 v178, s32, v173
    v_mfma_f32_32x32x16_bf16 a[48:63], v[224:227], v[100:103], a[48:63]
    v_dot2c_f32_bf16 v179, s33, v173
    v_dot2c_f32_bf16 v180, s32, v174
    v_dot2c_f32_bf16 v181, s33, v174
    v_dot2c_f32_bf16 v182, s32, v175
    v_dot2c_f32_bf16 v183, s33, v175
    s_nop 2
    s_waitcnt lgkmcnt(5)
    v_mfma_f32_32x32x16_bf16 v[208:223], v[228:231], v[196:199], v[208:223]
    ds_read_b64_tr_b16 v[224:225], v247 offset:41600
    ds_read_b64_tr_b16 v[226:227], v247 offset:43680
    ds_read_b128 v[196:199], v245 offset:11264
    v_permlane32_swap_b32 v176, v180
    v_permlane32_swap_b32 v177, v181
    s_waitcnt lgkmcnt(5)
    v_mfma_f32_32x32x16_bf16 a[0:15], v[232:235], v[40:43], a[0:15]
    ds_read_b64_tr_b16 v[228:229], v244 offset:46272
    ds_read_b64_tr_b16 v[230:231], v244 offset:48352
    v_permlane32_swap_b32 v178, v182
    v_permlane32_swap_b32 v179, v183
    v_add_f32 v176, v176, v180
    v_mfma_f32_32x32x16_bf16 a[16:31], v[232:235], v[104:107], a[16:31]
    v_add_f32 v177, v177, v181
    v_add_f32 v178, v178, v182
    v_add_f32 v179, v179, v183
    v_cvt_pk_bf16_f32 v184, v176, v177
    v_cvt_pk_bf16_f32 v185, v178, v179
    buffer_store_dwordx2 v[184:185], v241, s[92:95], s87 offen
    s_waitcnt lgkmcnt(5)
    v_mfma_f32_32x32x16_bf16 a[32:47], v[236:239], v[40:43], a[32:47]
    ds_read_b64_tr_b16 v[232:233], v244 offset:46528
    ds_read_b64_tr_b16 v[234:235], v244 offset:48608
    buffer_load_dword v186, v242, s[24:27], s91 offen sc1
    v_mfma_f32_32x32x16_bf16 a[48:63], v[236:239], v[104:107], a[48:63]
    s_waitcnt lgkmcnt(5)
    v_mfma_f32_32x32x16_bf16 v[208:223], v[224:227], v[192:195], v[208:223]
    ds_read_b64_tr_b16 v[236:237], v247 offset:45760
    ds_read_b64_tr_b16 v[238:239], v247 offset:47840
    ds_read_b128 v[192:195], v245 offset:12288
    s_waitcnt lgkmcnt(5)
    v_mfma_f32_32x32x16_bf16 a[0:15], v[228:231], v[44:47], a[0:15]
    ds_read_b64_tr_b16 v[224:225], v244 offset:50432
    ds_read_b64_tr_b16 v[226:227], v244 offset:52512
    v_mfma_f32_32x32x16_bf16 a[16:31], v[228:231], v[108:111], a[16:31]
    s_waitcnt lgkmcnt(5)
    v_mfma_f32_32x32x16_bf16 a[32:47], v[232:235], v[44:47], a[32:47]
    ds_read_b64_tr_b16 v[228:229], v244 offset:50688
    ds_read_b64_tr_b16 v[230:231], v244 offset:52768
    v_mfma_f32_32x32x16_bf16 a[48:63], v[232:235], v[108:111], a[48:63]
    s_waitcnt lgkmcnt(5)
    v_mfma_f32_32x32x16_bf16 v[208:223], v[236:239], v[196:199], v[208:223]
    ds_read_b64_tr_b16 v[232:233], v247 offset:49920
    ds_read_b64_tr_b16 v[234:235], v247 offset:52000
    ds_read_b128 v[196:199], v245 offset:13312
    s_waitcnt lgkmcnt(5)
    v_mfma_f32_32x32x16_bf16 a[0:15], v[224:227], v[48:51], a[0:15]
    ds_read_b64_tr_b16 v[236:237], v244 offset:54592
    ds_read_b64_tr_b16 v[238:239], v244 offset:56672
    v_mfma_f32_32x32x16_bf16 a[16:31], v[224:227], v[112:115], a[16:31]
    s_waitcnt lgkmcnt(5)
    v_mfma_f32_32x32x16_bf16 a[32:47], v[228:231], v[48:51], a[32:47]
    ds_read_b64_tr_b16 v[224:225], v244 offset:54848
    ds_read_b64_tr_b16 v[226:227], v244 offset:56928
    v_mfma_f32_32x32x16_bf16 a[48:63], v[228:231], v[112:115], a[48:63]
    s_waitcnt lgkmcnt(5)
    v_mfma_f32_32x32x16_bf16 v[208:223], v[232:235], v[192:195], v[208:223]
    ds_read_b64_tr_b16 v[228:229], v247 offset:54080
    ds_read_b64_tr_b16 v[230:231], v247 offset:56160
    ds_read_b128 v[192:195], v245 offset:14336
    s_waitcnt lgkmcnt(5)
    v_mfma_f32_32x32x16_bf16 a[0:15], v[236:239], v[52:55], a[0:15]
    ds_read_b64_tr_b16 v[232:233], v244 offset:58752
    ds_read_b64_tr_b16 v[234:235], v244 offset:60832
    v_mfma_f32_32x32x16_bf16 a[16:31], v[236:239], v[116:119], a[16:31]
    s_waitcnt lgkmcnt(5)
    v_mfma_f32_32x32x16_bf16 a[32:47], v[224:227], v[52:55], a[32:47]
    ds_read_b64_tr_b16 v[236:237], v244 offset:59008
    ds_read_b64_tr_b16 v[238:239], v244 offset:61088
    v_mfma_f32_32x32x16_bf16 a[48:63], v[224:227], v[116:119], a[48:63]
    s_waitcnt lgkmcnt(5)
    v_mfma_f32_32x32x16_bf16 v[208:223], v[228:231], v[196:199], v[208:223]
    ds_read_b64_tr_b16 v[224:225], v247 offset:58240
    ds_read_b64_tr_b16 v[226:227], v247 offset:60320
    ds_read_b128 v[196:199], v245 offset:15360
    s_waitcnt lgkmcnt(5)
    v_mfma_f32_32x32x16_bf16 a[0:15], v[232:235], v[56:59], a[0:15]
    ds_read_b64_tr_b16 v[228:229], v244 offset:62912
    ds_read_b64_tr_b16 v[230:231], v244 offset:64992
    v_mfma_f32_32x32x16_bf16 a[16:31], v[232:235], v[120:123], a[16:31]
    s_waitcnt lgkmcnt(5)
    v_mfma_f32_32x32x16_bf16 a[32:47], v[236:239], v[56:59], a[32:47]
    ds_read_b64_tr_b16 v[232:233], v244 offset:63168
    ds_read_b64_tr_b16 v[234:235], v244 offset:65248
    v_mfma_f32_32x32x16_bf16 a[48:63], v[236:239], v[120:123], a[48:63]
    s_waitcnt vmcnt(0)
    s_add_u32 s39, s13, 5
    s_mov_b64 exec, 1
    v_mov_b32 v187, s39
    s_cmp_eq_u32 s12, 16
    s_cbranch_scc1 L_arf5
    buffer_store_dword v187, off, s[24:27], s41 sc1
    s_branch L_are5
L_arf5:
    buffer_store_dword v187, off, s[24:27], s41
L_are5:
    s_mov_b64 exec, -1
    s_lshl_b32 s88, s86, 19
    s_add_u32 s88, s88, s37
    s_lshl_b32 s87, s86, 7
    s_add_u32 s87, s87, s42
    v_sub_u32 v186, v186, v243
    v_cmp_lt_u32 vcc, s86, v186
    s_nop 0
    s_cmp_eq_u64 vcc, -1
    s_cselect_b32 s88, s88, 0x7fff0000
    s_cselect_b32 s87, s87, 0x7fff0000
    s_addc_u32 s86, s86, 0
    s_waitcnt lgkmcnt(5)
    v_mfma_f32_32x32x16_bf16 v[208:223], v[224:227], v[192:195], v[208:223]
    ds_read_b64_tr_b16 v[236:237], v247 offset:62400
    ds_read_b64_tr_b16 v[238:239], v247 offset:64480
    buffer_load_dwordx4 v[144:147], v245, s[24:27], s88 offen sc1
    buffer_load_dwordx4 v[148:151], v245, s[24:27], s88 offen offset:1024 sc1
    s_waitcnt lgkmcnt(4)
    v_mfma_f32_32x32x16_bf16 a[0:15], v[228:231], v[60:63], a[0:15]
    buffer_load_dwordx4 v[152:155], v245, s[24:27], s88 offen offset:2048 sc1
    buffer_load_dwordx4 v[156:159], v245, s[24:27], s88 offen offset:3072 sc1
    v_mfma_f32_32x32x16_bf16 a[16:31], v[228:231], v[124:127], a[16:31]
    s_add_u32 s88, s88, 4096
    buffer_load_dwordx4 v[160:163], v245, s[24:27], s88 offen sc1
    s_waitcnt lgkmcnt(2)
    v_mfma_f32_32x32x16_bf16 a[32:47], v[232:235], v[60:63], a[32:47]
    buffer_load_dwordx4 v[164:167], v245, s[24:27], s88 offen offset:1024 sc1
    buffer_load_dwordx4 v[168:171], v245, s[24:27], s88 offen offset:2048 sc1
    v_mfma_f32_32x32x16_bf16 a[48:63], v[232:235], v[124:127], a[48:63]
    buffer_load_dwordx4 v[172:175], v245, s[24:27], s88 offen offset:3072 sc1
    s_waitcnt lgkmcnt(0)
    v_mfma_f32_32x32x16_bf16 v[208:223], v[236:239], v[196:199], v[208:223]
    s_barrier
    s_lshl_b32 s39, s30, 8
    v_add_u32 v248, s39, v246
    ds_read_b64_tr_b16 v[224:225], v246
    ds_read_b64_tr_b16 v[226:227], v246 offset:2080
    ds_read_b64_tr_b16 v[228:229], v246 offset:256
    ds_read_b64_tr_b16 v[230:231], v246 offset:2336
    ds_read_b64_tr_b16 v[232:233], v248
    ds_read_b64_tr_b16 v[234:235], v248 offset:2080
    ds_read_b128 v[192:195], v245
    ds_read_b128 v[196:199], v245 offset:1024
    s_waitcnt lgkmcnt(6)
    v_mfma_f32_32x32x16_bf16 a[64:79], v[224:227], v[0:3], 0
    ds_read_b64_tr_b16 v[236:237], v246 offset:4160
    ds_read_b64_tr_b16 v[238:239], v246 offset:6240
    v_mfma_f32_32x32x16_bf16 a[80:95], v[224:227], v[64:67], 0
    s_waitcnt lgkmcnt(6)
    v_mfma_f32_32x32x16_bf16 a[96:111], v[228:231], v[0:3], 0
    ds_read_b64_tr_b16 v[224:225], v246 offset:4416
    ds_read_b64_tr_b16 v[226:227], v246 offset:6496
    v_mfma_f32_32x32x16_bf16 a[112:127], v[228:231], v[64:67], 0
    v_accvgpr_read_b32 v250, a0
    v_accvgpr_read_b32 v251, a1
    v_cvt_pk_bf16_f32 v252, v250, v251
    v_accvgpr_read_b32 v250, a2
    v_accvgpr_read_b32 v251, a3
    v_cvt_pk_bf16_f32 v253, v250, v251
    s_waitcnt lgkmcnt(5)
    v_mfma_f32_32x32x16_bf16 v[128:143], v[232:235], v[192:195], 0
    ds_read_b64_tr_b16 v[228:229], v248 offset:4160
    ds_read_b64_tr_b16 v[230:231], v248 offset:6240
    ds_read_b128 v[192:195], v245 offset:2048
    v_accvgpr_read_b32 v250, a4
    v_accvgpr_read_b32 v251, a5
    s_waitcnt lgkmcnt(5)
    v_mfma_f32_32x32x16_bf16 a[64:79], v[236:239], v[4:7], a[64:79]
    ds_read_b64_tr_b16 v[232:233], v246 offset:8320
    ds_read_b64_tr_b16 v[234:235], v246 offset:10400
    v_cvt_pk_bf16_f32 v254, v250, v251
    v_accvgpr_read_b32 v250, a6
    v_accvgpr_read_b32 v251, a7
    v_mfma_f32_32x32x16_bf16 a[80:95], v[236:239], v[68:71], a[80:95]
    v_cvt_pk_bf16_f32 v255, v250, v251
    s_add_u32 s39, s58, 2621440
    buffer_store_dwordx4 v[252:255], v240, s[24:27], s39 offen sc1
    v_accvgpr_read_b32 v250, a8
    v_accvgpr_read_b32 v251, a9
    v_cvt_pk_bf16_f32 v204, v250, v251
    v_accvgpr_read_b32 v250, a10
    s_waitcnt lgkmcnt(5)
    v_mfma_f32_32x32x16_bf16 a[96:111], v[224:227], v[4:7], a[96:111]
    ds_read_b64_tr_b16 v[236:237], v246 offset:8576
    ds_read_b64_tr_b16 v[238:239], v246 offset:10656
    v_accvgpr_read_b32 v251, a11
    v_cvt_pk_bf16_f32 v205, v250, v251
    v_accvgpr_read_b32 v250, a12
    v_mfma_f32_32x32x16_bf16 a[112:127], v[224:227], v[68:71], a[112:127]
    v_accvgpr_read_b32 v251, a13
    v_cvt_pk_bf16_f32 v206, v250, v251
    v_accvgpr_read_b32 v250, a14
    v_accvgpr_read_b32 v251, a15
    v_cvt_pk_bf16_f32 v207, v250, v251
    s_waitcnt lgkmcnt(5)
    v_mfma_f32_32x32x16_bf16 v[128:143], v[228:231], v[196:199], v[128:143]
    ds_read_b64_tr_b16 v[224:225], v248 offset:8320
    ds_read_b64_tr_b16 v[226:227], v248 offset:10400
    ds_read_b128 v[196:199], v245 offset:3072
    s_add_u32 s39, s58, 2621440
    buffer_store_dwordx4 v[204:207], v240, s[24:27], s39 offen offset:128 sc1
    v_accvgpr_read_b32 v250, a16
    s_waitcnt lgkmcnt(5)
    v_mfma_f32_32x32x16_bf16 a[64:79], v[232:235], v[8:11], a[64:79]
    ds_read_b64_tr_b16 v[228:229], v246 offset:12480
    ds_read_b64_tr_b16 v[230:231], v246 offset:14560
    v_accvgpr_read_b32 v251, a17
    v_cvt_pk_bf16_f32 v252, v250, v251
    v_accvgpr_read_b32 v250, a18
    v_mfma_f32_32x32x16_bf16 a[80:95], v[232:235], v[72:75], a[80:95]
    v_accvgpr_read_b32 v251, a19
    v_cvt_pk_bf16_f32 v253, v250, v251
    v_accvgpr_read_b32 v250, a20
    v_accvgpr_read_b32 v251, a21
    v_cvt_pk_bf16_f32 v254, v250, v251
    v_accvgpr_read_b32 v250, a22
    s_waitcnt lgkmcnt(5)
    v_mfma_f32_32x32x16_bf16 a[96:111], v[236:239], v[8:11], a[96:111]
    ds_read_b64_tr_b16 v[232:233], v246 offset:12736
    ds_read_b64_tr_b16 v[234:235], v246 offset:14816
    v_accvgpr_read_b32 v251, a23
    v_cvt_pk_bf16_f32 v255, v250, v251
    s_add_u32 s39, s58, 2686976
    buffer_store_dwordx4 v[252:255], v240, s[24:27], s39 offen sc1
    v_mfma_f32_32x32x16_bf16 a[112:127], v[236:239], v[72:75], a[112:127]
    v_accvgpr_read_b32 v250, a24
    v_accvgpr_read_b32 v251, a25
    v_cvt_pk_bf16_f32 v204, v250, v251
    v_accvgpr_read_b32 v250, a26
    v_accvgpr_read_b32 v251, a27
    v_cvt_pk_bf16_f32 v205, v250, v251
    s_waitcnt lgkmcnt(5)
    v_mfma_f32_32x32x16_bf16 v[128:143], v[224:227], v[192:195], v[128:143]
    ds_read_b64_tr_b16 v[236:237], v248 offset:12480
    ds_read_b64_tr_b16 v[238:239], v248 offset:14560
    ds_read_b128 v[192:195], v245 offset:4096
    v_accvgpr_read_b32 v250, a28
    v_accvgpr_read_b32 v251, a29
    s_waitcnt lgkmcnt(5)
    v_mfma_f32_32x32x16_bf16 a[64:79], v[228:231], v[12:15], a[64:79]
    ds_read_b64_tr_b16 v[224:225], v246 offset:16640
    ds_read_b64_tr_b16 v[226:227], v246 offset:18720
    v_cvt_pk_bf16_f32 v206, v250, v251
    v_accvgpr_read_b32 v250, a30
    v_accvgpr_read_b32 v251, a31
    v_mfma_f32_32x32x16_bf16 a[80:95], v[228:231], v[76:79], a[80:95]
    v_cvt_pk_bf16_f32 v207, v250, v251
    s_add_u32 s39, s58, 2686976
    buffer_store_dwordx4 v[204:207], v240, s[24:27], s39 offen offset:128 sc1
    v_accvgpr_read_b32 v250, a32
    v_accvgpr_read_b32 v251, a33
    v_cvt_pk_bf16_f32 v252, v250, v251
    s_waitcnt lgkmcnt(5)
    v_mfma_f32_32x32x16_bf16 a[96:111], v[232:235], v[12:15], a[96:111]
    ds_read_b64_tr_b16 v[228:229], v246 offset:16896
    ds_read_b64_tr_b16 v[230:231], v246 offset:18976
    v_accvgpr_read_b32 v250, a34
    v_accvgpr_read_b32 v251, a35
    v_cvt_pk_bf16_f32 v253, v250, v251
    v_mfma_f32_32x32x16_bf16 a[112:127], v[232:235], v[76:79], a[112:127]
    v_accvgpr_read_b32 v250, a36
    v_accvgpr_read_b32 v251, a37
    v_cvt_pk_bf16_f32 v254, v250, v251
    v_accvgpr_read_b32 v250, a38
    v_accvgpr_read_b32 v251, a39
    v_cvt_pk_bf16_f32 v255, v250, v251
    s_waitcnt lgkmcnt(5)
    v_mfma_f32_32x32x16_bf16 v[128:143], v[236:239], v[196:199], v[128:143]
    ds_read_b64_tr_b16 v[232:233], v248 offset:16640
    ds_read_b64_tr_b16 v[234:235], v248 offset:18720
    ds_read_b128 v[196:199], v245 offset:5120
    s_add_u32 s39, s58, 2621440
    buffer_store_dwordx4 v[252:255], v240, s[24:27], s39 offen offset:256 sc1
    s_waitcnt lgkmcnt(5)
    v_mfma_f32_32x32x16_bf16 a[64:79], v[224:227], v[16:19], a[64:79]
    ds_read_b64_tr_b16 v[236:237], v246 offset:20800
    ds_read_b64_tr_b16 v[238:239], v246 offset:22880
    v_accvgpr_read_b32 v250, a40
    v_accvgpr_read_b32 v251, a41
    v_cvt_pk_bf16_f32 v204, v250, v251
    v_mfma_f32_32x32x16_bf16 a[80:95], v[224:227], v[80:83], a[80:95]
    v_accvgpr_read_b32 v250, a42
    v_accvgpr_read_b32 v251, a43
    v_cvt_pk_bf16_f32 v205, v250, v251
    v_accvgpr_read_b32 v250, a44
    v_accvgpr_read_b32 v251, a45
    v_cvt_pk_bf16_f32 v206, v250, v251
    v_accvgpr_read_b32 v250, a46
    s_waitcnt lgkmcnt(5)
    v_mfma_f32_32x32x16_bf16 a[96:111], v[228:231], v[16:19], a[96:111]
    ds_read_b64_tr_b16 v[224:225], v246 offset:21056
    ds_read_b64_tr_b16 v[226:227], v246 offset:23136
    v_accvgpr_read_b32 v251, a47
    v_cvt_pk_bf16_f32 v207, v250, v251
    v_mfma_f32_32x32x16_bf16 a[112:127], v[228:231], v[80:83], a[112:127]
    s_add_u32 s39, s58, 2621440
    buffer_store_dwordx4 v[204:207], v240, s[24:27], s39 offen offset:384 sc1
    v_accvgpr_read_b32 v250, a48
    v_accvgpr_read_b32 v251, a49
    v_cvt_pk_bf16_f32 v252, v250, v251
    v_accvgpr_read_b32 v250, a50
    v_accvgpr_read_b32 v251, a51
    s_waitcnt lgkmcnt(5)
    v_mfma_f32_32x32x16_bf16 v[128:143], v[232:235], v[192:195], v[128:143]
    ds_read_b64_tr_b16 v[228:229], v248 offset:20800
    ds_read_b64_tr_b16 v[230:231], v248 offset:22880
    ds_read_b128 v[192:195], v245 offset:6144
    v_cvt_pk_bf16_f32 v253, v250, v251
    v_accvgpr_read_b32 v250, a52
    s_waitcnt lgkmcnt(5)
    v_mfma_f32_32x32x16_bf16 a[64:79], v[236:239], v[20:23], a[64:79]
    ds_read_b64_tr_b16 v[232:233], v246 offset:24960
    ds_read_b64_tr_b16 v[234:235], v246 offset:27040
    v_accvgpr_read_b32 v251, a53
    v_cvt_pk_bf16_f32 v254, v250, v251
    v_accvgpr_read_b32 v250, a54
    v_mfma_f32_32x32x16_bf16 a[80:95], v[236:239], v[84:87], a[80:95]
    v_accvgpr_read_b32 v251, a55
    v_cvt_pk_bf16_f32 v255, v250, v251
    s_add_u32 s39, s58, 2686976
    buffer_store_dwordx4 v[252:255], v240, s[24:27], s39 offen offset:256 sc1
    v_accvgpr_read_b32 v250, a56
    v_accvgpr_read_b32 v251, a57
    s_waitcnt lgkmcnt(5)
    v_mfma_f32_32x32x16_bf16 a[96:111], v[224:227], v[20:23], a[96:111]
    ds_read_b64_tr_b16 v[236:237], v246 offset:25216
    ds_read_b64_tr_b16 v[238:239], v246 offset:27296
    v_cvt_pk_bf16_f32 v204, v250, v251
    v_accvgpr_read_b32 v250, a58
    v_accvgpr_read_b32 v251, a59
    v_mfma_f32_32x32x16_bf16 a[112:127], v[224:227], v[84:87], a[112:127]
    v_cvt_pk_bf16_f32 v205, v250, v251
    v_accvgpr_read_b32 v250, a60
    v_accvgpr_read_b32 v251, a61
    v_cvt_pk_bf16_f32 v206, v250, v251
    v_accvgpr_read_b32 v250, a62
    v_accvgpr_read_b32 v251, a63
    v_cvt_pk_bf16_f32 v207, v250, v251
    s_waitcnt lgkmcnt(5)
    v_mfma_f32_32x32x16_bf16 v[128:143], v[228:231], v[196:199], v[128:143]
    ds_read_b64_tr_b16 v[224:225], v248 offset:24960
    ds_read_b64_tr_b16 v[226:227], v248 offset:27040
    ds_read_b128 v[196:199], v245 offset:7168
    s_add_u32 s39, s58, 2686976
    buffer_store_dwordx4 v[204:207], v240, s[24:27], s39 offen offset:384 sc1
    s_waitcnt lgkmcnt(5)
    v_mfma_f32_32x32x16_bf16 a[64:79], v[232:235], v[24:27], a[64:79]
    ds_read_b64_tr_b16 v[228:229], v246 offset:29120
    ds_read_b64_tr_b16 v[230:231], v246 offset:31200
    v_cvt_pk_bf16_f32 v252, v208, v209
    v_cvt_pk_bf16_f32 v253, v210, v211
    v_cvt_pk_bf16_f32 v254, v212, v213
    v_mfma_f32_32x32x16_bf16 a[80:95], v[232:235], v[88:91], a[80:95]
    v_cvt_pk_bf16_f32 v255, v214, v215
    s_add_u32 s39, s50, 262144
    buffer_store_dwordx4 v[252:255], v240, s[24:27], s39 offen sc1
    v_cvt_pk_bf16_f32 v204, v216, v217
    v_cvt_pk_bf16_f32 v205, v218, v219
    v_cvt_pk_bf16_f32 v206, v220, v221
    s_waitcnt lgkmcnt(5)
    v_mfma_f32_32x32x16_bf16 a[96:111], v[236:239], v[24:27], a[96:111]
    ds_read_b64_tr_b16 v[232:233], v246 offset:29376
    ds_read_b64_tr_b16 v[234:235], v246 offset:31456
    v_cvt_pk_bf16_f32 v207, v222, v223
    s_add_u32 s39, s50, 262144
    buffer_store_dwordx4 v[204:207], v240, s[24:27], s39 offen offset:128 sc1
    v_mfma_f32_32x32x16_bf16 a[112:127], v[236:239], v[88:91], a[112:127]
    s_waitcnt vmcnt(17)
    v_lshlrev_b32 v176, 16, v144
    v_and_b32 v177, 0xffff0000, v144
    v_lshlrev_b32 v178, 16, v145
    v_and_b32 v179, 0xffff0000, v145
    v_lshlrev_b32 v180, 16, v146
    v_and_b32 v181, 0xffff0000, v146
    s_waitcnt lgkmcnt(5)
    v_mfma_f32_32x32x16_bf16 v[128:143], v[224:227], v[192:195], v[128:143]
    ds_read_b64_tr_b16 v[236:237], v248 offset:29120
    ds_read_b64_tr_b16 v[238:239], v248 offset:31200
    ds_read_b128 v[192:195], v245 offset:8192
    v_lshlrev_b32 v182, 16, v147
    v_and_b32 v183, 0xffff0000, v147
    s_waitcnt lgkmcnt(5)
    v_mfma_f32_32x32x16_bf16 a[64:79], v[228:231], v[28:31], a[64:79]
    ds_read_b64_tr_b16 v[224:225], v246 offset:33280
    ds_read_b64_tr_b16 v[226:227], v246 offset:35360
    s_waitcnt vmcnt(16)
    v_dot2c_f32_bf16 v176, s32, v148
    v_dot2c_f32_bf16 v177, s33, v148
    v_dot2c_f32_bf16 v178, s32, v149
    v_mfma_f32_32x32x16_bf16 a[80:95], v[228:231], v[92:95], a[80:95]
    v_dot2c_f32_bf16 v179, s33, v149
    v_dot2c_f32_bf16 v180, s32, v150
    v_dot2c_f32_bf16 v181, s33, v150
    v_dot2c_f32_bf16 v182, s32, v151
    v_dot2c_f32_bf16 v183, s33, v151
    s_waitcnt vmcnt(15)
    v_dot2c_f32_bf16 v176, s32, v152
    s_waitcnt lgkmcnt(5)
    v_mfma_f32_32x32x16_bf16 a[96:111], v[232:235], v[28:31], a[96:111]
    ds_read_b64_tr_b16 v[228:229], v246 offset:33536
    ds_read_b64_tr_b16 v[230:231], v246 offset:35616
    v_dot2c_f32_bf16 v177, s33, v152
    v_dot2c_f32_bf16 v178, s32, v153
    v_dot2c_f32_bf16 v179, s33, v153
    v_mfma_f32_32x32x16_bf16 a[112:127], v[232:235], v[92:95], a[112:127]
    v_dot2c_f32_bf16 v180, s32, v154
    v_dot2c_f32_bf16 v181, s33, v154
    v_dot2c_f32_bf16 v182, s32, v155
    v_dot2c_f32_bf16 v183, s33, v155
    s_waitcnt vmcnt(14)
    v_dot2c_f32_bf16 v176, s32, v156
    v_dot2c_f32_bf16 v177, s33, v156
    s_waitcnt lgkmcnt(5)
    v_mfma_f32_32x32x16_bf16 v[128:143], v[236:239], v[196:199], v[128:143]
    ds_read_b64_tr_b16 v[232:233], v248 offset:33280
    ds_read_b64_tr_b16 v[234:235], v248 offset:35360
    ds_read_b128 v[196:199], v245 offset:9216
    v_dot2c_f32_bf16 v178, s32, v157
    v_dot2c_f32_bf16 v179, s33, v157
    s_waitcnt lgkmcnt(5)
    v_mfma_f32_32x32x16_bf16 a[64:79], v[224:227], v[32:35], a[64:79]
    ds_read_b64_tr_b16 v[236:237], v246 offset:37440
    ds_read_b64_tr_b16 v[238:239], v246 offset:39520
    v_dot2c_f32_bf16 v180, s32, v158
    v_dot2c_f32_bf16 v181, s33, v158
    v_dot2c_f32_bf16 v182, s32, v159
    v_mfma_f32_32x32x16_bf16 a[80:95], v[224:227], v[96:99], a[80:95]
    v_dot2c_f32_bf16 v183, s33, v159
    s_waitcnt vmcnt(13)
    v_dot2c_f32_bf16 v176, s32, v160
    v_dot2c_f32_bf16 v177, s33, v160
    v_dot2c_f32_bf16 v178, s32, v161
    v_dot2c_f32_bf16 v179, s33, v161
    v_dot2c_f32_bf16 v180, s32, v162
    s_waitcnt lgkmcnt(5)
    v_mfma_f32_32x32x16_bf16 a[96:111], v[228:231], v[32:35], a[96:111]
    ds_read_b64_tr_b16 v[224:225], v246 offset:37696
    ds_read_b64_tr_b16 v[226:227], v246 offset:39776
    v_dot2c_f32_bf16 v181, s33, v162
    v_dot2c_f32_bf16 v182, s32, v163
    v_mfma_f32_32x32x16_bf16 a[112:127], v[228:231], v[96:99], a[112:127]
    v_dot2c_f32_bf16 v183, s33, v163
    s_waitcnt vmcnt(12)
    v_dot2c_f32_bf16 v176, s32, v164
    v_dot2c_f32_bf16 v177, s33, v164
    v_dot2c_f32_bf16 v178, s32, v165
    v_dot2c_f32_bf16 v179, s33, v165
    v_dot2c_f32_bf16 v180, s32, v166
    s_waitcnt lgkmcnt(5)
    v_mfma_f32_32x32x16_bf16 v[128:143], v[232:235], v[192:195], v[128:143]
    ds_read_b64_tr_b16 v[228:229], v248 offset:37440
    ds_read_b64_tr_b16 v[230:231], v248 offset:39520
    ds_read_b128 v[192:195], v245 offset:10240
    v_dot2c_f32_bf16 v181, s33, v166
    v_dot2c_f32_bf16 v182, s32, v167
    s_waitcnt lgkmcnt(5)
    v_mfma_f32_32x32x16_bf16 a[64:79], v[236:239], v[36:39], a[64:79]
    ds_read_b64_tr_b16 v[232:233], v246 offset:41600
    ds_read_b64_tr_b16 v[234:235], v246 offset:43680
    v_dot2c_f32_bf16 v183, s33, v167
    s_waitcnt vmcnt(11)
    v_dot2c_f32_bf16 v176, s32, v168
    v_dot2c_f32_bf16 v177, s33, v168
    v_mfma_f32_32x32x16_bf16 a[80:95], v[236:239], v[100:103], a[80:95]
    v_dot2c_f32_bf16 v178, s32, v169
    v_dot2c_f32_bf16 v179, s33, v169
    v_dot2c_f32_bf16 v180, s32, v170
    v_dot2c_f32_bf16 v181, s33, v170
    v_dot2c_f32_bf16 v182, s32, v171
    v_dot2c_f32_bf16 v183, s33, v171
    s_waitcnt lgkmcnt(5)
    v_mfma_f32_32x32x16_bf16 a[96:111], v[224:227], v[36:39], a[96:111]
    ds_read_b64_tr_b16 v[236:237], v246 offset:41856
    ds_read_b64_tr_b16 v[238:239], v246 offset:43936
    s_waitcnt vmcnt(10)
    v_dot2c_f32_bf16 v176, s32, v172
    v_dot2c_f32_bf16 v177, s33, v172
    v_dot2c_f32_bf16 v178, s32, v173
    v_mfma_f32_32x32x16_bf16 a[112:127], v[224:227], v[100:103], a[112:127]
    v_dot2c_f32_bf16 v179, s33, v173
    v_dot2c_f32_bf16 v180, s32, v174
    v_dot2c_f32_bf16 v181, s33, v174
    v_dot2c_f32_bf16 v182, s32, v175
    v_dot2c_f32_bf16 v183, s33, v175
    s_nop 2
    s_waitcnt lgkmcnt(5)
    v_mfma_f32_32x32x16_bf16 v[128:143], v[228:231], v[196:199], v[128:143]
    ds_read_b64_tr_b16 v[224:225], v248 offset:41600
    ds_read_b64_tr_b16 v[226:227], v248 offset:43680
    ds_read_b128 v[196:199], v245 offset:11264
    v_permlane32_swap_b32 v176, v180
    v_permlane32_swap_b32 v177, v181
    s_waitcnt lgkmcnt(5)
    v_mfma_f32_32x32x16_bf16 a[64:79], v[232:235], v[40:43], a[64:79]
    ds_read_b64_tr_b16 v[228:229], v246 offset:45760
    ds_read_b64_tr_b16 v[230:231], v246 offset:47840
    v_permlane32_swap_b32 v178, v182
    v_permlane32_swap_b32 v179, v183
    v_add_f32 v176, v176, v180
    v_mfma_f32_32x32x16_bf16 a[80:95], v[232:235], v[104:107], a[80:95]
    v_add_f32 v177, v177, v181
    v_add_f32 v178, v178, v182
    v_add_f32 v179, v179, v183
    v_cvt_pk_bf16_f32 v184, v176, v177
    v_cvt_pk_bf16_f32 v185, v178, v179
    buffer_store_dwordx2 v[184:185], v241, s[92:95], s87 offen
    s_waitcnt lgkmcnt(5)
    v_mfma_f32_32x32x16_bf16 a[96:111], v[236:239], v[40:43], a[96:111]
    ds_read_b64_tr_b16 v[232:233], v246 offset:46016
    ds_read_b64_tr_b16 v[234:235], v246 offset:48096
    buffer_load_dword v186, v242, s[24:27], s91 offen sc1
    v_mfma_f32_32x32x16_bf16 a[112:127], v[236:239], v[104:107], a[112:127]
    s_waitcnt lgkmcnt(5)
    v_mfma_f32_32x32x16_bf16 v[128:143], v[224:227], v[192:195], v[128:143]
    ds_read_b64_tr_b16 v[236:237], v248 offset:45760
    ds_read_b64_tr_b16 v[238:239], v248 offset:47840
    ds_read_b128 v[192:195], v245 offset:12288
    s_waitcnt lgkmcnt(5)
    v_mfma_f32_32x32x16_bf16 a[64:79], v[228:231], v[44:47], a[64:79]
    ds_read_b64_tr_b16 v[224:225], v246 offset:49920
    ds_read_b64_tr_b16 v[226:227], v246 offset:52000
    v_mfma_f32_32x32x16_bf16 a[80:95], v[228:231], v[108:111], a[80:95]
    s_waitcnt lgkmcnt(5)
    v_mfma_f32_32x32x16_bf16 a[96:111], v[232:235], v[44:47], a[96:111]
    ds_read_b64_tr_b16 v[228:229], v246 offset:50176
    ds_read_b64_tr_b16 v[230:231], v246 offset:52256
    v_mfma_f32_32x32x16_bf16 a[112:127], v[232:235], v[108:111], a[112:127]
    s_waitcnt lgkmcnt(5)
    v_mfma_f32_32x32x16_bf16 v[128:143], v[236:239], v[196:199], v[128:143]
    ds_read_b64_tr_b16 v[232:233], v248 offset:49920
    ds_read_b64_tr_b16 v[234:235], v248 offset:52000
    ds_read_b128 v[196:199], v245 offset:13312
    s_waitcnt lgkmcnt(5)
    v_mfma_f32_32x32x16_bf16 a[64:79], v[224:227], v[48:51], a[64:79]
    ds_read_b64_tr_b16 v[236:237], v246 offset:54080
    ds_read_b64_tr_b16 v[238:239], v246 offset:56160
    v_mfma_f32_32x32x16_bf16 a[80:95], v[224:227], v[112:115], a[80:95]
    s_waitcnt lgkmcnt(5)
    v_mfma_f32_32x32x16_bf16 a[96:111], v[228:231], v[48:51], a[96:111]
    ds_read_b64_tr_b16 v[224:225], v246 offset:54336
    ds_read_b64_tr_b16 v[226:227], v246 offset:56416
    v_mfma_f32_32x32x16_bf16 a[112:127], v[228:231], v[112:115], a[112:127]
    s_waitcnt lgkmcnt(5)
    v_mfma_f32_32x32x16_bf16 v[128:143], v[232:235], v[192:195], v[128:143]
    ds_read_b64_tr_b16 v[228:229], v248 offset:54080
    ds_read_b64_tr_b16 v[230:231], v248 offset:56160
    ds_read_b128 v[192:195], v245 offset:14336
    s_waitcnt lgkmcnt(5)
    v_mfma_f32_32x32x16_bf16 a[64:79], v[236:239], v[52:55], a[64:79]
    ds_read_b64_tr_b16 v[232:233], v246 offset:58240
    ds_read_b64_tr_b16 v[234:235], v246 offset:60320
    v_mfma_f32_32x32x16_bf16 a[80:95], v[236:239], v[116:119], a[80:95]
    s_waitcnt lgkmcnt(5)
    v_mfma_f32_32x32x16_bf16 a[96:111], v[224:227], v[52:55], a[96:111]
    ds_read_b64_tr_b16 v[236:237], v246 offset:58496
    ds_read_b64_tr_b16 v[238:239], v246 offset:60576
    v_mfma_f32_32x32x16_bf16 a[112:127], v[224:227], v[116:119], a[112:127]
    s_waitcnt lgkmcnt(5)
    v_mfma_f32_32x32x16_bf16 v[128:143], v[228:231], v[196:199], v[128:143]
    ds_read_b64_tr_b16 v[224:225], v248 offset:58240
    ds_read_b64_tr_b16 v[226:227], v248 offset:60320
    ds_read_b128 v[196:199], v245 offset:15360
    s_waitcnt lgkmcnt(5)
    v_mfma_f32_32x32x16_bf16 a[64:79], v[232:235], v[56:59], a[64:79]
    ds_read_b64_tr_b16 v[228:229], v246 offset:62400
    ds_read_b64_tr_b16 v[230:231], v246 offset:64480
    v_mfma_f32_32x32x16_bf16 a[80:95], v[232:235], v[120:123], a[80:95]
    s_waitcnt lgkmcnt(5)
    v_mfma_f32_32x32x16_bf16 a[96:111], v[236:239], v[56:59], a[96:111]
    ds_read_b64_tr_b16 v[232:233], v246 offset:62656
    ds_read_b64_tr_b16 v[234:235], v246 offset:64736
    v_mfma_f32_32x32x16_bf16 a[112:127], v[236:239], v[120:123], a[112:127]
    s_waitcnt vmcnt(0)
    s_add_u32 s39, s13, 6
    s_mov_b64 exec, 1
    v_mov_b32 v187, s39
    s_cmp_eq_u32 s12, 16
    s_cbranch_scc1 L_arf6
    buffer_store_dword v187, off, s[24:27], s41 sc1
    s_branch L_are6
L_arf6:
    buffer_store_dword v187, off, s[24:27], s41
L_are6:
    s_mov_b64 exec, -1
    s_lshl_b32 s88, s86, 19
    s_add_u32 s88, s88, s37
    s_lshl_b32 s87, s86, 7
    s_add_u32 s87, s87, s42
    v_sub_u32 v186, v186, v243
    v_cmp_lt_u32 vcc, s86, v186
    s_nop 0
    s_cmp_eq_u64 vcc, -1
    s_cselect_b32 s88, s88, 0x7fff0000
    s_cselect_b32 s87, s87, 0x7fff0000
    s_addc_u32 s86, s86, 0
    s_waitcnt lgkmcnt(5)
    v_mfma_f32_32x32x16_bf16 v[128:143], v[224:227], v[192:195], v[128:143]
    ds_read_b64_tr_b16 v[236:237], v248 offset:62400
    ds_read_b64_tr_b16 v[238:239], v248 offset:64480
    buffer_load_dwordx4 v[144:147], v245, s[24:27], s88 offen sc1
    buffer_load_dwordx4 v[148:151], v245, s[24:27], s88 offen offset:1024 sc1
    s_waitcnt lgkmcnt(4)
    v_mfma_f32_32x32x16_bf16 a[64:79], v[228:231], v[60:63], a[64:79]
    buffer_load_dwordx4 v[152:155], v245, s[24:27], s88 offen offset:2048 sc1
    buffer_load_dwordx4 v[156:159], v245, s[24:27], s88 offen offset:3072 sc1
    v_mfma_f32_32x32x16_bf16 a[80:95], v[228:231], v[124:127], a[80:95]
    s_add_u32 s88, s88, 4096
    buffer_load_dwordx4 v[160:163], v245, s[24:27], s88 offen sc1
    s_waitcnt lgkmcnt(2)
    v_mfma_f32_32x32x16_bf16 a[96:111], v[232:235], v[60:63], a[96:111]
    buffer_load_dwordx4 v[164:167], v245, s[24:27], s88 offen offset:1024 sc1
    buffer_load_dwordx4 v[168:171], v245, s[24:27], s88 offen offset:2048 sc1
    v_mfma_f32_32x32x16_bf16 a[112:127], v[232:235], v[124:127], a[112:127]
    buffer_load_dwordx4 v[172:175], v245, s[24:27], s88 offen offset:3072 sc1
    s_waitcnt lgkmcnt(0)
    v_mfma_f32_32x32x16_bf16 v[128:143], v[236:239], v[196:199], v[128:143]
    v_accvgpr_read_b32 v250, a64
    v_accvgpr_read_b32 v251, a65
    v_cvt_pk_bf16_f32 v252, v250, v251
    v_accvgpr_read_b32 v250, a66
    v_accvgpr_read_b32 v251, a67
    v_cvt_pk_bf16_f32 v253, v250, v251
    v_accvgpr_read_b32 v250, a68
    v_accvgpr_read_b32 v251, a69
    v_cvt_pk_bf16_f32 v254, v250, v251
    v_accvgpr_read_b32 v250, a70
    v_accvgpr_read_b32 v251, a71
    v_cvt_pk_bf16_f32 v255, v250, v251
    s_add_u32 s39, s58, 3145728
    buffer_store_dwordx4 v[252:255], v240, s[24:27], s39 offen sc1
    v_accvgpr_read_b32 v250, a72
    v_accvgpr_read_b32 v251, a73
    v_cvt_pk_bf16_f32 v204, v250, v251
    v_accvgpr_read_b32 v250, a74
    v_accvgpr_read_b32 v251, a75
    v_cvt_pk_bf16_f32 v205, v250, v251
    v_accvgpr_read_b32 v250, a76
    v_accvgpr_read_b32 v251, a77
    v_cvt_pk_bf16_f32 v206, v250, v251
    v_accvgpr_read_b32 v250, a78
    v_accvgpr_read_b32 v251, a79
    v_cvt_pk_bf16_f32 v207, v250, v251
    s_add_u32 s39, s58, 3145728
    buffer_store_dwordx4 v[204:207], v240, s[24:27], s39 offen offset:128 sc1
    v_accvgpr_read_b32 v250, a80
    v_accvgpr_read_b32 v251, a81
    v_cvt_pk_bf16_f32 v252, v250, v251
    v_accvgpr_read_b32 v250, a82
    v_accvgpr_read_b32 v251, a83
    v_cvt_pk_bf16_f32 v253, v250, v251
    v_accvgpr_read_b32 v250, a84
    v_accvgpr_read_b32 v251, a85
    v_cvt_pk_bf16_f32 v254, v250, v251
    v_accvgpr_read_b32 v250, a86
    v_accvgpr_read_b32 v251, a87
    v_cvt_pk_bf16_f32 v255, v250, v251
    s_add_u32 s39, s58, 3211264
    buffer_store_dwordx4 v[252:255], v240, s[24:27], s39 offen sc1
    v_accvgpr_read_b32 v250, a88
    v_accvgpr_read_b32 v251, a89
    v_cvt_pk_bf16_f32 v204, v250, v251
    v_accvgpr_read_b32 v250, a90
    v_accvgpr_read_b32 v251, a91
    v_cvt_pk_bf16_f32 v205, v250, v251
    v_accvgpr_read_b32 v250, a92
    v_accvgpr_read_b32 v251, a93
    v_cvt_pk_bf16_f32 v206, v250, v251
    v_accvgpr_read_b32 v250, a94
    v_accvgpr_read_b32 v251, a95
    v_cvt_pk_bf16_f32 v207, v250, v251
    s_add_u32 s39, s58, 3211264
    buffer_store_dwordx4 v[204:207], v240, s[24:27], s39 offen offset:128 sc1
    v_accvgpr_read_b32 v250, a96
    v_accvgpr_read_b32 v251, a97
    v_cvt_pk_bf16_f32 v252, v250, v251
    v_accvgpr_read_b32 v250, a98
    v_accvgpr_read_b32 v251, a99
    v_cvt_pk_bf16_f32 v253, v250, v251
    v_accvgpr_read_b32 v250, a100
    v_accvgpr_read_b32 v251, a101
    v_cvt_pk_bf16_f32 v254, v250, v251
    v_accvgpr_read_b32 v250, a102
    v_accvgpr_read_b32 v251, a103
    v_cvt_pk_bf16_f32 v255, v250, v251
    s_add_u32 s39, s58, 3145728
    buffer_store_dwordx4 v[252:255], v240, s[24:27], s39 offen offset:256 sc1
    v_accvgpr_read_b32 v250, a104
    v_accvgpr_read_b32 v251, a105
    v_cvt_pk_bf16_f32 v204, v250, v251
    v_accvgpr_read_b32 v250, a106
    v_accvgpr_read_b32 v251, a107
    v_cvt_pk_bf16_f32 v205, v250, v251
    v_accvgpr_read_b32 v250, a108
    v_accvgpr_read_b32 v251, a109
    v_cvt_pk_bf16_f32 v206, v250, v251
    v_accvgpr_read_b32 v250, a110
    v_accvgpr_read_b32 v251, a111
    v_cvt_pk_bf16_f32 v207, v250, v251
    s_add_u32 s39, s58, 3145728
    buffer_store_dwordx4 v[204:207], v240, s[24:27], s39 offen offset:384 sc1
    v_accvgpr_read_b32 v250, a112
    v_accvgpr_read_b32 v251, a113
    v_cvt_pk_bf16_f32 v252, v250, v251
    v_accvgpr_read_b32 v250, a114
    v_accvgpr_read_b32 v251, a115
    v_cvt_pk_bf16_f32 v253, v250, v251
    v_accvgpr_read_b32 v250, a116
    v_accvgpr_read_b32 v251, a117
    v_cvt_pk_bf16_f32 v254, v250, v251
    v_accvgpr_read_b32 v250, a118
    v_accvgpr_read_b32 v251, a119
    v_cvt_pk_bf16_f32 v255, v250, v251
    s_add_u32 s39, s58, 3211264
    buffer_store_dwordx4 v[252:255], v240, s[24:27], s39 offen offset:256 sc1
    v_accvgpr_read_b32 v250, a120
    v_accvgpr_read_b32 v251, a121
    v_cvt_pk_bf16_f32 v204, v250, v251
    v_accvgpr_read_b32 v250, a122
    v_accvgpr_read_b32 v251, a123
    v_cvt_pk_bf16_f32 v205, v250, v251
    v_accvgpr_read_b32 v250, a124
    v_accvgpr_read_b32 v251, a125
    v_cvt_pk_bf16_f32 v206, v250, v251
    v_accvgpr_read_b32 v250, a126
    v_accvgpr_read_b32 v251, a127
    v_cvt_pk_bf16_f32 v207, v250, v251
    s_add_u32 s39, s58, 3211264
    buffer_store_dwordx4 v[204:207], v240, s[24:27], s39 offen offset:384 sc1
    v_cvt_pk_bf16_f32 v252, v128, v129
    v_cvt_pk_bf16_f32 v253, v130, v131
    v_cvt_pk_bf16_f32 v254, v132, v133
    v_cvt_pk_bf16_f32 v255, v134, v135
    s_add_u32 s39, s51, 393216
    buffer_store_dwordx4 v[252:255], v240, s[24:27], s39 offen sc1
    v_cvt_pk_bf16_f32 v204, v136, v137
    v_cvt_pk_bf16_f32 v205, v138, v139
    v_cvt_pk_bf16_f32 v206, v140, v141
    v_cvt_pk_bf16_f32 v207, v142, v143
    s_add_u32 s39, s51, 393216
    buffer_store_dwordx4 v[204:207], v240, s[24:27], s39 offen offset:128 sc1
    s_waitcnt vmcnt(17)
    v_lshlrev_b32 v176, 16, v144
    v_and_b32 v177, 0xffff0000, v144
    v_lshlrev_b32 v178, 16, v145
    v_and_b32 v179, 0xffff0000, v145
    v_lshlrev_b32 v180, 16, v146
    v_and_b32 v181, 0xffff0000, v146
    v_lshlrev_b32 v182, 16, v147
    v_and_b32 v183, 0xffff0000, v147
    s_waitcnt vmcnt(16)
    v_dot2c_f32_bf16 v176, s32, v148
    v_dot2c_f32_bf16 v177, s33, v148
    v_dot2c_f32_bf16 v178, s32, v149
    v_dot2c_f32_bf16 v179, s33, v149
    v_dot2c_f32_bf16 v180, s32, v150
    v_dot2c_f32_bf16 v181, s33, v150
    v_dot2c_f32_bf16 v182, s32, v151
    v_dot2c_f32_bf16 v183, s33, v151
    s_waitcnt vmcnt(15)
    v_dot2c_f32_bf16 v176, s32, v152
    v_dot2c_f32_bf16 v177, s33, v152
    v_dot2c_f32_bf16 v178, s32, v153
    v_dot2c_f32_bf16 v179, s33, v153
    v_dot2c_f32_bf16 v180, s32, v154
    v_dot2c_f32_bf16 v181, s33, v154
    v_dot2c_f32_bf16 v182, s32, v155
    v_dot2c_f32_bf16 v183, s33, v155
    s_waitcnt vmcnt(14)
    v_dot2c_f32_bf16 v176, s32, v156
    v_dot2c_f32_bf16 v177, s33, v156
    v_dot2c_f32_bf16 v178, s32, v157
    v_dot2c_f32_bf16 v179, s33, v157
    v_dot2c_f32_bf16 v180, s32, v158
    v_dot2c_f32_bf16 v181, s33, v158
    v_dot2c_f32_bf16 v182, s32, v159
    v_dot2c_f32_bf16 v183, s33, v159
    s_waitcnt vmcnt(13)
    v_dot2c_f32_bf16 v176, s32, v160
    v_dot2c_f32_bf16 v177, s33, v160
    v_dot2c_f32_bf16 v178, s32, v161
    v_dot2c_f32_bf16 v179, s33, v161
    v_dot2c_f32_bf16 v180, s32, v162
    v_dot2c_f32_bf16 v181, s33, v162
    v_dot2c_f32_bf16 v182, s32, v163
    v_dot2c_f32_bf16 v183, s33, v163
    s_waitcnt vmcnt(12)
    v_dot2c_f32_bf16 v176, s32, v164
    v_dot2c_f32_bf16 v177, s33, v164
    v_dot2c_f32_bf16 v178, s32, v165
    v_dot2c_f32_bf16 v179, s33, v165
    v_dot2c_f32_bf16 v180, s32, v166
    v_dot2c_f32_bf16 v181, s33, v166
    v_dot2c_f32_bf16 v182, s32, v167
    v_dot2c_f32_bf16 v183, s33, v167
    s_waitcnt vmcnt(11)
    v_dot2c_f32_bf16 v176, s32, v168
    v_dot2c_f32_bf16 v177, s33, v168
    v_dot2c_f32_bf16 v178, s32, v169
    v_dot2c_f32_bf16 v179, s33, v169
    v_dot2c_f32_bf16 v180, s32, v170
    v_dot2c_f32_bf16 v181, s33, v170
    v_dot2c_f32_bf16 v182, s32, v171
    v_dot2c_f32_bf16 v183, s33, v171
    s_waitcnt vmcnt(10)
    v_dot2c_f32_bf16 v176, s32, v172
    v_dot2c_f32_bf16 v177, s33, v172
    v_dot2c_f32_bf16 v178, s32, v173
    v_dot2c_f32_bf16 v179, s33, v173
    v_dot2c_f32_bf16 v180, s32, v174
    v_dot2c_f32_bf16 v181, s33, v174
    v_dot2c_f32_bf16 v182, s32, v175
    v_dot2c_f32_bf16 v183, s33, v175
    s_nop 2
    v_permlane32_swap_b32 v176, v180
    v_permlane32_swap_b32 v177, v181
    v_permlane32_swap_b32 v178, v182
    v_permlane32_swap_b32 v179, v183
    v_add_f32 v176, v176, v180
    v_add_f32 v177, v177, v181
    v_add_f32 v178, v178, v182
    v_add_f32 v179, v179, v183
    v_cvt_pk_bf16_f32 v184, v176, v177
    v_cvt_pk_bf16_f32 v185, v178, v179
    buffer_store_dwordx2 v[184:185], v241, s[92:95], s87 offen
    buffer_load_dword v186, v242, s[24:27], s91 offen sc1
    s_waitcnt vmcnt(0)
    s_add_u32 s39, s13, 7
    s_mov_b64 exec, 1
    v_mov_b32 v187, s39
    s_cmp_eq_u32 s12, 16
    s_cbranch_scc1 L_arf7
    buffer_store_dword v187, off, s[24:27], s41 sc1
    s_branch L_are7
L_arf7:
    buffer_store_dword v187, off, s[24:27], s41
L_are7:
    s_mov_b64 exec, -1
    s_lshl_b32 s8, 1, s86
    s_sub_u32 s8, s8, 1
    s_mov_b32 s9, 4000
    s_branch L_eval
L_poll:
    buffer_load_dword v186, v242, s[24:27], s91 offen sc1
    s_waitcnt vmcnt(0)
L_eval:
    v_sub_u32 v186, v186, v243
    s_mov_b32 s3, 0
    v_cmp_le_u32 vcc, 1, v186
    s_nop 0
    s_cmp_eq_u64 vcc, -1
    s_cselect_b32 s39, 1, 0
    s_or_b32 s3, s3, s39
    v_cmp_le_u32 vcc, 2, v186
    s_nop 0
    s_cmp_eq_u64 vcc, -1
    s_cselect_b32 s39, 2, 0
    s_or_b32 s3, s3, s39
    v_cmp_le_u32 vcc, 3, v186
    s_nop 0
    s_cmp_eq_u64 vcc, -1
    s_cselect_b32 s39, 4, 0
    s_or_b32 s3, s3, s39
    v_cmp_le_u32 vcc, 4, v186
    s_nop 0
    s_cmp_eq_u64 vcc, -1
    s_cselect_b32 s39, 8, 0
    s_or_b32 s3, s3, s39
    v_cmp_le_u32 vcc, 5, v186
    s_nop 0
    s_cmp_eq_u64 vcc, -1
    s_cselect_b32 s39, 16, 0
    s_or_b32 s3, s3, s39
    v_cmp_le_u32 vcc, 6, v186
    s_nop 0
    s_cmp_eq_u64 vcc, -1
    s_cselect_b32 s39, 32, 0
    s_or_b32 s3, s3, s39
    v_cmp_le_u32 vcc, 7, v186
    s_nop 0
    s_cmp_eq_u64 vcc, -1
    s_cselect_b32 s39, 192, 0
    s_or_b32 s3, s3, s39
    s_andn2_b32 s3, s3, s8
    s_cbranch_scc1 L_have
    s_sleep 1
    s_sub_u32 s9, s9, 1
    s_cmp_lg_u32 s9, 0
    s_cbranch_scc1 L_poll
    v_mov_b32 v0, 161792
    v_mov_b32 v1, 1
    ds_write_b32 v0, v1 offset:256
    s_branch L_mine_done
L_have:
    s_or_b32 s8, s8, s3
    s_and_b32 s58, s3, 15
    s_cbranch_scc0 L_hi
    s_mov_b32 s11, 0
    s_call_b64 s[44:45], L_proc4
L_hi:
    s_lshr_b32 s58, s3, 4
    s_cbranch_scc0 L_nohi
    s_mov_b32 s11, 4
    s_call_b64 s[44:45], L_proc4
L_nohi:
    s_cmp_lg_u32 s8, 255
    s_cbranch_scc1 L_poll
L_mine_done:
    s_waitcnt vmcnt(0) lgkmcnt(0)
    s_barrier
    s_cmp_lg_u32 s28, 0
    s_cbranch_scc1 L_alldone
    v_mov_b32 v0, 161792
    ds_read_b32 v1, v0 offset:256
    s_add_u32 s40, s47, 16
    s_waitcnt lgkmcnt(0)
    v_readfirstlane_b32 s39, v1
    s_nop 0
    s_lshl_b32 s100, s39, s40
    s_add_u32 s39, s100, 1
    s_mov_b64 exec, 1
    v_mov_b32 v188, s39
    buffer_atomic_add v188, off, s[96:99], s90 sc0 sc1
    s_waitcnt vmcnt(0)
    v_readfirstlane_b32 s10, v188
    s_mov_b64 exec, -1
    s_and_b32 s39, s10, 31
    s_or_b32 s100, s100, s10
    s_lshr_b32 s100, s100, 16
    s_cmp_lg_u32 s39, 15
    s_cbranch_scc1 L_alldone
L_gu:
    s_cmp_eq_u32 s100, 0
    s_cbranch_scc1 L_alldone
    s_ff1_i32_b32 s10, s100
    s_bitset0_b32 s100, s10
    s_lshl_b32 s36, s10, 2
L_guw:
    s_lshl_b32 s37, s36, 13
    s_add_u32 s37, s37, s56
    s_mul_i32 s42, s36, 7168
    s_add_u32 s42, s42, s35
    s_and_b32 s39, s36, 7
    s_mul_i32 s43, s39, 7168
    s_lshr_b32 s39, s36, 3
    s_lshl_b32 s39, s39, 7
    s_add_u32 s43, s43, s39
    s_add_u32 s43, s43, s35
    s_add_u32 s43, s43, 458752
    s_add_u32 s46, s37, 3670016
    s_cmp_lt_u32 s36, 56
    s_cselect_b32 s43, s43, 0x7fff0000
    s_cselect_b32 s46, s46, 0x7fff0000
    s_mov_b32 s58, 15
    s_mov_b32 s11, 0
    s_call_b64 s[44:45], L_proc4
    s_mov_b32 s58, 15
    s_mov_b32 s11, 4
    s_call_b64 s[44:45], L_proc4
    s_add_u32 s36, s36, 1
    s_and_b32 s39, s36, 3
    s_cbranch_scc1 L_guw
    s_branch L_gu
L_alldone:
    s_waitcnt vmcnt(0)
L_exit:
    s_endpgm
L_proc4:
    s_add_u32 s39, s11, 0
    s_lshl_b32 s88, s39, 19
    s_add_u32 s88, s88, s37
    s_lshl_b32 s50, s39, 7
    s_add_u32 s50, s50, s42
    s_cmp_eq_u32 s39, 7
    s_cselect_b32 s88, s46, s88
    s_cselect_b32 s50, s43, s50
    s_bitcmp1_b32 s58, 0
    s_cselect_b32 s88, s88, 0x7fff0000
    s_cselect_b32 s50, s50, 0x7fff0000
    buffer_load_dwordx4 v[0:3], v245, s[24:27], s88 offen sc1
    buffer_load_dwordx4 v[4:7], v245, s[24:27], s88 offen offset:1024 sc1
    buffer_load_dwordx4 v[8:11], v245, s[24:27], s88 offen offset:2048 sc1
    buffer_load_dwordx4 v[12:15], v245, s[24:27], s88 offen offset:3072 sc1
    s_add_u32 s88, s88, 4096
    buffer_load_dwordx4 v[16:19], v245, s[24:27], s88 offen sc1
    buffer_load_dwordx4 v[20:23], v245, s[24:27], s88 offen offset:1024 sc1
    buffer_load_dwordx4 v[24:27], v245, s[24:27], s88 offen offset:2048 sc1
    buffer_load_dwordx4 v[28:31], v245, s[24:27], s88 offen offset:3072 sc1
    s_add_u32 s39, s11, 1
    s_lshl_b32 s88, s39, 19
    s_add_u32 s88, s88, s37
    s_lshl_b32 s51, s39, 7
    s_add_u32 s51, s51, s42
    s_cmp_eq_u32 s39, 7
    s_cselect_b32 s88, s46, s88
    s_cselect_b32 s51, s43, s51
    s_bitcmp1_b32 s58, 1
    s_cselect_b32 s88, s88, 0x7fff0000
    s_cselect_b32 s51, s51, 0x7fff0000
    buffer_load_dwordx4 v[32:35], v245, s[24:27], s88 offen sc1
    buffer_load_dwordx4 v[36:39], v245, s[24:27], s88 offen offset:1024 sc1
    buffer_load_dwordx4 v[40:43], v245, s[24:27], s88 offen offset:2048 sc1
    buffer_load_dwordx4 v[44:47], v245, s[24:27], s88 offen offset:3072 sc1
    s_add_u32 s88, s88, 4096
    buffer_load_dwordx4 v[48:51], v245, s[24:27], s88 offen sc1
    buffer_load_dwordx4 v[52:55], v245, s[24:27], s88 offen offset:1024 sc1
    buffer_load_dwordx4 v[56:59], v245, s[24:27], s88 offen offset:2048 sc1
    buffer_load_dwordx4 v[60:63], v245, s[24:27], s88 offen offset:3072 sc1
    s_add_u32 s39, s11, 2
    s_lshl_b32 s88, s39, 19
    s_add_u32 s88, s88, s37
    s_lshl_b32 s57, s39, 7
    s_add_u32 s57, s57, s42
    s_cmp_eq_u32 s39, 7
    s_cselect_b32 s88, s46, s88
    s_cselect_b32 s57, s43, s57
    s_bitcmp1_b32 s58, 2
    s_cselect_b32 s88, s88, 0x7fff0000
    s_cselect_b32 s57, s57, 0x7fff0000
    buffer_load_dwordx4 v[64:67], v245, s[24:27], s88 offen sc1
    buffer_load_dwordx4 v[68:71], v245, s[24:27], s88 offen offset:1024 sc1
    buffer_load_dwordx4 v[72:75], v245, s[24:27], s88 offen offset:2048 sc1
    buffer_load_dwordx4 v[76:79], v245, s[24:27], s88 offen offset:3072 sc1
    s_add_u32 s88, s88, 4096
    buffer_load_dwordx4 v[80:83], v245, s[24:27], s88 offen sc1
    buffer_load_dwordx4 v[84:87], v245, s[24:27], s88 offen offset:1024 sc1
    buffer_load_dwordx4 v[88:91], v245, s[24:27], s88 offen offset:2048 sc1
    buffer_load_dwordx4 v[92:95], v245, s[24:27], s88 offen offset:3072 sc1
    s_add_u32 s39, s11, 3
    s_lshl_b32 s88, s39, 19
    s_add_u32 s88, s88, s37
    s_lshl_b32 s101, s39, 7
    s_add_u32 s101, s101, s42
    s_cmp_eq_u32 s39, 7
    s_cselect_b32 s88, s46, s88
    s_cselect_b32 s101, s43, s101
    s_bitcmp1_b32 s58, 3
    s_cselect_b32 s88, s88, 0x7fff0000
    s_cselect_b32 s101, s101, 0x7fff0000
    buffer_load_dwordx4 v[96:99], v245, s[24:27], s88 offen sc1
    buffer_load_dwordx4 v[100:103], v245, s[24:27], s88 offen offset:1024 sc1
    buffer_load_dwordx4 v[104:107], v245, s[24:27], s88 offen offset:2048 sc1
    buffer_load_dwordx4 v[108:111], v245, s[24:27], s88 offen offset:3072 sc1
    s_add_u32 s88, s88, 4096
    buffer_load_dwordx4 v[112:115], v245, s[24:27], s88 offen sc1
    buffer_load_dwordx4 v[116:119], v245, s[24:27], s88 offen offset:1024 sc1
    buffer_load_dwordx4 v[120:123], v245, s[24:27], s88 offen offset:2048 sc1
    buffer_load_dwordx4 v[124:127], v245, s[24:27], s88 offen offset:3072 sc1
    s_bitcmp1_b32 s58, 0
    s_cbranch_scc0 L_p4s1_0
    s_waitcnt vmcnt(24)
    v_lshlrev_b32 v192, 16, v0
    v_and_b32 v193, 0xffff0000, v0
    v_lshlrev_b32 v194, 16, v1
    v_and_b32 v195, 0xffff0000, v1
    v_lshlrev_b32 v196, 16, v2
    v_and_b32 v197, 0xffff0000, v2
    v_lshlrev_b32 v198, 16, v3
    v_and_b32 v199, 0xffff0000, v3
    v_dot2c_f32_bf16 v192, s32, v4
    v_dot2c_f32_bf16 v193, s33, v4
    v_dot2c_f32_bf16 v194, s32, v5
    v_dot2c_f32_bf16 v195, s33, v5
    v_dot2c_f32_bf16 v196, s32, v6
    v_dot2c_f32_bf16 v197, s33, v6
    v_dot2c_f32_bf16 v198, s32, v7
    v_dot2c_f32_bf16 v199, s33, v7
    v_dot2c_f32_bf16 v192, s32, v8
    v_dot2c_f32_bf16 v193, s33, v8
    v_dot2c_f32_bf16 v194, s32, v9
    v_dot2c_f32_bf16 v195, s33, v9
    v_dot2c_f32_bf16 v196, s32, v10
    v_dot2c_f32_bf16 v197, s33, v10
    v_dot2c_f32_bf16 v198, s32, v11
    v_dot2c_f32_bf16 v199, s33, v11
    v_dot2c_f32_bf16 v192, s32, v12
    v_dot2c_f32_bf16 v193, s33, v12
    v_dot2c_f32_bf16 v194, s32, v13
    v_dot2c_f32_bf16 v195, s33, v13
    v_dot2c_f32_bf16 v196, s32, v14
    v_dot2c_f32_bf16 v197, s33, v14
    v_dot2c_f32_bf16 v198, s32, v15
    v_dot2c_f32_bf16 v199, s33, v15
    v_dot2c_f32_bf16 v192, s32, v16
    v_dot2c_f32_bf16 v193, s33, v16
    v_dot2c_f32_bf16 v194, s32, v17
    v_dot2c_f32_bf16 v195, s33, v17
    v_dot2c_f32_bf16 v196, s32, v18
    v_dot2c_f32_bf16 v197, s33, v18
    v_dot2c_f32_bf16 v198, s32, v19
    v_dot2c_f32_bf16 v199, s33, v19
    v_dot2c_f32_bf16 v192, s32, v20
    v_dot2c_f32_bf16 v193, s33, v20
    v_dot2c_f32_bf16 v194, s32, v21
    v_dot2c_f32_bf16 v195, s33, v21
    v_dot2c_f32_bf16 v196, s32, v22
    v_dot2c_f32_bf16 v197, s33, v22
    v_dot2c_f32_bf16 v198, s32, v23
    v_dot2c_f32_bf16 v199, s33, v23
    v_dot2c_f32_bf16 v192, s32, v24
    v_dot2c_f32_bf16 v193, s33, v24
    v_dot2c_f32_bf16 v194, s32, v25
    v_dot2c_f32_bf16 v195, s33, v25
    v_dot2c_f32_bf16 v196, s32, v26
    v_dot2c_f32_bf16 v197, s33, v26
    v_dot2c_f32_bf16 v198, s32, v27
    v_dot2c_f32_bf16 v199, s33, v27
    v_dot2c_f32_bf16 v192, s32, v28
    v_dot2c_f32_bf16 v193, s33, v28
    v_dot2c_f32_bf16 v194, s32, v29
    v_dot2c_f32_bf16 v195, s33, v29
    v_dot2c_f32_bf16 v196, s32, v30
    v_dot2c_f32_bf16 v197, s33, v30
    v_dot2c_f32_bf16 v198, s32, v31
    v_dot2c_f32_bf16 v199, s33, v31
    s_nop 2
    v_permlane32_swap_b32 v192, v196
    v_permlane32_swap_b32 v193, v197
    v_permlane32_swap_b32 v194, v198
    v_permlane32_swap_b32 v195, v199
    v_add_f32 v192, v192, v196
    v_add_f32 v193, v193, v197
    v_add_f32 v194, v194, v198
    v_add_f32 v195, v195, v199
    v_cvt_pk_bf16_f32 v224, v192, v193
    v_cvt_pk_bf16_f32 v225, v194, v195
    buffer_store_dwordx2 v[224:225], v241, s[92:95], s50 offen
L_p4s1_0:
    s_bitcmp1_b32 s58, 1
    s_cbranch_scc0 L_p4s1_1
    s_waitcnt vmcnt(16)
    v_lshlrev_b32 v200, 16, v32
    v_and_b32 v201, 0xffff0000, v32
    v_lshlrev_b32 v202, 16, v33
    v_and_b32 v203, 0xffff0000, v33
    v_lshlrev_b32 v204, 16, v34
    v_and_b32 v205, 0xffff0000, v34
    v_lshlrev_b32 v206, 16, v35
    v_and_b32 v207, 0xffff0000, v35
    v_dot2c_f32_bf16 v200, s32, v36
    v_dot2c_f32_bf16 v201, s33, v36
    v_dot2c_f32_bf16 v202, s32, v37
    v_dot2c_f32_bf16 v203, s33, v37
    v_dot2c_f32_bf16 v204, s32, v38
    v_dot2c_f32_bf16 v205, s33, v38
    v_dot2c_f32_bf16 v206, s32, v39
    v_dot2c_f32_bf16 v207, s33, v39
    v_dot2c_f32_bf16 v200, s32, v40
    v_dot2c_f32_bf16 v201, s33, v40
    v_dot2c_f32_bf16 v202, s32, v41
    v_dot2c_f32_bf16 v203, s33, v41
    v_dot2c_f32_bf16 v204, s32, v42
    v_dot2c_f32_bf16 v205, s33, v42
    v_dot2c_f32_bf16 v206, s32, v43
    v_dot2c_f32_bf16 v207, s33, v43
    v_dot2c_f32_bf16 v200, s32, v44
    v_dot2c_f32_bf16 v201, s33, v44
    v_dot2c_f32_bf16 v202, s32, v45
    v_dot2c_f32_bf16 v203, s33, v45
    v_dot2c_f32_bf16 v204, s32, v46
    v_dot2c_f32_bf16 v205, s33, v46
    v_dot2c_f32_bf16 v206, s32, v47
    v_dot2c_f32_bf16 v207, s33, v47
    v_dot2c_f32_bf16 v200, s32, v48
    v_dot2c_f32_bf16 v201, s33, v48
    v_dot2c_f32_bf16 v202, s32, v49
    v_dot2c_f32_bf16 v203, s33, v49
    v_dot2c_f32_bf16 v204, s32, v50
    v_dot2c_f32_bf16 v205, s33, v50
    v_dot2c_f32_bf16 v206, s32, v51
    v_dot2c_f32_bf16 v207, s33, v51
    v_dot2c_f32_bf16 v200, s32, v52
    v_dot2c_f32_bf16 v201, s33, v52
    v_dot2c_f32_bf16 v202, s32, v53
    v_dot2c_f32_bf16 v203, s33, v53
    v_dot2c_f32_bf16 v204, s32, v54
    v_dot2c_f32_bf16 v205, s33, v54
    v_dot2c_f32_bf16 v206, s32, v55
    v_dot2c_f32_bf16 v207, s33, v55
    v_dot2c_f32_bf16 v200, s32, v56
    v_dot2c_f32_bf16 v201, s33, v56
    v_dot2c_f32_bf16 v202, s32, v57
    v_dot2c_f32_bf16 v203, s33, v57
    v_dot2c_f32_bf16 v204, s32, v58
    v_dot2c_f32_bf16 v205, s33, v58
    v_dot2c_f32_bf16 v206, s32, v59
    v_dot2c_f32_bf16 v207, s33, v59
    v_dot2c_f32_bf16 v200, s32, v60
    v_dot2c_f32_bf16 v201, s33, v60
    v_dot2c_f32_bf16 v202, s32, v61
    v_dot2c_f32_bf16 v203, s33, v61
    v_dot2c_f32_bf16 v204, s32, v62
    v_dot2c_f32_bf16 v205, s33, v62
    v_dot2c_f32_bf16 v206, s32, v63
    v_dot2c_f32_bf16 v207, s33, v63
    s_nop 2
    v_permlane32_swap_b32 v200, v204
    v_permlane32_swap_b32 v201, v205
    v_permlane32_swap_b32 v202, v206
    v_permlane32_swap_b32 v203, v207
    v_add_f32 v200, v200, v204
    v_add_f32 v201, v201, v205
    v_add_f32 v202, v202, v206
    v_add_f32 v203, v203, v207
    v_cvt_pk_bf16_f32 v226, v200, v201
    v_cvt_pk_bf16_f32 v227, v202, v203
    buffer_store_dwordx2 v[226:227], v241, s[92:95], s51 offen
L_p4s1_1:
    s_bitcmp1_b32 s58, 2
    s_cbranch_scc0 L_p4s1_2
    s_waitcnt vmcnt(8)
    v_lshlrev_b32 v208, 16, v64
    v_and_b32 v209, 0xffff0000, v64
    v_lshlrev_b32 v210, 16, v65
    v_and_b32 v211, 0xffff0000, v65
    v_lshlrev_b32 v212, 16, v66
    v_and_b32 v213, 0xffff0000, v66
    v_lshlrev_b32 v214, 16, v67
    v_and_b32 v215, 0xffff0000, v67
    v_dot2c_f32_bf16 v208, s32, v68
    v_dot2c_f32_bf16 v209, s33, v68
    v_dot2c_f32_bf16 v210, s32, v69
    v_dot2c_f32_bf16 v211, s33, v69
    v_dot2c_f32_bf16 v212, s32, v70
    v_dot2c_f32_bf16 v213, s33, v70
    v_dot2c_f32_bf16 v214, s32, v71
    v_dot2c_f32_bf16 v215, s33, v71
    v_dot2c_f32_bf16 v208, s32, v72
    v_dot2c_f32_bf16 v209, s33, v72
    v_dot2c_f32_bf16 v210, s32, v73
    v_dot2c_f32_bf16 v211, s33, v73
    v_dot2c_f32_bf16 v212, s32, v74
    v_dot2c_f32_bf16 v213, s33, v74
    v_dot2c_f32_bf16 v214, s32, v75
    v_dot2c_f32_bf16 v215, s33, v75
    v_dot2c_f32_bf16 v208, s32, v76
    v_dot2c_f32_bf16 v209, s33, v76
    v_dot2c_f32_bf16 v210, s32, v77
    v_dot2c_f32_bf16 v211, s33, v77
    v_dot2c_f32_bf16 v212, s32, v78
    v_dot2c_f32_bf16 v213, s33, v78
    v_dot2c_f32_bf16 v214, s32, v79
    v_dot2c_f32_bf16 v215, s33, v79
    v_dot2c_f32_bf16 v208, s32, v80
    v_dot2c_f32_bf16 v209, s33, v80
    v_dot2c_f32_bf16 v210, s32, v81
    v_dot2c_f32_bf16 v211, s33, v81
    v_dot2c_f32_bf16 v212, s32, v82
    v_dot2c_f32_bf16 v213, s33, v82
    v_dot2c_f32_bf16 v214, s32, v83
    v_dot2c_f32_bf16 v215, s33, v83
    v_dot2c_f32_bf16 v208, s32, v84
    v_dot2c_f32_bf16 v209, s33, v84
    v_dot2c_f32_bf16 v210, s32, v85
    v_dot2c_f32_bf16 v211, s33, v85
    v_dot2c_f32_bf16 v212, s32, v86
    v_dot2c_f32_bf16 v213, s33, v86
    v_dot2c_f32_bf16 v214, s32, v87
    v_dot2c_f32_bf16 v215, s33, v87
    v_dot2c_f32_bf16 v208, s32, v88
    v_dot2c_f32_bf16 v209, s33, v88
    v_dot2c_f32_bf16 v210, s32, v89
    v_dot2c_f32_bf16 v211, s33, v89
    v_dot2c_f32_bf16 v212, s32, v90
    v_dot2c_f32_bf16 v213, s33, v90
    v_dot2c_f32_bf16 v214, s32, v91
    v_dot2c_f32_bf16 v215, s33, v91
    v_dot2c_f32_bf16 v208, s32, v92
    v_dot2c_f32_bf16 v209, s33, v92
    v_dot2c_f32_bf16 v210, s32, v93
    v_dot2c_f32_bf16 v211, s33, v93
    v_dot2c_f32_bf16 v212, s32, v94
    v_dot2c_f32_bf16 v213, s33, v94
    v_dot2c_f32_bf16 v214, s32, v95
    v_dot2c_f32_bf16 v215, s33, v95
    s_nop 2
    v_permlane32_swap_b32 v208, v212
    v_permlane32_swap_b32 v209, v213
    v_permlane32_swap_b32 v210, v214
    v_permlane32_swap_b32 v211, v215
    v_add_f32 v208, v208, v212
    v_add_f32 v209, v209, v213
    v_add_f32 v210, v210, v214
    v_add_f32 v211, v211, v215
    v_cvt_pk_bf16_f32 v228, v208, v209
    v_cvt_pk_bf16_f32 v229, v210, v211
    buffer_store_dwordx2 v[228:229], v241, s[92:95], s57 offen
L_p4s1_2:
    s_bitcmp1_b32 s58, 3
    s_cbranch_scc0 L_p4s1_3
    s_waitcnt vmcnt(0)
    v_lshlrev_b32 v216, 16, v96
    v_and_b32 v217, 0xffff0000, v96
    v_lshlrev_b32 v218, 16, v97
    v_and_b32 v219, 0xffff0000, v97
    v_lshlrev_b32 v220, 16, v98
    v_and_b32 v221, 0xffff0000, v98
    v_lshlrev_b32 v222, 16, v99
    v_and_b32 v223, 0xffff0000, v99
    v_dot2c_f32_bf16 v216, s32, v100
    v_dot2c_f32_bf16 v217, s33, v100
    v_dot2c_f32_bf16 v218, s32, v101
    v_dot2c_f32_bf16 v219, s33, v101
    v_dot2c_f32_bf16 v220, s32, v102
    v_dot2c_f32_bf16 v221, s33, v102
    v_dot2c_f32_bf16 v222, s32, v103
    v_dot2c_f32_bf16 v223, s33, v103
    v_dot2c_f32_bf16 v216, s32, v104
    v_dot2c_f32_bf16 v217, s33, v104
    v_dot2c_f32_bf16 v218, s32, v105
    v_dot2c_f32_bf16 v219, s33, v105
    v_dot2c_f32_bf16 v220, s32, v106
    v_dot2c_f32_bf16 v221, s33, v106
    v_dot2c_f32_bf16 v222, s32, v107
    v_dot2c_f32_bf16 v223, s33, v107
    v_dot2c_f32_bf16 v216, s32, v108
    v_dot2c_f32_bf16 v217, s33, v108
    v_dot2c_f32_bf16 v218, s32, v109
    v_dot2c_f32_bf16 v219, s33, v109
    v_dot2c_f32_bf16 v220, s32, v110
    v_dot2c_f32_bf16 v221, s33, v110
    v_dot2c_f32_bf16 v222, s32, v111
    v_dot2c_f32_bf16 v223, s33, v111
    v_dot2c_f32_bf16 v216, s32, v112
    v_dot2c_f32_bf16 v217, s33, v112
    v_dot2c_f32_bf16 v218, s32, v113
    v_dot2c_f32_bf16 v219, s33, v113
    v_dot2c_f32_bf16 v220, s32, v114
    v_dot2c_f32_bf16 v221, s33, v114
    v_dot2c_f32_bf16 v222, s32, v115
    v_dot2c_f32_bf16 v223, s33, v115
    v_dot2c_f32_bf16 v216, s32, v116
    v_dot2c_f32_bf16 v217, s33, v116
    v_dot2c_f32_bf16 v218, s32, v117
    v_dot2c_f32_bf16 v219, s33, v117
    v_dot2c_f32_bf16 v220, s32, v118
    v_dot2c_f32_bf16 v221, s33, v118
    v_dot2c_f32_bf16 v222, s32, v119
    v_dot2c_f32_bf16 v223, s33, v119
    v_dot2c_f32_bf16 v216, s32, v120
    v_dot2c_f32_bf16 v217, s33, v120
    v_dot2c_f32_bf16 v218, s32, v121
    v_dot2c_f32_bf16 v219, s33, v121
    v_dot2c_f32_bf16 v220, s32, v122
    v_dot2c_f32_bf16 v221, s33, v122
    v_dot2c_f32_bf16 v222, s32, v123
    v_dot2c_f32_bf16 v223, s33, v123
    v_dot2c_f32_bf16 v216, s32, v124
    v_dot2c_f32_bf16 v217, s33, v124
    v_dot2c_f32_bf16 v218, s32, v125
    v_dot2c_f32_bf16 v219, s33, v125
    v_dot2c_f32_bf16 v220, s32, v126
    v_dot2c_f32_bf16 v221, s33, v126
    v_dot2c_f32_bf16 v222, s32, v127
    v_dot2c_f32_bf16 v223, s33, v127
    s_nop 2
    v_permlane32_swap_b32 v216, v220
    v_permlane32_swap_b32 v217, v221
    v_permlane32_swap_b32 v218, v222
    v_permlane32_swap_b32 v219, v223
    v_add_f32 v216, v216, v220
    v_add_f32 v217, v217, v221
    v_add_f32 v218, v218, v222
    v_add_f32 v219, v219, v223
    v_cvt_pk_bf16_f32 v230, v216, v217
    v_cvt_pk_bf16_f32 v231, v218, v219
    buffer_store_dwordx2 v[230:231], v241, s[92:95], s101 offen
L_p4s1_3:
    s_setpc_b64 s[44:45]
L_rare0:
    s_nop 15
    v_max3_f32 v144, v160, v161, v162
    v_max3_f32 v144, v144, v163, v164
    v_max3_f32 v144, v144, v165, v166
    v_max3_f32 v144, v144, v167, v168
    v_max3_f32 v144, v144, v169, v170
    v_max3_f32 v144, v144, v171, v172
    v_max3_f32 v144, v144, v173, v174
    v_max_f32 v144, v144, v175
    v_mov_b32 v145, v144
    s_nop 1
    v_permlane32_swap_b32 v144, v145
    v_max3_f32 v144, v144, v145, 0
    v_sub_f32 v160, v160, v144
    v_sub_f32 v161, v161, v144
    v_sub_f32 v162, v162, v144
    v_sub_f32 v163, v163, v144
    v_sub_f32 v164, v164, v144
    v_sub_f32 v165, v165, v144
    v_sub_f32 v166, v166, v144
    v_sub_f32 v167, v167, v144
    v_sub_f32 v168, v168, v144
    v_sub_f32 v169, v169, v144
    v_sub_f32 v170, v170, v144
    v_sub_f32 v171, v171, v144
    v_sub_f32 v172, v172, v144
    v_sub_f32 v173, v173, v144
    v_sub_f32 v174, v174, v144
    v_sub_f32 v175, v175, v144
    v_sub_f32 v250, v250, v144
    v_sub_f32 v146, 0, v144
    v_exp_f32 v146, v146
    s_nop 0
    v_mul_f32 v252, v252, v146
    v_accvgpr_read_b32 v128, a0
    v_accvgpr_read_b32 v129, a1
    v_accvgpr_read_b32 v130, a2
    v_accvgpr_read_b32 v131, a3
    v_accvgpr_read_b32 v132, a4
    v_accvgpr_read_b32 v133, a5
    v_accvgpr_read_b32 v134, a6
    v_accvgpr_read_b32 v135, a7
    v_accvgpr_read_b32 v136, a8
    v_accvgpr_read_b32 v137, a9
    v_accvgpr_read_b32 v138, a10
    v_accvgpr_read_b32 v139, a11
    v_accvgpr_read_b32 v140, a12
    v_accvgpr_read_b32 v141, a13
    v_accvgpr_read_b32 v142, a14
    v_accvgpr_read_b32 v143, a15
    v_mul_f32 v128, v128, v146
    v_mul_f32 v129, v129, v146
    v_mul_f32 v130, v130, v146
    v_mul_f32 v131, v131, v146
    v_mul_f32 v132, v132, v146
    v_mul_f32 v133, v133, v146
    v_mul_f32 v134, v134, v146
    v_mul_f32 v135, v135, v146
    v_mul_f32 v136, v136, v146
    v_mul_f32 v137, v137, v146
    v_mul_f32 v138, v138, v146
    v_mul_f32 v139, v139, v146
    v_mul_f32 v140, v140, v146
    v_mul_f32 v141, v141, v146
    v_mul_f32 v142, v142, v146
    v_mul_f32 v143, v143, v146
    v_accvgpr_write_b32 a0, v128
    v_accvgpr_write_b32 a1, v129
    v_accvgpr_write_b32 a2, v130
    v_accvgpr_write_b32 a3, v131
    v_accvgpr_write_b32 a4, v132
    v_accvgpr_write_b32 a5, v133
    v_accvgpr_write_b32 a6, v134
    v_accvgpr_write_b32 a7, v135
    v_accvgpr_write_b32 a8, v136
    v_accvgpr_write_b32 a9, v137
    v_accvgpr_write_b32 a10, v138
    v_accvgpr_write_b32 a11, v139
    v_accvgpr_write_b32 a12, v140
    v_accvgpr_write_b32 a13, v141
    v_accvgpr_write_b32 a14, v142
    v_accvgpr_write_b32 a15, v143
    v_accvgpr_read_b32 v128, a16
    v_accvgpr_read_b32 v129, a17
    v_accvgpr_read_b32 v130, a18
    v_accvgpr_read_b32 v131, a19
    v_accvgpr_read_b32 v132, a20
    v_accvgpr_read_b32 v133, a21
    v_accvgpr_read_b32 v134, a22
    v_accvgpr_read_b32 v135, a23
    v_accvgpr_read_b32 v136, a24
    v_accvgpr_read_b32 v137, a25
    v_accvgpr_read_b32 v138, a26
    v_accvgpr_read_b32 v139, a27
    v_accvgpr_read_b32 v140, a28
    v_accvgpr_read_b32 v141, a29
    v_accvgpr_read_b32 v142, a30
    v_accvgpr_read_b32 v143, a31
    v_mul_f32 v128, v128, v146
    v_mul_f32 v129, v129, v146
    v_mul_f32 v130, v130, v146
    v_mul_f32 v131, v131, v146
    v_mul_f32 v132, v132, v146
    v_mul_f32 v133, v133, v146
    v_mul_f32 v134, v134, v146
    v_mul_f32 v135, v135, v146
    v_mul_f32 v136, v136, v146
    v_mul_f32 v137, v137, v146
    v_mul_f32 v138, v138, v146
    v_mul_f32 v139, v139, v146
    v_mul_f32 v140, v140, v146
    v_mul_f32 v141, v141, v146
    v_mul_f32 v142, v142, v146
    v_mul_f32 v143, v143, v146
    v_accvgpr_write_b32 a16, v128
    v_accvgpr_write_b32 a17, v129
    v_accvgpr_write_b32 a18, v130
    v_accvgpr_write_b32 a19, v131
    v_accvgpr_write_b32 a20, v132
    v_accvgpr_write_b32 a21, v133
    v_accvgpr_write_b32 a22, v134
    v_accvgpr_write_b32 a23, v135
    v_accvgpr_write_b32 a24, v136
    v_accvgpr_write_b32 a25, v137
    v_accvgpr_write_b32 a26, v138
    v_accvgpr_write_b32 a27, v139
    v_accvgpr_write_b32 a28, v140
    v_accvgpr_write_b32 a29, v141
    v_accvgpr_write_b32 a30, v142
    v_accvgpr_write_b32 a31, v143
    v_accvgpr_read_b32 v128, a32
    v_accvgpr_read_b32 v129, a33
    v_accvgpr_read_b32 v130, a34
    v_accvgpr_read_b32 v131, a35
    v_accvgpr_read_b32 v132, a36
    v_accvgpr_read_b32 v133, a37
    v_accvgpr_read_b32 v134, a38
    v_accvgpr_read_b32 v135, a39
    v_accvgpr_read_b32 v136, a40
    v_accvgpr_read_b32 v137, a41
    v_accvgpr_read_b32 v138, a42
    v_accvgpr_read_b32 v139, a43
    v_accvgpr_read_b32 v140, a44
    v_accvgpr_read_b32 v141, a45
    v_accvgpr_read_b32 v142, a46
    v_accvgpr_read_b32 v143, a47
    v_mul_f32 v128, v128, v146
    v_mul_f32 v129, v129, v146
    v_mul_f32 v130, v130, v146
    v_mul_f32 v131, v131, v146
    v_mul_f32 v132, v132, v146
    v_mul_f32 v133, v133, v146
    v_mul_f32 v134, v134, v146
    v_mul_f32 v135, v135, v146
    v_mul_f32 v136, v136, v146
    v_mul_f32 v137, v137, v146
    v_mul_f32 v138, v138, v146
    v_mul_f32 v139, v139, v146
    v_mul_f32 v140, v140, v146
    v_mul_f32 v141, v141, v146
    v_mul_f32 v142, v142, v146
    v_mul_f32 v143, v143, v146
    v_accvgpr_write_b32 a32, v128
    v_accvgpr_write_b32 a33, v129
    v_accvgpr_write_b32 a34, v130
    v_accvgpr_write_b32 a35, v131
    v_accvgpr_write_b32 a36, v132
    v_accvgpr_write_b32 a37, v133
    v_accvgpr_write_b32 a38, v134
    v_accvgpr_write_b32 a39, v135
    v_accvgpr_write_b32 a40, v136
    v_accvgpr_write_b32 a41, v137
    v_accvgpr_write_b32 a42, v138
    v_accvgpr_write_b32 a43, v139
    v_accvgpr_write_b32 a44, v140
    v_accvgpr_write_b32 a45, v141
    v_accvgpr_write_b32 a46, v142
    v_accvgpr_write_b32 a47, v143
    v_accvgpr_read_b32 v128, a48
    v_accvgpr_read_b32 v129, a49
    v_accvgpr_read_b32 v130, a50
    v_accvgpr_read_b32 v131, a51
    v_accvgpr_read_b32 v132, a52
    v_accvgpr_read_b32 v133, a53
    v_accvgpr_read_b32 v134, a54
    v_accvgpr_read_b32 v135, a55
    v_accvgpr_read_b32 v136, a56
    v_accvgpr_read_b32 v137, a57
    v_accvgpr_read_b32 v138, a58
    v_accvgpr_read_b32 v139, a59
    v_accvgpr_read_b32 v140, a60
    v_accvgpr_read_b32 v141, a61
    v_accvgpr_read_b32 v142, a62
    v_accvgpr_read_b32 v143, a63
    v_mul_f32 v128, v128, v146
    v_mul_f32 v129, v129, v146
    v_mul_f32 v130, v130, v146
    v_mul_f32 v131, v131, v146
    v_mul_f32 v132, v132, v146
    v_mul_f32 v133, v133, v146
    v_mul_f32 v134, v134, v146
    v_mul_f32 v135, v135, v146
    v_mul_f32 v136, v136, v146
    v_mul_f32 v137, v137, v146
    v_mul_f32 v138, v138, v146
    v_mul_f32 v139, v139, v146
    v_mul_f32 v140, v140, v146
    v_mul_f32 v141, v141, v146
    v_mul_f32 v142, v142, v146
    v_mul_f32 v143, v143, v146
    v_accvgpr_write_b32 a48, v128
    v_accvgpr_write_b32 a49, v129
    v_accvgpr_write_b32 a50, v130
    v_accvgpr_write_b32 a51, v131
    v_accvgpr_write_b32 a52, v132
    v_accvgpr_write_b32 a53, v133
    v_accvgpr_write_b32 a54, v134
    v_accvgpr_write_b32 a55, v135
    v_accvgpr_write_b32 a56, v136
    v_accvgpr_write_b32 a57, v137
    v_accvgpr_write_b32 a58, v138
    v_accvgpr_write_b32 a59, v139
    v_accvgpr_write_b32 a60, v140
    v_accvgpr_write_b32 a61, v141
    v_accvgpr_write_b32 a62, v142
    v_accvgpr_write_b32 a63, v143
    v_accvgpr_read_b32 v128, a64
    v_accvgpr_read_b32 v129, a65
    v_accvgpr_read_b32 v130, a66
    v_accvgpr_read_b32 v131, a67
    v_accvgpr_read_b32 v132, a68
    v_accvgpr_read_b32 v133, a69
    v_accvgpr_read_b32 v134, a70
    v_accvgpr_read_b32 v135, a71
    v_accvgpr_read_b32 v136, a72
    v_accvgpr_read_b32 v137, a73
    v_accvgpr_read_b32 v138, a74
    v_accvgpr_read_b32 v139, a75
    v_accvgpr_read_b32 v140, a76
    v_accvgpr_read_b32 v141, a77
    v_accvgpr_read_b32 v142, a78
    v_accvgpr_read_b32 v143, a79
    v_mul_f32 v128, v128, v146
    v_mul_f32 v129, v129, v146
    v_mul_f32 v130, v130, v146
    v_mul_f32 v131, v131, v146
    v_mul_f32 v132, v132, v146
    v_mul_f32 v133, v133, v146
    v_mul_f32 v134, v134, v146
    v_mul_f32 v135, v135, v146
    v_mul_f32 v136, v136, v146
    v_mul_f32 v137, v137, v146
    v_mul_f32 v138, v138, v146
    v_mul_f32 v139, v139, v146
    v_mul_f32 v140, v140, v146
    v_mul_f32 v141, v141, v146
    v_mul_f32 v142, v142, v146
    v_mul_f32 v143, v143, v146
    v_accvgpr_write_b32 a64, v128
    v_accvgpr_write_b32 a65, v129
    v_accvgpr_write_b32 a66, v130
    v_accvgpr_write_b32 a67, v131
    v_accvgpr_write_b32 a68, v132
    v_accvgpr_write_b32 a69, v133
    v_accvgpr_write_b32 a70, v134
    v_accvgpr_write_b32 a71, v135
    v_accvgpr_write_b32 a72, v136
    v_accvgpr_write_b32 a73, v137
    v_accvgpr_write_b32 a74, v138
    v_accvgpr_write_b32 a75, v139
    v_accvgpr_write_b32 a76, v140
    v_accvgpr_write_b32 a77, v141
    v_accvgpr_write_b32 a78, v142
    v_accvgpr_write_b32 a79, v143
    v_accvgpr_read_b32 v128, a80
    v_accvgpr_read_b32 v129, a81
    v_accvgpr_read_b32 v130, a82
    v_accvgpr_read_b32 v131, a83
    v_accvgpr_read_b32 v132, a84
    v_accvgpr_read_b32 v133, a85
    v_accvgpr_read_b32 v134, a86
    v_accvgpr_read_b32 v135, a87
    v_accvgpr_read_b32 v136, a88
    v_accvgpr_read_b32 v137, a89
    v_accvgpr_read_b32 v138, a90
    v_accvgpr_read_b32 v139, a91
    v_accvgpr_read_b32 v140, a92
    v_accvgpr_read_b32 v141, a93
    v_accvgpr_read_b32 v142, a94
    v_accvgpr_read_b32 v143, a95
    v_mul_f32 v128, v128, v146
    v_mul_f32 v129, v129, v146
    v_mul_f32 v130, v130, v146
    v_mul_f32 v131, v131, v146
    v_mul_f32 v132, v132, v146
    v_mul_f32 v133, v133, v146
    v_mul_f32 v134, v134, v146
    v_mul_f32 v135, v135, v146
    v_mul_f32 v136, v136, v146
    v_mul_f32 v137, v137, v146
    v_mul_f32 v138, v138, v146
    v_mul_f32 v139, v139, v146
    v_mul_f32 v140, v140, v146
    v_mul_f32 v141, v141, v146
    v_mul_f32 v142, v142, v146
    v_mul_f32 v143, v143, v146
    v_accvgpr_write_b32 a80, v128
    v_accvgpr_write_b32 a81, v129
    v_accvgpr_write_b32 a82, v130
    v_accvgpr_write_b32 a83, v131
    v_accvgpr_write_b32 a84, v132
    v_accvgpr_write_b32 a85, v133
    v_accvgpr_write_b32 a86, v134
    v_accvgpr_write_b32 a87, v135
    v_accvgpr_write_b32 a88, v136
    v_accvgpr_write_b32 a89, v137
    v_accvgpr_write_b32 a90, v138
    v_accvgpr_write_b32 a91, v139
    v_accvgpr_write_b32 a92, v140
    v_accvgpr_write_b32 a93, v141
    v_accvgpr_write_b32 a94, v142
    v_accvgpr_write_b32 a95, v143
    v_accvgpr_read_b32 v128, a96
    v_accvgpr_read_b32 v129, a97
    v_accvgpr_read_b32 v130, a98
    v_accvgpr_read_b32 v131, a99
    v_accvgpr_read_b32 v132, a100
    v_accvgpr_read_b32 v133, a101
    v_accvgpr_read_b32 v134, a102
    v_accvgpr_read_b32 v135, a103
    v_accvgpr_read_b32 v136, a104
    v_accvgpr_read_b32 v137, a105
    v_accvgpr_read_b32 v138, a106
    v_accvgpr_read_b32 v139, a107
    v_accvgpr_read_b32 v140, a108
    v_accvgpr_read_b32 v141, a109
    v_accvgpr_read_b32 v142, a110
    v_accvgpr_read_b32 v143, a111
    v_mul_f32 v128, v128, v146
    v_mul_f32 v129, v129, v146
    v_mul_f32 v130, v130, v146
    v_mul_f32 v131, v131, v146
    v_mul_f32 v132, v132, v146
    v_mul_f32 v133, v133, v146
    v_mul_f32 v134, v134, v146
    v_mul_f32 v135, v135, v146
    v_mul_f32 v136, v136, v146
    v_mul_f32 v137, v137, v146
    v_mul_f32 v138, v138, v146
    v_mul_f32 v139, v139, v146
    v_mul_f32 v140, v140, v146
    v_mul_f32 v141, v141, v146
    v_mul_f32 v142, v142, v146
    v_mul_f32 v143, v143, v146
    v_accvgpr_write_b32 a96, v128
    v_accvgpr_write_b32 a97, v129
    v_accvgpr_write_b32 a98, v130
    v_accvgpr_write_b32 a99, v131
    v_accvgpr_write_b32 a100, v132
    v_accvgpr_write_b32 a101, v133
    v_accvgpr_write_b32 a102, v134
    v_accvgpr_write_b32 a103, v135
    v_accvgpr_write_b32 a104, v136
    v_accvgpr_write_b32 a105, v137
    v_accvgpr_write_b32 a106, v138
    v_accvgpr_write_b32 a107, v139
    v_accvgpr_write_b32 a108, v140
    v_accvgpr_write_b32 a109, v141
    v_accvgpr_write_b32 a110, v142
    v_accvgpr_write_b32 a111, v143
    v_accvgpr_read_b32 v128, a112
    v_accvgpr_read_b32 v129, a113
    v_accvgpr_read_b32 v130, a114
    v_accvgpr_read_b32 v131, a115
    v_accvgpr_read_b32 v132, a116
    v_accvgpr_read_b32 v133, a117
    v_accvgpr_read_b32 v134, a118
    v_accvgpr_read_b32 v135, a119
    v_accvgpr_read_b32 v136, a120
    v_accvgpr_read_b32 v137, a121
    v_accvgpr_read_b32 v138, a122
    v_accvgpr_read_b32 v139, a123
    v_accvgpr_read_b32 v140, a124
    v_accvgpr_read_b32 v141, a125
    v_accvgpr_read_b32 v142, a126
    v_accvgpr_read_b32 v143, a127
    v_mul_f32 v128, v128, v146
    v_mul_f32 v129, v129, v146
    v_mul_f32 v130, v130, v146
    v_mul_f32 v131, v131, v146
    v_mul_f32 v132, v132, v146
    v_mul_f32 v133, v133, v146
    v_mul_f32 v134, v134, v146
    v_mul_f32 v135, v135, v146
    v_mul_f32 v136, v136, v146
    v_mul_f32 v137, v137, v146
    v_mul_f32 v138, v138, v146
    v_mul_f32 v139, v139, v146
    v_mul_f32 v140, v140, v146
    v_mul_f32 v141, v141, v146
    v_mul_f32 v142, v142, v146
    v_mul_f32 v143, v143, v146
    v_accvgpr_write_b32 a112, v128
    v_accvgpr_write_b32 a113, v129
    v_accvgpr_write_b32 a114, v130
    v_accvgpr_write_b32 a115, v131
    v_accvgpr_write_b32 a116, v132
    v_accvgpr_write_b32 a117, v133
    v_accvgpr_write_b32 a118, v134
    v_accvgpr_write_b32 a119, v135
    v_accvgpr_write_b32 a120, v136
    v_accvgpr_write_b32 a121, v137
    v_accvgpr_write_b32 a122, v138
    v_accvgpr_write_b32 a123, v139
    v_accvgpr_write_b32 a124, v140
    v_accvgpr_write_b32 a125, v141
    v_accvgpr_write_b32 a126, v142
    v_accvgpr_write_b32 a127, v143
    v_max3_f32 v144, v176, v177, v178
    v_max3_f32 v144, v144, v179, v180
    v_max3_f32 v144, v144, v181, v182
    v_max3_f32 v144, v144, v183, v184
    v_max3_f32 v144, v144, v185, v186
    v_max3_f32 v144, v144, v187, v188
    v_max3_f32 v144, v144, v189, v190
    v_max_f32 v144, v144, v191
    v_mov_b32 v145, v144
    s_nop 1
    v_permlane32_swap_b32 v144, v145
    v_max3_f32 v144, v144, v145, 0
    v_sub_f32 v176, v176, v144
    v_sub_f32 v177, v177, v144
    v_sub_f32 v178, v178, v144
    v_sub_f32 v179, v179, v144
    v_sub_f32 v180, v180, v144
    v_sub_f32 v181, v181, v144
    v_sub_f32 v182, v182, v144
    v_sub_f32 v183, v183, v144
    v_sub_f32 v184, v184, v144
    v_sub_f32 v185, v185, v144
    v_sub_f32 v186, v186, v144
    v_sub_f32 v187, v187, v144
    v_sub_f32 v188, v188, v144
    v_sub_f32 v189, v189, v144
    v_sub_f32 v190, v190, v144
    v_sub_f32 v191, v191, v144
    v_sub_f32 v251, v251, v144
    v_sub_f32 v146, 0, v144
    v_exp_f32 v146, v146
    s_nop 0
    v_mul_f32 v253, v253, v146
    v_accvgpr_read_b32 v128, a128
    v_accvgpr_read_b32 v129, a129
    v_accvgpr_read_b32 v130, a130
    v_accvgpr_read_b32 v131, a131
    v_accvgpr_read_b32 v132, a132
    v_accvgpr_read_b32 v133, a133
    v_accvgpr_read_b32 v134, a134
    v_accvgpr_read_b32 v135, a135
    v_accvgpr_read_b32 v136, a136
    v_accvgpr_read_b32 v137, a137
    v_accvgpr_read_b32 v138, a138
    v_accvgpr_read_b32 v139, a139
    v_accvgpr_read_b32 v140, a140
    v_accvgpr_read_b32 v141, a141
    v_accvgpr_read_b32 v142, a142
    v_accvgpr_read_b32 v143, a143
    v_mul_f32 v128, v128, v146
    v_mul_f32 v129, v129, v146
    v_mul_f32 v130, v130, v146
    v_mul_f32 v131, v131, v146
    v_mul_f32 v132, v132, v146
    v_mul_f32 v133, v133, v146
    v_mul_f32 v134, v134, v146
    v_mul_f32 v135, v135, v146
    v_mul_f32 v136, v136, v146
    v_mul_f32 v137, v137, v146
    v_mul_f32 v138, v138, v146
    v_mul_f32 v139, v139, v146
    v_mul_f32 v140, v140, v146
    v_mul_f32 v141, v141, v146
    v_mul_f32 v142, v142, v146
    v_mul_f32 v143, v143, v146
    v_accvgpr_write_b32 a128, v128
    v_accvgpr_write_b32 a129, v129
    v_accvgpr_write_b32 a130, v130
    v_accvgpr_write_b32 a131, v131
    v_accvgpr_write_b32 a132, v132
    v_accvgpr_write_b32 a133, v133
    v_accvgpr_write_b32 a134, v134
    v_accvgpr_write_b32 a135, v135
    v_accvgpr_write_b32 a136, v136
    v_accvgpr_write_b32 a137, v137
    v_accvgpr_write_b32 a138, v138
    v_accvgpr_write_b32 a139, v139
    v_accvgpr_write_b32 a140, v140
    v_accvgpr_write_b32 a141, v141
    v_accvgpr_write_b32 a142, v142
    v_accvgpr_write_b32 a143, v143
    v_accvgpr_read_b32 v128, a144
    v_accvgpr_read_b32 v129, a145
    v_accvgpr_read_b32 v130, a146
    v_accvgpr_read_b32 v131, a147
    v_accvgpr_read_b32 v132, a148
    v_accvgpr_read_b32 v133, a149
    v_accvgpr_read_b32 v134, a150
    v_accvgpr_read_b32 v135, a151
    v_accvgpr_read_b32 v136, a152
    v_accvgpr_read_b32 v137, a153
    v_accvgpr_read_b32 v138, a154
    v_accvgpr_read_b32 v139, a155
    v_accvgpr_read_b32 v140, a156
    v_accvgpr_read_b32 v141, a157
    v_accvgpr_read_b32 v142, a158
    v_accvgpr_read_b32 v143, a159
    v_mul_f32 v128, v128, v146
    v_mul_f32 v129, v129, v146
    v_mul_f32 v130, v130, v146
    v_mul_f32 v131, v131, v146
    v_mul_f32 v132, v132, v146
    v_mul_f32 v133, v133, v146
    v_mul_f32 v134, v134, v146
    v_mul_f32 v135, v135, v146
    v_mul_f32 v136, v136, v146
    v_mul_f32 v137, v137, v146
    v_mul_f32 v138, v138, v146
    v_mul_f32 v139, v139, v146
    v_mul_f32 v140, v140, v146
    v_mul_f32 v141, v141, v146
    v_mul_f32 v142, v142, v146
    v_mul_f32 v143, v143, v146
    v_accvgpr_write_b32 a144, v128
    v_accvgpr_write_b32 a145, v129
    v_accvgpr_write_b32 a146, v130
    v_accvgpr_write_b32 a147, v131
    v_accvgpr_write_b32 a148, v132
    v_accvgpr_write_b32 a149, v133
    v_accvgpr_write_b32 a150, v134
    v_accvgpr_write_b32 a151, v135
    v_accvgpr_write_b32 a152, v136
    v_accvgpr_write_b32 a153, v137
    v_accvgpr_write_b32 a154, v138
    v_accvgpr_write_b32 a155, v139
    v_accvgpr_write_b32 a156, v140
    v_accvgpr_write_b32 a157, v141
    v_accvgpr_write_b32 a158, v142
    v_accvgpr_write_b32 a159, v143
    v_accvgpr_read_b32 v128, a160
    v_accvgpr_read_b32 v129, a161
    v_accvgpr_read_b32 v130, a162
    v_accvgpr_read_b32 v131, a163
    v_accvgpr_read_b32 v132, a164
    v_accvgpr_read_b32 v133, a165
    v_accvgpr_read_b32 v134, a166
    v_accvgpr_read_b32 v135, a167
    v_accvgpr_read_b32 v136, a168
    v_accvgpr_read_b32 v137, a169
    v_accvgpr_read_b32 v138, a170
    v_accvgpr_read_b32 v139, a171
    v_accvgpr_read_b32 v140, a172
    v_accvgpr_read_b32 v141, a173
    v_accvgpr_read_b32 v142, a174
    v_accvgpr_read_b32 v143, a175
    v_mul_f32 v128, v128, v146
    v_mul_f32 v129, v129, v146
    v_mul_f32 v130, v130, v146
    v_mul_f32 v131, v131, v146
    v_mul_f32 v132, v132, v146
    v_mul_f32 v133, v133, v146
    v_mul_f32 v134, v134, v146
    v_mul_f32 v135, v135, v146
    v_mul_f32 v136, v136, v146
    v_mul_f32 v137, v137, v146
    v_mul_f32 v138, v138, v146
    v_mul_f32 v139, v139, v146
    v_mul_f32 v140, v140, v146
    v_mul_f32 v141, v141, v146
    v_mul_f32 v142, v142, v146
    v_mul_f32 v143, v143, v146
    v_accvgpr_write_b32 a160, v128
    v_accvgpr_write_b32 a161, v129
    v_accvgpr_write_b32 a162, v130
    v_accvgpr_write_b32 a163, v131
    v_accvgpr_write_b32 a164, v132
    v_accvgpr_write_b32 a165, v133
    v_accvgpr_write_b32 a166, v134
    v_accvgpr_write_b32 a167, v135
    v_accvgpr_write_b32 a168, v136
    v_accvgpr_write_b32 a169, v137
    v_accvgpr_write_b32 a170, v138
    v_accvgpr_write_b32 a171, v139
    v_accvgpr_write_b32 a172, v140
    v_accvgpr_write_b32 a173, v141
    v_accvgpr_write_b32 a174, v142
    v_accvgpr_write_b32 a175, v143
    v_accvgpr_read_b32 v128, a176
    v_accvgpr_read_b32 v129, a177
    v_accvgpr_read_b32 v130, a178
    v_accvgpr_read_b32 v131, a179
    v_accvgpr_read_b32 v132, a180
    v_accvgpr_read_b32 v133, a181
    v_accvgpr_read_b32 v134, a182
    v_accvgpr_read_b32 v135, a183
    v_accvgpr_read_b32 v136, a184
    v_accvgpr_read_b32 v137, a185
    v_accvgpr_read_b32 v138, a186
    v_accvgpr_read_b32 v139, a187
    v_accvgpr_read_b32 v140, a188
    v_accvgpr_read_b32 v141, a189
    v_accvgpr_read_b32 v142, a190
    v_accvgpr_read_b32 v143, a191
    v_mul_f32 v128, v128, v146
    v_mul_f32 v129, v129, v146
    v_mul_f32 v130, v130, v146
    v_mul_f32 v131, v131, v146
    v_mul_f32 v132, v132, v146
    v_mul_f32 v133, v133, v146
    v_mul_f32 v134, v134, v146
    v_mul_f32 v135, v135, v146
    v_mul_f32 v136, v136, v146
    v_mul_f32 v137, v137, v146
    v_mul_f32 v138, v138, v146
    v_mul_f32 v139, v139, v146
    v_mul_f32 v140, v140, v146
    v_mul_f32 v141, v141, v146
    v_mul_f32 v142, v142, v146
    v_mul_f32 v143, v143, v146
    v_accvgpr_write_b32 a176, v128
    v_accvgpr_write_b32 a177, v129
    v_accvgpr_write_b32 a178, v130
    v_accvgpr_write_b32 a179, v131
    v_accvgpr_write_b32 a180, v132
    v_accvgpr_write_b32 a181, v133
    v_accvgpr_write_b32 a182, v134
    v_accvgpr_write_b32 a183, v135
    v_accvgpr_write_b32 a184, v136
    v_accvgpr_write_b32 a185, v137
    v_accvgpr_write_b32 a186, v138
    v_accvgpr_write_b32 a187, v139
    v_accvgpr_write_b32 a188, v140
    v_accvgpr_write_b32 a189, v141
    v_accvgpr_write_b32 a190, v142
    v_accvgpr_write_b32 a191, v143
    v_accvgpr_read_b32 v128, a192
    v_accvgpr_read_b32 v129, a193
    v_accvgpr_read_b32 v130, a194
    v_accvgpr_read_b32 v131, a195
    v_accvgpr_read_b32 v132, a196
    v_accvgpr_read_b32 v133, a197
    v_accvgpr_read_b32 v134, a198
    v_accvgpr_read_b32 v135, a199
    v_accvgpr_read_b32 v136, a200
    v_accvgpr_read_b32 v137, a201
    v_accvgpr_read_b32 v138, a202
    v_accvgpr_read_b32 v139, a203
    v_accvgpr_read_b32 v140, a204
    v_accvgpr_read_b32 v141, a205
    v_accvgpr_read_b32 v142, a206
    v_accvgpr_read_b32 v143, a207
    v_mul_f32 v128, v128, v146
    v_mul_f32 v129, v129, v146
    v_mul_f32 v130, v130, v146
    v_mul_f32 v131, v131, v146
    v_mul_f32 v132, v132, v146
    v_mul_f32 v133, v133, v146
    v_mul_f32 v134, v134, v146
    v_mul_f32 v135, v135, v146
    v_mul_f32 v136, v136, v146
    v_mul_f32 v137, v137, v146
    v_mul_f32 v138, v138, v146
    v_mul_f32 v139, v139, v146
    v_mul_f32 v140, v140, v146
    v_mul_f32 v141, v141, v146
    v_mul_f32 v142, v142, v146
    v_mul_f32 v143, v143, v146
    v_accvgpr_write_b32 a192, v128
    v_accvgpr_write_b32 a193, v129
    v_accvgpr_write_b32 a194, v130
    v_accvgpr_write_b32 a195, v131
    v_accvgpr_write_b32 a196, v132
    v_accvgpr_write_b32 a197, v133
    v_accvgpr_write_b32 a198, v134
    v_accvgpr_write_b32 a199, v135
    v_accvgpr_write_b32 a200, v136
    v_accvgpr_write_b32 a201, v137
    v_accvgpr_write_b32 a202, v138
    v_accvgpr_write_b32 a203, v139
    v_accvgpr_write_b32 a204, v140
    v_accvgpr_write_b32 a205, v141
    v_accvgpr_write_b32 a206, v142
    v_accvgpr_write_b32 a207, v143
    v_accvgpr_read_b32 v128, a208
    v_accvgpr_read_b32 v129, a209
    v_accvgpr_read_b32 v130, a210
    v_accvgpr_read_b32 v131, a211
    v_accvgpr_read_b32 v132, a212
    v_accvgpr_read_b32 v133, a213
    v_accvgpr_read_b32 v134, a214
    v_accvgpr_read_b32 v135, a215
    v_accvgpr_read_b32 v136, a216
    v_accvgpr_read_b32 v137, a217
    v_accvgpr_read_b32 v138, a218
    v_accvgpr_read_b32 v139, a219
    v_accvgpr_read_b32 v140, a220
    v_accvgpr_read_b32 v141, a221
    v_accvgpr_read_b32 v142, a222
    v_accvgpr_read_b32 v143, a223
    v_mul_f32 v128, v128, v146
    v_mul_f32 v129, v129, v146
    v_mul_f32 v130, v130, v146
    v_mul_f32 v131, v131, v146
    v_mul_f32 v132, v132, v146
    v_mul_f32 v133, v133, v146
    v_mul_f32 v134, v134, v146
    v_mul_f32 v135, v135, v146
    v_mul_f32 v136, v136, v146
    v_mul_f32 v137, v137, v146
    v_mul_f32 v138, v138, v146
    v_mul_f32 v139, v139, v146
    v_mul_f32 v140, v140, v146
    v_mul_f32 v141, v141, v146
    v_mul_f32 v142, v142, v146
    v_mul_f32 v143, v143, v146
    v_accvgpr_write_b32 a208, v128
    v_accvgpr_write_b32 a209, v129
    v_accvgpr_write_b32 a210, v130
    v_accvgpr_write_b32 a211, v131
    v_accvgpr_write_b32 a212, v132
    v_accvgpr_write_b32 a213, v133
    v_accvgpr_write_b32 a214, v134
    v_accvgpr_write_b32 a215, v135
    v_accvgpr_write_b32 a216, v136
    v_accvgpr_write_b32 a217, v137
    v_accvgpr_write_b32 a218, v138
    v_accvgpr_write_b32 a219, v139
    v_accvgpr_write_b32 a220, v140
    v_accvgpr_write_b32 a221, v141
    v_accvgpr_write_b32 a222, v142
    v_accvgpr_write_b32 a223, v143
    v_accvgpr_read_b32 v128, a224
    v_accvgpr_read_b32 v129, a225
    v_accvgpr_read_b32 v130, a226
    v_accvgpr_read_b32 v131, a227
    v_accvgpr_read_b32 v132, a228
    v_accvgpr_read_b32 v133, a229
    v_accvgpr_read_b32 v134, a230
    v_accvgpr_read_b32 v135, a231
    v_accvgpr_read_b32 v136, a232
    v_accvgpr_read_b32 v137, a233
    v_accvgpr_read_b32 v138, a234
    v_accvgpr_read_b32 v139, a235
    v_accvgpr_read_b32 v140, a236
    v_accvgpr_read_b32 v141, a237
    v_accvgpr_read_b32 v142, a238
    v_accvgpr_read_b32 v143, a239
    v_mul_f32 v128, v128, v146
    v_mul_f32 v129, v129, v146
    v_mul_f32 v130, v130, v146
    v_mul_f32 v131, v131, v146
    v_mul_f32 v132, v132, v146
    v_mul_f32 v133, v133, v146
    v_mul_f32 v134, v134, v146
    v_mul_f32 v135, v135, v146
    v_mul_f32 v136, v136, v146
    v_mul_f32 v137, v137, v146
    v_mul_f32 v138, v138, v146
    v_mul_f32 v139, v139, v146
    v_mul_f32 v140, v140, v146
    v_mul_f32 v141, v141, v146
    v_mul_f32 v142, v142, v146
    v_mul_f32 v143, v143, v146
    v_accvgpr_write_b32 a224, v128
    v_accvgpr_write_b32 a225, v129
    v_accvgpr_write_b32 a226, v130
    v_accvgpr_write_b32 a227, v131
    v_accvgpr_write_b32 a228, v132
    v_accvgpr_write_b32 a229, v133
    v_accvgpr_write_b32 a230, v134
    v_accvgpr_write_b32 a231, v135
    v_accvgpr_write_b32 a232, v136
    v_accvgpr_write_b32 a233, v137
    v_accvgpr_write_b32 a234, v138
    v_accvgpr_write_b32 a235, v139
    v_accvgpr_write_b32 a236, v140
    v_accvgpr_write_b32 a237, v141
    v_accvgpr_write_b32 a238, v142
    v_accvgpr_write_b32 a239, v143
    v_accvgpr_read_b32 v128, a240
    v_accvgpr_read_b32 v129, a241
    v_accvgpr_read_b32 v130, a242
    v_accvgpr_read_b32 v131, a243
    v_accvgpr_read_b32 v132, a244
    v_accvgpr_read_b32 v133, a245
    v_accvgpr_read_b32 v134, a246
    v_accvgpr_read_b32 v135, a247
    v_accvgpr_read_b32 v136, a248
    v_accvgpr_read_b32 v137, a249
    v_accvgpr_read_b32 v138, a250
    v_accvgpr_read_b32 v139, a251
    v_accvgpr_read_b32 v140, a252
    v_accvgpr_read_b32 v141, a253
    v_accvgpr_read_b32 v142, a254
    v_accvgpr_read_b32 v143, a255
    v_mul_f32 v128, v128, v146
    v_mul_f32 v129, v129, v146
    v_mul_f32 v130, v130, v146
    v_mul_f32 v131, v131, v146
    v_mul_f32 v132, v132, v146
    v_mul_f32 v133, v133, v146
    v_mul_f32 v134, v134, v146
    v_mul_f32 v135, v135, v146
    v_mul_f32 v136, v136, v146
    v_mul_f32 v137, v137, v146
    v_mul_f32 v138, v138, v146
    v_mul_f32 v139, v139, v146
    v_mul_f32 v140, v140, v146
    v_mul_f32 v141, v141, v146
    v_mul_f32 v142, v142, v146
    v_mul_f32 v143, v143, v146
    v_accvgpr_write_b32 a240, v128
    v_accvgpr_write_b32 a241, v129
    v_accvgpr_write_b32 a242, v130
    v_accvgpr_write_b32 a243, v131
    v_accvgpr_write_b32 a244, v132
    v_accvgpr_write_b32 a245, v133
    v_accvgpr_write_b32 a246, v134
    v_accvgpr_write_b32 a247, v135
    v_accvgpr_write_b32 a248, v136
    v_accvgpr_write_b32 a249, v137
    v_accvgpr_write_b32 a250, v138
    v_accvgpr_write_b32 a251, v139
    v_accvgpr_write_b32 a252, v140
    v_accvgpr_write_b32 a253, v141
    v_accvgpr_write_b32 a254, v142
    v_accvgpr_write_b32 a255, v143
    s_nop 3
    s_setpc_b64 s[44:45]
L_rare1:
    s_nop 15
    v_max3_f32 v176, v128, v129, v130
    v_max3_f32 v176, v176, v131, v132
    v_max3_f32 v176, v176, v133, v134
    v_max3_f32 v176, v176, v135, v136
    v_max3_f32 v176, v176, v137, v138
    v_max3_f32 v176, v176, v139, v140
    v_max3_f32 v176, v176, v141, v142
    v_max_f32 v176, v176, v143
    v_mov_b32 v177, v176
    s_nop 1
    v_permlane32_swap_b32 v176, v177
    v_max3_f32 v176, v176, v177, 0
    v_sub_f32 v128, v128, v176
    v_sub_f32 v129, v129, v176
    v_sub_f32 v130, v130, v176
    v_sub_f32 v131, v131, v176
    v_sub_f32 v132, v132, v176
    v_sub_f32 v133, v133, v176
    v_sub_f32 v134, v134, v176
    v_sub_f32 v135, v135, v176
    v_sub_f32 v136, v136, v176
    v_sub_f32 v137, v137, v176
    v_sub_f32 v138, v138, v176
    v_sub_f32 v139, v139, v176
    v_sub_f32 v140, v140, v176
    v_sub_f32 v141, v141, v176
    v_sub_f32 v142, v142, v176
    v_sub_f32 v143, v143, v176
    v_sub_f32 v250, v250, v176
    v_sub_f32 v178, 0, v176
    v_exp_f32 v178, v178
    s_nop 0
    v_mul_f32 v252, v252, v178
    v_accvgpr_read_b32 v160, a0
    v_accvgpr_read_b32 v161, a1
    v_accvgpr_read_b32 v162, a2
    v_accvgpr_read_b32 v163, a3
    v_accvgpr_read_b32 v164, a4
    v_accvgpr_read_b32 v165, a5
    v_accvgpr_read_b32 v166, a6
    v_accvgpr_read_b32 v167, a7
    v_accvgpr_read_b32 v168, a8
    v_accvgpr_read_b32 v169, a9
    v_accvgpr_read_b32 v170, a10
    v_accvgpr_read_b32 v171, a11
    v_accvgpr_read_b32 v172, a12
    v_accvgpr_read_b32 v173, a13
    v_accvgpr_read_b32 v174, a14
    v_accvgpr_read_b32 v175, a15
    v_mul_f32 v160, v160, v178
    v_mul_f32 v161, v161, v178
    v_mul_f32 v162, v162, v178
    v_mul_f32 v163, v163, v178
    v_mul_f32 v164, v164, v178
    v_mul_f32 v165, v165, v178
    v_mul_f32 v166, v166, v178
    v_mul_f32 v167, v167, v178
    v_mul_f32 v168, v168, v178
    v_mul_f32 v169, v169, v178
    v_mul_f32 v170, v170, v178
    v_mul_f32 v171, v171, v178
    v_mul_f32 v172, v172, v178
    v_mul_f32 v173, v173, v178
    v_mul_f32 v174, v174, v178
    v_mul_f32 v175, v175, v178
    v_accvgpr_write_b32 a0, v160
    v_accvgpr_write_b32 a1, v161
    v_accvgpr_write_b32 a2, v162
    v_accvgpr_write_b32 a3, v163
    v_accvgpr_write_b32 a4, v164
    v_accvgpr_write_b32 a5, v165
    v_accvgpr_write_b32 a6, v166
    v_accvgpr_write_b32 a7, v167
    v_accvgpr_write_b32 a8, v168
    v_accvgpr_write_b32 a9, v169
    v_accvgpr_write_b32 a10, v170
    v_accvgpr_write_b32 a11, v171
    v_accvgpr_write_b32 a12, v172
    v_accvgpr_write_b32 a13, v173
    v_accvgpr_write_b32 a14, v174
    v_accvgpr_write_b32 a15, v175
    v_accvgpr_read_b32 v160, a16
    v_accvgpr_read_b32 v161, a17
    v_accvgpr_read_b32 v162, a18
    v_accvgpr_read_b32 v163, a19
    v_accvgpr_read_b32 v164, a20
    v_accvgpr_read_b32 v165, a21
    v_accvgpr_read_b32 v166, a22
    v_accvgpr_read_b32 v167, a23
    v_accvgpr_read_b32 v168, a24
    v_accvgpr_read_b32 v169, a25
    v_accvgpr_read_b32 v170, a26
    v_accvgpr_read_b32 v171, a27
    v_accvgpr_read_b32 v172, a28
    v_accvgpr_read_b32 v173, a29
    v_accvgpr_read_b32 v174, a30
    v_accvgpr_read_b32 v175, a31
    v_mul_f32 v160, v160, v178
    v_mul_f32 v161, v161, v178
    v_mul_f32 v162, v162, v178
    v_mul_f32 v163, v163, v178
    v_mul_f32 v164, v164, v178
    v_mul_f32 v165, v165, v178
    v_mul_f32 v166, v166, v178
    v_mul_f32 v167, v167, v178
    v_mul_f32 v168, v168, v178
    v_mul_f32 v169, v169, v178
    v_mul_f32 v170, v170, v178
    v_mul_f32 v171, v171, v178
    v_mul_f32 v172, v172, v178
    v_mul_f32 v173, v173, v178
    v_mul_f32 v174, v174, v178
    v_mul_f32 v175, v175, v178
    v_accvgpr_write_b32 a16, v160
    v_accvgpr_write_b32 a17, v161
    v_accvgpr_write_b32 a18, v162
    v_accvgpr_write_b32 a19, v163
    v_accvgpr_write_b32 a20, v164
    v_accvgpr_write_b32 a21, v165
    v_accvgpr_write_b32 a22, v166
    v_accvgpr_write_b32 a23, v167
    v_accvgpr_write_b32 a24, v168
    v_accvgpr_write_b32 a25, v169
    v_accvgpr_write_b32 a26, v170
    v_accvgpr_write_b32 a27, v171
    v_accvgpr_write_b32 a28, v172
    v_accvgpr_write_b32 a29, v173
    v_accvgpr_write_b32 a30, v174
    v_accvgpr_write_b32 a31, v175
    v_accvgpr_read_b32 v160, a32
    v_accvgpr_read_b32 v161, a33
    v_accvgpr_read_b32 v162, a34
    v_accvgpr_read_b32 v163, a35
    v_accvgpr_read_b32 v164, a36
    v_accvgpr_read_b32 v165, a37
    v_accvgpr_read_b32 v166, a38
    v_accvgpr_read_b32 v167, a39
    v_accvgpr_read_b32 v168, a40
    v_accvgpr_read_b32 v169, a41
    v_accvgpr_read_b32 v170, a42
    v_accvgpr_read_b32 v171, a43
    v_accvgpr_read_b32 v172, a44
    v_accvgpr_read_b32 v173, a45
    v_accvgpr_read_b32 v174, a46
    v_accvgpr_read_b32 v175, a47
    v_mul_f32 v160, v160, v178
    v_mul_f32 v161, v161, v178
    v_mul_f32 v162, v162, v178
    v_mul_f32 v163, v163, v178
    v_mul_f32 v164, v164, v178
    v_mul_f32 v165, v165, v178
    v_mul_f32 v166, v166, v178
    v_mul_f32 v167, v167, v178
    v_mul_f32 v168, v168, v178
    v_mul_f32 v169, v169, v178
    v_mul_f32 v170, v170, v178
    v_mul_f32 v171, v171, v178
    v_mul_f32 v172, v172, v178
    v_mul_f32 v173, v173, v178
    v_mul_f32 v174, v174, v178
    v_mul_f32 v175, v175, v178
    v_accvgpr_write_b32 a32, v160
    v_accvgpr_write_b32 a33, v161
    v_accvgpr_write_b32 a34, v162
    v_accvgpr_write_b32 a35, v163
    v_accvgpr_write_b32 a36, v164
    v_accvgpr_write_b32 a37, v165
    v_accvgpr_write_b32 a38, v166
    v_accvgpr_write_b32 a39, v167
    v_accvgpr_write_b32 a40, v168
    v_accvgpr_write_b32 a41, v169
    v_accvgpr_write_b32 a42, v170
    v_accvgpr_write_b32 a43, v171
    v_accvgpr_write_b32 a44, v172
    v_accvgpr_write_b32 a45, v173
    v_accvgpr_write_b32 a46, v174
    v_accvgpr_write_b32 a47, v175
    v_accvgpr_read_b32 v160, a48
    v_accvgpr_read_b32 v161, a49
    v_accvgpr_read_b32 v162, a50
    v_accvgpr_read_b32 v163, a51
    v_accvgpr_read_b32 v164, a52
    v_accvgpr_read_b32 v165, a53
    v_accvgpr_read_b32 v166, a54
    v_accvgpr_read_b32 v167, a55
    v_accvgpr_read_b32 v168, a56
    v_accvgpr_read_b32 v169, a57
    v_accvgpr_read_b32 v170, a58
    v_accvgpr_read_b32 v171, a59
    v_accvgpr_read_b32 v172, a60
    v_accvgpr_read_b32 v173, a61
    v_accvgpr_read_b32 v174, a62
    v_accvgpr_read_b32 v175, a63
    v_mul_f32 v160, v160, v178
    v_mul_f32 v161, v161, v178
    v_mul_f32 v162, v162, v178
    v_mul_f32 v163, v163, v178
    v_mul_f32 v164, v164, v178
    v_mul_f32 v165, v165, v178
    v_mul_f32 v166, v166, v178
    v_mul_f32 v167, v167, v178
    v_mul_f32 v168, v168, v178
    v_mul_f32 v169, v169, v178
    v_mul_f32 v170, v170, v178
    v_mul_f32 v171, v171, v178
    v_mul_f32 v172, v172, v178
    v_mul_f32 v173, v173, v178
    v_mul_f32 v174, v174, v178
    v_mul_f32 v175, v175, v178
    v_accvgpr_write_b32 a48, v160
    v_accvgpr_write_b32 a49, v161
    v_accvgpr_write_b32 a50, v162
    v_accvgpr_write_b32 a51, v163
    v_accvgpr_write_b32 a52, v164
    v_accvgpr_write_b32 a53, v165
    v_accvgpr_write_b32 a54, v166
    v_accvgpr_write_b32 a55, v167
    v_accvgpr_write_b32 a56, v168
    v_accvgpr_write_b32 a57, v169
    v_accvgpr_write_b32 a58, v170
    v_accvgpr_write_b32 a59, v171
    v_accvgpr_write_b32 a60, v172
    v_accvgpr_write_b32 a61, v173
    v_accvgpr_write_b32 a62, v174
    v_accvgpr_write_b32 a63, v175
    v_accvgpr_read_b32 v160, a64
    v_accvgpr_read_b32 v161, a65
    v_accvgpr_read_b32 v162, a66
    v_accvgpr_read_b32 v163, a67
    v_accvgpr_read_b32 v164, a68
    v_accvgpr_read_b32 v165, a69
    v_accvgpr_read_b32 v166, a70
    v_accvgpr_read_b32 v167, a71
    v_accvgpr_read_b32 v168, a72
    v_accvgpr_read_b32 v169, a73
    v_accvgpr_read_b32 v170, a74
    v_accvgpr_read_b32 v171, a75
    v_accvgpr_read_b32 v172, a76
    v_accvgpr_read_b32 v173, a77
    v_accvgpr_read_b32 v174, a78
    v_accvgpr_read_b32 v175, a79
    v_mul_f32 v160, v160, v178
    v_mul_f32 v161, v161, v178
    v_mul_f32 v162, v162, v178
    v_mul_f32 v163, v163, v178
    v_mul_f32 v164, v164, v178
    v_mul_f32 v165, v165, v178
    v_mul_f32 v166, v166, v178
    v_mul_f32 v167, v167, v178
    v_mul_f32 v168, v168, v178
    v_mul_f32 v169, v169, v178
    v_mul_f32 v170, v170, v178
    v_mul_f32 v171, v171, v178
    v_mul_f32 v172, v172, v178
    v_mul_f32 v173, v173, v178
    v_mul_f32 v174, v174, v178
    v_mul_f32 v175, v175, v178
    v_accvgpr_write_b32 a64, v160
    v_accvgpr_write_b32 a65, v161
    v_accvgpr_write_b32 a66, v162
    v_accvgpr_write_b32 a67, v163
    v_accvgpr_write_b32 a68, v164
    v_accvgpr_write_b32 a69, v165
    v_accvgpr_write_b32 a70, v166
    v_accvgpr_write_b32 a71, v167
    v_accvgpr_write_b32 a72, v168
    v_accvgpr_write_b32 a73, v169
    v_accvgpr_write_b32 a74, v170
    v_accvgpr_write_b32 a75, v171
    v_accvgpr_write_b32 a76, v172
    v_accvgpr_write_b32 a77, v173
    v_accvgpr_write_b32 a78, v174
    v_accvgpr_write_b32 a79, v175
    v_accvgpr_read_b32 v160, a80
    v_accvgpr_read_b32 v161, a81
    v_accvgpr_read_b32 v162, a82
    v_accvgpr_read_b32 v163, a83
    v_accvgpr_read_b32 v164, a84
    v_accvgpr_read_b32 v165, a85
    v_accvgpr_read_b32 v166, a86
    v_accvgpr_read_b32 v167, a87
    v_accvgpr_read_b32 v168, a88
    v_accvgpr_read_b32 v169, a89
    v_accvgpr_read_b32 v170, a90
    v_accvgpr_read_b32 v171, a91
    v_accvgpr_read_b32 v172, a92
    v_accvgpr_read_b32 v173, a93
    v_accvgpr_read_b32 v174, a94
    v_accvgpr_read_b32 v175, a95
    v_mul_f32 v160, v160, v178
    v_mul_f32 v161, v161, v178
    v_mul_f32 v162, v162, v178
    v_mul_f32 v163, v163, v178
    v_mul_f32 v164, v164, v178
    v_mul_f32 v165, v165, v178
    v_mul_f32 v166, v166, v178
    v_mul_f32 v167, v167, v178
    v_mul_f32 v168, v168, v178
    v_mul_f32 v169, v169, v178
    v_mul_f32 v170, v170, v178
    v_mul_f32 v171, v171, v178
    v_mul_f32 v172, v172, v178
    v_mul_f32 v173, v173, v178
    v_mul_f32 v174, v174, v178
    v_mul_f32 v175, v175, v178
    v_accvgpr_write_b32 a80, v160
    v_accvgpr_write_b32 a81, v161
    v_accvgpr_write_b32 a82, v162
    v_accvgpr_write_b32 a83, v163
    v_accvgpr_write_b32 a84, v164
    v_accvgpr_write_b32 a85, v165
    v_accvgpr_write_b32 a86, v166
    v_accvgpr_write_b32 a87, v167
    v_accvgpr_write_b32 a88, v168
    v_accvgpr_write_b32 a89, v169
    v_accvgpr_write_b32 a90, v170
    v_accvgpr_write_b32 a91, v171
    v_accvgpr_write_b32 a92, v172
    v_accvgpr_write_b32 a93, v173
    v_accvgpr_write_b32 a94, v174
    v_accvgpr_write_b32 a95, v175
    v_accvgpr_read_b32 v160, a96
    v_accvgpr_read_b32 v161, a97
    v_accvgpr_read_b32 v162, a98
    v_accvgpr_read_b32 v163, a99
    v_accvgpr_read_b32 v164, a100
    v_accvgpr_read_b32 v165, a101
    v_accvgpr_read_b32 v166, a102
    v_accvgpr_read_b32 v167, a103
    v_accvgpr_read_b32 v168, a104
    v_accvgpr_read_b32 v169, a105
    v_accvgpr_read_b32 v170, a106
    v_accvgpr_read_b32 v171, a107
    v_accvgpr_read_b32 v172, a108
    v_accvgpr_read_b32 v173, a109
    v_accvgpr_read_b32 v174, a110
    v_accvgpr_read_b32 v175, a111
    v_mul_f32 v160, v160, v178
    v_mul_f32 v161, v161, v178
    v_mul_f32 v162, v162, v178
    v_mul_f32 v163, v163, v178
    v_mul_f32 v164, v164, v178
    v_mul_f32 v165, v165, v178
    v_mul_f32 v166, v166, v178
    v_mul_f32 v167, v167, v178
    v_mul_f32 v168, v168, v178
    v_mul_f32 v169, v169, v178
    v_mul_f32 v170, v170, v178
    v_mul_f32 v171, v171, v178
    v_mul_f32 v172, v172, v178
    v_mul_f32 v173, v173, v178
    v_mul_f32 v174, v174, v178
    v_mul_f32 v175, v175, v178
    v_accvgpr_write_b32 a96, v160
    v_accvgpr_write_b32 a97, v161
    v_accvgpr_write_b32 a98, v162
    v_accvgpr_write_b32 a99, v163
    v_accvgpr_write_b32 a100, v164
    v_accvgpr_write_b32 a101, v165
    v_accvgpr_write_b32 a102, v166
    v_accvgpr_write_b32 a103, v167
    v_accvgpr_write_b32 a104, v168
    v_accvgpr_write_b32 a105, v169
    v_accvgpr_write_b32 a106, v170
    v_accvgpr_write_b32 a107, v171
    v_accvgpr_write_b32 a108, v172
    v_accvgpr_write_b32 a109, v173
    v_accvgpr_write_b32 a110, v174
    v_accvgpr_write_b32 a111, v175
    v_accvgpr_read_b32 v160, a112
    v_accvgpr_read_b32 v161, a113
    v_accvgpr_read_b32 v162, a114
    v_accvgpr_read_b32 v163, a115
    v_accvgpr_read_b32 v164, a116
    v_accvgpr_read_b32 v165, a117
    v_accvgpr_read_b32 v166, a118
    v_accvgpr_read_b32 v167, a119
    v_accvgpr_read_b32 v168, a120
    v_accvgpr_read_b32 v169, a121
    v_accvgpr_read_b32 v170, a122
    v_accvgpr_read_b32 v171, a123
    v_accvgpr_read_b32 v172, a124
    v_accvgpr_read_b32 v173, a125
    v_accvgpr_read_b32 v174, a126
    v_accvgpr_read_b32 v175, a127
    v_mul_f32 v160, v160, v178
    v_mul_f32 v161, v161, v178
    v_mul_f32 v162, v162, v178
    v_mul_f32 v163, v163, v178
    v_mul_f32 v164, v164, v178
    v_mul_f32 v165, v165, v178
    v_mul_f32 v166, v166, v178
    v_mul_f32 v167, v167, v178
    v_mul_f32 v168, v168, v178
    v_mul_f32 v169, v169, v178
    v_mul_f32 v170, v170, v178
    v_mul_f32 v171, v171, v178
    v_mul_f32 v172, v172, v178
    v_mul_f32 v173, v173, v178
    v_mul_f32 v174, v174, v178
    v_mul_f32 v175, v175, v178
    v_accvgpr_write_b32 a112, v160
    v_accvgpr_write_b32 a113, v161
    v_accvgpr_write_b32 a114, v162
    v_accvgpr_write_b32 a115, v163
    v_accvgpr_write_b32 a116, v164
    v_accvgpr_write_b32 a117, v165
    v_accvgpr_write_b32 a118, v166
    v_accvgpr_write_b32 a119, v167
    v_accvgpr_write_b32 a120, v168
    v_accvgpr_write_b32 a121, v169
    v_accvgpr_write_b32 a122, v170
    v_accvgpr_write_b32 a123, v171
    v_accvgpr_write_b32 a124, v172
    v_accvgpr_write_b32 a125, v173
    v_accvgpr_write_b32 a126, v174
    v_accvgpr_write_b32 a127, v175
    v_max3_f32 v176, v144, v145, v146
    v_max3_f32 v176, v176, v147, v148
    v_max3_f32 v176, v176, v149, v150
    v_max3_f32 v176, v176, v151, v152
    v_max3_f32 v176, v176, v153, v154
    v_max3_f32 v176, v176, v155, v156
    v_max3_f32 v176, v176, v157, v158
    v_max_f32 v176, v176, v159
    v_mov_b32 v177, v176
    s_nop 1
    v_permlane32_swap_b32 v176, v177
    v_max3_f32 v176, v176, v177, 0
    v_sub_f32 v144, v144, v176
    v_sub_f32 v145, v145, v176
    v_sub_f32 v146, v146, v176
    v_sub_f32 v147, v147, v176
    v_sub_f32 v148, v148, v176
    v_sub_f32 v149, v149, v176
    v_sub_f32 v150, v150, v176
    v_sub_f32 v151, v151, v176
    v_sub_f32 v152, v152, v176
    v_sub_f32 v153, v153, v176
    v_sub_f32 v154, v154, v176
    v_sub_f32 v155, v155, v176
    v_sub_f32 v156, v156, v176
    v_sub_f32 v157, v157, v176
    v_sub_f32 v158, v158, v176
    v_sub_f32 v159, v159, v176
    v_sub_f32 v251, v251, v176
    v_sub_f32 v178, 0, v176
    v_exp_f32 v178, v178
    s_nop 0
    v_mul_f32 v253, v253, v178
    v_accvgpr_read_b32 v160, a128
    v_accvgpr_read_b32 v161, a129
    v_accvgpr_read_b32 v162, a130
    v_accvgpr_read_b32 v163, a131
    v_accvgpr_read_b32 v164, a132
    v_accvgpr_read_b32 v165, a133
    v_accvgpr_read_b32 v166, a134
    v_accvgpr_read_b32 v167, a135
    v_accvgpr_read_b32 v168, a136
    v_accvgpr_read_b32 v169, a137
    v_accvgpr_read_b32 v170, a138
    v_accvgpr_read_b32 v171, a139
    v_accvgpr_read_b32 v172, a140
    v_accvgpr_read_b32 v173, a141
    v_accvgpr_read_b32 v174, a142
    v_accvgpr_read_b32 v175, a143
    v_mul_f32 v160, v160, v178
    v_mul_f32 v161, v161, v178
    v_mul_f32 v162, v162, v178
    v_mul_f32 v163, v163, v178
    v_mul_f32 v164, v164, v178
    v_mul_f32 v165, v165, v178
    v_mul_f32 v166, v166, v178
    v_mul_f32 v167, v167, v178
    v_mul_f32 v168, v168, v178
    v_mul_f32 v169, v169, v178
    v_mul_f32 v170, v170, v178
    v_mul_f32 v171, v171, v178
    v_mul_f32 v172, v172, v178
    v_mul_f32 v173, v173, v178
    v_mul_f32 v174, v174, v178
    v_mul_f32 v175, v175, v178
    v_accvgpr_write_b32 a128, v160
    v_accvgpr_write_b32 a129, v161
    v_accvgpr_write_b32 a130, v162
    v_accvgpr_write_b32 a131, v163
    v_accvgpr_write_b32 a132, v164
    v_accvgpr_write_b32 a133, v165
    v_accvgpr_write_b32 a134, v166
    v_accvgpr_write_b32 a135, v167
    v_accvgpr_write_b32 a136, v168
    v_accvgpr_write_b32 a137, v169
    v_accvgpr_write_b32 a138, v170
    v_accvgpr_write_b32 a139, v171
    v_accvgpr_write_b32 a140, v172
    v_accvgpr_write_b32 a141, v173
    v_accvgpr_write_b32 a142, v174
    v_accvgpr_write_b32 a143, v175
    v_accvgpr_read_b32 v160, a144
    v_accvgpr_read_b32 v161, a145
    v_accvgpr_read_b32 v162, a146
    v_accvgpr_read_b32 v163, a147
    v_accvgpr_read_b32 v164, a148
    v_accvgpr_read_b32 v165, a149
    v_accvgpr_read_b32 v166, a150
    v_accvgpr_read_b32 v167, a151
    v_accvgpr_read_b32 v168, a152
    v_accvgpr_read_b32 v169, a153
    v_accvgpr_read_b32 v170, a154
    v_accvgpr_read_b32 v171, a155
    v_accvgpr_read_b32 v172, a156
    v_accvgpr_read_b32 v173, a157
    v_accvgpr_read_b32 v174, a158
    v_accvgpr_read_b32 v175, a159
    v_mul_f32 v160, v160, v178
    v_mul_f32 v161, v161, v178
    v_mul_f32 v162, v162, v178
    v_mul_f32 v163, v163, v178
    v_mul_f32 v164, v164, v178
    v_mul_f32 v165, v165, v178
    v_mul_f32 v166, v166, v178
    v_mul_f32 v167, v167, v178
    v_mul_f32 v168, v168, v178
    v_mul_f32 v169, v169, v178
    v_mul_f32 v170, v170, v178
    v_mul_f32 v171, v171, v178
    v_mul_f32 v172, v172, v178
    v_mul_f32 v173, v173, v178
    v_mul_f32 v174, v174, v178
    v_mul_f32 v175, v175, v178
    v_accvgpr_write_b32 a144, v160
    v_accvgpr_write_b32 a145, v161
    v_accvgpr_write_b32 a146, v162
    v_accvgpr_write_b32 a147, v163
    v_accvgpr_write_b32 a148, v164
    v_accvgpr_write_b32 a149, v165
    v_accvgpr_write_b32 a150, v166
    v_accvgpr_write_b32 a151, v167
    v_accvgpr_write_b32 a152, v168
    v_accvgpr_write_b32 a153, v169
    v_accvgpr_write_b32 a154, v170
    v_accvgpr_write_b32 a155, v171
    v_accvgpr_write_b32 a156, v172
    v_accvgpr_write_b32 a157, v173
    v_accvgpr_write_b32 a158, v174
    v_accvgpr_write_b32 a159, v175
    v_accvgpr_read_b32 v160, a160
    v_accvgpr_read_b32 v161, a161
    v_accvgpr_read_b32 v162, a162
    v_accvgpr_read_b32 v163, a163
    v_accvgpr_read_b32 v164, a164
    v_accvgpr_read_b32 v165, a165
    v_accvgpr_read_b32 v166, a166
    v_accvgpr_read_b32 v167, a167
    v_accvgpr_read_b32 v168, a168
    v_accvgpr_read_b32 v169, a169
    v_accvgpr_read_b32 v170, a170
    v_accvgpr_read_b32 v171, a171
    v_accvgpr_read_b32 v172, a172
    v_accvgpr_read_b32 v173, a173
    v_accvgpr_read_b32 v174, a174
    v_accvgpr_read_b32 v175, a175
    v_mul_f32 v160, v160, v178
    v_mul_f32 v161, v161, v178
    v_mul_f32 v162, v162, v178
    v_mul_f32 v163, v163, v178
    v_mul_f32 v164, v164, v178
    v_mul_f32 v165, v165, v178
    v_mul_f32 v166, v166, v178
    v_mul_f32 v167, v167, v178
    v_mul_f32 v168, v168, v178
    v_mul_f32 v169, v169, v178
    v_mul_f32 v170, v170, v178
    v_mul_f32 v171, v171, v178
    v_mul_f32 v172, v172, v178
    v_mul_f32 v173, v173, v178
    v_mul_f32 v174, v174, v178
    v_mul_f32 v175, v175, v178
    v_accvgpr_write_b32 a160, v160
    v_accvgpr_write_b32 a161, v161
    v_accvgpr_write_b32 a162, v162
    v_accvgpr_write_b32 a163, v163
    v_accvgpr_write_b32 a164, v164
    v_accvgpr_write_b32 a165, v165
    v_accvgpr_write_b32 a166, v166
    v_accvgpr_write_b32 a167, v167
    v_accvgpr_write_b32 a168, v168
    v_accvgpr_write_b32 a169, v169
    v_accvgpr_write_b32 a170, v170
    v_accvgpr_write_b32 a171, v171
    v_accvgpr_write_b32 a172, v172
    v_accvgpr_write_b32 a173, v173
    v_accvgpr_write_b32 a174, v174
    v_accvgpr_write_b32 a175, v175
    v_accvgpr_read_b32 v160, a176
    v_accvgpr_read_b32 v161, a177
    v_accvgpr_read_b32 v162, a178
    v_accvgpr_read_b32 v163, a179
    v_accvgpr_read_b32 v164, a180
    v_accvgpr_read_b32 v165, a181
    v_accvgpr_read_b32 v166, a182
    v_accvgpr_read_b32 v167, a183
    v_accvgpr_read_b32 v168, a184
    v_accvgpr_read_b32 v169, a185
    v_accvgpr_read_b32 v170, a186
    v_accvgpr_read_b32 v171, a187
    v_accvgpr_read_b32 v172, a188
    v_accvgpr_read_b32 v173, a189
    v_accvgpr_read_b32 v174, a190
    v_accvgpr_read_b32 v175, a191
    v_mul_f32 v160, v160, v178
    v_mul_f32 v161, v161, v178
    v_mul_f32 v162, v162, v178
    v_mul_f32 v163, v163, v178
    v_mul_f32 v164, v164, v178
    v_mul_f32 v165, v165, v178
    v_mul_f32 v166, v166, v178
    v_mul_f32 v167, v167, v178
    v_mul_f32 v168, v168, v178
    v_mul_f32 v169, v169, v178
    v_mul_f32 v170, v170, v178
    v_mul_f32 v171, v171, v178
    v_mul_f32 v172, v172, v178
    v_mul_f32 v173, v173, v178
    v_mul_f32 v174, v174, v178
    v_mul_f32 v175, v175, v178
    v_accvgpr_write_b32 a176, v160
    v_accvgpr_write_b32 a177, v161
    v_accvgpr_write_b32 a178, v162
    v_accvgpr_write_b32 a179, v163
    v_accvgpr_write_b32 a180, v164
    v_accvgpr_write_b32 a181, v165
    v_accvgpr_write_b32 a182, v166
    v_accvgpr_write_b32 a183, v167
    v_accvgpr_write_b32 a184, v168
    v_accvgpr_write_b32 a185, v169
    v_accvgpr_write_b32 a186, v170
    v_accvgpr_write_b32 a187, v171
    v_accvgpr_write_b32 a188, v172
    v_accvgpr_write_b32 a189, v173
    v_accvgpr_write_b32 a190, v174
    v_accvgpr_write_b32 a191, v175
    v_accvgpr_read_b32 v160, a192
    v_accvgpr_read_b32 v161, a193
    v_accvgpr_read_b32 v162, a194
    v_accvgpr_read_b32 v163, a195
    v_accvgpr_read_b32 v164, a196
    v_accvgpr_read_b32 v165, a197
    v_accvgpr_read_b32 v166, a198
    v_accvgpr_read_b32 v167, a199
    v_accvgpr_read_b32 v168, a200
    v_accvgpr_read_b32 v169, a201
    v_accvgpr_read_b32 v170, a202
    v_accvgpr_read_b32 v171, a203
    v_accvgpr_read_b32 v172, a204
    v_accvgpr_read_b32 v173, a205
    v_accvgpr_read_b32 v174, a206
    v_accvgpr_read_b32 v175, a207
    v_mul_f32 v160, v160, v178
    v_mul_f32 v161, v161, v178
    v_mul_f32 v162, v162, v178
    v_mul_f32 v163, v163, v178
    v_mul_f32 v164, v164, v178
    v_mul_f32 v165, v165, v178
    v_mul_f32 v166, v166, v178
    v_mul_f32 v167, v167, v178
    v_mul_f32 v168, v168, v178
    v_mul_f32 v169, v169, v178
    v_mul_f32 v170, v170, v178
    v_mul_f32 v171, v171, v178
    v_mul_f32 v172, v172, v178
    v_mul_f32 v173, v173, v178
    v_mul_f32 v174, v174, v178
    v_mul_f32 v175, v175, v178
    v_accvgpr_write_b32 a192, v160
    v_accvgpr_write_b32 a193, v161
    v_accvgpr_write_b32 a194, v162
    v_accvgpr_write_b32 a195, v163
    v_accvgpr_write_b32 a196, v164
    v_accvgpr_write_b32 a197, v165
    v_accvgpr_write_b32 a198, v166
    v_accvgpr_write_b32 a199, v167
    v_accvgpr_write_b32 a200, v168
    v_accvgpr_write_b32 a201, v169
    v_accvgpr_write_b32 a202, v170
    v_accvgpr_write_b32 a203, v171
    v_accvgpr_write_b32 a204, v172
    v_accvgpr_write_b32 a205, v173
    v_accvgpr_write_b32 a206, v174
    v_accvgpr_write_b32 a207, v175
    v_accvgpr_read_b32 v160, a208
    v_accvgpr_read_b32 v161, a209
    v_accvgpr_read_b32 v162, a210
    v_accvgpr_read_b32 v163, a211
    v_accvgpr_read_b32 v164, a212
    v_accvgpr_read_b32 v165, a213
    v_accvgpr_read_b32 v166, a214
    v_accvgpr_read_b32 v167, a215
    v_accvgpr_read_b32 v168, a216
    v_accvgpr_read_b32 v169, a217
    v_accvgpr_read_b32 v170, a218
    v_accvgpr_read_b32 v171, a219
    v_accvgpr_read_b32 v172, a220
    v_accvgpr_read_b32 v173, a221
    v_accvgpr_read_b32 v174, a222
    v_accvgpr_read_b32 v175, a223
    v_mul_f32 v160, v160, v178
    v_mul_f32 v161, v161, v178
    v_mul_f32 v162, v162, v178
    v_mul_f32 v163, v163, v178
    v_mul_f32 v164, v164, v178
    v_mul_f32 v165, v165, v178
    v_mul_f32 v166, v166, v178
    v_mul_f32 v167, v167, v178
    v_mul_f32 v168, v168, v178
    v_mul_f32 v169, v169, v178
    v_mul_f32 v170, v170, v178
    v_mul_f32 v171, v171, v178
    v_mul_f32 v172, v172, v178
    v_mul_f32 v173, v173, v178
    v_mul_f32 v174, v174, v178
    v_mul_f32 v175, v175, v178
    v_accvgpr_write_b32 a208, v160
    v_accvgpr_write_b32 a209, v161
    v_accvgpr_write_b32 a210, v162
    v_accvgpr_write_b32 a211, v163
    v_accvgpr_write_b32 a212, v164
    v_accvgpr_write_b32 a213, v165
    v_accvgpr_write_b32 a214, v166
    v_accvgpr_write_b32 a215, v167
    v_accvgpr_write_b32 a216, v168
    v_accvgpr_write_b32 a217, v169
    v_accvgpr_write_b32 a218, v170
    v_accvgpr_write_b32 a219, v171
    v_accvgpr_write_b32 a220, v172
    v_accvgpr_write_b32 a221, v173
    v_accvgpr_write_b32 a222, v174
    v_accvgpr_write_b32 a223, v175
    v_accvgpr_read_b32 v160, a224
    v_accvgpr_read_b32 v161, a225
    v_accvgpr_read_b32 v162, a226
    v_accvgpr_read_b32 v163, a227
    v_accvgpr_read_b32 v164, a228
    v_accvgpr_read_b32 v165, a229
    v_accvgpr_read_b32 v166, a230
    v_accvgpr_read_b32 v167, a231
    v_accvgpr_read_b32 v168, a232
    v_accvgpr_read_b32 v169, a233
    v_accvgpr_read_b32 v170, a234
    v_accvgpr_read_b32 v171, a235
    v_accvgpr_read_b32 v172, a236
    v_accvgpr_read_b32 v173, a237
    v_accvgpr_read_b32 v174, a238
    v_accvgpr_read_b32 v175, a239
    v_mul_f32 v160, v160, v178
    v_mul_f32 v161, v161, v178
    v_mul_f32 v162, v162, v178
    v_mul_f32 v163, v163, v178
    v_mul_f32 v164, v164, v178
    v_mul_f32 v165, v165, v178
    v_mul_f32 v166, v166, v178
    v_mul_f32 v167, v167, v178
    v_mul_f32 v168, v168, v178
    v_mul_f32 v169, v169, v178
    v_mul_f32 v170, v170, v178
    v_mul_f32 v171, v171, v178
    v_mul_f32 v172, v172, v178
    v_mul_f32 v173, v173, v178
    v_mul_f32 v174, v174, v178
    v_mul_f32 v175, v175, v178
    v_accvgpr_write_b32 a224, v160
    v_accvgpr_write_b32 a225, v161
    v_accvgpr_write_b32 a226, v162
    v_accvgpr_write_b32 a227, v163
    v_accvgpr_write_b32 a228, v164
    v_accvgpr_write_b32 a229, v165
    v_accvgpr_write_b32 a230, v166
    v_accvgpr_write_b32 a231, v167
    v_accvgpr_write_b32 a232, v168
    v_accvgpr_write_b32 a233, v169
    v_accvgpr_write_b32 a234, v170
    v_accvgpr_write_b32 a235, v171
    v_accvgpr_write_b32 a236, v172
    v_accvgpr_write_b32 a237, v173
    v_accvgpr_write_b32 a238, v174
    v_accvgpr_write_b32 a239, v175
    v_accvgpr_read_b32 v160, a240
    v_accvgpr_read_b32 v161, a241
    v_accvgpr_read_b32 v162, a242
    v_accvgpr_read_b32 v163, a243
    v_accvgpr_read_b32 v164, a244
    v_accvgpr_read_b32 v165, a245
    v_accvgpr_read_b32 v166, a246
    v_accvgpr_read_b32 v167, a247
    v_accvgpr_read_b32 v168, a248
    v_accvgpr_read_b32 v169, a249
    v_accvgpr_read_b32 v170, a250
    v_accvgpr_read_b32 v171, a251
    v_accvgpr_read_b32 v172, a252
    v_accvgpr_read_b32 v173, a253
    v_accvgpr_read_b32 v174, a254
    v_accvgpr_read_b32 v175, a255
    v_mul_f32 v160, v160, v178
    v_mul_f32 v161, v161, v178
    v_mul_f32 v162, v162, v178
    v_mul_f32 v163, v163, v178
    v_mul_f32 v164, v164, v178
    v_mul_f32 v165, v165, v178
    v_mul_f32 v166, v166, v178
    v_mul_f32 v167, v167, v178
    v_mul_f32 v168, v168, v178
    v_mul_f32 v169, v169, v178
    v_mul_f32 v170, v170, v178
    v_mul_f32 v171, v171, v178
    v_mul_f32 v172, v172, v178
    v_mul_f32 v173, v173, v178
    v_mul_f32 v174, v174, v178
    v_mul_f32 v175, v175, v178
    v_accvgpr_write_b32 a240, v160
    v_accvgpr_write_b32 a241, v161
    v_accvgpr_write_b32 a242, v162
    v_accvgpr_write_b32 a243, v163
    v_accvgpr_write_b32 a244, v164
    v_accvgpr_write_b32 a245, v165
    v_accvgpr_write_b32 a246, v166
    v_accvgpr_write_b32 a247, v167
    v_accvgpr_write_b32 a248, v168
    v_accvgpr_write_b32 a249, v169
    v_accvgpr_write_b32 a250, v170
    v_accvgpr_write_b32 a251, v171
    v_accvgpr_write_b32 a252, v172
    v_accvgpr_write_b32 a253, v173
    v_accvgpr_write_b32 a254, v174
    v_accvgpr_write_b32 a255, v175
    s_nop 3
    s_setpc_b64 s[44:45]

.section .rodata,"a"
.p2align 6
.amdhsa_kernel concat_heads__mha_block_cached__mha_block_cached__near_ridge_kernel
  .amdhsa_next_free_vgpr 512
  .amdhsa_next_free_sgpr 102
  .amdhsa_accum_offset 256
  .amdhsa_group_segment_fixed_size 0
  .amdhsa_kernarg_size 104
  .amdhsa_user_sgpr_count 2
  .amdhsa_user_sgpr_kernarg_segment_ptr 1
  .amdhsa_system_sgpr_workgroup_id_x 1
.end_amdhsa_kernel
```
